```python
import torch

def _softmax(x, axis=-1):
    return torch.softmax(x, dim=axis)

def _gelu(x):
    return torch.nn.functional.gelu(x, approximate='tanh')

def _silu(x):
    return torch.nn.functional.silu(x)

def _sigmoid(x):
    return torch.sigmoid(x)

def _layernorm(x, axis=-1, eps=1e-05):
    m = x.mean(dim=axis, keepdim=True)
    v = x.var(dim=axis, keepdim=True, unbiased=False)
    return (x - m) / torch.sqrt(v + eps)

def _scatter_add(tgt, idx, src, axis=0):
    return tgt.clone().index_add_(axis, idx, src)

def _segment_sum(src, seg, n):
    out = torch.zeros((n,) + src.shape[1:], dtype=src.dtype)
    return out.index_add_(0, seg, src)

def _pad(x, pw):
    flat = tuple((v for pair in reversed(pw) for v in pair))
    return torch.nn.functional.pad(x, flat)
kernel_name = 'interleave_layers__memory_aug_recurrent_mem_tr__swiglu_ffn__prompt'

def setup_inputs():

    _w = lambda a: (lambda t: t.to(torch.bfloat16) if t.is_floating_point() else t)(torch.as_tensor(a))

    def _A_setup():
        B, S, Dm = (1, 2048, 512)
        H, Dh = (32, 128)
        M, seg = (8, 32)
        seg = min(seg, S)
        S = S // seg * seg
        return {'x': _w((lambda *s: torch.randn(*s, dtype=torch.bfloat16) * 0.05)(B, S, Dm)), 'mem0': _w((lambda *s: torch.randn(*s, dtype=torch.bfloat16) * 0.8)(B, M, Dm)), 'Wq': _w((lambda *s: torch.randn(*s, dtype=torch.bfloat16) * 0.8)(Dm, H, Dh) * Dm ** (-0.5)), 'Wk': _w((lambda *s: torch.randn(*s, dtype=torch.bfloat16) * 0.8)(Dm, H, Dh) * Dm ** (-0.5)), 'Wv': _w((lambda *s: torch.randn(*s, dtype=torch.bfloat16) * 0.8)(Dm, H, Dh) * Dm ** (-0.5)), 'Wo': _w((lambda *s: torch.randn(*s, dtype=torch.bfloat16) * 0.8)(H, Dh, Dm) * (H * Dh) ** (-0.5)), 'seg_len': seg}
    _A_in = _A_setup()

    def _B_setup():
        B, S, D, F = (1, 2048, 512, 1376)
        return {'x': _w((lambda *s: torch.randn(*s, dtype=torch.bfloat16) * 0.05)(B, S, D)), 'w_gate': _w((lambda *s: torch.randn(*s, dtype=torch.bfloat16) * 0.05)(D, F)), 'w_up': _w((lambda *s: torch.randn(*s, dtype=torch.bfloat16) * 0.05)(D, F)), 'w_down': _w((lambda *s: torch.randn(*s, dtype=torch.bfloat16) * 0.05)(F, D))}
    _B_in = _B_setup()
    return {'A_x': _A_in['x'], 'A_mem0': _A_in['mem0'], 'A_Wq': _A_in['Wq'], 'A_Wk': _A_in['Wk'], 'A_Wv': _A_in['Wv'], 'A_Wo': _A_in['Wo'], 'A_seg_len': _A_in['seg_len'], 'B_x': _B_in['x'], 'B_w_gate': _B_in['w_gate'], 'B_w_up': _B_in['w_up'], 'B_w_down': _B_in['w_down']}

def reference(A_x, A_mem0, A_Wq, A_Wk, A_Wv, A_Wo, A_seg_len, B_x, B_w_gate, B_w_up, B_w_down):

    def _A_ref(x, mem0, Wq, Wk, Wv, Wo, seg_len):
        B, S, Dm = x.shape
        H, Dh = (Wq.shape[1], Wq.shape[2])
        M = mem0.shape[1]
        scale = Dh ** (-0.5)
        n_seg = S // seg_len
        L = M + seg_len
        idx = torch.arange(L)
        mask = (idx[:, None] < M) | (idx[:, None] >= idx[None, :])
        mem = mem0
        outs = []
        for s in range(n_seg):
            xs = x[:, s * seg_len:(s + 1) * seg_len, :].clone()
            h = torch.concatenate([mem, xs], axis=1)
            q = torch.einsum('btd,dhe->bhte', h, Wq)
            k = torch.einsum('btd,dhe->bhte', h, Wk)
            v = torch.einsum('btd,dhe->bhte', h, Wv)
            scores = torch.einsum('bhqe,bhke->bhqk', q, k) * scale
            scores = torch.where(mask[None, None], scores, -1000000000.0)
            p = _softmax(scores, axis=-1)
            o = torch.einsum('bhqk,bhke->bhqe', p, v)
            o = torch.einsum('bhte,hed->btd', o, Wo)
            mem = o[:, :M, :].clone()
            outs.append(o[:, M:, :])
        return torch.concatenate(outs, axis=1)

    def _B_ref(x, w_gate, w_up, w_down):
        g = _silu(x @ w_gate)
        u = x @ w_up
        return g * u @ w_down
    x = A_x
    x = x + _A_ref(_layernorm(x, axis=-1), A_mem0, A_Wq, A_Wk, A_Wv, A_Wo, A_seg_len)
    x = x + _B_ref(_layernorm(x, axis=-1), B_w_gate, B_w_up, B_w_down)
    x = x + _A_ref(_layernorm(x, axis=-1), A_mem0, A_Wq, A_Wk, A_Wv, A_Wo, A_seg_len)
    x = x + _B_ref(_layernorm(x, axis=-1), B_w_gate, B_w_up, B_w_down)
    return x
```

```asm
; @launch grid=(256,1,1) block=(256,1,1) lds=163840
.amdgcn_target "amdgcn-amd-amdhsa--gfx950"
.text
.p2align 8
.globl interleave_layers__memory_aug_recurrent_mem_tr__swiglu_ffn__prompt_kernel
.type interleave_layers__memory_aug_recurrent_mem_tr__swiglu_ffn__prompt_kernel,@function
interleave_layers__memory_aug_recurrent_mem_tr__swiglu_ffn__prompt_kernel:
 s_cmp_ge_u32 s2, 256
 s_cbranch_scc1 k_exit
 s_load_dwordx16 s[64:79], s[0:1], 0
 s_load_dwordx8 s[80:87], s[0:1], 64
 s_load_dwordx4 s[88:91], s[0:1], 96
 v_and_b32 v1, 63, v0
 v_lshrrev_b32 v5, 6, v0
 v_lshlrev_b32 v2, 4, v1
 v_readfirstlane_b32 s3, v5
 s_waitcnt lgkmcnt(0)
 s_mov_b32 s8, s64
 s_mov_b32 s9, s65
 s_mov_b32 s10, 2097152
 s_mov_b32 s11, 0x00020000
 s_mov_b32 s12, s66
 s_mov_b32 s13, s67
 s_mov_b32 s14, 8192
 s_mov_b32 s15, 0x00020000
 s_mov_b32 s16, s68
 s_mov_b32 s17, s69
 s_mov_b32 s18, 4194304
 s_mov_b32 s19, 0x00020000
 s_mov_b32 s20, s70
 s_mov_b32 s21, s71
 s_mov_b32 s22, 4194304
 s_mov_b32 s23, 0x00020000
 s_mov_b32 s24, s72
 s_mov_b32 s25, s73
 s_mov_b32 s26, 4194304
 s_mov_b32 s27, 0x00020000
 s_mov_b32 s28, s74
 s_mov_b32 s29, s75
 s_mov_b32 s30, 4194304
 s_mov_b32 s31, 0x00020000
 s_mov_b32 s32, s80
 s_mov_b32 s33, s81
 s_mov_b32 s34, 1409024
 s_mov_b32 s35, 0x00020000
 s_mov_b32 s36, s82
 s_mov_b32 s37, s83
 s_mov_b32 s38, 1409024
 s_mov_b32 s39, 0x00020000
 s_mov_b32 s40, s84
 s_mov_b32 s41, s85
 s_mov_b32 s42, 1409024
 s_mov_b32 s43, 0x00020000
 s_mov_b32 s44, s86
 s_mov_b32 s45, s87
 s_mov_b32 s46, 2097152
 s_mov_b32 s47, 0x00020000
 s_mov_b32 s48, s88
 s_mov_b32 s49, s89
 s_mov_b32 s50, 256
 s_mov_b32 s51, 0x00020000
 s_mov_b32 s52, s90
 s_mov_b32 s53, s91
 s_mov_b32 s54, 268435456
 s_mov_b32 s55, 0x00020000
 s_cmp_lg_u32 s3, 0
 s_cbranch_scc1 reg_wait
 s_getreg_b32 s84, hwreg(HW_REG_XCC_ID)
 s_and_b32 s84, s84, 15
 s_and_b32 s71, s84, 7
 s_lshl_b32 s71, s71, 5
 s_lshr_b32 s72, s84, 3
 s_lshl_b32 s72, s72, 2
 s_add_u32 s71, s71, s72
 v_mov_b32 v10, 0
 v_mov_b32 v11, 1
 v_and_b32 v14, 7, v1
 v_lshlrev_b32 v14, 5, v14
 v_bfe_u32 v15, v1, 3, 1
 v_lshl_add_u32 v14, v15, 2, v14
 s_mov_b64 exec, 1
 buffer_atomic_add v11, v10, s[48:51], s71 offen sc0
 s_waitcnt vmcnt(0)
 s_mov_b64 exec, -1
 v_readfirstlane_b32 s85, v11
 s_lshl_b32 s86, s84, 5
 s_add_u32 s86, s86, s85
 s_cmp_ge_u32 s84, 8
 s_cbranch_scc1 reg_over
 s_cmp_lt_u32 s85, 32
 s_cbranch_scc1 reg_pub
reg_over:
 s_mov_b32 s74, 0x400000
reg_poll:
 s_mov_b64 exec, 0xffff
 buffer_load_dword v15, v14, s[48:51], 0 offen sc1
 s_waitcnt vmcnt(0)
 s_mov_b64 exec, -1
 s_mov_b32 s72, 0
 s_mov_b32 s73, 0
 v_readlane_b32 s70, v15, 0
 s_add_u32 s72, s72, s70
 s_max_u32 s70, s70, 32
 s_sub_u32 s70, s70, 32
 s_cmp_gt_u32 s84, 0
 s_cselect_b32 s70, s70, 0
 s_add_u32 s73, s73, s70
 v_readlane_b32 s70, v15, 1
 s_add_u32 s72, s72, s70
 s_max_u32 s70, s70, 32
 s_sub_u32 s70, s70, 32
 s_cmp_gt_u32 s84, 1
 s_cselect_b32 s70, s70, 0
 s_add_u32 s73, s73, s70
 v_readlane_b32 s70, v15, 2
 s_add_u32 s72, s72, s70
 s_max_u32 s70, s70, 32
 s_sub_u32 s70, s70, 32
 s_cmp_gt_u32 s84, 2
 s_cselect_b32 s70, s70, 0
 s_add_u32 s73, s73, s70
 v_readlane_b32 s70, v15, 3
 s_add_u32 s72, s72, s70
 s_max_u32 s70, s70, 32
 s_sub_u32 s70, s70, 32
 s_cmp_gt_u32 s84, 3
 s_cselect_b32 s70, s70, 0
 s_add_u32 s73, s73, s70
 v_readlane_b32 s70, v15, 4
 s_add_u32 s72, s72, s70
 s_max_u32 s70, s70, 32
 s_sub_u32 s70, s70, 32
 s_cmp_gt_u32 s84, 4
 s_cselect_b32 s70, s70, 0
 s_add_u32 s73, s73, s70
 v_readlane_b32 s70, v15, 5
 s_add_u32 s72, s72, s70
 s_max_u32 s70, s70, 32
 s_sub_u32 s70, s70, 32
 s_cmp_gt_u32 s84, 5
 s_cselect_b32 s70, s70, 0
 s_add_u32 s73, s73, s70
 v_readlane_b32 s70, v15, 6
 s_add_u32 s72, s72, s70
 s_max_u32 s70, s70, 32
 s_sub_u32 s70, s70, 32
 s_cmp_gt_u32 s84, 6
 s_cselect_b32 s70, s70, 0
 s_add_u32 s73, s73, s70
 v_readlane_b32 s70, v15, 7
 s_add_u32 s72, s72, s70
 s_max_u32 s70, s70, 32
 s_sub_u32 s70, s70, 32
 s_cmp_gt_u32 s84, 7
 s_cselect_b32 s70, s70, 0
 s_add_u32 s73, s73, s70
 v_readlane_b32 s70, v15, 8
 s_add_u32 s72, s72, s70
 s_max_u32 s70, s70, 0
 s_sub_u32 s70, s70, 0
 s_cmp_gt_u32 s84, 8
 s_cselect_b32 s70, s70, 0
 s_add_u32 s73, s73, s70
 v_readlane_b32 s70, v15, 9
 s_add_u32 s72, s72, s70
 s_max_u32 s70, s70, 0
 s_sub_u32 s70, s70, 0
 s_cmp_gt_u32 s84, 9
 s_cselect_b32 s70, s70, 0
 s_add_u32 s73, s73, s70
 v_readlane_b32 s70, v15, 10
 s_add_u32 s72, s72, s70
 s_max_u32 s70, s70, 0
 s_sub_u32 s70, s70, 0
 s_cmp_gt_u32 s84, 10
 s_cselect_b32 s70, s70, 0
 s_add_u32 s73, s73, s70
 v_readlane_b32 s70, v15, 11
 s_add_u32 s72, s72, s70
 s_max_u32 s70, s70, 0
 s_sub_u32 s70, s70, 0
 s_cmp_gt_u32 s84, 11
 s_cselect_b32 s70, s70, 0
 s_add_u32 s73, s73, s70
 v_readlane_b32 s70, v15, 12
 s_add_u32 s72, s72, s70
 s_max_u32 s70, s70, 0
 s_sub_u32 s70, s70, 0
 s_cmp_gt_u32 s84, 12
 s_cselect_b32 s70, s70, 0
 s_add_u32 s73, s73, s70
 v_readlane_b32 s70, v15, 13
 s_add_u32 s72, s72, s70
 s_max_u32 s70, s70, 0
 s_sub_u32 s70, s70, 0
 s_cmp_gt_u32 s84, 13
 s_cselect_b32 s70, s70, 0
 s_add_u32 s73, s73, s70
 v_readlane_b32 s70, v15, 14
 s_add_u32 s72, s72, s70
 s_max_u32 s70, s70, 0
 s_sub_u32 s70, s70, 0
 s_cmp_gt_u32 s84, 14
 s_cselect_b32 s70, s70, 0
 s_add_u32 s73, s73, s70
 v_readlane_b32 s70, v15, 15
 s_add_u32 s72, s72, s70
 s_max_u32 s70, s70, 0
 s_sub_u32 s70, s70, 0
 s_cmp_gt_u32 s84, 15
 s_cselect_b32 s70, s70, 0
 s_add_u32 s73, s73, s70
 s_cmp_ge_u32 s72, 256
 s_cbranch_scc1 reg_fin
 s_sleep 2
 s_sub_u32 s74, s74, 1
 s_cmp_lg_u32 s74, 0
 s_cbranch_scc1 reg_poll
 s_mov_b32 s86, 0xffff
 s_branch reg_pub
reg_fin:
 s_cmp_lt_u32 s84, 8
 s_cselect_b32 s70, 32, 0
 s_sub_u32 s70, s85, s70
 s_add_u32 s73, s73, s70
 s_mov_b32 s86, 0xffff
 v_readlane_b32 s70, v15, 0
 s_min_u32 s70, s70, 32
 s_sub_u32 s71, 32, s70
 s_add_u32 s70, s70, s73
 s_add_u32 s70, s70, 0
 s_cmp_lt_u32 s73, s71
 s_cselect_b32 s86, s70, s86
 s_sub_u32 s73, s73, s71
 v_readlane_b32 s70, v15, 1
 s_min_u32 s70, s70, 32
 s_sub_u32 s71, 32, s70
 s_add_u32 s70, s70, s73
 s_add_u32 s70, s70, 32
 s_cmp_lt_u32 s73, s71
 s_cselect_b32 s86, s70, s86
 s_sub_u32 s73, s73, s71
 v_readlane_b32 s70, v15, 2
 s_min_u32 s70, s70, 32
 s_sub_u32 s71, 32, s70
 s_add_u32 s70, s70, s73
 s_add_u32 s70, s70, 64
 s_cmp_lt_u32 s73, s71
 s_cselect_b32 s86, s70, s86
 s_sub_u32 s73, s73, s71
 v_readlane_b32 s70, v15, 3
 s_min_u32 s70, s70, 32
 s_sub_u32 s71, 32, s70
 s_add_u32 s70, s70, s73
 s_add_u32 s70, s70, 96
 s_cmp_lt_u32 s73, s71
 s_cselect_b32 s86, s70, s86
 s_sub_u32 s73, s73, s71
 v_readlane_b32 s70, v15, 4
 s_min_u32 s70, s70, 32
 s_sub_u32 s71, 32, s70
 s_add_u32 s70, s70, s73
 s_add_u32 s70, s70, 128
 s_cmp_lt_u32 s73, s71
 s_cselect_b32 s86, s70, s86
 s_sub_u32 s73, s73, s71
 v_readlane_b32 s70, v15, 5
 s_min_u32 s70, s70, 32
 s_sub_u32 s71, 32, s70
 s_add_u32 s70, s70, s73
 s_add_u32 s70, s70, 160
 s_cmp_lt_u32 s73, s71
 s_cselect_b32 s86, s70, s86
 s_sub_u32 s73, s73, s71
 v_readlane_b32 s70, v15, 6
 s_min_u32 s70, s70, 32
 s_sub_u32 s71, 32, s70
 s_add_u32 s70, s70, s73
 s_add_u32 s70, s70, 192
 s_cmp_lt_u32 s73, s71
 s_cselect_b32 s86, s70, s86
 s_sub_u32 s73, s73, s71
 v_readlane_b32 s70, v15, 7
 s_min_u32 s70, s70, 32
 s_sub_u32 s71, 32, s70
 s_add_u32 s70, s70, s73
 s_add_u32 s70, s70, 224
 s_cmp_lt_u32 s73, s71
 s_cselect_b32 s86, s70, s86
 s_sub_u32 s73, s73, s71
reg_pub:
 v_mov_b32 v10, s86
 v_mov_b32 v12, 0
 ds_write_b32 v12, v10
 s_waitcnt lgkmcnt(0)
reg_wait:
 s_barrier
 v_mov_b32 v12, 0
 ds_read_b32 v10, v12
 s_waitcnt lgkmcnt(0)
 v_readfirstlane_b32 s86, v10
 s_barrier
 s_cmp_ge_u32 s86, 256
 s_cbranch_scc1 k_exit
 s_cmp_ge_u32 s86, 64
 s_cbranch_scc1 bulk_roles
 s_lshr_b32 s68, s86, 5
 s_and_b32 s64, s86, 31
 s_cmp_eq_u32 s68, 0
 s_cbranch_scc1 role_rec
 v_mov_b32 v10, 0
 v_lshlrev_b32 v5, 1, v2
 s_mov_b32 s73, 0x200000
wz_1:
 s_mov_b64 exec, 0xff
 buffer_load_dword v6, v5, s[48:51], 0 offen offset:8 sc1
 s_waitcnt vmcnt(0)
 v_cmp_eq_u32 vcc, 16, v6
 s_mov_b64 exec, -1
 s_cmp_eq_u32 vcc_lo, 0xff
 s_cbranch_scc1 wzd_2
 s_sleep 4
 s_sub_u32 s73, s73, 1
 s_cmp_lg_u32 s73, 0
 s_cbranch_scc1 wz_1
 s_endpgm
wzd_2:
 s_mov_b32 s71, 225280
 s_mov_b32 s83, 0x200000
wf_3:
 buffer_load_dword v9, v10, s[52:55], s71 offen sc1
 s_waitcnt vmcnt(0)
 v_readfirstlane_b32 s70, v9
 s_cmp_ge_u32 s70, 1
 s_cbranch_scc1 wfd_4
 s_sleep 1
 s_sub_u32 s83, s83, 1
 s_cmp_lg_u32 s83, 0
 s_cbranch_scc1 wf_3
 s_endpgm
wfd_4:
 s_branch role_rec
bulk_roles:
 s_cmp_lt_u32 s86, 128
 s_cbranch_scc1 bulk_go
 v_mov_b32 v16, 0
 v_mov_b32 v17, 0
 v_mov_b32 v18, 0
 v_mov_b32 v19, 0
 v_lshlrev_b32 v5, 4, v0
 s_sub_u32 s74, s86, 128
 s_add_u32 s70, s74, 0
 s_cmp_ge_u32 s70, 444
 s_cbranch_scc1 zp_5
 s_lshl_b32 s70, s70, 12
 s_add_u32 s70, s70, 0
 buffer_store_dwordx4 v[16:19], v5, s[52:55], s70 offen sc1
zp_5:
 s_add_u32 s70, s74, 128
 s_cmp_ge_u32 s70, 444
 s_cbranch_scc1 zp_6
 s_lshl_b32 s70, s70, 12
 s_add_u32 s70, s70, 0
 buffer_store_dwordx4 v[16:19], v5, s[52:55], s70 offen sc1
zp_6:
 s_add_u32 s70, s74, 256
 s_cmp_ge_u32 s70, 444
 s_cbranch_scc1 zp_7
 s_lshl_b32 s70, s70, 12
 s_add_u32 s70, s70, 0
 buffer_store_dwordx4 v[16:19], v5, s[52:55], s70 offen sc1
zp_7:
 s_add_u32 s70, s74, 384
 s_cmp_ge_u32 s70, 444
 s_cbranch_scc1 zp_8
 s_lshl_b32 s70, s70, 12
 s_add_u32 s70, s70, 0
 buffer_store_dwordx4 v[16:19], v5, s[52:55], s70 offen sc1
zp_8:
 s_waitcnt vmcnt(0)
 s_barrier
 v_mov_b32 v10, 0
 v_mov_b32 v11, 1
 s_cmp_lg_u32 s3, 0
 s_cbranch_scc1 z_sig
 s_and_b32 s70, s74, 7
 s_lshl_b32 s70, s70, 5
 s_mov_b64 exec, 1
 buffer_atomic_add v11, v10, s[48:51], s70 offen offset:8
 s_mov_b64 exec, -1
z_sig:
 s_mov_b32 s88, s86
 v_lshrrev_b32 v5, 3, v1
 v_bfe_u32 v6, v1, 1, 2
 v_and_b32 v7, 1, v1
 v_lshlrev_b32 v7, 4, v7
 v_lshl_add_u32 v8, v5, 5, v7
 v_lshl_add_u32 v3, v6, 10, v8
 v_lshl_add_u32 v8, v6, 5, v7
 v_lshl_add_u32 v4, v5, 10, v8
 v_lshl_add_u32 v9, v5, 11, v8
 s_mov_b32 s86, 0xffff0000
 s_lshl_b32 s87, s74, 2
 s_add_u32 s87, s87, s3
 s_lshl_b32 s70, s87, 12
 s_add_u32 s71, s70, 0
 buffer_load_dwordx4 v[48:51], v3, s[8:11], s71 offen offset:0 sc1
 buffer_load_dwordx4 v[52:55], v3, s[8:11], s71 offen offset:256 sc1
 buffer_load_dwordx4 v[56:59], v3, s[8:11], s71 offen offset:512 sc1
 buffer_load_dwordx4 v[60:63], v3, s[8:11], s71 offen offset:768 sc1
 s_waitcnt vmcnt(0)
 v_lshlrev_b32 v16, 16, v48
 v_and_b32 v17, s86, v48
 v_lshlrev_b32 v18, 16, v49
 v_and_b32 v19, s86, v49
 v_lshlrev_b32 v20, 16, v50
 v_and_b32 v21, s86, v50
 v_lshlrev_b32 v22, 16, v51
 v_and_b32 v23, s86, v51
 v_lshlrev_b32 v24, 16, v52
 v_and_b32 v25, s86, v52
 v_lshlrev_b32 v26, 16, v53
 v_and_b32 v27, s86, v53
 v_lshlrev_b32 v28, 16, v54
 v_and_b32 v29, s86, v54
 v_lshlrev_b32 v30, 16, v55
 v_and_b32 v31, s86, v55
 v_lshlrev_b32 v32, 16, v56
 v_and_b32 v33, s86, v56
 v_lshlrev_b32 v34, 16, v57
 v_and_b32 v35, s86, v57
 v_lshlrev_b32 v36, 16, v58
 v_and_b32 v37, s86, v58
 v_lshlrev_b32 v38, 16, v59
 v_and_b32 v39, s86, v59
 v_lshlrev_b32 v40, 16, v60
 v_and_b32 v41, s86, v60
 v_lshlrev_b32 v42, 16, v61
 v_and_b32 v43, s86, v61
 v_lshlrev_b32 v44, 16, v62
 v_and_b32 v45, s86, v62
 v_lshlrev_b32 v46, 16, v63
 v_and_b32 v47, s86, v63
 v_pk_add_f32 v[160:161], v[16:17], v[32:33]
 v_pk_add_f32 v[162:163], v[18:19], v[34:35]
 v_pk_add_f32 v[164:165], v[20:21], v[36:37]
 v_pk_add_f32 v[166:167], v[22:23], v[38:39]
 v_pk_add_f32 v[168:169], v[24:25], v[40:41]
 v_pk_add_f32 v[170:171], v[26:27], v[42:43]
 v_pk_add_f32 v[172:173], v[28:29], v[44:45]
 v_pk_add_f32 v[174:175], v[30:31], v[46:47]
 v_pk_add_f32 v[160:161], v[160:161], v[168:169]
 v_pk_add_f32 v[162:163], v[162:163], v[170:171]
 v_pk_add_f32 v[164:165], v[164:165], v[172:173]
 v_pk_add_f32 v[166:167], v[166:167], v[174:175]
 v_pk_add_f32 v[160:161], v[160:161], v[164:165]
 v_pk_add_f32 v[162:163], v[162:163], v[166:167]
 v_pk_add_f32 v[160:161], v[160:161], v[162:163]
 v_add_f32 v6, v160, v161
 s_nop 1
 v_add_f32_dpp v6, v6, v6 quad_perm:[1,0,3,2] row_mask:0xf bank_mask:0xf
 s_nop 1
 v_add_f32_dpp v6, v6, v6 row_ror:8 row_mask:0xf bank_mask:0xf
 v_mov_b32 v5, v6
 s_nop 1
 v_permlane16_swap_b32 v6, v5
 s_nop 0
 v_add_f32 v6, v6, v5
 v_mov_b32 v5, v6
 s_nop 1
 v_permlane32_swap_b32 v6, v5
 s_nop 0
 v_add_f32 v6, v6, v5
 v_mul_f32 v6, 0xbb000000, v6
 v_mov_b32 v7, v6
 v_pk_add_f32 v[160:161], v[16:17], v[6:7]
 v_pk_add_f32 v[162:163], v[18:19], v[6:7]
 v_pk_add_f32 v[164:165], v[20:21], v[6:7]
 v_pk_add_f32 v[166:167], v[22:23], v[6:7]
 v_pk_add_f32 v[168:169], v[24:25], v[6:7]
 v_pk_add_f32 v[170:171], v[26:27], v[6:7]
 v_pk_add_f32 v[172:173], v[28:29], v[6:7]
 v_pk_add_f32 v[174:175], v[30:31], v[6:7]
 v_pk_add_f32 v[176:177], v[32:33], v[6:7]
 v_pk_add_f32 v[178:179], v[34:35], v[6:7]
 v_pk_add_f32 v[180:181], v[36:37], v[6:7]
 v_pk_add_f32 v[182:183], v[38:39], v[6:7]
 v_pk_add_f32 v[184:185], v[40:41], v[6:7]
 v_pk_add_f32 v[186:187], v[42:43], v[6:7]
 v_pk_add_f32 v[188:189], v[44:45], v[6:7]
 v_pk_add_f32 v[190:191], v[46:47], v[6:7]
 v_pk_mul_f32 v[64:65], v[160:161], v[160:161]
 v_pk_mul_f32 v[66:67], v[162:163], v[162:163]
 v_pk_fma_f32 v[64:65], v[164:165], v[164:165], v[64:65]
 v_pk_fma_f32 v[66:67], v[166:167], v[166:167], v[66:67]
 v_pk_fma_f32 v[64:65], v[168:169], v[168:169], v[64:65]
 v_pk_fma_f32 v[66:67], v[170:171], v[170:171], v[66:67]
 v_pk_fma_f32 v[64:65], v[172:173], v[172:173], v[64:65]
 v_pk_fma_f32 v[66:67], v[174:175], v[174:175], v[66:67]
 v_pk_fma_f32 v[64:65], v[176:177], v[176:177], v[64:65]
 v_pk_fma_f32 v[66:67], v[178:179], v[178:179], v[66:67]
 v_pk_fma_f32 v[64:65], v[180:181], v[180:181], v[64:65]
 v_pk_fma_f32 v[66:67], v[182:183], v[182:183], v[66:67]
 v_pk_fma_f32 v[64:65], v[184:185], v[184:185], v[64:65]
 v_pk_fma_f32 v[66:67], v[186:187], v[186:187], v[66:67]
 v_pk_fma_f32 v[64:65], v[188:189], v[188:189], v[64:65]
 v_pk_fma_f32 v[66:67], v[190:191], v[190:191], v[66:67]
 v_pk_add_f32 v[64:65], v[64:65], v[66:67]
 v_add_f32 v68, v64, v65
 s_nop 1
 v_add_f32_dpp v68, v68, v68 quad_perm:[1,0,3,2] row_mask:0xf bank_mask:0xf
 s_nop 1
 v_add_f32_dpp v68, v68, v68 row_ror:8 row_mask:0xf bank_mask:0xf
 v_mov_b32 v5, v68
 s_nop 1
 v_permlane16_swap_b32 v68, v5
 s_nop 0
 v_add_f32 v68, v68, v5
 v_mov_b32 v5, v68
 s_nop 1
 v_permlane32_swap_b32 v68, v5
 s_nop 0
 v_add_f32 v68, v68, v5
 v_mul_f32 v68, 0x3b000000, v68
 v_cvt_pk_bf16_f32 v5, v68, v68
 v_lshlrev_b32 v68, 16, v5
 v_add_f32 v68, 0x3727c5ac, v68
 v_cvt_pk_bf16_f32 v5, v68, v68
 v_lshlrev_b32 v68, 16, v5
 v_sqrt_f32 v68, v68
 s_nop 0
 v_cvt_pk_bf16_f32 v5, v68, v68
 v_lshlrev_b32 v68, 16, v5
 v_rcp_f32 v68, v68
 v_cvt_pk_bf16_f32 v5, v6, v6
 v_lshlrev_b32 v6, 16, v5
 v_mov_b32 v7, v6
 v_mov_b32 v69, v68
 v_pk_add_f32 v[16:17], v[16:17], v[6:7]
 v_pk_add_f32 v[18:19], v[18:19], v[6:7]
 v_pk_add_f32 v[20:21], v[20:21], v[6:7]
 v_pk_add_f32 v[22:23], v[22:23], v[6:7]
 v_pk_add_f32 v[24:25], v[24:25], v[6:7]
 v_pk_add_f32 v[26:27], v[26:27], v[6:7]
 v_pk_add_f32 v[28:29], v[28:29], v[6:7]
 v_pk_add_f32 v[30:31], v[30:31], v[6:7]
 v_pk_add_f32 v[32:33], v[32:33], v[6:7]
 v_pk_add_f32 v[34:35], v[34:35], v[6:7]
 v_pk_add_f32 v[36:37], v[36:37], v[6:7]
 v_pk_add_f32 v[38:39], v[38:39], v[6:7]
 v_pk_add_f32 v[40:41], v[40:41], v[6:7]
 v_pk_add_f32 v[42:43], v[42:43], v[6:7]
 v_pk_add_f32 v[44:45], v[44:45], v[6:7]
 v_pk_add_f32 v[46:47], v[46:47], v[6:7]
 v_cvt_pk_bf16_f32 v144, v16, v17
 v_cvt_pk_bf16_f32 v145, v18, v19
 v_cvt_pk_bf16_f32 v146, v20, v21
 v_cvt_pk_bf16_f32 v147, v22, v23
 v_cvt_pk_bf16_f32 v148, v24, v25
 v_cvt_pk_bf16_f32 v149, v26, v27
 v_cvt_pk_bf16_f32 v150, v28, v29
 v_cvt_pk_bf16_f32 v151, v30, v31
 v_cvt_pk_bf16_f32 v152, v32, v33
 v_cvt_pk_bf16_f32 v153, v34, v35
 v_cvt_pk_bf16_f32 v154, v36, v37
 v_cvt_pk_bf16_f32 v155, v38, v39
 v_cvt_pk_bf16_f32 v156, v40, v41
 v_cvt_pk_bf16_f32 v157, v42, v43
 v_cvt_pk_bf16_f32 v158, v44, v45
 v_cvt_pk_bf16_f32 v159, v46, v47
 v_lshlrev_b32 v16, 16, v144
 v_and_b32 v17, s86, v144
 v_lshlrev_b32 v18, 16, v145
 v_and_b32 v19, s86, v145
 v_lshlrev_b32 v20, 16, v146
 v_and_b32 v21, s86, v146
 v_lshlrev_b32 v22, 16, v147
 v_and_b32 v23, s86, v147
 v_lshlrev_b32 v24, 16, v148
 v_and_b32 v25, s86, v148
 v_lshlrev_b32 v26, 16, v149
 v_and_b32 v27, s86, v149
 v_lshlrev_b32 v28, 16, v150
 v_and_b32 v29, s86, v150
 v_lshlrev_b32 v30, 16, v151
 v_and_b32 v31, s86, v151
 v_lshlrev_b32 v32, 16, v152
 v_and_b32 v33, s86, v152
 v_lshlrev_b32 v34, 16, v153
 v_and_b32 v35, s86, v153
 v_lshlrev_b32 v36, 16, v154
 v_and_b32 v37, s86, v154
 v_lshlrev_b32 v38, 16, v155
 v_and_b32 v39, s86, v155
 v_lshlrev_b32 v40, 16, v156
 v_and_b32 v41, s86, v156
 v_lshlrev_b32 v42, 16, v157
 v_and_b32 v43, s86, v157
 v_lshlrev_b32 v44, 16, v158
 v_and_b32 v45, s86, v158
 v_lshlrev_b32 v46, 16, v159
 v_and_b32 v47, s86, v159
 v_pk_mul_f32 v[16:17], v[16:17], v[68:69]
 v_pk_mul_f32 v[18:19], v[18:19], v[68:69]
 v_pk_mul_f32 v[20:21], v[20:21], v[68:69]
 v_pk_mul_f32 v[22:23], v[22:23], v[68:69]
 v_pk_mul_f32 v[24:25], v[24:25], v[68:69]
 v_pk_mul_f32 v[26:27], v[26:27], v[68:69]
 v_pk_mul_f32 v[28:29], v[28:29], v[68:69]
 v_pk_mul_f32 v[30:31], v[30:31], v[68:69]
 v_pk_mul_f32 v[32:33], v[32:33], v[68:69]
 v_pk_mul_f32 v[34:35], v[34:35], v[68:69]
 v_pk_mul_f32 v[36:37], v[36:37], v[68:69]
 v_pk_mul_f32 v[38:39], v[38:39], v[68:69]
 v_pk_mul_f32 v[40:41], v[40:41], v[68:69]
 v_pk_mul_f32 v[42:43], v[42:43], v[68:69]
 v_pk_mul_f32 v[44:45], v[44:45], v[68:69]
 v_pk_mul_f32 v[46:47], v[46:47], v[68:69]
 v_cvt_pk_bf16_f32 v144, v16, v17
 v_cvt_pk_bf16_f32 v145, v18, v19
 v_cvt_pk_bf16_f32 v146, v20, v21
 v_cvt_pk_bf16_f32 v147, v22, v23
 v_cvt_pk_bf16_f32 v148, v24, v25
 v_cvt_pk_bf16_f32 v149, v26, v27
 v_cvt_pk_bf16_f32 v150, v28, v29
 v_cvt_pk_bf16_f32 v151, v30, v31
 v_cvt_pk_bf16_f32 v152, v32, v33
 v_cvt_pk_bf16_f32 v153, v34, v35
 v_cvt_pk_bf16_f32 v154, v36, v37
 v_cvt_pk_bf16_f32 v155, v38, v39
 v_cvt_pk_bf16_f32 v156, v40, v41
 v_cvt_pk_bf16_f32 v157, v42, v43
 v_cvt_pk_bf16_f32 v158, v44, v45
 v_cvt_pk_bf16_f32 v159, v46, v47
 s_add_u32 s71, s70, 1818624
 buffer_store_dwordx4 v[144:147], v3, s[52:55], s71 offen offset:0 sc1
 buffer_store_dwordx4 v[148:151], v3, s[52:55], s71 offen offset:256 sc1
 buffer_store_dwordx4 v[152:155], v3, s[52:55], s71 offen offset:512 sc1
 buffer_store_dwordx4 v[156:159], v3, s[52:55], s71 offen offset:768 sc1
 s_mov_b32 s86, s88
 v_lshlrev_b32 v5, 1, v2
 s_mov_b32 s73, 0x200000
wz_9:
 s_mov_b64 exec, 0xff
 buffer_load_dword v6, v5, s[48:51], 0 offen offset:8 sc1
 s_waitcnt vmcnt(0)
 v_cmp_eq_u32 vcc, 16, v6
 s_mov_b64 exec, -1
 s_cmp_eq_u32 vcc_lo, 0xff
 s_cbranch_scc1 wzd_10
 s_sleep 4
 s_sub_u32 s73, s73, 1
 s_cmp_lg_u32 s73, 0
 s_cbranch_scc1 wz_9
 s_endpgm
wzd_10:
 s_lshr_b32 s71, s87, 3
 s_lshl_b32 s71, s71, 8
 s_and_b32 s70, s87, 7
 s_lshl_b32 s70, s70, 2
 s_add_u32 s71, s71, s70
 s_add_u32 s71, s71, 0
 s_mov_b64 exec, 1
 buffer_store_dword v11, v10, s[52:55], s71 offen sc1
 s_mov_b64 exec, -1
 s_mov_b32 s71, 204800
 s_cmp_ge_u32 s86, 160
 s_cselect_b32 s71, 212992, s71
 s_cmp_ge_u32 s86, 208
 s_cselect_b32 s71, 221184, s71
 s_mov_b32 s83, 0x200000
wf_11:
 buffer_load_dword v9, v10, s[52:55], s71 offen sc1
 s_waitcnt vmcnt(0)
 v_readfirstlane_b32 s70, v9
 s_cmp_ge_u32 s70, 1
 s_cbranch_scc1 wfd_12
 s_sleep 1
 s_sub_u32 s83, s83, 1
 s_cmp_lg_u32 s83, 0
 s_cbranch_scc1 wf_11
 s_endpgm
wfd_12:
bulk_go:
 s_cmp_ge_u32 s86, 96
 s_cbranch_scc1 tb_13
 s_sub_u32 s64, s86, 64
 s_mov_b32 s6, 0
 s_mov_b32 s65, 64
 s_mov_b32 s7, 0
 s_mov_b32 s66, 0
 s_branch role_kv
tb_13:
 s_cmp_ge_u32 s86, 128
 s_cbranch_scc1 tb_14
 s_sub_u32 s64, s86, 96
 s_mov_b32 s6, 1
 s_mov_b32 s65, 56
 s_mov_b32 s7, 64
 s_mov_b32 s66, 64
 s_branch role_kv
tb_14:
 s_cmp_ge_u32 s86, 144
 s_cbranch_scc1 tb_15
 s_sub_u32 s64, s86, 128
 s_mov_b32 s6, 0
 s_mov_b32 s65, 0
 s_mov_b32 s7, 34
 s_mov_b32 s66, 34
 s_branch role_qa
tb_15:
 s_cmp_ge_u32 s86, 160
 s_cbranch_scc1 tb_16
 s_sub_u32 s64, s86, 144
 s_mov_b32 s6, 1
 s_mov_b32 s65, 1
 s_mov_b32 s7, 35
 s_mov_b32 s66, 35
 s_branch role_qa
tb_16:
 s_cmp_ge_u32 s86, 176
 s_cbranch_scc1 tb_17
 s_sub_u32 s64, s86, 160
 s_mov_b32 s6, 64
 s_mov_b32 s65, 64
 s_mov_b32 s7, 0
 s_mov_b32 s66, 33
 s_branch role_qa
tb_17:
 s_cmp_ge_u32 s86, 192
 s_cbranch_scc1 tb_18
 s_sub_u32 s64, s86, 176
 s_mov_b32 s6, 0
 s_mov_b32 s65, 0
 s_mov_b32 s7, 40
 s_mov_b32 s66, 40
 s_branch role_wo
tb_18:
 s_cmp_ge_u32 s86, 208
 s_cbranch_scc1 tb_19
 s_sub_u32 s64, s86, 192
 s_mov_b32 s6, 1
 s_mov_b32 s65, 1
 s_mov_b32 s7, 41
 s_mov_b32 s66, 41
 s_branch role_wo
tb_19:
 s_cmp_ge_u32 s86, 219
 s_cbranch_scc1 tb_20
 s_sub_u32 s64, s86, 208
 s_mov_b32 s6, 0
 s_mov_b32 s65, 0
 s_mov_b32 s7, 37
 s_mov_b32 s66, 37
 s_branch role_up
tb_20:
 s_cmp_ge_u32 s86, 224
 s_cbranch_scc1 tb_21
 s_sub_u32 s64, s86, 219
 s_branch role_rln
tb_21:
 s_cmp_ge_u32 s86, 235
 s_cbranch_scc1 tb_22
 s_sub_u32 s64, s86, 224
 s_mov_b32 s6, 1
 s_mov_b32 s65, 1
 s_mov_b32 s7, 38
 s_mov_b32 s66, 38
 s_branch role_up
tb_22:
 s_cmp_ge_u32 s86, 239
 s_cbranch_scc1 tb_23
 s_sub_u32 s64, s86, 235
 s_mov_b32 s6, 0
 s_mov_b32 s65, 0
 s_mov_b32 s7, 31
 s_mov_b32 s66, 31
 s_branch role_down
tb_23:
 s_cmp_ge_u32 s86, 243
 s_cbranch_scc1 tb_24
 s_sub_u32 s64, s86, 239
 s_mov_b32 s6, 1
 s_mov_b32 s65, 1
 s_mov_b32 s7, 32
 s_mov_b32 s66, 32
 s_branch role_down
tb_24:
 s_cmp_ge_u32 s86, 247
 s_cbranch_scc1 tb_25
 s_sub_u32 s64, s86, 243
 s_mov_b32 s6, 64
 s_mov_b32 s65, 64
 s_mov_b32 s7, 0
 s_mov_b32 s66, 30
 s_branch role_down
tb_25:
 s_cmp_ge_u32 s86, 256
 s_cbranch_scc1 tb_26
 s_sub_u32 s64, s86, 242
 s_branch role_rln
tb_26:
k_exit:
 s_endpgm
role_kv:
 s_cmp_lt_u32 s3, 2
 s_cselect_b32 s56, s20, s24
 s_cselect_b32 s57, s21, s25
 s_mov_b32 s58, 4194304
 s_mov_b32 s59, 0x00020000
 s_mov_b32 s60, s56
 s_mov_b32 s61, s57
 s_mov_b32 s62, 4194304
 s_mov_b32 s63, 0x00020000
 s_and_b32 s70, s3, 1
 s_lshl_b32 s70, s70, 7
 s_lshl_b32 s76, s64, 8
 s_add_u32 s76, s76, s70
 s_add_u32 s77, s76, 64
 v_lshrrev_b32 v5, 2, v1
 s_mov_b32 s70, 8192
 v_mul_lo_u32 v5, v5, s70
 v_and_b32 v6, 3, v1
 v_lshl_add_u32 v10, v6, 4, v5
 v_lshrrev_b32 v5, 5, v1
 v_lshlrev_b32 v5, 9, v5
 v_bfe_u32 v7, v1, 2, 2
 v_lshl_add_u32 v5, v7, 6, v5
 v_bfe_u32 v7, v1, 4, 1
 v_lshl_add_u32 v5, v7, 5, v5
 v_lshl_add_u32 v5, v6, 3, v5
 s_lshl_b32 s71, s3, 15
 v_add_u32 v9, s71, v5
 s_add_u32 m0, s71, 0
 s_nop 0
 buffer_load_dwordx4 v10, s[56:59], s76 offen lds
 s_add_u32 s76, s76, 131072
 s_add_u32 m0, s71, 8192
 s_nop 0
 buffer_load_dwordx4 v10, s[60:63], s77 offen lds
 s_add_u32 s77, s77, 131072
 s_add_u32 m0, s71, 1024
 s_nop 0
 buffer_load_dwordx4 v10, s[56:59], s76 offen lds
 s_add_u32 s76, s76, 131072
 s_add_u32 m0, s71, 9216
 s_nop 0
 buffer_load_dwordx4 v10, s[60:63], s77 offen lds
 s_add_u32 s77, s77, 131072
 s_add_u32 m0, s71, 2048
 s_nop 0
 buffer_load_dwordx4 v10, s[56:59], s76 offen lds
 s_add_u32 s76, s76, 131072
 s_add_u32 m0, s71, 10240
 s_nop 0
 buffer_load_dwordx4 v10, s[60:63], s77 offen lds
 s_add_u32 s77, s77, 131072
 s_add_u32 m0, s71, 3072
 s_nop 0
 buffer_load_dwordx4 v10, s[56:59], s76 offen lds
 s_add_u32 s76, s76, 131072
 s_add_u32 m0, s71, 11264
 s_nop 0
 buffer_load_dwordx4 v10, s[60:63], s77 offen lds
 s_add_u32 s77, s77, 131072
 s_add_u32 m0, s71, 4096
 s_nop 0
 buffer_load_dwordx4 v10, s[56:59], s76 offen lds
 s_add_u32 s76, s76, 131072
 s_add_u32 m0, s71, 12288
 s_nop 0
 buffer_load_dwordx4 v10, s[60:63], s77 offen lds
 s_add_u32 s77, s77, 131072
 s_add_u32 m0, s71, 5120
 s_nop 0
 buffer_load_dwordx4 v10, s[56:59], s76 offen lds
 s_add_u32 s76, s76, 131072
 s_add_u32 m0, s71, 13312
 s_nop 0
 buffer_load_dwordx4 v10, s[60:63], s77 offen lds
 s_add_u32 s77, s77, 131072
 s_add_u32 m0, s71, 6144
 s_nop 0
 buffer_load_dwordx4 v10, s[56:59], s76 offen lds
 s_add_u32 s76, s76, 131072
 s_add_u32 m0, s71, 14336
 s_nop 0
 buffer_load_dwordx4 v10, s[60:63], s77 offen lds
 s_add_u32 s77, s77, 131072
 s_add_u32 m0, s71, 7168
 s_nop 0
 buffer_load_dwordx4 v10, s[56:59], s76 offen lds
 s_add_u32 s76, s76, 131072
 s_add_u32 m0, s71, 15360
 s_nop 0
 buffer_load_dwordx4 v10, s[60:63], s77 offen lds
 s_add_u32 s77, s77, 131072
 s_add_u32 m0, s71, 16384
 s_nop 0
 buffer_load_dwordx4 v10, s[56:59], s76 offen lds
 s_add_u32 s76, s76, 131072
 s_add_u32 m0, s71, 24576
 s_nop 0
 buffer_load_dwordx4 v10, s[60:63], s77 offen lds
 s_add_u32 s77, s77, 131072
 s_add_u32 m0, s71, 17408
 s_nop 0
 buffer_load_dwordx4 v10, s[56:59], s76 offen lds
 s_add_u32 s76, s76, 131072
 s_add_u32 m0, s71, 25600
 s_nop 0
 buffer_load_dwordx4 v10, s[60:63], s77 offen lds
 s_add_u32 s77, s77, 131072
 s_add_u32 m0, s71, 18432
 s_nop 0
 buffer_load_dwordx4 v10, s[56:59], s76 offen lds
 s_add_u32 s76, s76, 131072
 s_add_u32 m0, s71, 26624
 s_nop 0
 buffer_load_dwordx4 v10, s[60:63], s77 offen lds
 s_add_u32 s77, s77, 131072
 s_add_u32 m0, s71, 19456
 s_nop 0
 buffer_load_dwordx4 v10, s[56:59], s76 offen lds
 s_add_u32 s76, s76, 131072
 s_add_u32 m0, s71, 27648
 s_nop 0
 buffer_load_dwordx4 v10, s[60:63], s77 offen lds
 s_add_u32 s77, s77, 131072
 s_add_u32 m0, s71, 20480
 s_nop 0
 buffer_load_dwordx4 v10, s[56:59], s76 offen lds
 s_add_u32 s76, s76, 131072
 s_add_u32 m0, s71, 28672
 s_nop 0
 buffer_load_dwordx4 v10, s[60:63], s77 offen lds
 s_add_u32 s77, s77, 131072
 s_add_u32 m0, s71, 21504
 s_nop 0
 buffer_load_dwordx4 v10, s[56:59], s76 offen lds
 s_add_u32 s76, s76, 131072
 s_add_u32 m0, s71, 29696
 s_nop 0
 buffer_load_dwordx4 v10, s[60:63], s77 offen lds
 s_add_u32 s77, s77, 131072
 s_add_u32 m0, s71, 22528
 s_nop 0
 buffer_load_dwordx4 v10, s[56:59], s76 offen lds
 s_add_u32 s76, s76, 131072
 s_add_u32 m0, s71, 30720
 s_nop 0
 buffer_load_dwordx4 v10, s[60:63], s77 offen lds
 s_add_u32 s77, s77, 131072
 s_add_u32 m0, s71, 23552
 s_nop 0
 buffer_load_dwordx4 v10, s[56:59], s76 offen lds
 s_add_u32 s76, s76, 131072
 s_add_u32 m0, s71, 31744
 s_nop 0
 buffer_load_dwordx4 v10, s[60:63], s77 offen lds
 s_add_u32 s77, s77, 131072
 s_waitcnt vmcnt(16)
 ds_read_b64_tr_b16 a[0:1], v9 offset:0
 ds_read_b64_tr_b16 a[2:3], v9 offset:256
 ds_read_b64_tr_b16 a[4:5], v9 offset:8192
 ds_read_b64_tr_b16 a[6:7], v9 offset:8448
 ds_read_b64_tr_b16 a[8:9], v9 offset:1024
 ds_read_b64_tr_b16 a[10:11], v9 offset:1280
 ds_read_b64_tr_b16 a[12:13], v9 offset:9216
 ds_read_b64_tr_b16 a[14:15], v9 offset:9472
 ds_read_b64_tr_b16 a[16:17], v9 offset:2048
 ds_read_b64_tr_b16 a[18:19], v9 offset:2304
 ds_read_b64_tr_b16 a[20:21], v9 offset:10240
 ds_read_b64_tr_b16 a[22:23], v9 offset:10496
 ds_read_b64_tr_b16 a[24:25], v9 offset:3072
 ds_read_b64_tr_b16 a[26:27], v9 offset:3328
 ds_read_b64_tr_b16 a[28:29], v9 offset:11264
 ds_read_b64_tr_b16 a[30:31], v9 offset:11520
 ds_read_b64_tr_b16 a[32:33], v9 offset:4096
 ds_read_b64_tr_b16 a[34:35], v9 offset:4352
 ds_read_b64_tr_b16 a[36:37], v9 offset:12288
 ds_read_b64_tr_b16 a[38:39], v9 offset:12544
 ds_read_b64_tr_b16 a[40:41], v9 offset:5120
 ds_read_b64_tr_b16 a[42:43], v9 offset:5376
 ds_read_b64_tr_b16 a[44:45], v9 offset:13312
 ds_read_b64_tr_b16 a[46:47], v9 offset:13568
 ds_read_b64_tr_b16 a[48:49], v9 offset:6144
 ds_read_b64_tr_b16 a[50:51], v9 offset:6400
 ds_read_b64_tr_b16 a[52:53], v9 offset:14336
 ds_read_b64_tr_b16 a[54:55], v9 offset:14592
 ds_read_b64_tr_b16 a[56:57], v9 offset:7168
 ds_read_b64_tr_b16 a[58:59], v9 offset:7424
 ds_read_b64_tr_b16 a[60:61], v9 offset:15360
 ds_read_b64_tr_b16 a[62:63], v9 offset:15616
 s_waitcnt lgkmcnt(0)
 s_add_u32 m0, s71, 0
 s_nop 0
 buffer_load_dwordx4 v10, s[56:59], s76 offen lds
 s_add_u32 s76, s76, 131072
 s_add_u32 m0, s71, 8192
 s_nop 0
 buffer_load_dwordx4 v10, s[60:63], s77 offen lds
 s_add_u32 s77, s77, 131072
 s_add_u32 m0, s71, 1024
 s_nop 0
 buffer_load_dwordx4 v10, s[56:59], s76 offen lds
 s_add_u32 s76, s76, 131072
 s_add_u32 m0, s71, 9216
 s_nop 0
 buffer_load_dwordx4 v10, s[60:63], s77 offen lds
 s_add_u32 s77, s77, 131072
 s_add_u32 m0, s71, 2048
 s_nop 0
 buffer_load_dwordx4 v10, s[56:59], s76 offen lds
 s_add_u32 s76, s76, 131072
 s_add_u32 m0, s71, 10240
 s_nop 0
 buffer_load_dwordx4 v10, s[60:63], s77 offen lds
 s_add_u32 s77, s77, 131072
 s_add_u32 m0, s71, 3072
 s_nop 0
 buffer_load_dwordx4 v10, s[56:59], s76 offen lds
 s_add_u32 s76, s76, 131072
 s_add_u32 m0, s71, 11264
 s_nop 0
 buffer_load_dwordx4 v10, s[60:63], s77 offen lds
 s_add_u32 s77, s77, 131072
 s_add_u32 m0, s71, 4096
 s_nop 0
 buffer_load_dwordx4 v10, s[56:59], s76 offen lds
 s_add_u32 s76, s76, 131072
 s_add_u32 m0, s71, 12288
 s_nop 0
 buffer_load_dwordx4 v10, s[60:63], s77 offen lds
 s_add_u32 s77, s77, 131072
 s_add_u32 m0, s71, 5120
 s_nop 0
 buffer_load_dwordx4 v10, s[56:59], s76 offen lds
 s_add_u32 s76, s76, 131072
 s_add_u32 m0, s71, 13312
 s_nop 0
 buffer_load_dwordx4 v10, s[60:63], s77 offen lds
 s_add_u32 s77, s77, 131072
 s_add_u32 m0, s71, 6144
 s_nop 0
 buffer_load_dwordx4 v10, s[56:59], s76 offen lds
 s_add_u32 s76, s76, 131072
 s_add_u32 m0, s71, 14336
 s_nop 0
 buffer_load_dwordx4 v10, s[60:63], s77 offen lds
 s_add_u32 s77, s77, 131072
 s_add_u32 m0, s71, 7168
 s_nop 0
 buffer_load_dwordx4 v10, s[56:59], s76 offen lds
 s_add_u32 s76, s76, 131072
 s_add_u32 m0, s71, 15360
 s_nop 0
 buffer_load_dwordx4 v10, s[60:63], s77 offen lds
 s_add_u32 s77, s77, 131072
 s_waitcnt vmcnt(16)
 ds_read_b64_tr_b16 a[64:65], v9 offset:16384
 ds_read_b64_tr_b16 a[66:67], v9 offset:16640
 ds_read_b64_tr_b16 a[68:69], v9 offset:24576
 ds_read_b64_tr_b16 a[70:71], v9 offset:24832
 ds_read_b64_tr_b16 a[72:73], v9 offset:17408
 ds_read_b64_tr_b16 a[74:75], v9 offset:17664
 ds_read_b64_tr_b16 a[76:77], v9 offset:25600
 ds_read_b64_tr_b16 a[78:79], v9 offset:25856
 ds_read_b64_tr_b16 a[80:81], v9 offset:18432
 ds_read_b64_tr_b16 a[82:83], v9 offset:18688
 ds_read_b64_tr_b16 a[84:85], v9 offset:26624
 ds_read_b64_tr_b16 a[86:87], v9 offset:26880
 ds_read_b64_tr_b16 a[88:89], v9 offset:19456
 ds_read_b64_tr_b16 a[90:91], v9 offset:19712
 ds_read_b64_tr_b16 a[92:93], v9 offset:27648
 ds_read_b64_tr_b16 a[94:95], v9 offset:27904
 ds_read_b64_tr_b16 a[96:97], v9 offset:20480
 ds_read_b64_tr_b16 a[98:99], v9 offset:20736
 ds_read_b64_tr_b16 a[100:101], v9 offset:28672
 ds_read_b64_tr_b16 a[102:103], v9 offset:28928
 ds_read_b64_tr_b16 a[104:105], v9 offset:21504
 ds_read_b64_tr_b16 a[106:107], v9 offset:21760
 ds_read_b64_tr_b16 a[108:109], v9 offset:29696
 ds_read_b64_tr_b16 a[110:111], v9 offset:29952
 ds_read_b64_tr_b16 a[112:113], v9 offset:22528
 ds_read_b64_tr_b16 a[114:115], v9 offset:22784
 ds_read_b64_tr_b16 a[116:117], v9 offset:30720
 ds_read_b64_tr_b16 a[118:119], v9 offset:30976
 ds_read_b64_tr_b16 a[120:121], v9 offset:23552
 ds_read_b64_tr_b16 a[122:123], v9 offset:23808
 ds_read_b64_tr_b16 a[124:125], v9 offset:31744
 ds_read_b64_tr_b16 a[126:127], v9 offset:32000
 s_waitcnt lgkmcnt(0)
 s_add_u32 m0, s71, 16384
 s_nop 0
 buffer_load_dwordx4 v10, s[56:59], s76 offen lds
 s_add_u32 s76, s76, 131072
 s_add_u32 m0, s71, 24576
 s_nop 0
 buffer_load_dwordx4 v10, s[60:63], s77 offen lds
 s_add_u32 s77, s77, 131072
 s_add_u32 m0, s71, 17408
 s_nop 0
 buffer_load_dwordx4 v10, s[56:59], s76 offen lds
 s_add_u32 s76, s76, 131072
 s_add_u32 m0, s71, 25600
 s_nop 0
 buffer_load_dwordx4 v10, s[60:63], s77 offen lds
 s_add_u32 s77, s77, 131072
 s_add_u32 m0, s71, 18432
 s_nop 0
 buffer_load_dwordx4 v10, s[56:59], s76 offen lds
 s_add_u32 s76, s76, 131072
 s_add_u32 m0, s71, 26624
 s_nop 0
 buffer_load_dwordx4 v10, s[60:63], s77 offen lds
 s_add_u32 s77, s77, 131072
 s_add_u32 m0, s71, 19456
 s_nop 0
 buffer_load_dwordx4 v10, s[56:59], s76 offen lds
 s_add_u32 s76, s76, 131072
 s_add_u32 m0, s71, 27648
 s_nop 0
 buffer_load_dwordx4 v10, s[60:63], s77 offen lds
 s_add_u32 s77, s77, 131072
 s_add_u32 m0, s71, 20480
 s_nop 0
 buffer_load_dwordx4 v10, s[56:59], s76 offen lds
 s_add_u32 s76, s76, 131072
 s_add_u32 m0, s71, 28672
 s_nop 0
 buffer_load_dwordx4 v10, s[60:63], s77 offen lds
 s_add_u32 s77, s77, 131072
 s_add_u32 m0, s71, 21504
 s_nop 0
 buffer_load_dwordx4 v10, s[56:59], s76 offen lds
 s_add_u32 s76, s76, 131072
 s_add_u32 m0, s71, 29696
 s_nop 0
 buffer_load_dwordx4 v10, s[60:63], s77 offen lds
 s_add_u32 s77, s77, 131072
 s_add_u32 m0, s71, 22528
 s_nop 0
 buffer_load_dwordx4 v10, s[56:59], s76 offen lds
 s_add_u32 s76, s76, 131072
 s_add_u32 m0, s71, 30720
 s_nop 0
 buffer_load_dwordx4 v10, s[60:63], s77 offen lds
 s_add_u32 s77, s77, 131072
 s_add_u32 m0, s71, 23552
 s_nop 0
 buffer_load_dwordx4 v10, s[56:59], s76 offen lds
 s_add_u32 s76, s76, 131072
 s_add_u32 m0, s71, 31744
 s_nop 0
 buffer_load_dwordx4 v10, s[60:63], s77 offen lds
 s_add_u32 s77, s77, 131072
 s_waitcnt vmcnt(16)
 ds_read_b64_tr_b16 a[128:129], v9 offset:0
 ds_read_b64_tr_b16 a[130:131], v9 offset:256
 ds_read_b64_tr_b16 a[132:133], v9 offset:8192
 ds_read_b64_tr_b16 a[134:135], v9 offset:8448
 ds_read_b64_tr_b16 a[136:137], v9 offset:1024
 ds_read_b64_tr_b16 a[138:139], v9 offset:1280
 ds_read_b64_tr_b16 a[140:141], v9 offset:9216
 ds_read_b64_tr_b16 a[142:143], v9 offset:9472
 ds_read_b64_tr_b16 a[144:145], v9 offset:2048
 ds_read_b64_tr_b16 a[146:147], v9 offset:2304
 ds_read_b64_tr_b16 a[148:149], v9 offset:10240
 ds_read_b64_tr_b16 a[150:151], v9 offset:10496
 ds_read_b64_tr_b16 a[152:153], v9 offset:3072
 ds_read_b64_tr_b16 a[154:155], v9 offset:3328
 ds_read_b64_tr_b16 a[156:157], v9 offset:11264
 ds_read_b64_tr_b16 a[158:159], v9 offset:11520
 ds_read_b64_tr_b16 a[160:161], v9 offset:4096
 ds_read_b64_tr_b16 a[162:163], v9 offset:4352
 ds_read_b64_tr_b16 a[164:165], v9 offset:12288
 ds_read_b64_tr_b16 a[166:167], v9 offset:12544
 ds_read_b64_tr_b16 a[168:169], v9 offset:5120
 ds_read_b64_tr_b16 a[170:171], v9 offset:5376
 ds_read_b64_tr_b16 a[172:173], v9 offset:13312
 ds_read_b64_tr_b16 a[174:175], v9 offset:13568
 ds_read_b64_tr_b16 a[176:177], v9 offset:6144
 ds_read_b64_tr_b16 a[178:179], v9 offset:6400
 ds_read_b64_tr_b16 a[180:181], v9 offset:14336
 ds_read_b64_tr_b16 a[182:183], v9 offset:14592
 ds_read_b64_tr_b16 a[184:185], v9 offset:7168
 ds_read_b64_tr_b16 a[186:187], v9 offset:7424
 ds_read_b64_tr_b16 a[188:189], v9 offset:15360
 ds_read_b64_tr_b16 a[190:191], v9 offset:15616
 s_waitcnt lgkmcnt(0)
 s_waitcnt vmcnt(0)
 ds_read_b64_tr_b16 a[192:193], v9 offset:16384
 ds_read_b64_tr_b16 a[194:195], v9 offset:16640
 ds_read_b64_tr_b16 a[196:197], v9 offset:24576
 ds_read_b64_tr_b16 a[198:199], v9 offset:24832
 ds_read_b64_tr_b16 a[200:201], v9 offset:17408
 ds_read_b64_tr_b16 a[202:203], v9 offset:17664
 ds_read_b64_tr_b16 a[204:205], v9 offset:25600
 ds_read_b64_tr_b16 a[206:207], v9 offset:25856
 ds_read_b64_tr_b16 a[208:209], v9 offset:18432
 ds_read_b64_tr_b16 a[210:211], v9 offset:18688
 ds_read_b64_tr_b16 a[212:213], v9 offset:26624
 ds_read_b64_tr_b16 a[214:215], v9 offset:26880
 ds_read_b64_tr_b16 a[216:217], v9 offset:19456
 ds_read_b64_tr_b16 a[218:219], v9 offset:19712
 ds_read_b64_tr_b16 a[220:221], v9 offset:27648
 ds_read_b64_tr_b16 a[222:223], v9 offset:27904
 ds_read_b64_tr_b16 a[224:225], v9 offset:20480
 ds_read_b64_tr_b16 a[226:227], v9 offset:20736
 ds_read_b64_tr_b16 a[228:229], v9 offset:28672
 ds_read_b64_tr_b16 a[230:231], v9 offset:28928
 ds_read_b64_tr_b16 a[232:233], v9 offset:21504
 ds_read_b64_tr_b16 a[234:235], v9 offset:21760
 ds_read_b64_tr_b16 a[236:237], v9 offset:29696
 ds_read_b64_tr_b16 a[238:239], v9 offset:29952
 ds_read_b64_tr_b16 a[240:241], v9 offset:22528
 ds_read_b64_tr_b16 a[242:243], v9 offset:22784
 ds_read_b64_tr_b16 a[244:245], v9 offset:30720
 ds_read_b64_tr_b16 a[246:247], v9 offset:30976
 ds_read_b64_tr_b16 a[248:249], v9 offset:23552
 ds_read_b64_tr_b16 a[250:251], v9 offset:23808
 ds_read_b64_tr_b16 a[252:253], v9 offset:31744
 ds_read_b64_tr_b16 a[254:255], v9 offset:32000
 s_waitcnt lgkmcnt(0)
 s_barrier
 v_lshlrev_b32 v5, 1, v2
 s_mov_b32 s73, 0x200000
wz_27:
 s_mov_b64 exec, 0xff
 buffer_load_dword v6, v5, s[48:51], 0 offen offset:8 sc1
 s_waitcnt vmcnt(0)
 v_cmp_eq_u32 vcc, 16, v6
 s_mov_b64 exec, -1
 s_cmp_eq_u32 vcc_lo, 0xff
 s_cbranch_scc1 wzd_28
 s_sleep 4
 s_sub_u32 s73, s73, 1
 s_cmp_lg_u32 s73, 0
 s_cbranch_scc1 wz_27
 s_endpgm
wzd_28:
 v_and_b32 v5, 31, v1
 s_movk_i32 s70, 1040
 v_mul_lo_u32 v5, v5, s70
 v_lshrrev_b32 v6, 5, v1
 v_lshl_add_u32 v3, v6, 4, v5
 s_cmp_lt_u32 s3, 2
 s_cselect_b32 s82, 0, 33554432
 s_lshl_b32 s70, s64, 13
 s_add_u32 s82, s82, s70
 s_and_b32 s70, s3, 1
 s_lshl_b32 s70, s70, 12
 s_add_u32 s82, s82, s70
 s_lshr_b32 s85, s3, 1
 v_and_b32 v5, 31, v1
 v_lshrrev_b32 v6, 5, v1
 v_lshlrev_b32 v7, 1, v5
 v_cmp_gt_u32 vcc, 8, v7
 v_add_u32 v8, 1, v7
 s_mov_b32 s70, 16640
 v_cndmask_b32 v57, 0, 1, vcc
 v_cndmask_b32 v5, 0, v5, vcc
 v_cmp_gt_u32 vcc, 8, v8
 v_mul_lo_u32 v6, v6, s70
 v_lshl_add_u32 v6, v5, 3, v6
 v_cndmask_b32 v58, 0, 1, vcc
 v_add_u32 v56, 0, v6
 s_mov_b32 s87, 0xf
 v_mov_b32 v62, 0
 v_mov_b32 v63, 0
 s_lshl_b32 s98, s64, 2
 s_add_u32 s98, s98, s3
 s_lshl_b32 s98, s98, 2
 s_lshl_b32 s98, s98, 2
 v_mov_b32 v10, 0
 v_mov_b32 v0, 1
 v_add_u32 v12, 65536, v3
 s_mov_b32 s95, 163824
 s_cmp_eq_u32 s85, 0
 s_cbranch_scc0 kvb_sched0
 s_branch kva_sched0
kva_pro0:
 s_mov_b32 s90, 0
 ds_read_b128 v[16:19], v3 offset:0
 ds_read_b128 v[20:23], v3 offset:32
 ds_read_b128 v[24:27], v3 offset:64
 ds_read_b128 v[28:31], v3 offset:96
 ds_read_b128 v[32:35], v3 offset:128
 ds_read_b128 v[36:39], v3 offset:160
 s_cmp_ge_u32 s94, 2
 s_cbranch_scc1 kva_plain0
kva_run0:
 s_cmp_lt_u32 s94, 2
 s_cselect_b64 vcc, -1, 0
 ds_read_b128 v[40:43], v3 offset:192
 s_waitcnt lgkmcnt(6)
 v_mfma_f32_32x32x16_bf16 v[64:79], a[0:3], v[16:19], 0
 s_mov_b32 s68, s4
 s_mov_b32 s67, s5
 s_mov_b32 s88, s6
 s_mov_b32 s89, s7
 v_mfma_f32_32x32x16_bf16 v[80:95], a[4:7], v[16:19], 0
 s_add_u32 s70, s88, 2
 s_cmp_lt_u32 s70, 56
 s_cselect_b32 s70, s70, s65
 s_add_u32 s71, s88, 1
 ds_read_b128 v[44:47], v3 offset:224
 s_waitcnt lgkmcnt(6)
 v_mfma_f32_32x32x16_bf16 v[64:79], a[8:11], v[20:23], v[64:79]
 s_cmp_lt_u32 s88, 56
 s_cselect_b32 s88, s70, s71
 s_add_u32 s89, s89, 1
 s_and_b32 s4, s94, 1
 s_barrier
 v_mfma_f32_32x32x16_bf16 v[80:95], a[12:15], v[20:23], v[80:95]
 s_cmp_eq_u32 s94, 0
 s_cselect_b32 s5, s6, s7
 s_cselect_b32 s6, s88, s6
 s_cmp_eq_u32 s94, 1
 s_cselect_b32 s7, s89, s7
 ds_read_b128 v[16:19], v3 offset:256
 s_waitcnt lgkmcnt(6)
 v_mfma_f32_32x32x16_bf16 v[64:79], a[16:19], v[24:27], v[64:79]
 s_mov_b32 s78, 65536
 s_mul_i32 s81, s4, 2097152
 s_add_u32 s81, s81, 1818624
 s_lshl_b32 s70, s5, 15
 s_bitcmp1_b32 s90, 0
 s_cbranch_scc0 g_29
 v_cvt_pk_bf16_f32 v128, v96, v97
 v_cvt_pk_bf16_f32 v129, v98, v99
 v_cvt_pk_bf16_f32 v130, v100, v101
 v_cvt_pk_bf16_f32 v131, v102, v103
 buffer_store_dwordx4 v[128:131], v2, s[52:55], s91 offen offset:0 sc1
g_29:
 v_mfma_f32_32x32x16_bf16 v[80:95], a[20:23], v[24:27], v[80:95]
 s_add_u32 s81, s81, s70
 s_mul_i32 s96, s3, 8320
 s_add_u32 s96, s96, s78
 s_lshl_b32 s97, s3, 13
 ds_read_b128 v[20:23], v3 offset:288
 s_waitcnt lgkmcnt(6)
 v_mfma_f32_32x32x16_bf16 v[64:79], a[24:27], v[28:31], v[64:79]
 s_add_u32 s97, s97, s81
 s_sub_u32 s97, s97, 1024
 s_bitcmp1_b32 s90, 0
 s_cbranch_scc0 g_30
 v_cvt_pk_bf16_f32 v132, v104, v105
 v_cvt_pk_bf16_f32 v133, v106, v107
 v_cvt_pk_bf16_f32 v134, v108, v109
 v_cvt_pk_bf16_f32 v135, v110, v111
 buffer_store_dwordx4 v[132:135], v2, s[52:55], s91 offen offset:1024 sc1
g_30:
 v_mfma_f32_32x32x16_bf16 v[80:95], a[28:31], v[28:31], v[80:95]
 s_cbranch_vccz g_31
 s_add_u32 m0, s96, 0
 s_add_u32 s97, s97, 1024
 buffer_load_dwordx4 v2, s[52:55], s97 offen sc1 lds
g_31:
 ds_read_b128 v[24:27], v3 offset:320
 s_waitcnt lgkmcnt(6)
 v_mfma_f32_32x32x16_bf16 v[64:79], a[32:35], v[32:35], v[64:79]
 s_bitcmp1_b32 s90, 0
 s_cbranch_scc0 g_32
 v_cvt_pk_bf16_f32 v136, v112, v113
 v_cvt_pk_bf16_f32 v137, v114, v115
 v_cvt_pk_bf16_f32 v138, v116, v117
 v_cvt_pk_bf16_f32 v139, v118, v119
 buffer_store_dwordx4 v[136:139], v2, s[52:55], s91 offen offset:2048 sc1
g_32:
 v_mfma_f32_32x32x16_bf16 v[80:95], a[36:39], v[32:35], v[80:95]
 s_cbranch_vccz g_33
 s_add_u32 m0, s96, 1040
 s_add_u32 s97, s97, 1024
 buffer_load_dwordx4 v2, s[52:55], s97 offen sc1 lds
g_33:
 ds_read_b128 v[28:31], v3 offset:352
 s_waitcnt lgkmcnt(6)
 v_mfma_f32_32x32x16_bf16 v[64:79], a[40:43], v[36:39], v[64:79]
 s_bitcmp1_b32 s90, 0
 s_cbranch_scc0 g_34
 v_cvt_pk_bf16_f32 v140, v120, v121
 v_cvt_pk_bf16_f32 v141, v122, v123
 v_cvt_pk_bf16_f32 v142, v124, v125
 v_cvt_pk_bf16_f32 v143, v126, v127
 buffer_store_dwordx4 v[140:143], v2, s[52:55], s91 offen offset:3072 sc1
g_34:
 v_mfma_f32_32x32x16_bf16 v[80:95], a[44:47], v[36:39], v[80:95]
 s_cbranch_vccz g_35
 s_add_u32 m0, s96, 2080
 s_add_u32 s97, s97, 1024
 buffer_load_dwordx4 v2, s[52:55], s97 offen sc1 lds
g_35:
 ds_read_b128 v[32:35], v3 offset:384
 s_waitcnt lgkmcnt(6)
 v_mfma_f32_32x32x16_bf16 v[64:79], a[48:51], v[40:43], v[64:79]
 s_cbranch_vccz g_36
 s_add_u32 m0, s96, 3120
 s_add_u32 s97, s97, 1024
 buffer_load_dwordx4 v2, s[52:55], s97 offen sc1 lds
g_36:
 v_mfma_f32_32x32x16_bf16 v[80:95], a[52:55], v[40:43], v[80:95]
 s_cbranch_vccz g_37
 s_add_u32 m0, s96, 4160
 s_add_u32 s97, s97, 1024
 buffer_load_dwordx4 v2, s[52:55], s97 offen sc1 lds
g_37:
 ds_read_b128 v[36:39], v3 offset:416
 s_waitcnt lgkmcnt(6)
 v_mfma_f32_32x32x16_bf16 v[64:79], a[56:59], v[44:47], v[64:79]
 s_cbranch_vccz g_38
 s_add_u32 m0, s96, 5200
 s_add_u32 s97, s97, 1024
 buffer_load_dwordx4 v2, s[52:55], s97 offen sc1 lds
g_38:
 v_mfma_f32_32x32x16_bf16 v[80:95], a[60:63], v[44:47], v[80:95]
 s_cbranch_vccz g_39
 s_add_u32 m0, s96, 6240
 s_add_u32 s97, s97, 1024
 buffer_load_dwordx4 v2, s[52:55], s97 offen sc1 lds
g_39:
 ds_read_b128 v[40:43], v3 offset:448
 s_waitcnt lgkmcnt(6)
 v_mfma_f32_32x32x16_bf16 v[64:79], a[64:67], v[16:19], v[64:79]
 s_cbranch_vccz g_40
 s_add_u32 m0, s96, 7280
 s_add_u32 s97, s97, 1024
 buffer_load_dwordx4 v2, s[52:55], s97 offen sc1 lds
g_40:
 v_mfma_f32_32x32x16_bf16 v[80:95], a[68:71], v[16:19], v[80:95]
 s_mul_i32 s80, s68, 16777216
 s_add_u32 s80, s80, 6012928
 s_lshl_b32 s70, s67, 18
 s_add_u32 s80, s80, s70
 ds_read_b128 v[44:47], v3 offset:480
 s_waitcnt lgkmcnt(6)
 v_mfma_f32_32x32x16_bf16 v[64:79], a[72:75], v[20:23], v[64:79]
 s_bitcmp1_b32 s90, 1
 s_cbranch_scc0 es_41
 s_cbranch_vccz es_42
 s_waitcnt vmcnt(8)
 s_branch es_43
es_42:
 s_waitcnt vmcnt(0)
es_43:
 s_mov_b64 exec, 1
 buffer_store_dword v0, v10, s[52:55], s69 offen sc1
 s_mov_b64 exec, -1
es_41:
 s_add_u32 s80, s80, s82
 s_mul_i32 s101, s68, 65
 s_add_u32 s101, s101, s67
 s_lshl_b32 s101, s101, 11
 v_mfma_f32_32x32x16_bf16 v[80:95], a[76:79], v[20:23], v[80:95]
 s_add_u32 s101, s101, 204800
 s_add_u32 s101, s101, s98
 ds_read_b128 v[16:19], v3 offset:512
 s_waitcnt lgkmcnt(6)
 v_mfma_f32_32x32x16_bf16 v[64:79], a[80:83], v[24:27], v[64:79]
 s_cmp_lg_u32 s3, 0
 s_cbranch_scc1 w0_44
 s_min_u32 s70, s6, 63
 s_min_u32 s71, s7, 63
 s_lshl_b32 s70, s70, 8
 s_lshl_b32 s71, s71, 8
 v_add_u32 v15, s70, v56
 s_mov_b32 exec_lo, 0
 v_add_u32 v15, s71, v56
 s_mov_b32 exec_lo, s87
 s_mov_b32 exec_hi, s87
 buffer_load_dwordx2 v[62:63], v15, s[52:55], 0 offen sc1
 s_mov_b64 exec, -1
w0_44:
 v_mfma_f32_32x32x16_bf16 v[80:95], a[84:87], v[24:27], v[80:95]
 ds_read_b128 v[20:23], v3 offset:544
 s_waitcnt lgkmcnt(6)
 v_mfma_f32_32x32x16_bf16 v[64:79], a[88:91], v[28:31], v[64:79]
 v_mfma_f32_32x32x16_bf16 v[80:95], a[92:95], v[28:31], v[80:95]
 ds_read_b128 v[24:27], v3 offset:576
 s_waitcnt lgkmcnt(6)
 v_mfma_f32_32x32x16_bf16 v[64:79], a[96:99], v[32:35], v[64:79]
 v_mfma_f32_32x32x16_bf16 v[80:95], a[100:103], v[32:35], v[80:95]
 ds_read_b128 v[28:31], v3 offset:608
 s_waitcnt lgkmcnt(6)
 v_mfma_f32_32x32x16_bf16 v[64:79], a[104:107], v[36:39], v[64:79]
 v_mfma_f32_32x32x16_bf16 v[80:95], a[108:111], v[36:39], v[80:95]
 ds_read_b128 v[32:35], v3 offset:640
 s_waitcnt lgkmcnt(6)
 v_mfma_f32_32x32x16_bf16 v[64:79], a[112:115], v[40:43], v[64:79]
 v_mfma_f32_32x32x16_bf16 v[80:95], a[116:119], v[40:43], v[80:95]
 ds_read_b128 v[36:39], v3 offset:672
 s_waitcnt lgkmcnt(6)
 v_mfma_f32_32x32x16_bf16 v[64:79], a[120:123], v[44:47], v[64:79]
 v_mfma_f32_32x32x16_bf16 v[80:95], a[124:127], v[44:47], v[80:95]
 ds_read_b128 v[40:43], v3 offset:704
 s_waitcnt lgkmcnt(6)
 v_mfma_f32_32x32x16_bf16 v[64:79], a[128:131], v[16:19], v[64:79]
 v_mfma_f32_32x32x16_bf16 v[80:95], a[132:135], v[16:19], v[80:95]
 ds_read_b128 v[44:47], v3 offset:736
 s_waitcnt lgkmcnt(6)
 v_mfma_f32_32x32x16_bf16 v[64:79], a[136:139], v[20:23], v[64:79]
 v_mfma_f32_32x32x16_bf16 v[80:95], a[140:143], v[20:23], v[80:95]
 ds_read_b128 v[16:19], v3 offset:768
 s_waitcnt lgkmcnt(6)
 v_mfma_f32_32x32x16_bf16 v[64:79], a[144:147], v[24:27], v[64:79]
 v_mfma_f32_32x32x16_bf16 v[80:95], a[148:151], v[24:27], v[80:95]
 ds_read_b128 v[20:23], v3 offset:800
 s_waitcnt lgkmcnt(6)
 v_mfma_f32_32x32x16_bf16 v[64:79], a[152:155], v[28:31], v[64:79]
 v_mfma_f32_32x32x16_bf16 v[80:95], a[156:159], v[28:31], v[80:95]
 ds_read_b128 v[24:27], v3 offset:832
 s_waitcnt lgkmcnt(6)
 v_mfma_f32_32x32x16_bf16 v[64:79], a[160:163], v[32:35], v[64:79]
 v_mfma_f32_32x32x16_bf16 v[80:95], a[164:167], v[32:35], v[80:95]
 ds_read_b128 v[28:31], v3 offset:864
 s_waitcnt lgkmcnt(6)
 v_mfma_f32_32x32x16_bf16 v[64:79], a[168:171], v[36:39], v[64:79]
 v_mfma_f32_32x32x16_bf16 v[80:95], a[172:175], v[36:39], v[80:95]
 ds_read_b128 v[32:35], v3 offset:896
 s_waitcnt lgkmcnt(6)
 v_mfma_f32_32x32x16_bf16 v[64:79], a[176:179], v[40:43], v[64:79]
 s_waitcnt vmcnt(0)
 s_bitcmp1_b32 s90, 0
 s_cbranch_scc0 sg_45
 s_mov_b64 exec, 1
 buffer_store_dword v0, v10, s[52:55], s69 offen sc1
 s_mov_b64 exec, -1
sg_45:
 s_cmp_lg_u32 s3, 0
 s_cbranch_scc1 w0_46
 v_cmp_ge_u32 s[72:73], v62, v57
 v_cmp_ge_u32 s[74:75], v63, v58
 s_and_b64 s[72:73], s[72:73], s[74:75]
 s_mov_b32 s70, 2
 s_cmp_lt_u32 s6, 64
 s_cselect_b32 s71, s72, 0
 s_cmp_eq_u32 s71, -1
 s_cselect_b32 s70, 0, s70
 s_cmp_lt_u32 s7, 64
 s_cselect_b32 s71, s73, 0
 s_cmp_eq_u32 s71, -1
 s_cselect_b32 s70, 1, s70
 v_mov_b32 v5, s70
 v_mov_b32 v6, s95
 ds_write_b32 v6, v5
w0_46:
 v_mfma_f32_32x32x16_bf16 v[80:95], a[180:183], v[40:43], v[80:95]
 ds_read_b128 v[36:39], v3 offset:928
 s_waitcnt lgkmcnt(6)
 v_mfma_f32_32x32x16_bf16 v[64:79], a[184:187], v[44:47], v[64:79]
 v_mfma_f32_32x32x16_bf16 v[80:95], a[188:191], v[44:47], v[80:95]
 ds_read_b128 v[40:43], v3 offset:960
 s_waitcnt lgkmcnt(6)
 v_mfma_f32_32x32x16_bf16 v[64:79], a[192:195], v[16:19], v[64:79]
 v_mov_b32 v6, s95
 s_waitcnt lgkmcnt(2)
 s_barrier
 ds_read_b32 v61, v6
 s_xor_b32 s95, s95, 4
 v_mfma_f32_32x32x16_bf16 v[80:95], a[196:199], v[16:19], v[80:95]
 ds_read_b128 v[44:47], v3 offset:992
 s_waitcnt lgkmcnt(6)
 v_mfma_f32_32x32x16_bf16 v[64:79], a[200:203], v[20:23], v[64:79]
 v_mfma_f32_32x32x16_bf16 v[80:95], a[204:207], v[20:23], v[80:95]
 s_cbranch_vccz kva_tail0
 ds_read_b128 v[16:19], v12 offset:0
 s_waitcnt lgkmcnt(6)
 v_mfma_f32_32x32x16_bf16 v[64:79], a[208:211], v[24:27], v[64:79]
 v_mfma_f32_32x32x16_bf16 v[80:95], a[212:215], v[24:27], v[80:95]
 ds_read_b128 v[20:23], v12 offset:32
 s_waitcnt lgkmcnt(6)
 v_mfma_f32_32x32x16_bf16 v[64:79], a[216:219], v[28:31], v[64:79]
 v_mfma_f32_32x32x16_bf16 v[80:95], a[220:223], v[28:31], v[80:95]
 ds_read_b128 v[24:27], v12 offset:64
 s_waitcnt lgkmcnt(6)
 v_mfma_f32_32x32x16_bf16 v[64:79], a[224:227], v[32:35], v[64:79]
 v_mfma_f32_32x32x16_bf16 v[80:95], a[228:231], v[32:35], v[80:95]
 ds_read_b128 v[28:31], v12 offset:96
 s_waitcnt lgkmcnt(6)
 v_mfma_f32_32x32x16_bf16 v[64:79], a[232:235], v[36:39], v[64:79]
 v_mfma_f32_32x32x16_bf16 v[80:95], a[236:239], v[36:39], v[80:95]
 ds_read_b128 v[32:35], v12 offset:128
 s_waitcnt lgkmcnt(6)
 v_mfma_f32_32x32x16_bf16 v[64:79], a[240:243], v[40:43], v[64:79]
 v_mfma_f32_32x32x16_bf16 v[80:95], a[244:247], v[40:43], v[80:95]
 s_mov_b32 s90, 1
 s_mov_b32 s91, s80
 s_mov_b32 s69, s101
 ds_read_b128 v[36:39], v12 offset:160
 s_waitcnt lgkmcnt(6)
 v_mfma_f32_32x32x16_bf16 v[64:79], a[248:251], v[44:47], v[64:79]
 v_mfma_f32_32x32x16_bf16 v[80:95], a[252:255], v[44:47], v[80:95]
 v_readfirstlane_b32 s94, v61
 s_cmp_eq_u32 s68, 0
 s_cbranch_scc1 kva_run1
 s_mov_b32 s90, 2
 s_nop 7
 v_cvt_pk_bf16_f32 v128, v64, v65
 v_cvt_pk_bf16_f32 v129, v66, v67
 v_cvt_pk_bf16_f32 v130, v68, v69
 v_cvt_pk_bf16_f32 v131, v70, v71
 buffer_store_dwordx4 v[128:131], v2, s[52:55], s80 offen offset:0 sc1
 v_cvt_pk_bf16_f32 v132, v72, v73
 v_cvt_pk_bf16_f32 v133, v74, v75
 v_cvt_pk_bf16_f32 v134, v76, v77
 v_cvt_pk_bf16_f32 v135, v78, v79
 buffer_store_dwordx4 v[132:135], v2, s[52:55], s80 offen offset:1024 sc1
 v_cvt_pk_bf16_f32 v136, v80, v81
 v_cvt_pk_bf16_f32 v137, v82, v83
 v_cvt_pk_bf16_f32 v138, v84, v85
 v_cvt_pk_bf16_f32 v139, v86, v87
 buffer_store_dwordx4 v[136:139], v2, s[52:55], s80 offen offset:2048 sc1
 v_cvt_pk_bf16_f32 v140, v88, v89
 v_cvt_pk_bf16_f32 v141, v90, v91
 v_cvt_pk_bf16_f32 v142, v92, v93
 v_cvt_pk_bf16_f32 v143, v94, v95
 buffer_store_dwordx4 v[140:143], v2, s[52:55], s80 offen offset:3072 sc1
 s_branch kva_run1
kva_plain0:
 ds_read_b128 v[40:43], v3 offset:192
 s_waitcnt lgkmcnt(6)
 v_mfma_f32_32x32x16_bf16 v[64:79], a[0:3], v[16:19], 0
 s_mov_b32 s68, s4
 s_mov_b32 s67, s5
 s_mul_i32 s80, s68, 16777216
 s_add_u32 s80, s80, 6012928
 v_mfma_f32_32x32x16_bf16 v[80:95], a[4:7], v[16:19], 0
 s_lshl_b32 s70, s67, 18
 s_add_u32 s80, s80, s70
 s_add_u32 s80, s80, s82
 s_mul_i32 s101, s68, 65
 ds_read_b128 v[44:47], v3 offset:224
 s_waitcnt lgkmcnt(6)
 v_mfma_f32_32x32x16_bf16 v[64:79], a[8:11], v[20:23], v[64:79]
 s_add_u32 s101, s101, s67
 s_lshl_b32 s101, s101, 11
 s_add_u32 s101, s101, 204800
 s_add_u32 s101, s101, s98
 s_barrier
 v_mfma_f32_32x32x16_bf16 v[80:95], a[12:15], v[20:23], v[80:95]
 ds_read_b128 v[16:19], v3 offset:256
 s_waitcnt lgkmcnt(6)
 v_mfma_f32_32x32x16_bf16 v[64:79], a[16:19], v[24:27], v[64:79]
 v_mfma_f32_32x32x16_bf16 v[80:95], a[20:23], v[24:27], v[80:95]
 ds_read_b128 v[20:23], v3 offset:288
 s_waitcnt lgkmcnt(6)
 v_mfma_f32_32x32x16_bf16 v[64:79], a[24:27], v[28:31], v[64:79]
 v_mfma_f32_32x32x16_bf16 v[80:95], a[28:31], v[28:31], v[80:95]
 ds_read_b128 v[24:27], v3 offset:320
 s_waitcnt lgkmcnt(6)
 v_mfma_f32_32x32x16_bf16 v[64:79], a[32:35], v[32:35], v[64:79]
 v_mfma_f32_32x32x16_bf16 v[80:95], a[36:39], v[32:35], v[80:95]
 ds_read_b128 v[28:31], v3 offset:352
 s_waitcnt lgkmcnt(6)
 v_mfma_f32_32x32x16_bf16 v[64:79], a[40:43], v[36:39], v[64:79]
 v_mfma_f32_32x32x16_bf16 v[80:95], a[44:47], v[36:39], v[80:95]
 ds_read_b128 v[32:35], v3 offset:384
 s_waitcnt lgkmcnt(6)
 v_mfma_f32_32x32x16_bf16 v[64:79], a[48:51], v[40:43], v[64:79]
 v_mfma_f32_32x32x16_bf16 v[80:95], a[52:55], v[40:43], v[80:95]
 ds_read_b128 v[36:39], v3 offset:416
 s_waitcnt lgkmcnt(6)
 v_mfma_f32_32x32x16_bf16 v[64:79], a[56:59], v[44:47], v[64:79]
 v_mfma_f32_32x32x16_bf16 v[80:95], a[60:63], v[44:47], v[80:95]
 ds_read_b128 v[40:43], v3 offset:448
 s_waitcnt lgkmcnt(6)
 v_mfma_f32_32x32x16_bf16 v[64:79], a[64:67], v[16:19], v[64:79]
 v_mfma_f32_32x32x16_bf16 v[80:95], a[68:71], v[16:19], v[80:95]
 ds_read_b128 v[44:47], v3 offset:480
 s_waitcnt lgkmcnt(6)
 v_mfma_f32_32x32x16_bf16 v[64:79], a[72:75], v[20:23], v[64:79]
 v_mfma_f32_32x32x16_bf16 v[80:95], a[76:79], v[20:23], v[80:95]
 ds_read_b128 v[16:19], v3 offset:512
 s_waitcnt lgkmcnt(6)
 v_mfma_f32_32x32x16_bf16 v[64:79], a[80:83], v[24:27], v[64:79]
 v_mfma_f32_32x32x16_bf16 v[80:95], a[84:87], v[24:27], v[80:95]
 ds_read_b128 v[20:23], v3 offset:544
 s_waitcnt lgkmcnt(6)
 v_mfma_f32_32x32x16_bf16 v[64:79], a[88:91], v[28:31], v[64:79]
 v_mfma_f32_32x32x16_bf16 v[80:95], a[92:95], v[28:31], v[80:95]
 ds_read_b128 v[24:27], v3 offset:576
 s_waitcnt lgkmcnt(6)
 v_mfma_f32_32x32x16_bf16 v[64:79], a[96:99], v[32:35], v[64:79]
 v_mfma_f32_32x32x16_bf16 v[80:95], a[100:103], v[32:35], v[80:95]
 ds_read_b128 v[28:31], v3 offset:608
 s_waitcnt lgkmcnt(6)
 v_mfma_f32_32x32x16_bf16 v[64:79], a[104:107], v[36:39], v[64:79]
 v_mfma_f32_32x32x16_bf16 v[80:95], a[108:111], v[36:39], v[80:95]
 ds_read_b128 v[32:35], v3 offset:640
 s_waitcnt lgkmcnt(6)
 v_mfma_f32_32x32x16_bf16 v[64:79], a[112:115], v[40:43], v[64:79]
 s_cmp_lg_u32 s3, 0
 s_cbranch_scc1 w0_47
 s_min_u32 s70, s6, 63
 s_min_u32 s71, s7, 63
 s_lshl_b32 s70, s70, 8
 s_lshl_b32 s71, s71, 8
 v_add_u32 v15, s70, v56
 s_mov_b32 exec_lo, 0
 v_add_u32 v15, s71, v56
 s_mov_b32 exec_lo, s87
 s_mov_b32 exec_hi, s87
 buffer_load_dwordx2 v[62:63], v15, s[52:55], 0 offen sc1
 s_mov_b64 exec, -1
w0_47:
 v_mfma_f32_32x32x16_bf16 v[80:95], a[116:119], v[40:43], v[80:95]
 ds_read_b128 v[36:39], v3 offset:672
 s_waitcnt lgkmcnt(6)
 v_mfma_f32_32x32x16_bf16 v[64:79], a[120:123], v[44:47], v[64:79]
 v_mfma_f32_32x32x16_bf16 v[80:95], a[124:127], v[44:47], v[80:95]
 ds_read_b128 v[40:43], v3 offset:704
 s_waitcnt lgkmcnt(6)
 v_mfma_f32_32x32x16_bf16 v[64:79], a[128:131], v[16:19], v[64:79]
 v_mfma_f32_32x32x16_bf16 v[80:95], a[132:135], v[16:19], v[80:95]
 ds_read_b128 v[44:47], v3 offset:736
 s_waitcnt lgkmcnt(6)
 v_mfma_f32_32x32x16_bf16 v[64:79], a[136:139], v[20:23], v[64:79]
 v_mfma_f32_32x32x16_bf16 v[80:95], a[140:143], v[20:23], v[80:95]
 ds_read_b128 v[16:19], v3 offset:768
 s_waitcnt lgkmcnt(6)
 v_mfma_f32_32x32x16_bf16 v[64:79], a[144:147], v[24:27], v[64:79]
 v_mfma_f32_32x32x16_bf16 v[80:95], a[148:151], v[24:27], v[80:95]
 ds_read_b128 v[20:23], v3 offset:800
 s_waitcnt lgkmcnt(6)
 v_mfma_f32_32x32x16_bf16 v[64:79], a[152:155], v[28:31], v[64:79]
 v_mfma_f32_32x32x16_bf16 v[80:95], a[156:159], v[28:31], v[80:95]
 ds_read_b128 v[24:27], v3 offset:832
 s_waitcnt lgkmcnt(6)
 v_mfma_f32_32x32x16_bf16 v[64:79], a[160:163], v[32:35], v[64:79]
 v_mfma_f32_32x32x16_bf16 v[80:95], a[164:167], v[32:35], v[80:95]
 ds_read_b128 v[28:31], v3 offset:864
 s_waitcnt lgkmcnt(6)
 v_mfma_f32_32x32x16_bf16 v[64:79], a[168:171], v[36:39], v[64:79]
 v_mfma_f32_32x32x16_bf16 v[80:95], a[172:175], v[36:39], v[80:95]
 ds_read_b128 v[32:35], v3 offset:896
 s_waitcnt lgkmcnt(6)
 v_mfma_f32_32x32x16_bf16 v[64:79], a[176:179], v[40:43], v[64:79]
 s_cmp_lg_u32 s3, 0
 s_cbranch_scc1 w0_48
 s_waitcnt vmcnt(0)
 v_cmp_ge_u32 s[72:73], v62, v57
 v_cmp_ge_u32 s[74:75], v63, v58
 s_and_b64 s[72:73], s[72:73], s[74:75]
 s_mov_b32 s70, 2
 s_cmp_lt_u32 s6, 64
 s_cselect_b32 s71, s72, 0
 s_cmp_eq_u32 s71, -1
 s_cselect_b32 s70, 0, s70
 s_cmp_lt_u32 s7, 64
 s_cselect_b32 s71, s73, 0
 s_cmp_eq_u32 s71, -1
 s_cselect_b32 s70, 1, s70
 v_mov_b32 v5, s70
 v_mov_b32 v6, s95
 ds_write_b32 v6, v5
w0_48:
 v_mfma_f32_32x32x16_bf16 v[80:95], a[180:183], v[40:43], v[80:95]
 ds_read_b128 v[36:39], v3 offset:928
 s_waitcnt lgkmcnt(6)
 v_mfma_f32_32x32x16_bf16 v[64:79], a[184:187], v[44:47], v[64:79]
 v_mfma_f32_32x32x16_bf16 v[80:95], a[188:191], v[44:47], v[80:95]
 ds_read_b128 v[40:43], v3 offset:960
 s_waitcnt lgkmcnt(6)
 v_mfma_f32_32x32x16_bf16 v[64:79], a[192:195], v[16:19], v[64:79]
 v_mov_b32 v6, s95
 s_waitcnt lgkmcnt(2)
 s_barrier
 ds_read_b32 v61, v6
 s_xor_b32 s95, s95, 4
 v_mfma_f32_32x32x16_bf16 v[80:95], a[196:199], v[16:19], v[80:95]
 ds_read_b128 v[44:47], v3 offset:992
 s_waitcnt lgkmcnt(6)
 v_mfma_f32_32x32x16_bf16 v[64:79], a[200:203], v[20:23], v[64:79]
 v_mfma_f32_32x32x16_bf16 v[80:95], a[204:207], v[20:23], v[80:95]
kva_tail0:
 s_waitcnt lgkmcnt(5)
 v_mfma_f32_32x32x16_bf16 v[64:79], a[208:211], v[24:27], v[64:79]
 v_mfma_f32_32x32x16_bf16 v[80:95], a[212:215], v[24:27], v[80:95]
 s_waitcnt lgkmcnt(4)
 v_mfma_f32_32x32x16_bf16 v[64:79], a[216:219], v[28:31], v[64:79]
 v_mfma_f32_32x32x16_bf16 v[80:95], a[220:223], v[28:31], v[80:95]
 s_waitcnt lgkmcnt(3)
 v_mfma_f32_32x32x16_bf16 v[64:79], a[224:227], v[32:35], v[64:79]
 v_mfma_f32_32x32x16_bf16 v[80:95], a[228:231], v[32:35], v[80:95]
 s_waitcnt lgkmcnt(2)
 v_mfma_f32_32x32x16_bf16 v[64:79], a[232:235], v[36:39], v[64:79]
 v_mfma_f32_32x32x16_bf16 v[80:95], a[236:239], v[36:39], v[80:95]
 s_waitcnt lgkmcnt(1)
 v_mfma_f32_32x32x16_bf16 v[64:79], a[240:243], v[40:43], v[64:79]
 v_mfma_f32_32x32x16_bf16 v[80:95], a[244:247], v[40:43], v[80:95]
 s_waitcnt lgkmcnt(0)
 v_mfma_f32_32x32x16_bf16 v[64:79], a[248:251], v[44:47], v[64:79]
 v_mfma_f32_32x32x16_bf16 v[80:95], a[252:255], v[44:47], v[80:95]
 v_readfirstlane_b32 s94, v61
 s_mov_b32 s88, s6
 s_mov_b32 s89, s7
 s_add_u32 s70, s88, 2
 s_cmp_lt_u32 s70, 56
 s_cselect_b32 s70, s70, s65
 s_add_u32 s71, s88, 1
 s_cmp_lt_u32 s88, 56
 s_cselect_b32 s88, s70, s71
 s_add_u32 s89, s89, 1
 s_and_b32 s4, s94, 1
 s_cmp_eq_u32 s94, 0
 s_cselect_b32 s5, s6, s7
 s_cselect_b32 s6, s88, s6
 s_cmp_eq_u32 s94, 1
 s_cselect_b32 s7, s89, s7
 s_mov_b32 s78, 65536
 s_mul_i32 s81, s4, 2097152
 s_add_u32 s81, s81, 1818624
 s_lshl_b32 s70, s5, 15
 s_add_u32 s81, s81, s70
 s_mul_i32 s96, s3, 8320
 s_add_u32 s96, s96, s78
 s_lshl_b32 s97, s3, 13
 s_add_u32 s97, s97, s81
 s_sub_u32 s97, s97, 1024
 v_cvt_pk_bf16_f32 v128, v64, v65
 v_cvt_pk_bf16_f32 v129, v66, v67
 v_cvt_pk_bf16_f32 v130, v68, v69
 v_cvt_pk_bf16_f32 v131, v70, v71
 buffer_store_dwordx4 v[128:131], v2, s[52:55], s80 offen offset:0 sc1
 v_cvt_pk_bf16_f32 v132, v72, v73
 v_cvt_pk_bf16_f32 v133, v74, v75
 v_cvt_pk_bf16_f32 v134, v76, v77
 v_cvt_pk_bf16_f32 v135, v78, v79
 buffer_store_dwordx4 v[132:135], v2, s[52:55], s80 offen offset:1024 sc1
 v_cvt_pk_bf16_f32 v136, v80, v81
 v_cvt_pk_bf16_f32 v137, v82, v83
 v_cvt_pk_bf16_f32 v138, v84, v85
 v_cvt_pk_bf16_f32 v139, v86, v87
 buffer_store_dwordx4 v[136:139], v2, s[52:55], s80 offen offset:2048 sc1
 v_cvt_pk_bf16_f32 v140, v88, v89
 v_cvt_pk_bf16_f32 v141, v90, v91
 v_cvt_pk_bf16_f32 v142, v92, v93
 v_cvt_pk_bf16_f32 v143, v94, v95
 buffer_store_dwordx4 v[140:143], v2, s[52:55], s80 offen offset:3072 sc1
 s_cmp_ge_u32 s94, 2
 s_cbranch_scc1 kva_idle0
 s_add_u32 m0, s96, 0
 s_add_u32 s97, s97, 1024
 buffer_load_dwordx4 v2, s[52:55], s97 offen sc1 lds
 s_add_u32 m0, s96, 1040
 s_add_u32 s97, s97, 1024
 buffer_load_dwordx4 v2, s[52:55], s97 offen sc1 lds
 s_add_u32 m0, s96, 2080
 s_add_u32 s97, s97, 1024
 buffer_load_dwordx4 v2, s[52:55], s97 offen sc1 lds
 s_add_u32 m0, s96, 3120
 s_add_u32 s97, s97, 1024
 buffer_load_dwordx4 v2, s[52:55], s97 offen sc1 lds
 s_add_u32 m0, s96, 4160
 s_add_u32 s97, s97, 1024
 buffer_load_dwordx4 v2, s[52:55], s97 offen sc1 lds
 s_add_u32 m0, s96, 5200
 s_add_u32 s97, s97, 1024
 buffer_load_dwordx4 v2, s[52:55], s97 offen sc1 lds
 s_add_u32 m0, s96, 6240
 s_add_u32 s97, s97, 1024
 buffer_load_dwordx4 v2, s[52:55], s97 offen sc1 lds
 s_add_u32 m0, s96, 7280
 s_add_u32 s97, s97, 1024
 buffer_load_dwordx4 v2, s[52:55], s97 offen sc1 lds
 s_waitcnt vmcnt(8)
 s_mov_b64 exec, 1
 buffer_store_dword v0, v10, s[52:55], s101 offen sc1
 s_mov_b64 exec, -1
 s_branch sc_53
kva_idle0:
 s_mov_b32 s83, 0x200000
 s_cmp_lg_u32 s3, 0
 s_cbranch_scc1 nw_55
 s_min_u32 s70, s6, 63
 s_min_u32 s71, s7, 63
 s_lshl_b32 s70, s70, 8
 s_lshl_b32 s71, s71, 8
 v_add_u32 v15, s70, v56
 s_mov_b32 exec_lo, 0
 v_add_u32 v15, s71, v56
 s_mov_b32 exec_lo, s87
 s_mov_b32 exec_hi, s87
 buffer_load_dwordx2 v[62:63], v15, s[52:55], 0 offen sc1
 s_mov_b64 exec, -1
 s_waitcnt vmcnt(1)
 s_mov_b64 exec, 1
 buffer_store_dword v0, v10, s[52:55], s101 offen sc1
 s_mov_b64 exec, -1
 s_min_u32 s70, s6, s7
 s_cmp_ge_u32 s70, 64
 s_cbranch_scc1 kv_exit
 s_waitcnt vmcnt(1)
 s_branch ev_54
nw_55:
 s_waitcnt vmcnt(0)
 s_mov_b64 exec, 1
 buffer_store_dword v0, v10, s[52:55], s101 offen sc1
 s_mov_b64 exec, -1
kva_sched1:
 s_min_u32 s70, s6, s7
 s_cmp_ge_u32 s70, 64
 s_cbranch_scc1 kv_exit
 s_cmp_lg_u32 s3, 0
 s_cbranch_scc1 sc_49
 s_mov_b32 s83, 0x200000
sc_50:
 s_min_u32 s70, s6, 63
 s_min_u32 s71, s7, 63
 s_lshl_b32 s70, s70, 8
 s_lshl_b32 s71, s71, 8
 v_add_u32 v15, s70, v56
 s_mov_b32 exec_lo, 0
 v_add_u32 v15, s71, v56
 s_mov_b32 exec_lo, s87
 s_mov_b32 exec_hi, s87
 buffer_load_dwordx2 v[62:63], v15, s[52:55], 0 offen sc1
 s_mov_b64 exec, -1
 s_waitcnt vmcnt(0)
ev_54:
 v_cmp_ge_u32 s[72:73], v62, v57
 v_cmp_ge_u32 s[74:75], v63, v58
 s_and_b64 s[72:73], s[72:73], s[74:75]
 s_mov_b32 s70, 2
 s_cmp_lt_u32 s6, 64
 s_cselect_b32 s71, s72, 0
 s_cmp_eq_u32 s71, -1
 s_cselect_b32 s70, 0, s70
 s_cmp_lt_u32 s7, 64
 s_cselect_b32 s71, s73, 0
 s_cmp_eq_u32 s71, -1
 s_cselect_b32 s70, 1, s70
 s_cmp_lt_u32 s70, 2
 s_cbranch_scc1 sc_51
 s_sub_u32 s83, s83, 1
 s_cmp_lg_u32 s83, 0
 s_cbranch_scc1 sc_50
 s_mov_b32 s70, 3
sc_51:
 v_mov_b32 v5, s70
 v_mov_b32 v6, 163832
 ds_write_b32 v6, v5
 s_waitcnt lgkmcnt(0)
sc_49:
 s_barrier
 v_mov_b32 v6, 163832
 ds_read_b32 v61, v6
 s_waitcnt lgkmcnt(0)
 v_readfirstlane_b32 s94, v61
 s_cmp_ge_u32 s94, 2
 s_cbranch_scc1 k_exit
 s_mov_b32 s88, s6
 s_mov_b32 s89, s7
 s_add_u32 s70, s88, 2
 s_cmp_lt_u32 s70, 56
 s_cselect_b32 s70, s70, s65
 s_add_u32 s71, s88, 1
 s_cmp_lt_u32 s88, 56
 s_cselect_b32 s88, s70, s71
 s_add_u32 s89, s89, 1
 s_and_b32 s4, s94, 1
 s_cmp_eq_u32 s94, 0
 s_cselect_b32 s5, s6, s7
 s_cselect_b32 s6, s88, s6
 s_cmp_eq_u32 s94, 1
 s_cselect_b32 s7, s89, s7
 s_mov_b32 s78, 65536
 s_mul_i32 s81, s4, 2097152
 s_add_u32 s81, s81, 1818624
 s_lshl_b32 s70, s5, 15
 s_add_u32 s81, s81, s70
 s_mul_i32 s96, s3, 8320
 s_add_u32 s96, s96, s78
 s_lshl_b32 s97, s3, 13
 s_add_u32 s97, s97, s81
 s_sub_u32 s97, s97, 1024
 s_add_u32 m0, s96, 0
 s_add_u32 s97, s97, 1024
 buffer_load_dwordx4 v2, s[52:55], s97 offen sc1 lds
 s_add_u32 m0, s96, 1040
 s_add_u32 s97, s97, 1024
 buffer_load_dwordx4 v2, s[52:55], s97 offen sc1 lds
 s_add_u32 m0, s96, 2080
 s_add_u32 s97, s97, 1024
 buffer_load_dwordx4 v2, s[52:55], s97 offen sc1 lds
 s_add_u32 m0, s96, 3120
 s_add_u32 s97, s97, 1024
 buffer_load_dwordx4 v2, s[52:55], s97 offen sc1 lds
 s_add_u32 m0, s96, 4160
 s_add_u32 s97, s97, 1024
 buffer_load_dwordx4 v2, s[52:55], s97 offen sc1 lds
 s_add_u32 m0, s96, 5200
 s_add_u32 s97, s97, 1024
 buffer_load_dwordx4 v2, s[52:55], s97 offen sc1 lds
 s_add_u32 m0, s96, 6240
 s_add_u32 s97, s97, 1024
 buffer_load_dwordx4 v2, s[52:55], s97 offen sc1 lds
 s_add_u32 m0, s96, 7280
 s_add_u32 s97, s97, 1024
 buffer_load_dwordx4 v2, s[52:55], s97 offen sc1 lds
sc_53:
 s_cmp_lg_u32 s3, 0
 s_cbranch_scc1 sc_52
 s_min_u32 s70, s6, 63
 s_min_u32 s71, s7, 63
 s_lshl_b32 s70, s70, 8
 s_lshl_b32 s71, s71, 8
 v_add_u32 v15, s70, v56
 s_mov_b32 exec_lo, 0
 v_add_u32 v15, s71, v56
 s_mov_b32 exec_lo, s87
 s_mov_b32 exec_hi, s87
 buffer_load_dwordx2 v[62:63], v15, s[52:55], 0 offen sc1
 s_mov_b64 exec, -1
 s_waitcnt vmcnt(0)
 v_cmp_ge_u32 s[72:73], v62, v57
 v_cmp_ge_u32 s[74:75], v63, v58
 s_and_b64 s[72:73], s[72:73], s[74:75]
 s_mov_b32 s70, 2
 s_cmp_lt_u32 s6, 64
 s_cselect_b32 s71, s72, 0
 s_cmp_eq_u32 s71, -1
 s_cselect_b32 s70, 0, s70
 s_cmp_lt_u32 s7, 64
 s_cselect_b32 s71, s73, 0
 s_cmp_eq_u32 s71, -1
 s_cselect_b32 s70, 1, s70
 v_mov_b32 v5, s70
 v_mov_b32 v6, s95
 ds_write_b32 v6, v5
 s_waitcnt lgkmcnt(0)
sc_52:
 s_waitcnt vmcnt(0)
 v_mov_b32 v6, s95
 s_barrier
 ds_read_b32 v61, v6
 s_xor_b32 s95, s95, 4
 s_waitcnt lgkmcnt(0)
 v_readfirstlane_b32 s94, v61
 s_branch kva_pro1
kva_pro1:
 s_mov_b32 s90, 0
 ds_read_b128 v[16:19], v12 offset:0
 ds_read_b128 v[20:23], v12 offset:32
 ds_read_b128 v[24:27], v12 offset:64
 ds_read_b128 v[28:31], v12 offset:96
 ds_read_b128 v[32:35], v12 offset:128
 ds_read_b128 v[36:39], v12 offset:160
 s_cmp_ge_u32 s94, 2
 s_cbranch_scc1 kva_plain1
kva_run1:
 s_cmp_lt_u32 s94, 2
 s_cselect_b64 vcc, -1, 0
 ds_read_b128 v[40:43], v12 offset:192
 s_waitcnt lgkmcnt(6)
 v_mfma_f32_32x32x16_bf16 v[96:111], a[0:3], v[16:19], 0
 s_mov_b32 s68, s4
 s_mov_b32 s67, s5
 s_mov_b32 s88, s6
 s_mov_b32 s89, s7
 v_mfma_f32_32x32x16_bf16 v[112:127], a[4:7], v[16:19], 0
 s_add_u32 s70, s88, 2
 s_cmp_lt_u32 s70, 56
 s_cselect_b32 s70, s70, s65
 s_add_u32 s71, s88, 1
 ds_read_b128 v[44:47], v12 offset:224
 s_waitcnt lgkmcnt(6)
 v_mfma_f32_32x32x16_bf16 v[96:111], a[8:11], v[20:23], v[96:111]
 s_cmp_lt_u32 s88, 56
 s_cselect_b32 s88, s70, s71
 s_add_u32 s89, s89, 1
 s_and_b32 s4, s94, 1
 s_barrier
 v_mfma_f32_32x32x16_bf16 v[112:127], a[12:15], v[20:23], v[112:127]
 s_cmp_eq_u32 s94, 0
 s_cselect_b32 s5, s6, s7
 s_cselect_b32 s6, s88, s6
 s_cmp_eq_u32 s94, 1
 s_cselect_b32 s7, s89, s7
 ds_read_b128 v[16:19], v12 offset:256
 s_waitcnt lgkmcnt(6)
 v_mfma_f32_32x32x16_bf16 v[96:111], a[16:19], v[24:27], v[96:111]
 s_mov_b32 s78, 0
 s_mul_i32 s81, s4, 2097152
 s_add_u32 s81, s81, 1818624
 s_lshl_b32 s70, s5, 15
 s_bitcmp1_b32 s90, 0
 s_cbranch_scc0 g_56
 v_cvt_pk_bf16_f32 v128, v64, v65
 v_cvt_pk_bf16_f32 v129, v66, v67
 v_cvt_pk_bf16_f32 v130, v68, v69
 v_cvt_pk_bf16_f32 v131, v70, v71
 buffer_store_dwordx4 v[128:131], v2, s[52:55], s91 offen offset:0 sc1
g_56:
 v_mfma_f32_32x32x16_bf16 v[112:127], a[20:23], v[24:27], v[112:127]
 s_add_u32 s81, s81, s70
 s_mul_i32 s96, s3, 8320
 s_add_u32 s96, s96, s78
 s_lshl_b32 s97, s3, 13
 ds_read_b128 v[20:23], v12 offset:288
 s_waitcnt lgkmcnt(6)
 v_mfma_f32_32x32x16_bf16 v[96:111], a[24:27], v[28:31], v[96:111]
 s_add_u32 s97, s97, s81
 s_sub_u32 s97, s97, 1024
 s_bitcmp1_b32 s90, 0
 s_cbranch_scc0 g_57
 v_cvt_pk_bf16_f32 v132, v72, v73
 v_cvt_pk_bf16_f32 v133, v74, v75
 v_cvt_pk_bf16_f32 v134, v76, v77
 v_cvt_pk_bf16_f32 v135, v78, v79
 buffer_store_dwordx4 v[132:135], v2, s[52:55], s91 offen offset:1024 sc1
g_57:
 v_mfma_f32_32x32x16_bf16 v[112:127], a[28:31], v[28:31], v[112:127]
 s_cbranch_vccz g_58
 s_add_u32 m0, s96, 0
 s_add_u32 s97, s97, 1024
 buffer_load_dwordx4 v2, s[52:55], s97 offen sc1 lds
g_58:
 ds_read_b128 v[24:27], v12 offset:320
 s_waitcnt lgkmcnt(6)
 v_mfma_f32_32x32x16_bf16 v[96:111], a[32:35], v[32:35], v[96:111]
 s_bitcmp1_b32 s90, 0
 s_cbranch_scc0 g_59
 v_cvt_pk_bf16_f32 v136, v80, v81
 v_cvt_pk_bf16_f32 v137, v82, v83
 v_cvt_pk_bf16_f32 v138, v84, v85
 v_cvt_pk_bf16_f32 v139, v86, v87
 buffer_store_dwordx4 v[136:139], v2, s[52:55], s91 offen offset:2048 sc1
g_59:
 v_mfma_f32_32x32x16_bf16 v[112:127], a[36:39], v[32:35], v[112:127]
 s_cbranch_vccz g_60
 s_add_u32 m0, s96, 1040
 s_add_u32 s97, s97, 1024
 buffer_load_dwordx4 v2, s[52:55], s97 offen sc1 lds
g_60:
 ds_read_b128 v[28:31], v12 offset:352
 s_waitcnt lgkmcnt(6)
 v_mfma_f32_32x32x16_bf16 v[96:111], a[40:43], v[36:39], v[96:111]
 s_bitcmp1_b32 s90, 0
 s_cbranch_scc0 g_61
 v_cvt_pk_bf16_f32 v140, v88, v89
 v_cvt_pk_bf16_f32 v141, v90, v91
 v_cvt_pk_bf16_f32 v142, v92, v93
 v_cvt_pk_bf16_f32 v143, v94, v95
 buffer_store_dwordx4 v[140:143], v2, s[52:55], s91 offen offset:3072 sc1
g_61:
 v_mfma_f32_32x32x16_bf16 v[112:127], a[44:47], v[36:39], v[112:127]
 s_cbranch_vccz g_62
 s_add_u32 m0, s96, 2080
 s_add_u32 s97, s97, 1024
 buffer_load_dwordx4 v2, s[52:55], s97 offen sc1 lds
g_62:
 ds_read_b128 v[32:35], v12 offset:384
 s_waitcnt lgkmcnt(6)
 v_mfma_f32_32x32x16_bf16 v[96:111], a[48:51], v[40:43], v[96:111]
 s_cbranch_vccz g_63
 s_add_u32 m0, s96, 3120
 s_add_u32 s97, s97, 1024
 buffer_load_dwordx4 v2, s[52:55], s97 offen sc1 lds
g_63:
 v_mfma_f32_32x32x16_bf16 v[112:127], a[52:55], v[40:43], v[112:127]
 s_cbranch_vccz g_64
 s_add_u32 m0, s96, 4160
 s_add_u32 s97, s97, 1024
 buffer_load_dwordx4 v2, s[52:55], s97 offen sc1 lds
g_64:
 ds_read_b128 v[36:39], v12 offset:416
 s_waitcnt lgkmcnt(6)
 v_mfma_f32_32x32x16_bf16 v[96:111], a[56:59], v[44:47], v[96:111]
 s_cbranch_vccz g_65
 s_add_u32 m0, s96, 5200
 s_add_u32 s97, s97, 1024
 buffer_load_dwordx4 v2, s[52:55], s97 offen sc1 lds
g_65:
 v_mfma_f32_32x32x16_bf16 v[112:127], a[60:63], v[44:47], v[112:127]
 s_cbranch_vccz g_66
 s_add_u32 m0, s96, 6240
 s_add_u32 s97, s97, 1024
 buffer_load_dwordx4 v2, s[52:55], s97 offen sc1 lds
g_66:
 ds_read_b128 v[40:43], v12 offset:448
 s_waitcnt lgkmcnt(6)
 v_mfma_f32_32x32x16_bf16 v[96:111], a[64:67], v[16:19], v[96:111]
 s_cbranch_vccz g_67
 s_add_u32 m0, s96, 7280
 s_add_u32 s97, s97, 1024
 buffer_load_dwordx4 v2, s[52:55], s97 offen sc1 lds
g_67:
 v_mfma_f32_32x32x16_bf16 v[112:127], a[68:71], v[16:19], v[112:127]
 s_mul_i32 s80, s68, 16777216
 s_add_u32 s80, s80, 6012928
 s_lshl_b32 s70, s67, 18
 s_add_u32 s80, s80, s70
 ds_read_b128 v[44:47], v12 offset:480
 s_waitcnt lgkmcnt(6)
 v_mfma_f32_32x32x16_bf16 v[96:111], a[72:75], v[20:23], v[96:111]
 s_bitcmp1_b32 s90, 1
 s_cbranch_scc0 es_68
 s_cbranch_vccz es_69
 s_waitcnt vmcnt(8)
 s_branch es_70
es_69:
 s_waitcnt vmcnt(0)
es_70:
 s_mov_b64 exec, 1
 buffer_store_dword v0, v10, s[52:55], s69 offen sc1
 s_mov_b64 exec, -1
es_68:
 s_add_u32 s80, s80, s82
 s_mul_i32 s101, s68, 65
 s_add_u32 s101, s101, s67
 s_lshl_b32 s101, s101, 11
 v_mfma_f32_32x32x16_bf16 v[112:127], a[76:79], v[20:23], v[112:127]
 s_add_u32 s101, s101, 204800
 s_add_u32 s101, s101, s98
 ds_read_b128 v[16:19], v12 offset:512
 s_waitcnt lgkmcnt(6)
 v_mfma_f32_32x32x16_bf16 v[96:111], a[80:83], v[24:27], v[96:111]
 s_cmp_lg_u32 s3, 0
 s_cbranch_scc1 w0_71
 s_min_u32 s70, s6, 63
 s_min_u32 s71, s7, 63
 s_lshl_b32 s70, s70, 8
 s_lshl_b32 s71, s71, 8
 v_add_u32 v15, s70, v56
 s_mov_b32 exec_lo, 0
 v_add_u32 v15, s71, v56
 s_mov_b32 exec_lo, s87
 s_mov_b32 exec_hi, s87
 buffer_load_dwordx2 v[62:63], v15, s[52:55], 0 offen sc1
 s_mov_b64 exec, -1
w0_71:
 v_mfma_f32_32x32x16_bf16 v[112:127], a[84:87], v[24:27], v[112:127]
 ds_read_b128 v[20:23], v12 offset:544
 s_waitcnt lgkmcnt(6)
 v_mfma_f32_32x32x16_bf16 v[96:111], a[88:91], v[28:31], v[96:111]
 v_mfma_f32_32x32x16_bf16 v[112:127], a[92:95], v[28:31], v[112:127]
 ds_read_b128 v[24:27], v12 offset:576
 s_waitcnt lgkmcnt(6)
 v_mfma_f32_32x32x16_bf16 v[96:111], a[96:99], v[32:35], v[96:111]
 v_mfma_f32_32x32x16_bf16 v[112:127], a[100:103], v[32:35], v[112:127]
 ds_read_b128 v[28:31], v12 offset:608
 s_waitcnt lgkmcnt(6)
 v_mfma_f32_32x32x16_bf16 v[96:111], a[104:107], v[36:39], v[96:111]
 v_mfma_f32_32x32x16_bf16 v[112:127], a[108:111], v[36:39], v[112:127]
 ds_read_b128 v[32:35], v12 offset:640
 s_waitcnt lgkmcnt(6)
 v_mfma_f32_32x32x16_bf16 v[96:111], a[112:115], v[40:43], v[96:111]
 v_mfma_f32_32x32x16_bf16 v[112:127], a[116:119], v[40:43], v[112:127]
 ds_read_b128 v[36:39], v12 offset:672
 s_waitcnt lgkmcnt(6)
 v_mfma_f32_32x32x16_bf16 v[96:111], a[120:123], v[44:47], v[96:111]
 v_mfma_f32_32x32x16_bf16 v[112:127], a[124:127], v[44:47], v[112:127]
 ds_read_b128 v[40:43], v12 offset:704
 s_waitcnt lgkmcnt(6)
 v_mfma_f32_32x32x16_bf16 v[96:111], a[128:131], v[16:19], v[96:111]
 v_mfma_f32_32x32x16_bf16 v[112:127], a[132:135], v[16:19], v[112:127]
 ds_read_b128 v[44:47], v12 offset:736
 s_waitcnt lgkmcnt(6)
 v_mfma_f32_32x32x16_bf16 v[96:111], a[136:139], v[20:23], v[96:111]
 v_mfma_f32_32x32x16_bf16 v[112:127], a[140:143], v[20:23], v[112:127]
 ds_read_b128 v[16:19], v12 offset:768
 s_waitcnt lgkmcnt(6)
 v_mfma_f32_32x32x16_bf16 v[96:111], a[144:147], v[24:27], v[96:111]
 v_mfma_f32_32x32x16_bf16 v[112:127], a[148:151], v[24:27], v[112:127]
 ds_read_b128 v[20:23], v12 offset:800
 s_waitcnt lgkmcnt(6)
 v_mfma_f32_32x32x16_bf16 v[96:111], a[152:155], v[28:31], v[96:111]
 v_mfma_f32_32x32x16_bf16 v[112:127], a[156:159], v[28:31], v[112:127]
 ds_read_b128 v[24:27], v12 offset:832
 s_waitcnt lgkmcnt(6)
 v_mfma_f32_32x32x16_bf16 v[96:111], a[160:163], v[32:35], v[96:111]
 v_mfma_f32_32x32x16_bf16 v[112:127], a[164:167], v[32:35], v[112:127]
 ds_read_b128 v[28:31], v12 offset:864
 s_waitcnt lgkmcnt(6)
 v_mfma_f32_32x32x16_bf16 v[96:111], a[168:171], v[36:39], v[96:111]
 v_mfma_f32_32x32x16_bf16 v[112:127], a[172:175], v[36:39], v[112:127]
 ds_read_b128 v[32:35], v12 offset:896
 s_waitcnt lgkmcnt(6)
 v_mfma_f32_32x32x16_bf16 v[96:111], a[176:179], v[40:43], v[96:111]
 s_waitcnt vmcnt(0)
 s_bitcmp1_b32 s90, 0
 s_cbranch_scc0 sg_72
 s_mov_b64 exec, 1
 buffer_store_dword v0, v10, s[52:55], s69 offen sc1
 s_mov_b64 exec, -1
sg_72:
 s_cmp_lg_u32 s3, 0
 s_cbranch_scc1 w0_73
 v_cmp_ge_u32 s[72:73], v62, v57
 v_cmp_ge_u32 s[74:75], v63, v58
 s_and_b64 s[72:73], s[72:73], s[74:75]
 s_mov_b32 s70, 2
 s_cmp_lt_u32 s6, 64
 s_cselect_b32 s71, s72, 0
 s_cmp_eq_u32 s71, -1
 s_cselect_b32 s70, 0, s70
 s_cmp_lt_u32 s7, 64
 s_cselect_b32 s71, s73, 0
 s_cmp_eq_u32 s71, -1
 s_cselect_b32 s70, 1, s70
 v_mov_b32 v5, s70
 v_mov_b32 v6, s95
 ds_write_b32 v6, v5
w0_73:
 v_mfma_f32_32x32x16_bf16 v[112:127], a[180:183], v[40:43], v[112:127]
 ds_read_b128 v[36:39], v12 offset:928
 s_waitcnt lgkmcnt(6)
 v_mfma_f32_32x32x16_bf16 v[96:111], a[184:187], v[44:47], v[96:111]
 v_mfma_f32_32x32x16_bf16 v[112:127], a[188:191], v[44:47], v[112:127]
 ds_read_b128 v[40:43], v12 offset:960
 s_waitcnt lgkmcnt(6)
 v_mfma_f32_32x32x16_bf16 v[96:111], a[192:195], v[16:19], v[96:111]
 v_mov_b32 v6, s95
 s_waitcnt lgkmcnt(2)
 s_barrier
 ds_read_b32 v61, v6
 s_xor_b32 s95, s95, 4
 v_mfma_f32_32x32x16_bf16 v[112:127], a[196:199], v[16:19], v[112:127]
 ds_read_b128 v[44:47], v12 offset:992
 s_waitcnt lgkmcnt(6)
 v_mfma_f32_32x32x16_bf16 v[96:111], a[200:203], v[20:23], v[96:111]
 v_mfma_f32_32x32x16_bf16 v[112:127], a[204:207], v[20:23], v[112:127]
 s_cbranch_vccz kva_tail1
 ds_read_b128 v[16:19], v3 offset:0
 s_waitcnt lgkmcnt(6)
 v_mfma_f32_32x32x16_bf16 v[96:111], a[208:211], v[24:27], v[96:111]
 v_mfma_f32_32x32x16_bf16 v[112:127], a[212:215], v[24:27], v[112:127]
 ds_read_b128 v[20:23], v3 offset:32
 s_waitcnt lgkmcnt(6)
 v_mfma_f32_32x32x16_bf16 v[96:111], a[216:219], v[28:31], v[96:111]
 v_mfma_f32_32x32x16_bf16 v[112:127], a[220:223], v[28:31], v[112:127]
 ds_read_b128 v[24:27], v3 offset:64
 s_waitcnt lgkmcnt(6)
 v_mfma_f32_32x32x16_bf16 v[96:111], a[224:227], v[32:35], v[96:111]
 v_mfma_f32_32x32x16_bf16 v[112:127], a[228:231], v[32:35], v[112:127]
 ds_read_b128 v[28:31], v3 offset:96
 s_waitcnt lgkmcnt(6)
 v_mfma_f32_32x32x16_bf16 v[96:111], a[232:235], v[36:39], v[96:111]
 v_mfma_f32_32x32x16_bf16 v[112:127], a[236:239], v[36:39], v[112:127]
 ds_read_b128 v[32:35], v3 offset:128
 s_waitcnt lgkmcnt(6)
 v_mfma_f32_32x32x16_bf16 v[96:111], a[240:243], v[40:43], v[96:111]
 v_mfma_f32_32x32x16_bf16 v[112:127], a[244:247], v[40:43], v[112:127]
 s_mov_b32 s90, 1
 s_mov_b32 s91, s80
 s_mov_b32 s69, s101
 ds_read_b128 v[36:39], v3 offset:160
 s_waitcnt lgkmcnt(6)
 v_mfma_f32_32x32x16_bf16 v[96:111], a[248:251], v[44:47], v[96:111]
 v_mfma_f32_32x32x16_bf16 v[112:127], a[252:255], v[44:47], v[112:127]
 v_readfirstlane_b32 s94, v61
 s_cmp_eq_u32 s68, 0
 s_cbranch_scc1 kva_run0
 s_mov_b32 s90, 2
 s_nop 7
 v_cvt_pk_bf16_f32 v128, v96, v97
 v_cvt_pk_bf16_f32 v129, v98, v99
 v_cvt_pk_bf16_f32 v130, v100, v101
 v_cvt_pk_bf16_f32 v131, v102, v103
 buffer_store_dwordx4 v[128:131], v2, s[52:55], s80 offen offset:0 sc1
 v_cvt_pk_bf16_f32 v132, v104, v105
 v_cvt_pk_bf16_f32 v133, v106, v107
 v_cvt_pk_bf16_f32 v134, v108, v109
 v_cvt_pk_bf16_f32 v135, v110, v111
 buffer_store_dwordx4 v[132:135], v2, s[52:55], s80 offen offset:1024 sc1
 v_cvt_pk_bf16_f32 v136, v112, v113
 v_cvt_pk_bf16_f32 v137, v114, v115
 v_cvt_pk_bf16_f32 v138, v116, v117
 v_cvt_pk_bf16_f32 v139, v118, v119
 buffer_store_dwordx4 v[136:139], v2, s[52:55], s80 offen offset:2048 sc1
 v_cvt_pk_bf16_f32 v140, v120, v121
 v_cvt_pk_bf16_f32 v141, v122, v123
 v_cvt_pk_bf16_f32 v142, v124, v125
 v_cvt_pk_bf16_f32 v143, v126, v127
 buffer_store_dwordx4 v[140:143], v2, s[52:55], s80 offen offset:3072 sc1
 s_branch kva_run0
kva_plain1:
 ds_read_b128 v[40:43], v12 offset:192
 s_waitcnt lgkmcnt(6)
 v_mfma_f32_32x32x16_bf16 v[96:111], a[0:3], v[16:19], 0
 s_mov_b32 s68, s4
 s_mov_b32 s67, s5
 s_mul_i32 s80, s68, 16777216
 s_add_u32 s80, s80, 6012928
 v_mfma_f32_32x32x16_bf16 v[112:127], a[4:7], v[16:19], 0
 s_lshl_b32 s70, s67, 18
 s_add_u32 s80, s80, s70
 s_add_u32 s80, s80, s82
 s_mul_i32 s101, s68, 65
 ds_read_b128 v[44:47], v12 offset:224
 s_waitcnt lgkmcnt(6)
 v_mfma_f32_32x32x16_bf16 v[96:111], a[8:11], v[20:23], v[96:111]
 s_add_u32 s101, s101, s67
 s_lshl_b32 s101, s101, 11
 s_add_u32 s101, s101, 204800
 s_add_u32 s101, s101, s98
 s_barrier
 v_mfma_f32_32x32x16_bf16 v[112:127], a[12:15], v[20:23], v[112:127]
 ds_read_b128 v[16:19], v12 offset:256
 s_waitcnt lgkmcnt(6)
 v_mfma_f32_32x32x16_bf16 v[96:111], a[16:19], v[24:27], v[96:111]
 v_mfma_f32_32x32x16_bf16 v[112:127], a[20:23], v[24:27], v[112:127]
 ds_read_b128 v[20:23], v12 offset:288
 s_waitcnt lgkmcnt(6)
 v_mfma_f32_32x32x16_bf16 v[96:111], a[24:27], v[28:31], v[96:111]
 v_mfma_f32_32x32x16_bf16 v[112:127], a[28:31], v[28:31], v[112:127]
 ds_read_b128 v[24:27], v12 offset:320
 s_waitcnt lgkmcnt(6)
 v_mfma_f32_32x32x16_bf16 v[96:111], a[32:35], v[32:35], v[96:111]
 v_mfma_f32_32x32x16_bf16 v[112:127], a[36:39], v[32:35], v[112:127]
 ds_read_b128 v[28:31], v12 offset:352
 s_waitcnt lgkmcnt(6)
 v_mfma_f32_32x32x16_bf16 v[96:111], a[40:43], v[36:39], v[96:111]
 v_mfma_f32_32x32x16_bf16 v[112:127], a[44:47], v[36:39], v[112:127]
 ds_read_b128 v[32:35], v12 offset:384
 s_waitcnt lgkmcnt(6)
 v_mfma_f32_32x32x16_bf16 v[96:111], a[48:51], v[40:43], v[96:111]
 v_mfma_f32_32x32x16_bf16 v[112:127], a[52:55], v[40:43], v[112:127]
 ds_read_b128 v[36:39], v12 offset:416
 s_waitcnt lgkmcnt(6)
 v_mfma_f32_32x32x16_bf16 v[96:111], a[56:59], v[44:47], v[96:111]
 v_mfma_f32_32x32x16_bf16 v[112:127], a[60:63], v[44:47], v[112:127]
 ds_read_b128 v[40:43], v12 offset:448
 s_waitcnt lgkmcnt(6)
 v_mfma_f32_32x32x16_bf16 v[96:111], a[64:67], v[16:19], v[96:111]
 v_mfma_f32_32x32x16_bf16 v[112:127], a[68:71], v[16:19], v[112:127]
 ds_read_b128 v[44:47], v12 offset:480
 s_waitcnt lgkmcnt(6)
 v_mfma_f32_32x32x16_bf16 v[96:111], a[72:75], v[20:23], v[96:111]
 v_mfma_f32_32x32x16_bf16 v[112:127], a[76:79], v[20:23], v[112:127]
 ds_read_b128 v[16:19], v12 offset:512
 s_waitcnt lgkmcnt(6)
 v_mfma_f32_32x32x16_bf16 v[96:111], a[80:83], v[24:27], v[96:111]
 v_mfma_f32_32x32x16_bf16 v[112:127], a[84:87], v[24:27], v[112:127]
 ds_read_b128 v[20:23], v12 offset:544
 s_waitcnt lgkmcnt(6)
 v_mfma_f32_32x32x16_bf16 v[96:111], a[88:91], v[28:31], v[96:111]
 v_mfma_f32_32x32x16_bf16 v[112:127], a[92:95], v[28:31], v[112:127]
 ds_read_b128 v[24:27], v12 offset:576
 s_waitcnt lgkmcnt(6)
 v_mfma_f32_32x32x16_bf16 v[96:111], a[96:99], v[32:35], v[96:111]
 v_mfma_f32_32x32x16_bf16 v[112:127], a[100:103], v[32:35], v[112:127]
 ds_read_b128 v[28:31], v12 offset:608
 s_waitcnt lgkmcnt(6)
 v_mfma_f32_32x32x16_bf16 v[96:111], a[104:107], v[36:39], v[96:111]
 v_mfma_f32_32x32x16_bf16 v[112:127], a[108:111], v[36:39], v[112:127]
 ds_read_b128 v[32:35], v12 offset:640
 s_waitcnt lgkmcnt(6)
 v_mfma_f32_32x32x16_bf16 v[96:111], a[112:115], v[40:43], v[96:111]
 s_cmp_lg_u32 s3, 0
 s_cbranch_scc1 w0_74
 s_min_u32 s70, s6, 63
 s_min_u32 s71, s7, 63
 s_lshl_b32 s70, s70, 8
 s_lshl_b32 s71, s71, 8
 v_add_u32 v15, s70, v56
 s_mov_b32 exec_lo, 0
 v_add_u32 v15, s71, v56
 s_mov_b32 exec_lo, s87
 s_mov_b32 exec_hi, s87
 buffer_load_dwordx2 v[62:63], v15, s[52:55], 0 offen sc1
 s_mov_b64 exec, -1
w0_74:
 v_mfma_f32_32x32x16_bf16 v[112:127], a[116:119], v[40:43], v[112:127]
 ds_read_b128 v[36:39], v12 offset:672
 s_waitcnt lgkmcnt(6)
 v_mfma_f32_32x32x16_bf16 v[96:111], a[120:123], v[44:47], v[96:111]
 v_mfma_f32_32x32x16_bf16 v[112:127], a[124:127], v[44:47], v[112:127]
 ds_read_b128 v[40:43], v12 offset:704
 s_waitcnt lgkmcnt(6)
 v_mfma_f32_32x32x16_bf16 v[96:111], a[128:131], v[16:19], v[96:111]
 v_mfma_f32_32x32x16_bf16 v[112:127], a[132:135], v[16:19], v[112:127]
 ds_read_b128 v[44:47], v12 offset:736
 s_waitcnt lgkmcnt(6)
 v_mfma_f32_32x32x16_bf16 v[96:111], a[136:139], v[20:23], v[96:111]
 v_mfma_f32_32x32x16_bf16 v[112:127], a[140:143], v[20:23], v[112:127]
 ds_read_b128 v[16:19], v12 offset:768
 s_waitcnt lgkmcnt(6)
 v_mfma_f32_32x32x16_bf16 v[96:111], a[144:147], v[24:27], v[96:111]
 v_mfma_f32_32x32x16_bf16 v[112:127], a[148:151], v[24:27], v[112:127]
 ds_read_b128 v[20:23], v12 offset:800
 s_waitcnt lgkmcnt(6)
 v_mfma_f32_32x32x16_bf16 v[96:111], a[152:155], v[28:31], v[96:111]
 v_mfma_f32_32x32x16_bf16 v[112:127], a[156:159], v[28:31], v[112:127]
 ds_read_b128 v[24:27], v12 offset:832
 s_waitcnt lgkmcnt(6)
 v_mfma_f32_32x32x16_bf16 v[96:111], a[160:163], v[32:35], v[96:111]
 v_mfma_f32_32x32x16_bf16 v[112:127], a[164:167], v[32:35], v[112:127]
 ds_read_b128 v[28:31], v12 offset:864
 s_waitcnt lgkmcnt(6)
 v_mfma_f32_32x32x16_bf16 v[96:111], a[168:171], v[36:39], v[96:111]
 v_mfma_f32_32x32x16_bf16 v[112:127], a[172:175], v[36:39], v[112:127]
 ds_read_b128 v[32:35], v12 offset:896
 s_waitcnt lgkmcnt(6)
 v_mfma_f32_32x32x16_bf16 v[96:111], a[176:179], v[40:43], v[96:111]
 s_cmp_lg_u32 s3, 0
 s_cbranch_scc1 w0_75
 s_waitcnt vmcnt(0)
 v_cmp_ge_u32 s[72:73], v62, v57
 v_cmp_ge_u32 s[74:75], v63, v58
 s_and_b64 s[72:73], s[72:73], s[74:75]
 s_mov_b32 s70, 2
 s_cmp_lt_u32 s6, 64
 s_cselect_b32 s71, s72, 0
 s_cmp_eq_u32 s71, -1
 s_cselect_b32 s70, 0, s70
 s_cmp_lt_u32 s7, 64
 s_cselect_b32 s71, s73, 0
 s_cmp_eq_u32 s71, -1
 s_cselect_b32 s70, 1, s70
 v_mov_b32 v5, s70
 v_mov_b32 v6, s95
 ds_write_b32 v6, v5
w0_75:
 v_mfma_f32_32x32x16_bf16 v[112:127], a[180:183], v[40:43], v[112:127]
 ds_read_b128 v[36:39], v12 offset:928
 s_waitcnt lgkmcnt(6)
 v_mfma_f32_32x32x16_bf16 v[96:111], a[184:187], v[44:47], v[96:111]
 v_mfma_f32_32x32x16_bf16 v[112:127], a[188:191], v[44:47], v[112:127]
 ds_read_b128 v[40:43], v12 offset:960
 s_waitcnt lgkmcnt(6)
 v_mfma_f32_32x32x16_bf16 v[96:111], a[192:195], v[16:19], v[96:111]
 v_mov_b32 v6, s95
 s_waitcnt lgkmcnt(2)
 s_barrier
 ds_read_b32 v61, v6
 s_xor_b32 s95, s95, 4
 v_mfma_f32_32x32x16_bf16 v[112:127], a[196:199], v[16:19], v[112:127]
 ds_read_b128 v[44:47], v12 offset:992
 s_waitcnt lgkmcnt(6)
 v_mfma_f32_32x32x16_bf16 v[96:111], a[200:203], v[20:23], v[96:111]
 v_mfma_f32_32x32x16_bf16 v[112:127], a[204:207], v[20:23], v[112:127]
kva_tail1:
 s_waitcnt lgkmcnt(5)
 v_mfma_f32_32x32x16_bf16 v[96:111], a[208:211], v[24:27], v[96:111]
 v_mfma_f32_32x32x16_bf16 v[112:127], a[212:215], v[24:27], v[112:127]
 s_waitcnt lgkmcnt(4)
 v_mfma_f32_32x32x16_bf16 v[96:111], a[216:219], v[28:31], v[96:111]
 v_mfma_f32_32x32x16_bf16 v[112:127], a[220:223], v[28:31], v[112:127]
 s_waitcnt lgkmcnt(3)
 v_mfma_f32_32x32x16_bf16 v[96:111], a[224:227], v[32:35], v[96:111]
 v_mfma_f32_32x32x16_bf16 v[112:127], a[228:231], v[32:35], v[112:127]
 s_waitcnt lgkmcnt(2)
 v_mfma_f32_32x32x16_bf16 v[96:111], a[232:235], v[36:39], v[96:111]
 v_mfma_f32_32x32x16_bf16 v[112:127], a[236:239], v[36:39], v[112:127]
 s_waitcnt lgkmcnt(1)
 v_mfma_f32_32x32x16_bf16 v[96:111], a[240:243], v[40:43], v[96:111]
 v_mfma_f32_32x32x16_bf16 v[112:127], a[244:247], v[40:43], v[112:127]
 s_waitcnt lgkmcnt(0)
 v_mfma_f32_32x32x16_bf16 v[96:111], a[248:251], v[44:47], v[96:111]
 v_mfma_f32_32x32x16_bf16 v[112:127], a[252:255], v[44:47], v[112:127]
 v_readfirstlane_b32 s94, v61
 s_mov_b32 s88, s6
 s_mov_b32 s89, s7
 s_add_u32 s70, s88, 2
 s_cmp_lt_u32 s70, 56
 s_cselect_b32 s70, s70, s65
 s_add_u32 s71, s88, 1
 s_cmp_lt_u32 s88, 56
 s_cselect_b32 s88, s70, s71
 s_add_u32 s89, s89, 1
 s_and_b32 s4, s94, 1
 s_cmp_eq_u32 s94, 0
 s_cselect_b32 s5, s6, s7
 s_cselect_b32 s6, s88, s6
 s_cmp_eq_u32 s94, 1
 s_cselect_b32 s7, s89, s7
 s_mov_b32 s78, 0
 s_mul_i32 s81, s4, 2097152
 s_add_u32 s81, s81, 1818624
 s_lshl_b32 s70, s5, 15
 s_add_u32 s81, s81, s70
 s_mul_i32 s96, s3, 8320
 s_add_u32 s96, s96, s78
 s_lshl_b32 s97, s3, 13
 s_add_u32 s97, s97, s81
 s_sub_u32 s97, s97, 1024
 v_cvt_pk_bf16_f32 v128, v96, v97
 v_cvt_pk_bf16_f32 v129, v98, v99
 v_cvt_pk_bf16_f32 v130, v100, v101
 v_cvt_pk_bf16_f32 v131, v102, v103
 buffer_store_dwordx4 v[128:131], v2, s[52:55], s80 offen offset:0 sc1
 v_cvt_pk_bf16_f32 v132, v104, v105
 v_cvt_pk_bf16_f32 v133, v106, v107
 v_cvt_pk_bf16_f32 v134, v108, v109
 v_cvt_pk_bf16_f32 v135, v110, v111
 buffer_store_dwordx4 v[132:135], v2, s[52:55], s80 offen offset:1024 sc1
 v_cvt_pk_bf16_f32 v136, v112, v113
 v_cvt_pk_bf16_f32 v137, v114, v115
 v_cvt_pk_bf16_f32 v138, v116, v117
 v_cvt_pk_bf16_f32 v139, v118, v119
 buffer_store_dwordx4 v[136:139], v2, s[52:55], s80 offen offset:2048 sc1
 v_cvt_pk_bf16_f32 v140, v120, v121
 v_cvt_pk_bf16_f32 v141, v122, v123
 v_cvt_pk_bf16_f32 v142, v124, v125
 v_cvt_pk_bf16_f32 v143, v126, v127
 buffer_store_dwordx4 v[140:143], v2, s[52:55], s80 offen offset:3072 sc1
 s_cmp_ge_u32 s94, 2
 s_cbranch_scc1 kva_idle1
 s_add_u32 m0, s96, 0
 s_add_u32 s97, s97, 1024
 buffer_load_dwordx4 v2, s[52:55], s97 offen sc1 lds
 s_add_u32 m0, s96, 1040
 s_add_u32 s97, s97, 1024
 buffer_load_dwordx4 v2, s[52:55], s97 offen sc1 lds
 s_add_u32 m0, s96, 2080
 s_add_u32 s97, s97, 1024
 buffer_load_dwordx4 v2, s[52:55], s97 offen sc1 lds
 s_add_u32 m0, s96, 3120
 s_add_u32 s97, s97, 1024
 buffer_load_dwordx4 v2, s[52:55], s97 offen sc1 lds
 s_add_u32 m0, s96, 4160
 s_add_u32 s97, s97, 1024
 buffer_load_dwordx4 v2, s[52:55], s97 offen sc1 lds
 s_add_u32 m0, s96, 5200
 s_add_u32 s97, s97, 1024
 buffer_load_dwordx4 v2, s[52:55], s97 offen sc1 lds
 s_add_u32 m0, s96, 6240
 s_add_u32 s97, s97, 1024
 buffer_load_dwordx4 v2, s[52:55], s97 offen sc1 lds
 s_add_u32 m0, s96, 7280
 s_add_u32 s97, s97, 1024
 buffer_load_dwordx4 v2, s[52:55], s97 offen sc1 lds
 s_waitcnt vmcnt(8)
 s_mov_b64 exec, 1
 buffer_store_dword v0, v10, s[52:55], s101 offen sc1
 s_mov_b64 exec, -1
 s_branch sc_80
kva_idle1:
 s_mov_b32 s83, 0x200000
 s_cmp_lg_u32 s3, 0
 s_cbranch_scc1 nw_82
 s_min_u32 s70, s6, 63
 s_min_u32 s71, s7, 63
 s_lshl_b32 s70, s70, 8
 s_lshl_b32 s71, s71, 8
 v_add_u32 v15, s70, v56
 s_mov_b32 exec_lo, 0
 v_add_u32 v15, s71, v56
 s_mov_b32 exec_lo, s87
 s_mov_b32 exec_hi, s87
 buffer_load_dwordx2 v[62:63], v15, s[52:55], 0 offen sc1
 s_mov_b64 exec, -1
 s_waitcnt vmcnt(1)
 s_mov_b64 exec, 1
 buffer_store_dword v0, v10, s[52:55], s101 offen sc1
 s_mov_b64 exec, -1
 s_min_u32 s70, s6, s7
 s_cmp_ge_u32 s70, 64
 s_cbranch_scc1 kv_exit
 s_waitcnt vmcnt(1)
 s_branch ev_81
nw_82:
 s_waitcnt vmcnt(0)
 s_mov_b64 exec, 1
 buffer_store_dword v0, v10, s[52:55], s101 offen sc1
 s_mov_b64 exec, -1
kva_sched0:
 s_min_u32 s70, s6, s7
 s_cmp_ge_u32 s70, 64
 s_cbranch_scc1 kv_exit
 s_cmp_lg_u32 s3, 0
 s_cbranch_scc1 sc_76
 s_mov_b32 s83, 0x200000
sc_77:
 s_min_u32 s70, s6, 63
 s_min_u32 s71, s7, 63
 s_lshl_b32 s70, s70, 8
 s_lshl_b32 s71, s71, 8
 v_add_u32 v15, s70, v56
 s_mov_b32 exec_lo, 0
 v_add_u32 v15, s71, v56
 s_mov_b32 exec_lo, s87
 s_mov_b32 exec_hi, s87
 buffer_load_dwordx2 v[62:63], v15, s[52:55], 0 offen sc1
 s_mov_b64 exec, -1
 s_waitcnt vmcnt(0)
ev_81:
 v_cmp_ge_u32 s[72:73], v62, v57
 v_cmp_ge_u32 s[74:75], v63, v58
 s_and_b64 s[72:73], s[72:73], s[74:75]
 s_mov_b32 s70, 2
 s_cmp_lt_u32 s6, 64
 s_cselect_b32 s71, s72, 0
 s_cmp_eq_u32 s71, -1
 s_cselect_b32 s70, 0, s70
 s_cmp_lt_u32 s7, 64
 s_cselect_b32 s71, s73, 0
 s_cmp_eq_u32 s71, -1
 s_cselect_b32 s70, 1, s70
 s_cmp_lt_u32 s70, 2
 s_cbranch_scc1 sc_78
 s_sub_u32 s83, s83, 1
 s_cmp_lg_u32 s83, 0
 s_cbranch_scc1 sc_77
 s_mov_b32 s70, 3
sc_78:
 v_mov_b32 v5, s70
 v_mov_b32 v6, 163832
 ds_write_b32 v6, v5
 s_waitcnt lgkmcnt(0)
sc_76:
 s_barrier
 v_mov_b32 v6, 163832
 ds_read_b32 v61, v6
 s_waitcnt lgkmcnt(0)
 v_readfirstlane_b32 s94, v61
 s_cmp_ge_u32 s94, 2
 s_cbranch_scc1 k_exit
 s_mov_b32 s88, s6
 s_mov_b32 s89, s7
 s_add_u32 s70, s88, 2
 s_cmp_lt_u32 s70, 56
 s_cselect_b32 s70, s70, s65
 s_add_u32 s71, s88, 1
 s_cmp_lt_u32 s88, 56
 s_cselect_b32 s88, s70, s71
 s_add_u32 s89, s89, 1
 s_and_b32 s4, s94, 1
 s_cmp_eq_u32 s94, 0
 s_cselect_b32 s5, s6, s7
 s_cselect_b32 s6, s88, s6
 s_cmp_eq_u32 s94, 1
 s_cselect_b32 s7, s89, s7
 s_mov_b32 s78, 0
 s_mul_i32 s81, s4, 2097152
 s_add_u32 s81, s81, 1818624
 s_lshl_b32 s70, s5, 15
 s_add_u32 s81, s81, s70
 s_mul_i32 s96, s3, 8320
 s_add_u32 s96, s96, s78
 s_lshl_b32 s97, s3, 13
 s_add_u32 s97, s97, s81
 s_sub_u32 s97, s97, 1024
 s_add_u32 m0, s96, 0
 s_add_u32 s97, s97, 1024
 buffer_load_dwordx4 v2, s[52:55], s97 offen sc1 lds
 s_add_u32 m0, s96, 1040
 s_add_u32 s97, s97, 1024
 buffer_load_dwordx4 v2, s[52:55], s97 offen sc1 lds
 s_add_u32 m0, s96, 2080
 s_add_u32 s97, s97, 1024
 buffer_load_dwordx4 v2, s[52:55], s97 offen sc1 lds
 s_add_u32 m0, s96, 3120
 s_add_u32 s97, s97, 1024
 buffer_load_dwordx4 v2, s[52:55], s97 offen sc1 lds
 s_add_u32 m0, s96, 4160
 s_add_u32 s97, s97, 1024
 buffer_load_dwordx4 v2, s[52:55], s97 offen sc1 lds
 s_add_u32 m0, s96, 5200
 s_add_u32 s97, s97, 1024
 buffer_load_dwordx4 v2, s[52:55], s97 offen sc1 lds
 s_add_u32 m0, s96, 6240
 s_add_u32 s97, s97, 1024
 buffer_load_dwordx4 v2, s[52:55], s97 offen sc1 lds
 s_add_u32 m0, s96, 7280
 s_add_u32 s97, s97, 1024
 buffer_load_dwordx4 v2, s[52:55], s97 offen sc1 lds
sc_80:
 s_cmp_lg_u32 s3, 0
 s_cbranch_scc1 sc_79
 s_min_u32 s70, s6, 63
 s_min_u32 s71, s7, 63
 s_lshl_b32 s70, s70, 8
 s_lshl_b32 s71, s71, 8
 v_add_u32 v15, s70, v56
 s_mov_b32 exec_lo, 0
 v_add_u32 v15, s71, v56
 s_mov_b32 exec_lo, s87
 s_mov_b32 exec_hi, s87
 buffer_load_dwordx2 v[62:63], v15, s[52:55], 0 offen sc1
 s_mov_b64 exec, -1
 s_waitcnt vmcnt(0)
 v_cmp_ge_u32 s[72:73], v62, v57
 v_cmp_ge_u32 s[74:75], v63, v58
 s_and_b64 s[72:73], s[72:73], s[74:75]
 s_mov_b32 s70, 2
 s_cmp_lt_u32 s6, 64
 s_cselect_b32 s71, s72, 0
 s_cmp_eq_u32 s71, -1
 s_cselect_b32 s70, 0, s70
 s_cmp_lt_u32 s7, 64
 s_cselect_b32 s71, s73, 0
 s_cmp_eq_u32 s71, -1
 s_cselect_b32 s70, 1, s70
 v_mov_b32 v5, s70
 v_mov_b32 v6, s95
 ds_write_b32 v6, v5
 s_waitcnt lgkmcnt(0)
sc_79:
 s_waitcnt vmcnt(0)
 v_mov_b32 v6, s95
 s_barrier
 ds_read_b32 v61, v6
 s_xor_b32 s95, s95, 4
 s_waitcnt lgkmcnt(0)
 v_readfirstlane_b32 s94, v61
 s_branch kva_pro0
kvb_pro0:
 s_mov_b32 s90, 0
 ds_read_b128 v[16:19], v3 offset:0
 ds_read_b128 v[20:23], v3 offset:32
 ds_read_b128 v[24:27], v3 offset:64
 ds_read_b128 v[28:31], v3 offset:96
 ds_read_b128 v[32:35], v3 offset:128
 ds_read_b128 v[36:39], v3 offset:160
 s_cmp_ge_u32 s94, 2
 s_cbranch_scc1 kvb_plain0
kvb_run0:
 s_cmp_lt_u32 s94, 2
 s_cselect_b64 vcc, -1, 0
 ds_read_b128 v[40:43], v3 offset:192
 s_waitcnt lgkmcnt(6)
 v_mfma_f32_32x32x16_bf16 v[64:79], v[16:19], a[0:3], 0
 s_mov_b32 s68, s4
 s_mov_b32 s67, s5
 s_mov_b32 s88, s6
 s_mov_b32 s89, s7
 v_mfma_f32_32x32x16_bf16 v[80:95], v[16:19], a[4:7], 0
 s_add_u32 s70, s88, 2
 s_cmp_lt_u32 s70, 56
 s_cselect_b32 s70, s70, s65
 s_add_u32 s71, s88, 1
 ds_read_b128 v[44:47], v3 offset:224
 s_waitcnt lgkmcnt(6)
 v_mfma_f32_32x32x16_bf16 v[64:79], v[20:23], a[8:11], v[64:79]
 s_cmp_lt_u32 s88, 56
 s_cselect_b32 s88, s70, s71
 s_add_u32 s89, s89, 1
 s_and_b32 s4, s94, 1
 s_barrier
 v_mfma_f32_32x32x16_bf16 v[80:95], v[20:23], a[12:15], v[80:95]
 s_cmp_eq_u32 s94, 0
 s_cselect_b32 s5, s6, s7
 s_cselect_b32 s6, s88, s6
 s_cmp_eq_u32 s94, 1
 s_cselect_b32 s7, s89, s7
 ds_read_b128 v[16:19], v3 offset:256
 s_waitcnt lgkmcnt(6)
 v_mfma_f32_32x32x16_bf16 v[64:79], v[24:27], a[16:19], v[64:79]
 s_mov_b32 s78, 65536
 s_mul_i32 s81, s4, 2097152
 s_add_u32 s81, s81, 1818624
 s_lshl_b32 s70, s5, 15
 s_bitcmp1_b32 s90, 0
 s_cbranch_scc0 g_83
 v_cvt_pk_bf16_f32 v128, v96, v97
 v_cvt_pk_bf16_f32 v129, v98, v99
 v_cvt_pk_bf16_f32 v130, v100, v101
 v_cvt_pk_bf16_f32 v131, v102, v103
 buffer_store_dwordx4 v[128:131], v2, s[52:55], s91 offen offset:0 sc1
g_83:
 v_mfma_f32_32x32x16_bf16 v[80:95], v[24:27], a[20:23], v[80:95]
 s_add_u32 s81, s81, s70
 s_mul_i32 s96, s3, 8320
 s_add_u32 s96, s96, s78
 s_lshl_b32 s97, s3, 13
 ds_read_b128 v[20:23], v3 offset:288
 s_waitcnt lgkmcnt(6)
 v_mfma_f32_32x32x16_bf16 v[64:79], v[28:31], a[24:27], v[64:79]
 s_add_u32 s97, s97, s81
 s_sub_u32 s97, s97, 1024
 s_bitcmp1_b32 s90, 0
 s_cbranch_scc0 g_84
 v_cvt_pk_bf16_f32 v132, v104, v105
 v_cvt_pk_bf16_f32 v133, v106, v107
 v_cvt_pk_bf16_f32 v134, v108, v109
 v_cvt_pk_bf16_f32 v135, v110, v111
 buffer_store_dwordx4 v[132:135], v2, s[52:55], s91 offen offset:1024 sc1
g_84:
 v_mfma_f32_32x32x16_bf16 v[80:95], v[28:31], a[28:31], v[80:95]
 s_cbranch_vccz g_85
 s_add_u32 m0, s96, 0
 s_add_u32 s97, s97, 1024
 buffer_load_dwordx4 v2, s[52:55], s97 offen sc1 lds
g_85:
 ds_read_b128 v[24:27], v3 offset:320
 s_waitcnt lgkmcnt(6)
 v_mfma_f32_32x32x16_bf16 v[64:79], v[32:35], a[32:35], v[64:79]
 s_bitcmp1_b32 s90, 0
 s_cbranch_scc0 g_86
 v_cvt_pk_bf16_f32 v136, v112, v113
 v_cvt_pk_bf16_f32 v137, v114, v115
 v_cvt_pk_bf16_f32 v138, v116, v117
 v_cvt_pk_bf16_f32 v139, v118, v119
 buffer_store_dwordx4 v[136:139], v2, s[52:55], s91 offen offset:2048 sc1
g_86:
 v_mfma_f32_32x32x16_bf16 v[80:95], v[32:35], a[36:39], v[80:95]
 s_cbranch_vccz g_87
 s_add_u32 m0, s96, 1040
 s_add_u32 s97, s97, 1024
 buffer_load_dwordx4 v2, s[52:55], s97 offen sc1 lds
g_87:
 ds_read_b128 v[28:31], v3 offset:352
 s_waitcnt lgkmcnt(6)
 v_mfma_f32_32x32x16_bf16 v[64:79], v[36:39], a[40:43], v[64:79]
 s_bitcmp1_b32 s90, 0
 s_cbranch_scc0 g_88
 v_cvt_pk_bf16_f32 v140, v120, v121
 v_cvt_pk_bf16_f32 v141, v122, v123
 v_cvt_pk_bf16_f32 v142, v124, v125
 v_cvt_pk_bf16_f32 v143, v126, v127
 buffer_store_dwordx4 v[140:143], v2, s[52:55], s91 offen offset:3072 sc1
g_88:
 v_mfma_f32_32x32x16_bf16 v[80:95], v[36:39], a[44:47], v[80:95]
 s_cbranch_vccz g_89
 s_add_u32 m0, s96, 2080
 s_add_u32 s97, s97, 1024
 buffer_load_dwordx4 v2, s[52:55], s97 offen sc1 lds
g_89:
 ds_read_b128 v[32:35], v3 offset:384
 s_waitcnt lgkmcnt(6)
 v_mfma_f32_32x32x16_bf16 v[64:79], v[40:43], a[48:51], v[64:79]
 s_cbranch_vccz g_90
 s_add_u32 m0, s96, 3120
 s_add_u32 s97, s97, 1024
 buffer_load_dwordx4 v2, s[52:55], s97 offen sc1 lds
g_90:
 v_mfma_f32_32x32x16_bf16 v[80:95], v[40:43], a[52:55], v[80:95]
 s_cbranch_vccz g_91
 s_add_u32 m0, s96, 4160
 s_add_u32 s97, s97, 1024
 buffer_load_dwordx4 v2, s[52:55], s97 offen sc1 lds
g_91:
 ds_read_b128 v[36:39], v3 offset:416
 s_waitcnt lgkmcnt(6)
 v_mfma_f32_32x32x16_bf16 v[64:79], v[44:47], a[56:59], v[64:79]
 s_cbranch_vccz g_92
 s_add_u32 m0, s96, 5200
 s_add_u32 s97, s97, 1024
 buffer_load_dwordx4 v2, s[52:55], s97 offen sc1 lds
g_92:
 v_mfma_f32_32x32x16_bf16 v[80:95], v[44:47], a[60:63], v[80:95]
 s_cbranch_vccz g_93
 s_add_u32 m0, s96, 6240
 s_add_u32 s97, s97, 1024
 buffer_load_dwordx4 v2, s[52:55], s97 offen sc1 lds
g_93:
 ds_read_b128 v[40:43], v3 offset:448
 s_waitcnt lgkmcnt(6)
 v_mfma_f32_32x32x16_bf16 v[64:79], v[16:19], a[64:67], v[64:79]
 s_cbranch_vccz g_94
 s_add_u32 m0, s96, 7280
 s_add_u32 s97, s97, 1024
 buffer_load_dwordx4 v2, s[52:55], s97 offen sc1 lds
g_94:
 v_mfma_f32_32x32x16_bf16 v[80:95], v[16:19], a[68:71], v[80:95]
 s_mul_i32 s80, s68, 16777216
 s_add_u32 s80, s80, 6012928
 s_lshl_b32 s70, s67, 18
 s_add_u32 s80, s80, s70
 ds_read_b128 v[44:47], v3 offset:480
 s_waitcnt lgkmcnt(6)
 v_mfma_f32_32x32x16_bf16 v[64:79], v[20:23], a[72:75], v[64:79]
 s_bitcmp1_b32 s90, 1
 s_cbranch_scc0 es_95
 s_cbranch_vccz es_96
 s_waitcnt vmcnt(8)
 s_branch es_97
es_96:
 s_waitcnt vmcnt(0)
es_97:
 s_mov_b64 exec, 1
 buffer_store_dword v0, v10, s[52:55], s69 offen sc1
 s_mov_b64 exec, -1
es_95:
 s_add_u32 s80, s80, s82
 s_mul_i32 s101, s68, 65
 s_add_u32 s101, s101, s67
 s_lshl_b32 s101, s101, 11
 v_mfma_f32_32x32x16_bf16 v[80:95], v[20:23], a[76:79], v[80:95]
 s_add_u32 s101, s101, 204800
 s_add_u32 s101, s101, s98
 ds_read_b128 v[16:19], v3 offset:512
 s_waitcnt lgkmcnt(6)
 v_mfma_f32_32x32x16_bf16 v[64:79], v[24:27], a[80:83], v[64:79]
 s_cmp_lg_u32 s3, 0
 s_cbranch_scc1 w0_98
 s_min_u32 s70, s6, 63
 s_min_u32 s71, s7, 63
 s_lshl_b32 s70, s70, 8
 s_lshl_b32 s71, s71, 8
 v_add_u32 v15, s70, v56
 s_mov_b32 exec_lo, 0
 v_add_u32 v15, s71, v56
 s_mov_b32 exec_lo, s87
 s_mov_b32 exec_hi, s87
 buffer_load_dwordx2 v[62:63], v15, s[52:55], 0 offen sc1
 s_mov_b64 exec, -1
w0_98:
 v_mfma_f32_32x32x16_bf16 v[80:95], v[24:27], a[84:87], v[80:95]
 ds_read_b128 v[20:23], v3 offset:544
 s_waitcnt lgkmcnt(6)
 v_mfma_f32_32x32x16_bf16 v[64:79], v[28:31], a[88:91], v[64:79]
 v_mfma_f32_32x32x16_bf16 v[80:95], v[28:31], a[92:95], v[80:95]
 ds_read_b128 v[24:27], v3 offset:576
 s_waitcnt lgkmcnt(6)
 v_mfma_f32_32x32x16_bf16 v[64:79], v[32:35], a[96:99], v[64:79]
 v_mfma_f32_32x32x16_bf16 v[80:95], v[32:35], a[100:103], v[80:95]
 ds_read_b128 v[28:31], v3 offset:608
 s_waitcnt lgkmcnt(6)
 v_mfma_f32_32x32x16_bf16 v[64:79], v[36:39], a[104:107], v[64:79]
 v_mfma_f32_32x32x16_bf16 v[80:95], v[36:39], a[108:111], v[80:95]
 ds_read_b128 v[32:35], v3 offset:640
 s_waitcnt lgkmcnt(6)
 v_mfma_f32_32x32x16_bf16 v[64:79], v[40:43], a[112:115], v[64:79]
 v_mfma_f32_32x32x16_bf16 v[80:95], v[40:43], a[116:119], v[80:95]
 ds_read_b128 v[36:39], v3 offset:672
 s_waitcnt lgkmcnt(6)
 v_mfma_f32_32x32x16_bf16 v[64:79], v[44:47], a[120:123], v[64:79]
 v_mfma_f32_32x32x16_bf16 v[80:95], v[44:47], a[124:127], v[80:95]
 ds_read_b128 v[40:43], v3 offset:704
 s_waitcnt lgkmcnt(6)
 v_mfma_f32_32x32x16_bf16 v[64:79], v[16:19], a[128:131], v[64:79]
 v_mfma_f32_32x32x16_bf16 v[80:95], v[16:19], a[132:135], v[80:95]
 ds_read_b128 v[44:47], v3 offset:736
 s_waitcnt lgkmcnt(6)
 v_mfma_f32_32x32x16_bf16 v[64:79], v[20:23], a[136:139], v[64:79]
 v_mfma_f32_32x32x16_bf16 v[80:95], v[20:23], a[140:143], v[80:95]
 ds_read_b128 v[16:19], v3 offset:768
 s_waitcnt lgkmcnt(6)
 v_mfma_f32_32x32x16_bf16 v[64:79], v[24:27], a[144:147], v[64:79]
 v_mfma_f32_32x32x16_bf16 v[80:95], v[24:27], a[148:151], v[80:95]
 ds_read_b128 v[20:23], v3 offset:800
 s_waitcnt lgkmcnt(6)
 v_mfma_f32_32x32x16_bf16 v[64:79], v[28:31], a[152:155], v[64:79]
 v_mfma_f32_32x32x16_bf16 v[80:95], v[28:31], a[156:159], v[80:95]
 ds_read_b128 v[24:27], v3 offset:832
 s_waitcnt lgkmcnt(6)
 v_mfma_f32_32x32x16_bf16 v[64:79], v[32:35], a[160:163], v[64:79]
 v_mfma_f32_32x32x16_bf16 v[80:95], v[32:35], a[164:167], v[80:95]
 ds_read_b128 v[28:31], v3 offset:864
 s_waitcnt lgkmcnt(6)
 v_mfma_f32_32x32x16_bf16 v[64:79], v[36:39], a[168:171], v[64:79]
 v_mfma_f32_32x32x16_bf16 v[80:95], v[36:39], a[172:175], v[80:95]
 ds_read_b128 v[32:35], v3 offset:896
 s_waitcnt lgkmcnt(6)
 v_mfma_f32_32x32x16_bf16 v[64:79], v[40:43], a[176:179], v[64:79]
 s_waitcnt vmcnt(0)
 s_bitcmp1_b32 s90, 0
 s_cbranch_scc0 sg_99
 s_mov_b64 exec, 1
 buffer_store_dword v0, v10, s[52:55], s69 offen sc1
 s_mov_b64 exec, -1
sg_99:
 s_cmp_lg_u32 s3, 0
 s_cbranch_scc1 w0_100
 v_cmp_ge_u32 s[72:73], v62, v57
 v_cmp_ge_u32 s[74:75], v63, v58
 s_and_b64 s[72:73], s[72:73], s[74:75]
 s_mov_b32 s70, 2
 s_cmp_lt_u32 s6, 64
 s_cselect_b32 s71, s72, 0
 s_cmp_eq_u32 s71, -1
 s_cselect_b32 s70, 0, s70
 s_cmp_lt_u32 s7, 64
 s_cselect_b32 s71, s73, 0
 s_cmp_eq_u32 s71, -1
 s_cselect_b32 s70, 1, s70
 v_mov_b32 v5, s70
 v_mov_b32 v6, s95
 ds_write_b32 v6, v5
w0_100:
 v_mfma_f32_32x32x16_bf16 v[80:95], v[40:43], a[180:183], v[80:95]
 ds_read_b128 v[36:39], v3 offset:928
 s_waitcnt lgkmcnt(6)
 v_mfma_f32_32x32x16_bf16 v[64:79], v[44:47], a[184:187], v[64:79]
 v_mfma_f32_32x32x16_bf16 v[80:95], v[44:47], a[188:191], v[80:95]
 ds_read_b128 v[40:43], v3 offset:960
 s_waitcnt lgkmcnt(6)
 v_mfma_f32_32x32x16_bf16 v[64:79], v[16:19], a[192:195], v[64:79]
 v_mov_b32 v6, s95
 s_waitcnt lgkmcnt(2)
 s_barrier
 ds_read_b32 v61, v6
 s_xor_b32 s95, s95, 4
 v_mfma_f32_32x32x16_bf16 v[80:95], v[16:19], a[196:199], v[80:95]
 ds_read_b128 v[44:47], v3 offset:992
 s_waitcnt lgkmcnt(6)
 v_mfma_f32_32x32x16_bf16 v[64:79], v[20:23], a[200:203], v[64:79]
 v_mfma_f32_32x32x16_bf16 v[80:95], v[20:23], a[204:207], v[80:95]
 s_cbranch_vccz kvb_tail0
 ds_read_b128 v[16:19], v12 offset:0
 s_waitcnt lgkmcnt(6)
 v_mfma_f32_32x32x16_bf16 v[64:79], v[24:27], a[208:211], v[64:79]
 v_mfma_f32_32x32x16_bf16 v[80:95], v[24:27], a[212:215], v[80:95]
 ds_read_b128 v[20:23], v12 offset:32
 s_waitcnt lgkmcnt(6)
 v_mfma_f32_32x32x16_bf16 v[64:79], v[28:31], a[216:219], v[64:79]
 v_mfma_f32_32x32x16_bf16 v[80:95], v[28:31], a[220:223], v[80:95]
 ds_read_b128 v[24:27], v12 offset:64
 s_waitcnt lgkmcnt(6)
 v_mfma_f32_32x32x16_bf16 v[64:79], v[32:35], a[224:227], v[64:79]
 v_mfma_f32_32x32x16_bf16 v[80:95], v[32:35], a[228:231], v[80:95]
 ds_read_b128 v[28:31], v12 offset:96
 s_waitcnt lgkmcnt(6)
 v_mfma_f32_32x32x16_bf16 v[64:79], v[36:39], a[232:235], v[64:79]
 v_mfma_f32_32x32x16_bf16 v[80:95], v[36:39], a[236:239], v[80:95]
 ds_read_b128 v[32:35], v12 offset:128
 s_waitcnt lgkmcnt(6)
 v_mfma_f32_32x32x16_bf16 v[64:79], v[40:43], a[240:243], v[64:79]
 v_mfma_f32_32x32x16_bf16 v[80:95], v[40:43], a[244:247], v[80:95]
 s_mov_b32 s90, 1
 s_mov_b32 s91, s80
 s_mov_b32 s69, s101
 ds_read_b128 v[36:39], v12 offset:160
 s_waitcnt lgkmcnt(6)
 v_mfma_f32_32x32x16_bf16 v[64:79], v[44:47], a[248:251], v[64:79]
 v_mfma_f32_32x32x16_bf16 v[80:95], v[44:47], a[252:255], v[80:95]
 v_readfirstlane_b32 s94, v61
 s_cmp_eq_u32 s68, 0
 s_cbranch_scc1 kvb_run1
 s_mov_b32 s90, 2
 s_nop 7
 v_cvt_pk_bf16_f32 v128, v64, v65
 v_cvt_pk_bf16_f32 v129, v66, v67
 v_cvt_pk_bf16_f32 v130, v68, v69
 v_cvt_pk_bf16_f32 v131, v70, v71
 buffer_store_dwordx4 v[128:131], v2, s[52:55], s80 offen offset:0 sc1
 v_cvt_pk_bf16_f32 v132, v72, v73
 v_cvt_pk_bf16_f32 v133, v74, v75
 v_cvt_pk_bf16_f32 v134, v76, v77
 v_cvt_pk_bf16_f32 v135, v78, v79
 buffer_store_dwordx4 v[132:135], v2, s[52:55], s80 offen offset:1024 sc1
 v_cvt_pk_bf16_f32 v136, v80, v81
 v_cvt_pk_bf16_f32 v137, v82, v83
 v_cvt_pk_bf16_f32 v138, v84, v85
 v_cvt_pk_bf16_f32 v139, v86, v87
 buffer_store_dwordx4 v[136:139], v2, s[52:55], s80 offen offset:2048 sc1
 v_cvt_pk_bf16_f32 v140, v88, v89
 v_cvt_pk_bf16_f32 v141, v90, v91
 v_cvt_pk_bf16_f32 v142, v92, v93
 v_cvt_pk_bf16_f32 v143, v94, v95
 buffer_store_dwordx4 v[140:143], v2, s[52:55], s80 offen offset:3072 sc1
 s_branch kvb_run1
kvb_plain0:
 ds_read_b128 v[40:43], v3 offset:192
 s_waitcnt lgkmcnt(6)
 v_mfma_f32_32x32x16_bf16 v[64:79], v[16:19], a[0:3], 0
 s_mov_b32 s68, s4
 s_mov_b32 s67, s5
 s_mul_i32 s80, s68, 16777216
 s_add_u32 s80, s80, 6012928
 v_mfma_f32_32x32x16_bf16 v[80:95], v[16:19], a[4:7], 0
 s_lshl_b32 s70, s67, 18
 s_add_u32 s80, s80, s70
 s_add_u32 s80, s80, s82
 s_mul_i32 s101, s68, 65
 ds_read_b128 v[44:47], v3 offset:224
 s_waitcnt lgkmcnt(6)
 v_mfma_f32_32x32x16_bf16 v[64:79], v[20:23], a[8:11], v[64:79]
 s_add_u32 s101, s101, s67
 s_lshl_b32 s101, s101, 11
 s_add_u32 s101, s101, 204800
 s_add_u32 s101, s101, s98
 s_barrier
 v_mfma_f32_32x32x16_bf16 v[80:95], v[20:23], a[12:15], v[80:95]
 ds_read_b128 v[16:19], v3 offset:256
 s_waitcnt lgkmcnt(6)
 v_mfma_f32_32x32x16_bf16 v[64:79], v[24:27], a[16:19], v[64:79]
 v_mfma_f32_32x32x16_bf16 v[80:95], v[24:27], a[20:23], v[80:95]
 ds_read_b128 v[20:23], v3 offset:288
 s_waitcnt lgkmcnt(6)
 v_mfma_f32_32x32x16_bf16 v[64:79], v[28:31], a[24:27], v[64:79]
 v_mfma_f32_32x32x16_bf16 v[80:95], v[28:31], a[28:31], v[80:95]
 ds_read_b128 v[24:27], v3 offset:320
 s_waitcnt lgkmcnt(6)
 v_mfma_f32_32x32x16_bf16 v[64:79], v[32:35], a[32:35], v[64:79]
 v_mfma_f32_32x32x16_bf16 v[80:95], v[32:35], a[36:39], v[80:95]
 ds_read_b128 v[28:31], v3 offset:352
 s_waitcnt lgkmcnt(6)
 v_mfma_f32_32x32x16_bf16 v[64:79], v[36:39], a[40:43], v[64:79]
 v_mfma_f32_32x32x16_bf16 v[80:95], v[36:39], a[44:47], v[80:95]
 ds_read_b128 v[32:35], v3 offset:384
 s_waitcnt lgkmcnt(6)
 v_mfma_f32_32x32x16_bf16 v[64:79], v[40:43], a[48:51], v[64:79]
 v_mfma_f32_32x32x16_bf16 v[80:95], v[40:43], a[52:55], v[80:95]
 ds_read_b128 v[36:39], v3 offset:416
 s_waitcnt lgkmcnt(6)
 v_mfma_f32_32x32x16_bf16 v[64:79], v[44:47], a[56:59], v[64:79]
 v_mfma_f32_32x32x16_bf16 v[80:95], v[44:47], a[60:63], v[80:95]
 ds_read_b128 v[40:43], v3 offset:448
 s_waitcnt lgkmcnt(6)
 v_mfma_f32_32x32x16_bf16 v[64:79], v[16:19], a[64:67], v[64:79]
 v_mfma_f32_32x32x16_bf16 v[80:95], v[16:19], a[68:71], v[80:95]
 ds_read_b128 v[44:47], v3 offset:480
 s_waitcnt lgkmcnt(6)
 v_mfma_f32_32x32x16_bf16 v[64:79], v[20:23], a[72:75], v[64:79]
 v_mfma_f32_32x32x16_bf16 v[80:95], v[20:23], a[76:79], v[80:95]
 ds_read_b128 v[16:19], v3 offset:512
 s_waitcnt lgkmcnt(6)
 v_mfma_f32_32x32x16_bf16 v[64:79], v[24:27], a[80:83], v[64:79]
 v_mfma_f32_32x32x16_bf16 v[80:95], v[24:27], a[84:87], v[80:95]
 ds_read_b128 v[20:23], v3 offset:544
 s_waitcnt lgkmcnt(6)
 v_mfma_f32_32x32x16_bf16 v[64:79], v[28:31], a[88:91], v[64:79]
 v_mfma_f32_32x32x16_bf16 v[80:95], v[28:31], a[92:95], v[80:95]
 ds_read_b128 v[24:27], v3 offset:576
 s_waitcnt lgkmcnt(6)
 v_mfma_f32_32x32x16_bf16 v[64:79], v[32:35], a[96:99], v[64:79]
 v_mfma_f32_32x32x16_bf16 v[80:95], v[32:35], a[100:103], v[80:95]
 ds_read_b128 v[28:31], v3 offset:608
 s_waitcnt lgkmcnt(6)
 v_mfma_f32_32x32x16_bf16 v[64:79], v[36:39], a[104:107], v[64:79]
 v_mfma_f32_32x32x16_bf16 v[80:95], v[36:39], a[108:111], v[80:95]
 ds_read_b128 v[32:35], v3 offset:640
 s_waitcnt lgkmcnt(6)
 v_mfma_f32_32x32x16_bf16 v[64:79], v[40:43], a[112:115], v[64:79]
 s_cmp_lg_u32 s3, 0
 s_cbranch_scc1 w0_101
 s_min_u32 s70, s6, 63
 s_min_u32 s71, s7, 63
 s_lshl_b32 s70, s70, 8
 s_lshl_b32 s71, s71, 8
 v_add_u32 v15, s70, v56
 s_mov_b32 exec_lo, 0
 v_add_u32 v15, s71, v56
 s_mov_b32 exec_lo, s87
 s_mov_b32 exec_hi, s87
 buffer_load_dwordx2 v[62:63], v15, s[52:55], 0 offen sc1
 s_mov_b64 exec, -1
w0_101:
 v_mfma_f32_32x32x16_bf16 v[80:95], v[40:43], a[116:119], v[80:95]
 ds_read_b128 v[36:39], v3 offset:672
 s_waitcnt lgkmcnt(6)
 v_mfma_f32_32x32x16_bf16 v[64:79], v[44:47], a[120:123], v[64:79]
 v_mfma_f32_32x32x16_bf16 v[80:95], v[44:47], a[124:127], v[80:95]
 ds_read_b128 v[40:43], v3 offset:704
 s_waitcnt lgkmcnt(6)
 v_mfma_f32_32x32x16_bf16 v[64:79], v[16:19], a[128:131], v[64:79]
 v_mfma_f32_32x32x16_bf16 v[80:95], v[16:19], a[132:135], v[80:95]
 ds_read_b128 v[44:47], v3 offset:736
 s_waitcnt lgkmcnt(6)
 v_mfma_f32_32x32x16_bf16 v[64:79], v[20:23], a[136:139], v[64:79]
 v_mfma_f32_32x32x16_bf16 v[80:95], v[20:23], a[140:143], v[80:95]
 ds_read_b128 v[16:19], v3 offset:768
 s_waitcnt lgkmcnt(6)
 v_mfma_f32_32x32x16_bf16 v[64:79], v[24:27], a[144:147], v[64:79]
 v_mfma_f32_32x32x16_bf16 v[80:95], v[24:27], a[148:151], v[80:95]
 ds_read_b128 v[20:23], v3 offset:800
 s_waitcnt lgkmcnt(6)
 v_mfma_f32_32x32x16_bf16 v[64:79], v[28:31], a[152:155], v[64:79]
 v_mfma_f32_32x32x16_bf16 v[80:95], v[28:31], a[156:159], v[80:95]
 ds_read_b128 v[24:27], v3 offset:832
 s_waitcnt lgkmcnt(6)
 v_mfma_f32_32x32x16_bf16 v[64:79], v[32:35], a[160:163], v[64:79]
 v_mfma_f32_32x32x16_bf16 v[80:95], v[32:35], a[164:167], v[80:95]
 ds_read_b128 v[28:31], v3 offset:864
 s_waitcnt lgkmcnt(6)
 v_mfma_f32_32x32x16_bf16 v[64:79], v[36:39], a[168:171], v[64:79]
 v_mfma_f32_32x32x16_bf16 v[80:95], v[36:39], a[172:175], v[80:95]
 ds_read_b128 v[32:35], v3 offset:896
 s_waitcnt lgkmcnt(6)
 v_mfma_f32_32x32x16_bf16 v[64:79], v[40:43], a[176:179], v[64:79]
 s_cmp_lg_u32 s3, 0
 s_cbranch_scc1 w0_102
 s_waitcnt vmcnt(0)
 v_cmp_ge_u32 s[72:73], v62, v57
 v_cmp_ge_u32 s[74:75], v63, v58
 s_and_b64 s[72:73], s[72:73], s[74:75]
 s_mov_b32 s70, 2
 s_cmp_lt_u32 s6, 64
 s_cselect_b32 s71, s72, 0
 s_cmp_eq_u32 s71, -1
 s_cselect_b32 s70, 0, s70
 s_cmp_lt_u32 s7, 64
 s_cselect_b32 s71, s73, 0
 s_cmp_eq_u32 s71, -1
 s_cselect_b32 s70, 1, s70
 v_mov_b32 v5, s70
 v_mov_b32 v6, s95
 ds_write_b32 v6, v5
w0_102:
 v_mfma_f32_32x32x16_bf16 v[80:95], v[40:43], a[180:183], v[80:95]
 ds_read_b128 v[36:39], v3 offset:928
 s_waitcnt lgkmcnt(6)
 v_mfma_f32_32x32x16_bf16 v[64:79], v[44:47], a[184:187], v[64:79]
 v_mfma_f32_32x32x16_bf16 v[80:95], v[44:47], a[188:191], v[80:95]
 ds_read_b128 v[40:43], v3 offset:960
 s_waitcnt lgkmcnt(6)
 v_mfma_f32_32x32x16_bf16 v[64:79], v[16:19], a[192:195], v[64:79]
 v_mov_b32 v6, s95
 s_waitcnt lgkmcnt(2)
 s_barrier
 ds_read_b32 v61, v6
 s_xor_b32 s95, s95, 4
 v_mfma_f32_32x32x16_bf16 v[80:95], v[16:19], a[196:199], v[80:95]
 ds_read_b128 v[44:47], v3 offset:992
 s_waitcnt lgkmcnt(6)
 v_mfma_f32_32x32x16_bf16 v[64:79], v[20:23], a[200:203], v[64:79]
 v_mfma_f32_32x32x16_bf16 v[80:95], v[20:23], a[204:207], v[80:95]
kvb_tail0:
 s_waitcnt lgkmcnt(5)
 v_mfma_f32_32x32x16_bf16 v[64:79], v[24:27], a[208:211], v[64:79]
 v_mfma_f32_32x32x16_bf16 v[80:95], v[24:27], a[212:215], v[80:95]
 s_waitcnt lgkmcnt(4)
 v_mfma_f32_32x32x16_bf16 v[64:79], v[28:31], a[216:219], v[64:79]
 v_mfma_f32_32x32x16_bf16 v[80:95], v[28:31], a[220:223], v[80:95]
 s_waitcnt lgkmcnt(3)
 v_mfma_f32_32x32x16_bf16 v[64:79], v[32:35], a[224:227], v[64:79]
 v_mfma_f32_32x32x16_bf16 v[80:95], v[32:35], a[228:231], v[80:95]
 s_waitcnt lgkmcnt(2)
 v_mfma_f32_32x32x16_bf16 v[64:79], v[36:39], a[232:235], v[64:79]
 v_mfma_f32_32x32x16_bf16 v[80:95], v[36:39], a[236:239], v[80:95]
 s_waitcnt lgkmcnt(1)
 v_mfma_f32_32x32x16_bf16 v[64:79], v[40:43], a[240:243], v[64:79]
 v_mfma_f32_32x32x16_bf16 v[80:95], v[40:43], a[244:247], v[80:95]
 s_waitcnt lgkmcnt(0)
 v_mfma_f32_32x32x16_bf16 v[64:79], v[44:47], a[248:251], v[64:79]
 v_mfma_f32_32x32x16_bf16 v[80:95], v[44:47], a[252:255], v[80:95]
 v_readfirstlane_b32 s94, v61
 s_mov_b32 s88, s6
 s_mov_b32 s89, s7
 s_add_u32 s70, s88, 2
 s_cmp_lt_u32 s70, 56
 s_cselect_b32 s70, s70, s65
 s_add_u32 s71, s88, 1
 s_cmp_lt_u32 s88, 56
 s_cselect_b32 s88, s70, s71
 s_add_u32 s89, s89, 1
 s_and_b32 s4, s94, 1
 s_cmp_eq_u32 s94, 0
 s_cselect_b32 s5, s6, s7
 s_cselect_b32 s6, s88, s6
 s_cmp_eq_u32 s94, 1
 s_cselect_b32 s7, s89, s7
 s_mov_b32 s78, 65536
 s_mul_i32 s81, s4, 2097152
 s_add_u32 s81, s81, 1818624
 s_lshl_b32 s70, s5, 15
 s_add_u32 s81, s81, s70
 s_mul_i32 s96, s3, 8320
 s_add_u32 s96, s96, s78
 s_lshl_b32 s97, s3, 13
 s_add_u32 s97, s97, s81
 s_sub_u32 s97, s97, 1024
 v_cvt_pk_bf16_f32 v128, v64, v65
 v_cvt_pk_bf16_f32 v129, v66, v67
 v_cvt_pk_bf16_f32 v130, v68, v69
 v_cvt_pk_bf16_f32 v131, v70, v71
 buffer_store_dwordx4 v[128:131], v2, s[52:55], s80 offen offset:0 sc1
 v_cvt_pk_bf16_f32 v132, v72, v73
 v_cvt_pk_bf16_f32 v133, v74, v75
 v_cvt_pk_bf16_f32 v134, v76, v77
 v_cvt_pk_bf16_f32 v135, v78, v79
 buffer_store_dwordx4 v[132:135], v2, s[52:55], s80 offen offset:1024 sc1
 v_cvt_pk_bf16_f32 v136, v80, v81
 v_cvt_pk_bf16_f32 v137, v82, v83
 v_cvt_pk_bf16_f32 v138, v84, v85
 v_cvt_pk_bf16_f32 v139, v86, v87
 buffer_store_dwordx4 v[136:139], v2, s[52:55], s80 offen offset:2048 sc1
 v_cvt_pk_bf16_f32 v140, v88, v89
 v_cvt_pk_bf16_f32 v141, v90, v91
 v_cvt_pk_bf16_f32 v142, v92, v93
 v_cvt_pk_bf16_f32 v143, v94, v95
 buffer_store_dwordx4 v[140:143], v2, s[52:55], s80 offen offset:3072 sc1
 s_cmp_ge_u32 s94, 2
 s_cbranch_scc1 kvb_idle0
 s_add_u32 m0, s96, 0
 s_add_u32 s97, s97, 1024
 buffer_load_dwordx4 v2, s[52:55], s97 offen sc1 lds
 s_add_u32 m0, s96, 1040
 s_add_u32 s97, s97, 1024
 buffer_load_dwordx4 v2, s[52:55], s97 offen sc1 lds
 s_add_u32 m0, s96, 2080
 s_add_u32 s97, s97, 1024
 buffer_load_dwordx4 v2, s[52:55], s97 offen sc1 lds
 s_add_u32 m0, s96, 3120
 s_add_u32 s97, s97, 1024
 buffer_load_dwordx4 v2, s[52:55], s97 offen sc1 lds
 s_add_u32 m0, s96, 4160
 s_add_u32 s97, s97, 1024
 buffer_load_dwordx4 v2, s[52:55], s97 offen sc1 lds
 s_add_u32 m0, s96, 5200
 s_add_u32 s97, s97, 1024
 buffer_load_dwordx4 v2, s[52:55], s97 offen sc1 lds
 s_add_u32 m0, s96, 6240
 s_add_u32 s97, s97, 1024
 buffer_load_dwordx4 v2, s[52:55], s97 offen sc1 lds
 s_add_u32 m0, s96, 7280
 s_add_u32 s97, s97, 1024
 buffer_load_dwordx4 v2, s[52:55], s97 offen sc1 lds
 s_waitcnt vmcnt(8)
 s_mov_b64 exec, 1
 buffer_store_dword v0, v10, s[52:55], s101 offen sc1
 s_mov_b64 exec, -1
 s_branch sc_107
kvb_idle0:
 s_mov_b32 s83, 0x200000
 s_cmp_lg_u32 s3, 0
 s_cbranch_scc1 nw_109
 s_min_u32 s70, s6, 63
 s_min_u32 s71, s7, 63
 s_lshl_b32 s70, s70, 8
 s_lshl_b32 s71, s71, 8
 v_add_u32 v15, s70, v56
 s_mov_b32 exec_lo, 0
 v_add_u32 v15, s71, v56
 s_mov_b32 exec_lo, s87
 s_mov_b32 exec_hi, s87
 buffer_load_dwordx2 v[62:63], v15, s[52:55], 0 offen sc1
 s_mov_b64 exec, -1
 s_waitcnt vmcnt(1)
 s_mov_b64 exec, 1
 buffer_store_dword v0, v10, s[52:55], s101 offen sc1
 s_mov_b64 exec, -1
 s_min_u32 s70, s6, s7
 s_cmp_ge_u32 s70, 64
 s_cbranch_scc1 kv_exit
 s_waitcnt vmcnt(1)
 s_branch ev_108
nw_109:
 s_waitcnt vmcnt(0)
 s_mov_b64 exec, 1
 buffer_store_dword v0, v10, s[52:55], s101 offen sc1
 s_mov_b64 exec, -1
kvb_sched1:
 s_min_u32 s70, s6, s7
 s_cmp_ge_u32 s70, 64
 s_cbranch_scc1 kv_exit
 s_cmp_lg_u32 s3, 0
 s_cbranch_scc1 sc_103
 s_mov_b32 s83, 0x200000
sc_104:
 s_min_u32 s70, s6, 63
 s_min_u32 s71, s7, 63
 s_lshl_b32 s70, s70, 8
 s_lshl_b32 s71, s71, 8
 v_add_u32 v15, s70, v56
 s_mov_b32 exec_lo, 0
 v_add_u32 v15, s71, v56
 s_mov_b32 exec_lo, s87
 s_mov_b32 exec_hi, s87
 buffer_load_dwordx2 v[62:63], v15, s[52:55], 0 offen sc1
 s_mov_b64 exec, -1
 s_waitcnt vmcnt(0)
ev_108:
 v_cmp_ge_u32 s[72:73], v62, v57
 v_cmp_ge_u32 s[74:75], v63, v58
 s_and_b64 s[72:73], s[72:73], s[74:75]
 s_mov_b32 s70, 2
 s_cmp_lt_u32 s6, 64
 s_cselect_b32 s71, s72, 0
 s_cmp_eq_u32 s71, -1
 s_cselect_b32 s70, 0, s70
 s_cmp_lt_u32 s7, 64
 s_cselect_b32 s71, s73, 0
 s_cmp_eq_u32 s71, -1
 s_cselect_b32 s70, 1, s70
 s_cmp_lt_u32 s70, 2
 s_cbranch_scc1 sc_105
 s_sub_u32 s83, s83, 1
 s_cmp_lg_u32 s83, 0
 s_cbranch_scc1 sc_104
 s_mov_b32 s70, 3
sc_105:
 v_mov_b32 v5, s70
 v_mov_b32 v6, 163832
 ds_write_b32 v6, v5
 s_waitcnt lgkmcnt(0)
sc_103:
 s_barrier
 v_mov_b32 v6, 163832
 ds_read_b32 v61, v6
 s_waitcnt lgkmcnt(0)
 v_readfirstlane_b32 s94, v61
 s_cmp_ge_u32 s94, 2
 s_cbranch_scc1 k_exit
 s_mov_b32 s88, s6
 s_mov_b32 s89, s7
 s_add_u32 s70, s88, 2
 s_cmp_lt_u32 s70, 56
 s_cselect_b32 s70, s70, s65
 s_add_u32 s71, s88, 1
 s_cmp_lt_u32 s88, 56
 s_cselect_b32 s88, s70, s71
 s_add_u32 s89, s89, 1
 s_and_b32 s4, s94, 1
 s_cmp_eq_u32 s94, 0
 s_cselect_b32 s5, s6, s7
 s_cselect_b32 s6, s88, s6
 s_cmp_eq_u32 s94, 1
 s_cselect_b32 s7, s89, s7
 s_mov_b32 s78, 65536
 s_mul_i32 s81, s4, 2097152
 s_add_u32 s81, s81, 1818624
 s_lshl_b32 s70, s5, 15
 s_add_u32 s81, s81, s70
 s_mul_i32 s96, s3, 8320
 s_add_u32 s96, s96, s78
 s_lshl_b32 s97, s3, 13
 s_add_u32 s97, s97, s81
 s_sub_u32 s97, s97, 1024
 s_add_u32 m0, s96, 0
 s_add_u32 s97, s97, 1024
 buffer_load_dwordx4 v2, s[52:55], s97 offen sc1 lds
 s_add_u32 m0, s96, 1040
 s_add_u32 s97, s97, 1024
 buffer_load_dwordx4 v2, s[52:55], s97 offen sc1 lds
 s_add_u32 m0, s96, 2080
 s_add_u32 s97, s97, 1024
 buffer_load_dwordx4 v2, s[52:55], s97 offen sc1 lds
 s_add_u32 m0, s96, 3120
 s_add_u32 s97, s97, 1024
 buffer_load_dwordx4 v2, s[52:55], s97 offen sc1 lds
 s_add_u32 m0, s96, 4160
 s_add_u32 s97, s97, 1024
 buffer_load_dwordx4 v2, s[52:55], s97 offen sc1 lds
 s_add_u32 m0, s96, 5200
 s_add_u32 s97, s97, 1024
 buffer_load_dwordx4 v2, s[52:55], s97 offen sc1 lds
 s_add_u32 m0, s96, 6240
 s_add_u32 s97, s97, 1024
 buffer_load_dwordx4 v2, s[52:55], s97 offen sc1 lds
 s_add_u32 m0, s96, 7280
 s_add_u32 s97, s97, 1024
 buffer_load_dwordx4 v2, s[52:55], s97 offen sc1 lds
sc_107:
 s_cmp_lg_u32 s3, 0
 s_cbranch_scc1 sc_106
 s_min_u32 s70, s6, 63
 s_min_u32 s71, s7, 63
 s_lshl_b32 s70, s70, 8
 s_lshl_b32 s71, s71, 8
 v_add_u32 v15, s70, v56
 s_mov_b32 exec_lo, 0
 v_add_u32 v15, s71, v56
 s_mov_b32 exec_lo, s87
 s_mov_b32 exec_hi, s87
 buffer_load_dwordx2 v[62:63], v15, s[52:55], 0 offen sc1
 s_mov_b64 exec, -1
 s_waitcnt vmcnt(0)
 v_cmp_ge_u32 s[72:73], v62, v57
 v_cmp_ge_u32 s[74:75], v63, v58
 s_and_b64 s[72:73], s[72:73], s[74:75]
 s_mov_b32 s70, 2
 s_cmp_lt_u32 s6, 64
 s_cselect_b32 s71, s72, 0
 s_cmp_eq_u32 s71, -1
 s_cselect_b32 s70, 0, s70
 s_cmp_lt_u32 s7, 64
 s_cselect_b32 s71, s73, 0
 s_cmp_eq_u32 s71, -1
 s_cselect_b32 s70, 1, s70
 v_mov_b32 v5, s70
 v_mov_b32 v6, s95
 ds_write_b32 v6, v5
 s_waitcnt lgkmcnt(0)
sc_106:
 s_waitcnt vmcnt(0)
 v_mov_b32 v6, s95
 s_barrier
 ds_read_b32 v61, v6
 s_xor_b32 s95, s95, 4
 s_waitcnt lgkmcnt(0)
 v_readfirstlane_b32 s94, v61
 s_branch kvb_pro1
kvb_pro1:
 s_mov_b32 s90, 0
 ds_read_b128 v[16:19], v12 offset:0
 ds_read_b128 v[20:23], v12 offset:32
 ds_read_b128 v[24:27], v12 offset:64
 ds_read_b128 v[28:31], v12 offset:96
 ds_read_b128 v[32:35], v12 offset:128
 ds_read_b128 v[36:39], v12 offset:160
 s_cmp_ge_u32 s94, 2
 s_cbranch_scc1 kvb_plain1
kvb_run1:
 s_cmp_lt_u32 s94, 2
 s_cselect_b64 vcc, -1, 0
 ds_read_b128 v[40:43], v12 offset:192
 s_waitcnt lgkmcnt(6)
 v_mfma_f32_32x32x16_bf16 v[96:111], v[16:19], a[0:3], 0
 s_mov_b32 s68, s4
 s_mov_b32 s67, s5
 s_mov_b32 s88, s6
 s_mov_b32 s89, s7
 v_mfma_f32_32x32x16_bf16 v[112:127], v[16:19], a[4:7], 0
 s_add_u32 s70, s88, 2
 s_cmp_lt_u32 s70, 56
 s_cselect_b32 s70, s70, s65
 s_add_u32 s71, s88, 1
 ds_read_b128 v[44:47], v12 offset:224
 s_waitcnt lgkmcnt(6)
 v_mfma_f32_32x32x16_bf16 v[96:111], v[20:23], a[8:11], v[96:111]
 s_cmp_lt_u32 s88, 56
 s_cselect_b32 s88, s70, s71
 s_add_u32 s89, s89, 1
 s_and_b32 s4, s94, 1
 s_barrier
 v_mfma_f32_32x32x16_bf16 v[112:127], v[20:23], a[12:15], v[112:127]
 s_cmp_eq_u32 s94, 0
 s_cselect_b32 s5, s6, s7
 s_cselect_b32 s6, s88, s6
 s_cmp_eq_u32 s94, 1
 s_cselect_b32 s7, s89, s7
 ds_read_b128 v[16:19], v12 offset:256
 s_waitcnt lgkmcnt(6)
 v_mfma_f32_32x32x16_bf16 v[96:111], v[24:27], a[16:19], v[96:111]
 s_mov_b32 s78, 0
 s_mul_i32 s81, s4, 2097152
 s_add_u32 s81, s81, 1818624
 s_lshl_b32 s70, s5, 15
 s_bitcmp1_b32 s90, 0
 s_cbranch_scc0 g_110
 v_cvt_pk_bf16_f32 v128, v64, v65
 v_cvt_pk_bf16_f32 v129, v66, v67
 v_cvt_pk_bf16_f32 v130, v68, v69
 v_cvt_pk_bf16_f32 v131, v70, v71
 buffer_store_dwordx4 v[128:131], v2, s[52:55], s91 offen offset:0 sc1
g_110:
 v_mfma_f32_32x32x16_bf16 v[112:127], v[24:27], a[20:23], v[112:127]
 s_add_u32 s81, s81, s70
 s_mul_i32 s96, s3, 8320
 s_add_u32 s96, s96, s78
 s_lshl_b32 s97, s3, 13
 ds_read_b128 v[20:23], v12 offset:288
 s_waitcnt lgkmcnt(6)
 v_mfma_f32_32x32x16_bf16 v[96:111], v[28:31], a[24:27], v[96:111]
 s_add_u32 s97, s97, s81
 s_sub_u32 s97, s97, 1024
 s_bitcmp1_b32 s90, 0
 s_cbranch_scc0 g_111
 v_cvt_pk_bf16_f32 v132, v72, v73
 v_cvt_pk_bf16_f32 v133, v74, v75
 v_cvt_pk_bf16_f32 v134, v76, v77
 v_cvt_pk_bf16_f32 v135, v78, v79
 buffer_store_dwordx4 v[132:135], v2, s[52:55], s91 offen offset:1024 sc1
g_111:
 v_mfma_f32_32x32x16_bf16 v[112:127], v[28:31], a[28:31], v[112:127]
 s_cbranch_vccz g_112
 s_add_u32 m0, s96, 0
 s_add_u32 s97, s97, 1024
 buffer_load_dwordx4 v2, s[52:55], s97 offen sc1 lds
g_112:
 ds_read_b128 v[24:27], v12 offset:320
 s_waitcnt lgkmcnt(6)
 v_mfma_f32_32x32x16_bf16 v[96:111], v[32:35], a[32:35], v[96:111]
 s_bitcmp1_b32 s90, 0
 s_cbranch_scc0 g_113
 v_cvt_pk_bf16_f32 v136, v80, v81
 v_cvt_pk_bf16_f32 v137, v82, v83
 v_cvt_pk_bf16_f32 v138, v84, v85
 v_cvt_pk_bf16_f32 v139, v86, v87
 buffer_store_dwordx4 v[136:139], v2, s[52:55], s91 offen offset:2048 sc1
g_113:
 v_mfma_f32_32x32x16_bf16 v[112:127], v[32:35], a[36:39], v[112:127]
 s_cbranch_vccz g_114
 s_add_u32 m0, s96, 1040
 s_add_u32 s97, s97, 1024
 buffer_load_dwordx4 v2, s[52:55], s97 offen sc1 lds
g_114:
 ds_read_b128 v[28:31], v12 offset:352
 s_waitcnt lgkmcnt(6)
 v_mfma_f32_32x32x16_bf16 v[96:111], v[36:39], a[40:43], v[96:111]
 s_bitcmp1_b32 s90, 0
 s_cbranch_scc0 g_115
 v_cvt_pk_bf16_f32 v140, v88, v89
 v_cvt_pk_bf16_f32 v141, v90, v91
 v_cvt_pk_bf16_f32 v142, v92, v93
 v_cvt_pk_bf16_f32 v143, v94, v95
 buffer_store_dwordx4 v[140:143], v2, s[52:55], s91 offen offset:3072 sc1
g_115:
 v_mfma_f32_32x32x16_bf16 v[112:127], v[36:39], a[44:47], v[112:127]
 s_cbranch_vccz g_116
 s_add_u32 m0, s96, 2080
 s_add_u32 s97, s97, 1024
 buffer_load_dwordx4 v2, s[52:55], s97 offen sc1 lds
g_116:
 ds_read_b128 v[32:35], v12 offset:384
 s_waitcnt lgkmcnt(6)
 v_mfma_f32_32x32x16_bf16 v[96:111], v[40:43], a[48:51], v[96:111]
 s_cbranch_vccz g_117
 s_add_u32 m0, s96, 3120
 s_add_u32 s97, s97, 1024
 buffer_load_dwordx4 v2, s[52:55], s97 offen sc1 lds
g_117:
 v_mfma_f32_32x32x16_bf16 v[112:127], v[40:43], a[52:55], v[112:127]
 s_cbranch_vccz g_118
 s_add_u32 m0, s96, 4160
 s_add_u32 s97, s97, 1024
 buffer_load_dwordx4 v2, s[52:55], s97 offen sc1 lds
g_118:
 ds_read_b128 v[36:39], v12 offset:416
 s_waitcnt lgkmcnt(6)
 v_mfma_f32_32x32x16_bf16 v[96:111], v[44:47], a[56:59], v[96:111]
 s_cbranch_vccz g_119
 s_add_u32 m0, s96, 5200
 s_add_u32 s97, s97, 1024
 buffer_load_dwordx4 v2, s[52:55], s97 offen sc1 lds
g_119:
 v_mfma_f32_32x32x16_bf16 v[112:127], v[44:47], a[60:63], v[112:127]
 s_cbranch_vccz g_120
 s_add_u32 m0, s96, 6240
 s_add_u32 s97, s97, 1024
 buffer_load_dwordx4 v2, s[52:55], s97 offen sc1 lds
g_120:
 ds_read_b128 v[40:43], v12 offset:448
 s_waitcnt lgkmcnt(6)
 v_mfma_f32_32x32x16_bf16 v[96:111], v[16:19], a[64:67], v[96:111]
 s_cbranch_vccz g_121
 s_add_u32 m0, s96, 7280
 s_add_u32 s97, s97, 1024
 buffer_load_dwordx4 v2, s[52:55], s97 offen sc1 lds
g_121:
 v_mfma_f32_32x32x16_bf16 v[112:127], v[16:19], a[68:71], v[112:127]
 s_mul_i32 s80, s68, 16777216
 s_add_u32 s80, s80, 6012928
 s_lshl_b32 s70, s67, 18
 s_add_u32 s80, s80, s70
 ds_read_b128 v[44:47], v12 offset:480
 s_waitcnt lgkmcnt(6)
 v_mfma_f32_32x32x16_bf16 v[96:111], v[20:23], a[72:75], v[96:111]
 s_bitcmp1_b32 s90, 1
 s_cbranch_scc0 es_122
 s_cbranch_vccz es_123
 s_waitcnt vmcnt(8)
 s_branch es_124
es_123:
 s_waitcnt vmcnt(0)
es_124:
 s_mov_b64 exec, 1
 buffer_store_dword v0, v10, s[52:55], s69 offen sc1
 s_mov_b64 exec, -1
es_122:
 s_add_u32 s80, s80, s82
 s_mul_i32 s101, s68, 65
 s_add_u32 s101, s101, s67
 s_lshl_b32 s101, s101, 11
 v_mfma_f32_32x32x16_bf16 v[112:127], v[20:23], a[76:79], v[112:127]
 s_add_u32 s101, s101, 204800
 s_add_u32 s101, s101, s98
 ds_read_b128 v[16:19], v12 offset:512
 s_waitcnt lgkmcnt(6)
 v_mfma_f32_32x32x16_bf16 v[96:111], v[24:27], a[80:83], v[96:111]
 s_cmp_lg_u32 s3, 0
 s_cbranch_scc1 w0_125
 s_min_u32 s70, s6, 63
 s_min_u32 s71, s7, 63
 s_lshl_b32 s70, s70, 8
 s_lshl_b32 s71, s71, 8
 v_add_u32 v15, s70, v56
 s_mov_b32 exec_lo, 0
 v_add_u32 v15, s71, v56
 s_mov_b32 exec_lo, s87
 s_mov_b32 exec_hi, s87
 buffer_load_dwordx2 v[62:63], v15, s[52:55], 0 offen sc1
 s_mov_b64 exec, -1
w0_125:
 v_mfma_f32_32x32x16_bf16 v[112:127], v[24:27], a[84:87], v[112:127]
 ds_read_b128 v[20:23], v12 offset:544
 s_waitcnt lgkmcnt(6)
 v_mfma_f32_32x32x16_bf16 v[96:111], v[28:31], a[88:91], v[96:111]
 v_mfma_f32_32x32x16_bf16 v[112:127], v[28:31], a[92:95], v[112:127]
 ds_read_b128 v[24:27], v12 offset:576
 s_waitcnt lgkmcnt(6)
 v_mfma_f32_32x32x16_bf16 v[96:111], v[32:35], a[96:99], v[96:111]
 v_mfma_f32_32x32x16_bf16 v[112:127], v[32:35], a[100:103], v[112:127]
 ds_read_b128 v[28:31], v12 offset:608
 s_waitcnt lgkmcnt(6)
 v_mfma_f32_32x32x16_bf16 v[96:111], v[36:39], a[104:107], v[96:111]
 v_mfma_f32_32x32x16_bf16 v[112:127], v[36:39], a[108:111], v[112:127]
 ds_read_b128 v[32:35], v12 offset:640
 s_waitcnt lgkmcnt(6)
 v_mfma_f32_32x32x16_bf16 v[96:111], v[40:43], a[112:115], v[96:111]
 v_mfma_f32_32x32x16_bf16 v[112:127], v[40:43], a[116:119], v[112:127]
 ds_read_b128 v[36:39], v12 offset:672
 s_waitcnt lgkmcnt(6)
 v_mfma_f32_32x32x16_bf16 v[96:111], v[44:47], a[120:123], v[96:111]
 v_mfma_f32_32x32x16_bf16 v[112:127], v[44:47], a[124:127], v[112:127]
 ds_read_b128 v[40:43], v12 offset:704
 s_waitcnt lgkmcnt(6)
 v_mfma_f32_32x32x16_bf16 v[96:111], v[16:19], a[128:131], v[96:111]
 v_mfma_f32_32x32x16_bf16 v[112:127], v[16:19], a[132:135], v[112:127]
 ds_read_b128 v[44:47], v12 offset:736
 s_waitcnt lgkmcnt(6)
 v_mfma_f32_32x32x16_bf16 v[96:111], v[20:23], a[136:139], v[96:111]
 v_mfma_f32_32x32x16_bf16 v[112:127], v[20:23], a[140:143], v[112:127]
 ds_read_b128 v[16:19], v12 offset:768
 s_waitcnt lgkmcnt(6)
 v_mfma_f32_32x32x16_bf16 v[96:111], v[24:27], a[144:147], v[96:111]
 v_mfma_f32_32x32x16_bf16 v[112:127], v[24:27], a[148:151], v[112:127]
 ds_read_b128 v[20:23], v12 offset:800
 s_waitcnt lgkmcnt(6)
 v_mfma_f32_32x32x16_bf16 v[96:111], v[28:31], a[152:155], v[96:111]
 v_mfma_f32_32x32x16_bf16 v[112:127], v[28:31], a[156:159], v[112:127]
 ds_read_b128 v[24:27], v12 offset:832
 s_waitcnt lgkmcnt(6)
 v_mfma_f32_32x32x16_bf16 v[96:111], v[32:35], a[160:163], v[96:111]
 v_mfma_f32_32x32x16_bf16 v[112:127], v[32:35], a[164:167], v[112:127]
 ds_read_b128 v[28:31], v12 offset:864
 s_waitcnt lgkmcnt(6)
 v_mfma_f32_32x32x16_bf16 v[96:111], v[36:39], a[168:171], v[96:111]
 v_mfma_f32_32x32x16_bf16 v[112:127], v[36:39], a[172:175], v[112:127]
 ds_read_b128 v[32:35], v12 offset:896
 s_waitcnt lgkmcnt(6)
 v_mfma_f32_32x32x16_bf16 v[96:111], v[40:43], a[176:179], v[96:111]
 s_waitcnt vmcnt(0)
 s_bitcmp1_b32 s90, 0
 s_cbranch_scc0 sg_126
 s_mov_b64 exec, 1
 buffer_store_dword v0, v10, s[52:55], s69 offen sc1
 s_mov_b64 exec, -1
sg_126:
 s_cmp_lg_u32 s3, 0
 s_cbranch_scc1 w0_127
 v_cmp_ge_u32 s[72:73], v62, v57
 v_cmp_ge_u32 s[74:75], v63, v58
 s_and_b64 s[72:73], s[72:73], s[74:75]
 s_mov_b32 s70, 2
 s_cmp_lt_u32 s6, 64
 s_cselect_b32 s71, s72, 0
 s_cmp_eq_u32 s71, -1
 s_cselect_b32 s70, 0, s70
 s_cmp_lt_u32 s7, 64
 s_cselect_b32 s71, s73, 0
 s_cmp_eq_u32 s71, -1
 s_cselect_b32 s70, 1, s70
 v_mov_b32 v5, s70
 v_mov_b32 v6, s95
 ds_write_b32 v6, v5
w0_127:
 v_mfma_f32_32x32x16_bf16 v[112:127], v[40:43], a[180:183], v[112:127]
 ds_read_b128 v[36:39], v12 offset:928
 s_waitcnt lgkmcnt(6)
 v_mfma_f32_32x32x16_bf16 v[96:111], v[44:47], a[184:187], v[96:111]
 v_mfma_f32_32x32x16_bf16 v[112:127], v[44:47], a[188:191], v[112:127]
 ds_read_b128 v[40:43], v12 offset:960
 s_waitcnt lgkmcnt(6)
 v_mfma_f32_32x32x16_bf16 v[96:111], v[16:19], a[192:195], v[96:111]
 v_mov_b32 v6, s95
 s_waitcnt lgkmcnt(2)
 s_barrier
 ds_read_b32 v61, v6
 s_xor_b32 s95, s95, 4
 v_mfma_f32_32x32x16_bf16 v[112:127], v[16:19], a[196:199], v[112:127]
 ds_read_b128 v[44:47], v12 offset:992
 s_waitcnt lgkmcnt(6)
 v_mfma_f32_32x32x16_bf16 v[96:111], v[20:23], a[200:203], v[96:111]
 v_mfma_f32_32x32x16_bf16 v[112:127], v[20:23], a[204:207], v[112:127]
 s_cbranch_vccz kvb_tail1
 ds_read_b128 v[16:19], v3 offset:0
 s_waitcnt lgkmcnt(6)
 v_mfma_f32_32x32x16_bf16 v[96:111], v[24:27], a[208:211], v[96:111]
 v_mfma_f32_32x32x16_bf16 v[112:127], v[24:27], a[212:215], v[112:127]
 ds_read_b128 v[20:23], v3 offset:32
 s_waitcnt lgkmcnt(6)
 v_mfma_f32_32x32x16_bf16 v[96:111], v[28:31], a[216:219], v[96:111]
 v_mfma_f32_32x32x16_bf16 v[112:127], v[28:31], a[220:223], v[112:127]
 ds_read_b128 v[24:27], v3 offset:64
 s_waitcnt lgkmcnt(6)
 v_mfma_f32_32x32x16_bf16 v[96:111], v[32:35], a[224:227], v[96:111]
 v_mfma_f32_32x32x16_bf16 v[112:127], v[32:35], a[228:231], v[112:127]
 ds_read_b128 v[28:31], v3 offset:96
 s_waitcnt lgkmcnt(6)
 v_mfma_f32_32x32x16_bf16 v[96:111], v[36:39], a[232:235], v[96:111]
 v_mfma_f32_32x32x16_bf16 v[112:127], v[36:39], a[236:239], v[112:127]
 ds_read_b128 v[32:35], v3 offset:128
 s_waitcnt lgkmcnt(6)
 v_mfma_f32_32x32x16_bf16 v[96:111], v[40:43], a[240:243], v[96:111]
 v_mfma_f32_32x32x16_bf16 v[112:127], v[40:43], a[244:247], v[112:127]
 s_mov_b32 s90, 1
 s_mov_b32 s91, s80
 s_mov_b32 s69, s101
 ds_read_b128 v[36:39], v3 offset:160
 s_waitcnt lgkmcnt(6)
 v_mfma_f32_32x32x16_bf16 v[96:111], v[44:47], a[248:251], v[96:111]
 v_mfma_f32_32x32x16_bf16 v[112:127], v[44:47], a[252:255], v[112:127]
 v_readfirstlane_b32 s94, v61
 s_cmp_eq_u32 s68, 0
 s_cbranch_scc1 kvb_run0
 s_mov_b32 s90, 2
 s_nop 7
 v_cvt_pk_bf16_f32 v128, v96, v97
 v_cvt_pk_bf16_f32 v129, v98, v99
 v_cvt_pk_bf16_f32 v130, v100, v101
 v_cvt_pk_bf16_f32 v131, v102, v103
 buffer_store_dwordx4 v[128:131], v2, s[52:55], s80 offen offset:0 sc1
 v_cvt_pk_bf16_f32 v132, v104, v105
 v_cvt_pk_bf16_f32 v133, v106, v107
 v_cvt_pk_bf16_f32 v134, v108, v109
 v_cvt_pk_bf16_f32 v135, v110, v111
 buffer_store_dwordx4 v[132:135], v2, s[52:55], s80 offen offset:1024 sc1
 v_cvt_pk_bf16_f32 v136, v112, v113
 v_cvt_pk_bf16_f32 v137, v114, v115
 v_cvt_pk_bf16_f32 v138, v116, v117
 v_cvt_pk_bf16_f32 v139, v118, v119
 buffer_store_dwordx4 v[136:139], v2, s[52:55], s80 offen offset:2048 sc1
 v_cvt_pk_bf16_f32 v140, v120, v121
 v_cvt_pk_bf16_f32 v141, v122, v123
 v_cvt_pk_bf16_f32 v142, v124, v125
 v_cvt_pk_bf16_f32 v143, v126, v127
 buffer_store_dwordx4 v[140:143], v2, s[52:55], s80 offen offset:3072 sc1
 s_branch kvb_run0
kvb_plain1:
 ds_read_b128 v[40:43], v12 offset:192
 s_waitcnt lgkmcnt(6)
 v_mfma_f32_32x32x16_bf16 v[96:111], v[16:19], a[0:3], 0
 s_mov_b32 s68, s4
 s_mov_b32 s67, s5
 s_mul_i32 s80, s68, 16777216
 s_add_u32 s80, s80, 6012928
 v_mfma_f32_32x32x16_bf16 v[112:127], v[16:19], a[4:7], 0
 s_lshl_b32 s70, s67, 18
 s_add_u32 s80, s80, s70
 s_add_u32 s80, s80, s82
 s_mul_i32 s101, s68, 65
 ds_read_b128 v[44:47], v12 offset:224
 s_waitcnt lgkmcnt(6)
 v_mfma_f32_32x32x16_bf16 v[96:111], v[20:23], a[8:11], v[96:111]
 s_add_u32 s101, s101, s67
 s_lshl_b32 s101, s101, 11
 s_add_u32 s101, s101, 204800
 s_add_u32 s101, s101, s98
 s_barrier
 v_mfma_f32_32x32x16_bf16 v[112:127], v[20:23], a[12:15], v[112:127]
 ds_read_b128 v[16:19], v12 offset:256
 s_waitcnt lgkmcnt(6)
 v_mfma_f32_32x32x16_bf16 v[96:111], v[24:27], a[16:19], v[96:111]
 v_mfma_f32_32x32x16_bf16 v[112:127], v[24:27], a[20:23], v[112:127]
 ds_read_b128 v[20:23], v12 offset:288
 s_waitcnt lgkmcnt(6)
 v_mfma_f32_32x32x16_bf16 v[96:111], v[28:31], a[24:27], v[96:111]
 v_mfma_f32_32x32x16_bf16 v[112:127], v[28:31], a[28:31], v[112:127]
 ds_read_b128 v[24:27], v12 offset:320
 s_waitcnt lgkmcnt(6)
 v_mfma_f32_32x32x16_bf16 v[96:111], v[32:35], a[32:35], v[96:111]
 v_mfma_f32_32x32x16_bf16 v[112:127], v[32:35], a[36:39], v[112:127]
 ds_read_b128 v[28:31], v12 offset:352
 s_waitcnt lgkmcnt(6)
 v_mfma_f32_32x32x16_bf16 v[96:111], v[36:39], a[40:43], v[96:111]
 v_mfma_f32_32x32x16_bf16 v[112:127], v[36:39], a[44:47], v[112:127]
 ds_read_b128 v[32:35], v12 offset:384
 s_waitcnt lgkmcnt(6)
 v_mfma_f32_32x32x16_bf16 v[96:111], v[40:43], a[48:51], v[96:111]
 v_mfma_f32_32x32x16_bf16 v[112:127], v[40:43], a[52:55], v[112:127]
 ds_read_b128 v[36:39], v12 offset:416
 s_waitcnt lgkmcnt(6)
 v_mfma_f32_32x32x16_bf16 v[96:111], v[44:47], a[56:59], v[96:111]
 v_mfma_f32_32x32x16_bf16 v[112:127], v[44:47], a[60:63], v[112:127]
 ds_read_b128 v[40:43], v12 offset:448
 s_waitcnt lgkmcnt(6)
 v_mfma_f32_32x32x16_bf16 v[96:111], v[16:19], a[64:67], v[96:111]
 v_mfma_f32_32x32x16_bf16 v[112:127], v[16:19], a[68:71], v[112:127]
 ds_read_b128 v[44:47], v12 offset:480
 s_waitcnt lgkmcnt(6)
 v_mfma_f32_32x32x16_bf16 v[96:111], v[20:23], a[72:75], v[96:111]
 v_mfma_f32_32x32x16_bf16 v[112:127], v[20:23], a[76:79], v[112:127]
 ds_read_b128 v[16:19], v12 offset:512
 s_waitcnt lgkmcnt(6)
 v_mfma_f32_32x32x16_bf16 v[96:111], v[24:27], a[80:83], v[96:111]
 v_mfma_f32_32x32x16_bf16 v[112:127], v[24:27], a[84:87], v[112:127]
 ds_read_b128 v[20:23], v12 offset:544
 s_waitcnt lgkmcnt(6)
 v_mfma_f32_32x32x16_bf16 v[96:111], v[28:31], a[88:91], v[96:111]
 v_mfma_f32_32x32x16_bf16 v[112:127], v[28:31], a[92:95], v[112:127]
 ds_read_b128 v[24:27], v12 offset:576
 s_waitcnt lgkmcnt(6)
 v_mfma_f32_32x32x16_bf16 v[96:111], v[32:35], a[96:99], v[96:111]
 v_mfma_f32_32x32x16_bf16 v[112:127], v[32:35], a[100:103], v[112:127]
 ds_read_b128 v[28:31], v12 offset:608
 s_waitcnt lgkmcnt(6)
 v_mfma_f32_32x32x16_bf16 v[96:111], v[36:39], a[104:107], v[96:111]
 v_mfma_f32_32x32x16_bf16 v[112:127], v[36:39], a[108:111], v[112:127]
 ds_read_b128 v[32:35], v12 offset:640
 s_waitcnt lgkmcnt(6)
 v_mfma_f32_32x32x16_bf16 v[96:111], v[40:43], a[112:115], v[96:111]
 s_cmp_lg_u32 s3, 0
 s_cbranch_scc1 w0_128
 s_min_u32 s70, s6, 63
 s_min_u32 s71, s7, 63
 s_lshl_b32 s70, s70, 8
 s_lshl_b32 s71, s71, 8
 v_add_u32 v15, s70, v56
 s_mov_b32 exec_lo, 0
 v_add_u32 v15, s71, v56
 s_mov_b32 exec_lo, s87
 s_mov_b32 exec_hi, s87
 buffer_load_dwordx2 v[62:63], v15, s[52:55], 0 offen sc1
 s_mov_b64 exec, -1
w0_128:
 v_mfma_f32_32x32x16_bf16 v[112:127], v[40:43], a[116:119], v[112:127]
 ds_read_b128 v[36:39], v12 offset:672
 s_waitcnt lgkmcnt(6)
 v_mfma_f32_32x32x16_bf16 v[96:111], v[44:47], a[120:123], v[96:111]
 v_mfma_f32_32x32x16_bf16 v[112:127], v[44:47], a[124:127], v[112:127]
 ds_read_b128 v[40:43], v12 offset:704
 s_waitcnt lgkmcnt(6)
 v_mfma_f32_32x32x16_bf16 v[96:111], v[16:19], a[128:131], v[96:111]
 v_mfma_f32_32x32x16_bf16 v[112:127], v[16:19], a[132:135], v[112:127]
 ds_read_b128 v[44:47], v12 offset:736
 s_waitcnt lgkmcnt(6)
 v_mfma_f32_32x32x16_bf16 v[96:111], v[20:23], a[136:139], v[96:111]
 v_mfma_f32_32x32x16_bf16 v[112:127], v[20:23], a[140:143], v[112:127]
 ds_read_b128 v[16:19], v12 offset:768
 s_waitcnt lgkmcnt(6)
 v_mfma_f32_32x32x16_bf16 v[96:111], v[24:27], a[144:147], v[96:111]
 v_mfma_f32_32x32x16_bf16 v[112:127], v[24:27], a[148:151], v[112:127]
 ds_read_b128 v[20:23], v12 offset:800
 s_waitcnt lgkmcnt(6)
 v_mfma_f32_32x32x16_bf16 v[96:111], v[28:31], a[152:155], v[96:111]
 v_mfma_f32_32x32x16_bf16 v[112:127], v[28:31], a[156:159], v[112:127]
 ds_read_b128 v[24:27], v12 offset:832
 s_waitcnt lgkmcnt(6)
 v_mfma_f32_32x32x16_bf16 v[96:111], v[32:35], a[160:163], v[96:111]
 v_mfma_f32_32x32x16_bf16 v[112:127], v[32:35], a[164:167], v[112:127]
 ds_read_b128 v[28:31], v12 offset:864
 s_waitcnt lgkmcnt(6)
 v_mfma_f32_32x32x16_bf16 v[96:111], v[36:39], a[168:171], v[96:111]
 v_mfma_f32_32x32x16_bf16 v[112:127], v[36:39], a[172:175], v[112:127]
 ds_read_b128 v[32:35], v12 offset:896
 s_waitcnt lgkmcnt(6)
 v_mfma_f32_32x32x16_bf16 v[96:111], v[40:43], a[176:179], v[96:111]
 s_cmp_lg_u32 s3, 0
 s_cbranch_scc1 w0_129
 s_waitcnt vmcnt(0)
 v_cmp_ge_u32 s[72:73], v62, v57
 v_cmp_ge_u32 s[74:75], v63, v58
 s_and_b64 s[72:73], s[72:73], s[74:75]
 s_mov_b32 s70, 2
 s_cmp_lt_u32 s6, 64
 s_cselect_b32 s71, s72, 0
 s_cmp_eq_u32 s71, -1
 s_cselect_b32 s70, 0, s70
 s_cmp_lt_u32 s7, 64
 s_cselect_b32 s71, s73, 0
 s_cmp_eq_u32 s71, -1
 s_cselect_b32 s70, 1, s70
 v_mov_b32 v5, s70
 v_mov_b32 v6, s95
 ds_write_b32 v6, v5
w0_129:
 v_mfma_f32_32x32x16_bf16 v[112:127], v[40:43], a[180:183], v[112:127]
 ds_read_b128 v[36:39], v12 offset:928
 s_waitcnt lgkmcnt(6)
 v_mfma_f32_32x32x16_bf16 v[96:111], v[44:47], a[184:187], v[96:111]
 v_mfma_f32_32x32x16_bf16 v[112:127], v[44:47], a[188:191], v[112:127]
 ds_read_b128 v[40:43], v12 offset:960
 s_waitcnt lgkmcnt(6)
 v_mfma_f32_32x32x16_bf16 v[96:111], v[16:19], a[192:195], v[96:111]
 v_mov_b32 v6, s95
 s_waitcnt lgkmcnt(2)
 s_barrier
 ds_read_b32 v61, v6
 s_xor_b32 s95, s95, 4
 v_mfma_f32_32x32x16_bf16 v[112:127], v[16:19], a[196:199], v[112:127]
 ds_read_b128 v[44:47], v12 offset:992
 s_waitcnt lgkmcnt(6)
 v_mfma_f32_32x32x16_bf16 v[96:111], v[20:23], a[200:203], v[96:111]
 v_mfma_f32_32x32x16_bf16 v[112:127], v[20:23], a[204:207], v[112:127]
kvb_tail1:
 s_waitcnt lgkmcnt(5)
 v_mfma_f32_32x32x16_bf16 v[96:111], v[24:27], a[208:211], v[96:111]
 v_mfma_f32_32x32x16_bf16 v[112:127], v[24:27], a[212:215], v[112:127]
 s_waitcnt lgkmcnt(4)
 v_mfma_f32_32x32x16_bf16 v[96:111], v[28:31], a[216:219], v[96:111]
 v_mfma_f32_32x32x16_bf16 v[112:127], v[28:31], a[220:223], v[112:127]
 s_waitcnt lgkmcnt(3)
 v_mfma_f32_32x32x16_bf16 v[96:111], v[32:35], a[224:227], v[96:111]
 v_mfma_f32_32x32x16_bf16 v[112:127], v[32:35], a[228:231], v[112:127]
 s_waitcnt lgkmcnt(2)
 v_mfma_f32_32x32x16_bf16 v[96:111], v[36:39], a[232:235], v[96:111]
 v_mfma_f32_32x32x16_bf16 v[112:127], v[36:39], a[236:239], v[112:127]
 s_waitcnt lgkmcnt(1)
 v_mfma_f32_32x32x16_bf16 v[96:111], v[40:43], a[240:243], v[96:111]
 v_mfma_f32_32x32x16_bf16 v[112:127], v[40:43], a[244:247], v[112:127]
 s_waitcnt lgkmcnt(0)
 v_mfma_f32_32x32x16_bf16 v[96:111], v[44:47], a[248:251], v[96:111]
 v_mfma_f32_32x32x16_bf16 v[112:127], v[44:47], a[252:255], v[112:127]
 v_readfirstlane_b32 s94, v61
 s_mov_b32 s88, s6
 s_mov_b32 s89, s7
 s_add_u32 s70, s88, 2
 s_cmp_lt_u32 s70, 56
 s_cselect_b32 s70, s70, s65
 s_add_u32 s71, s88, 1
 s_cmp_lt_u32 s88, 56
 s_cselect_b32 s88, s70, s71
 s_add_u32 s89, s89, 1
 s_and_b32 s4, s94, 1
 s_cmp_eq_u32 s94, 0
 s_cselect_b32 s5, s6, s7
 s_cselect_b32 s6, s88, s6
 s_cmp_eq_u32 s94, 1
 s_cselect_b32 s7, s89, s7
 s_mov_b32 s78, 0
 s_mul_i32 s81, s4, 2097152
 s_add_u32 s81, s81, 1818624
 s_lshl_b32 s70, s5, 15
 s_add_u32 s81, s81, s70
 s_mul_i32 s96, s3, 8320
 s_add_u32 s96, s96, s78
 s_lshl_b32 s97, s3, 13
 s_add_u32 s97, s97, s81
 s_sub_u32 s97, s97, 1024
 v_cvt_pk_bf16_f32 v128, v96, v97
 v_cvt_pk_bf16_f32 v129, v98, v99
 v_cvt_pk_bf16_f32 v130, v100, v101
 v_cvt_pk_bf16_f32 v131, v102, v103
 buffer_store_dwordx4 v[128:131], v2, s[52:55], s80 offen offset:0 sc1
 v_cvt_pk_bf16_f32 v132, v104, v105
 v_cvt_pk_bf16_f32 v133, v106, v107
 v_cvt_pk_bf16_f32 v134, v108, v109
 v_cvt_pk_bf16_f32 v135, v110, v111
 buffer_store_dwordx4 v[132:135], v2, s[52:55], s80 offen offset:1024 sc1
 v_cvt_pk_bf16_f32 v136, v112, v113
 v_cvt_pk_bf16_f32 v137, v114, v115
 v_cvt_pk_bf16_f32 v138, v116, v117
 v_cvt_pk_bf16_f32 v139, v118, v119
 buffer_store_dwordx4 v[136:139], v2, s[52:55], s80 offen offset:2048 sc1
 v_cvt_pk_bf16_f32 v140, v120, v121
 v_cvt_pk_bf16_f32 v141, v122, v123
 v_cvt_pk_bf16_f32 v142, v124, v125
 v_cvt_pk_bf16_f32 v143, v126, v127
 buffer_store_dwordx4 v[140:143], v2, s[52:55], s80 offen offset:3072 sc1
 s_cmp_ge_u32 s94, 2
 s_cbranch_scc1 kvb_idle1
 s_add_u32 m0, s96, 0
 s_add_u32 s97, s97, 1024
 buffer_load_dwordx4 v2, s[52:55], s97 offen sc1 lds
 s_add_u32 m0, s96, 1040
 s_add_u32 s97, s97, 1024
 buffer_load_dwordx4 v2, s[52:55], s97 offen sc1 lds
 s_add_u32 m0, s96, 2080
 s_add_u32 s97, s97, 1024
 buffer_load_dwordx4 v2, s[52:55], s97 offen sc1 lds
 s_add_u32 m0, s96, 3120
 s_add_u32 s97, s97, 1024
 buffer_load_dwordx4 v2, s[52:55], s97 offen sc1 lds
 s_add_u32 m0, s96, 4160
 s_add_u32 s97, s97, 1024
 buffer_load_dwordx4 v2, s[52:55], s97 offen sc1 lds
 s_add_u32 m0, s96, 5200
 s_add_u32 s97, s97, 1024
 buffer_load_dwordx4 v2, s[52:55], s97 offen sc1 lds
 s_add_u32 m0, s96, 6240
 s_add_u32 s97, s97, 1024
 buffer_load_dwordx4 v2, s[52:55], s97 offen sc1 lds
 s_add_u32 m0, s96, 7280
 s_add_u32 s97, s97, 1024
 buffer_load_dwordx4 v2, s[52:55], s97 offen sc1 lds
 s_waitcnt vmcnt(8)
 s_mov_b64 exec, 1
 buffer_store_dword v0, v10, s[52:55], s101 offen sc1
 s_mov_b64 exec, -1
 s_branch sc_134
kvb_idle1:
 s_mov_b32 s83, 0x200000
 s_cmp_lg_u32 s3, 0
 s_cbranch_scc1 nw_136
 s_min_u32 s70, s6, 63
 s_min_u32 s71, s7, 63
 s_lshl_b32 s70, s70, 8
 s_lshl_b32 s71, s71, 8
 v_add_u32 v15, s70, v56
 s_mov_b32 exec_lo, 0
 v_add_u32 v15, s71, v56
 s_mov_b32 exec_lo, s87
 s_mov_b32 exec_hi, s87
 buffer_load_dwordx2 v[62:63], v15, s[52:55], 0 offen sc1
 s_mov_b64 exec, -1
 s_waitcnt vmcnt(1)
 s_mov_b64 exec, 1
 buffer_store_dword v0, v10, s[52:55], s101 offen sc1
 s_mov_b64 exec, -1
 s_min_u32 s70, s6, s7
 s_cmp_ge_u32 s70, 64
 s_cbranch_scc1 kv_exit
 s_waitcnt vmcnt(1)
 s_branch ev_135
nw_136:
 s_waitcnt vmcnt(0)
 s_mov_b64 exec, 1
 buffer_store_dword v0, v10, s[52:55], s101 offen sc1
 s_mov_b64 exec, -1
kvb_sched0:
 s_min_u32 s70, s6, s7
 s_cmp_ge_u32 s70, 64
 s_cbranch_scc1 kv_exit
 s_cmp_lg_u32 s3, 0
 s_cbranch_scc1 sc_130
 s_mov_b32 s83, 0x200000
sc_131:
 s_min_u32 s70, s6, 63
 s_min_u32 s71, s7, 63
 s_lshl_b32 s70, s70, 8
 s_lshl_b32 s71, s71, 8
 v_add_u32 v15, s70, v56
 s_mov_b32 exec_lo, 0
 v_add_u32 v15, s71, v56
 s_mov_b32 exec_lo, s87
 s_mov_b32 exec_hi, s87
 buffer_load_dwordx2 v[62:63], v15, s[52:55], 0 offen sc1
 s_mov_b64 exec, -1
 s_waitcnt vmcnt(0)
ev_135:
 v_cmp_ge_u32 s[72:73], v62, v57
 v_cmp_ge_u32 s[74:75], v63, v58
 s_and_b64 s[72:73], s[72:73], s[74:75]
 s_mov_b32 s70, 2
 s_cmp_lt_u32 s6, 64
 s_cselect_b32 s71, s72, 0
 s_cmp_eq_u32 s71, -1
 s_cselect_b32 s70, 0, s70
 s_cmp_lt_u32 s7, 64
 s_cselect_b32 s71, s73, 0
 s_cmp_eq_u32 s71, -1
 s_cselect_b32 s70, 1, s70
 s_cmp_lt_u32 s70, 2
 s_cbranch_scc1 sc_132
 s_sub_u32 s83, s83, 1
 s_cmp_lg_u32 s83, 0
 s_cbranch_scc1 sc_131
 s_mov_b32 s70, 3
sc_132:
 v_mov_b32 v5, s70
 v_mov_b32 v6, 163832
 ds_write_b32 v6, v5
 s_waitcnt lgkmcnt(0)
sc_130:
 s_barrier
 v_mov_b32 v6, 163832
 ds_read_b32 v61, v6
 s_waitcnt lgkmcnt(0)
 v_readfirstlane_b32 s94, v61
 s_cmp_ge_u32 s94, 2
 s_cbranch_scc1 k_exit
 s_mov_b32 s88, s6
 s_mov_b32 s89, s7
 s_add_u32 s70, s88, 2
 s_cmp_lt_u32 s70, 56
 s_cselect_b32 s70, s70, s65
 s_add_u32 s71, s88, 1
 s_cmp_lt_u32 s88, 56
 s_cselect_b32 s88, s70, s71
 s_add_u32 s89, s89, 1
 s_and_b32 s4, s94, 1
 s_cmp_eq_u32 s94, 0
 s_cselect_b32 s5, s6, s7
 s_cselect_b32 s6, s88, s6
 s_cmp_eq_u32 s94, 1
 s_cselect_b32 s7, s89, s7
 s_mov_b32 s78, 0
 s_mul_i32 s81, s4, 2097152
 s_add_u32 s81, s81, 1818624
 s_lshl_b32 s70, s5, 15
 s_add_u32 s81, s81, s70
 s_mul_i32 s96, s3, 8320
 s_add_u32 s96, s96, s78
 s_lshl_b32 s97, s3, 13
 s_add_u32 s97, s97, s81
 s_sub_u32 s97, s97, 1024
 s_add_u32 m0, s96, 0
 s_add_u32 s97, s97, 1024
 buffer_load_dwordx4 v2, s[52:55], s97 offen sc1 lds
 s_add_u32 m0, s96, 1040
 s_add_u32 s97, s97, 1024
 buffer_load_dwordx4 v2, s[52:55], s97 offen sc1 lds
 s_add_u32 m0, s96, 2080
 s_add_u32 s97, s97, 1024
 buffer_load_dwordx4 v2, s[52:55], s97 offen sc1 lds
 s_add_u32 m0, s96, 3120
 s_add_u32 s97, s97, 1024
 buffer_load_dwordx4 v2, s[52:55], s97 offen sc1 lds
 s_add_u32 m0, s96, 4160
 s_add_u32 s97, s97, 1024
 buffer_load_dwordx4 v2, s[52:55], s97 offen sc1 lds
 s_add_u32 m0, s96, 5200
 s_add_u32 s97, s97, 1024
 buffer_load_dwordx4 v2, s[52:55], s97 offen sc1 lds
 s_add_u32 m0, s96, 6240
 s_add_u32 s97, s97, 1024
 buffer_load_dwordx4 v2, s[52:55], s97 offen sc1 lds
 s_add_u32 m0, s96, 7280
 s_add_u32 s97, s97, 1024
 buffer_load_dwordx4 v2, s[52:55], s97 offen sc1 lds
sc_134:
 s_cmp_lg_u32 s3, 0
 s_cbranch_scc1 sc_133
 s_min_u32 s70, s6, 63
 s_min_u32 s71, s7, 63
 s_lshl_b32 s70, s70, 8
 s_lshl_b32 s71, s71, 8
 v_add_u32 v15, s70, v56
 s_mov_b32 exec_lo, 0
 v_add_u32 v15, s71, v56
 s_mov_b32 exec_lo, s87
 s_mov_b32 exec_hi, s87
 buffer_load_dwordx2 v[62:63], v15, s[52:55], 0 offen sc1
 s_mov_b64 exec, -1
 s_waitcnt vmcnt(0)
 v_cmp_ge_u32 s[72:73], v62, v57
 v_cmp_ge_u32 s[74:75], v63, v58
 s_and_b64 s[72:73], s[72:73], s[74:75]
 s_mov_b32 s70, 2
 s_cmp_lt_u32 s6, 64
 s_cselect_b32 s71, s72, 0
 s_cmp_eq_u32 s71, -1
 s_cselect_b32 s70, 0, s70
 s_cmp_lt_u32 s7, 64
 s_cselect_b32 s71, s73, 0
 s_cmp_eq_u32 s71, -1
 s_cselect_b32 s70, 1, s70
 v_mov_b32 v5, s70
 v_mov_b32 v6, s95
 ds_write_b32 v6, v5
 s_waitcnt lgkmcnt(0)
sc_133:
 s_waitcnt vmcnt(0)
 v_mov_b32 v6, s95
 s_barrier
 ds_read_b32 v61, v6
 s_xor_b32 s95, s95, 4
 s_waitcnt lgkmcnt(0)
 v_readfirstlane_b32 s94, v61
 s_branch kvb_pro0
role_qa:
 s_mov_b32 s56, s16
 s_mov_b32 s57, s17
 s_mov_b32 s58, 4194304
 s_mov_b32 s59, 0x00020000
 s_mov_b32 s60, s16
 s_mov_b32 s61, s17
 s_mov_b32 s62, 4194304
 s_mov_b32 s63, 0x00020000
 s_lshr_b32 s70, s3, 1
 s_lshl_b32 s84, s64, 1
 s_add_u32 s84, s84, s70
 s_and_b32 s85, s3, 1
 s_lshl_b32 s76, s64, 9
 s_lshl_b32 s70, s3, 7
 s_add_u32 s76, s76, s70
 s_add_u32 s77, s76, 64
 v_lshrrev_b32 v5, 2, v1
 s_mov_b32 s70, 8192
 v_mul_lo_u32 v5, v5, s70
 v_and_b32 v6, 3, v1
 v_lshl_add_u32 v10, v6, 4, v5
 v_lshrrev_b32 v5, 5, v1
 v_lshlrev_b32 v5, 9, v5
 v_bfe_u32 v7, v1, 2, 2
 v_lshl_add_u32 v5, v7, 6, v5
 v_bfe_u32 v7, v1, 4, 1
 v_lshl_add_u32 v5, v7, 5, v5
 v_lshl_add_u32 v5, v6, 3, v5
 s_lshl_b32 s71, s3, 15
 v_add_u32 v9, s71, v5
 s_add_u32 m0, s71, 0
 s_nop 0
 buffer_load_dwordx4 v10, s[56:59], s76 offen lds
 s_add_u32 s76, s76, 131072
 s_add_u32 m0, s71, 8192
 s_nop 0
 buffer_load_dwordx4 v10, s[60:63], s77 offen lds
 s_add_u32 s77, s77, 131072
 s_add_u32 m0, s71, 1024
 s_nop 0
 buffer_load_dwordx4 v10, s[56:59], s76 offen lds
 s_add_u32 s76, s76, 131072
 s_add_u32 m0, s71, 9216
 s_nop 0
 buffer_load_dwordx4 v10, s[60:63], s77 offen lds
 s_add_u32 s77, s77, 131072
 s_add_u32 m0, s71, 2048
 s_nop 0
 buffer_load_dwordx4 v10, s[56:59], s76 offen lds
 s_add_u32 s76, s76, 131072
 s_add_u32 m0, s71, 10240
 s_nop 0
 buffer_load_dwordx4 v10, s[60:63], s77 offen lds
 s_add_u32 s77, s77, 131072
 s_add_u32 m0, s71, 3072
 s_nop 0
 buffer_load_dwordx4 v10, s[56:59], s76 offen lds
 s_add_u32 s76, s76, 131072
 s_add_u32 m0, s71, 11264
 s_nop 0
 buffer_load_dwordx4 v10, s[60:63], s77 offen lds
 s_add_u32 s77, s77, 131072
 s_add_u32 m0, s71, 4096
 s_nop 0
 buffer_load_dwordx4 v10, s[56:59], s76 offen lds
 s_add_u32 s76, s76, 131072
 s_add_u32 m0, s71, 12288
 s_nop 0
 buffer_load_dwordx4 v10, s[60:63], s77 offen lds
 s_add_u32 s77, s77, 131072
 s_add_u32 m0, s71, 5120
 s_nop 0
 buffer_load_dwordx4 v10, s[56:59], s76 offen lds
 s_add_u32 s76, s76, 131072
 s_add_u32 m0, s71, 13312
 s_nop 0
 buffer_load_dwordx4 v10, s[60:63], s77 offen lds
 s_add_u32 s77, s77, 131072
 s_add_u32 m0, s71, 6144
 s_nop 0
 buffer_load_dwordx4 v10, s[56:59], s76 offen lds
 s_add_u32 s76, s76, 131072
 s_add_u32 m0, s71, 14336
 s_nop 0
 buffer_load_dwordx4 v10, s[60:63], s77 offen lds
 s_add_u32 s77, s77, 131072
 s_add_u32 m0, s71, 7168
 s_nop 0
 buffer_load_dwordx4 v10, s[56:59], s76 offen lds
 s_add_u32 s76, s76, 131072
 s_add_u32 m0, s71, 15360
 s_nop 0
 buffer_load_dwordx4 v10, s[60:63], s77 offen lds
 s_add_u32 s77, s77, 131072
 s_add_u32 m0, s71, 16384
 s_nop 0
 buffer_load_dwordx4 v10, s[56:59], s76 offen lds
 s_add_u32 s76, s76, 131072
 s_add_u32 m0, s71, 24576
 s_nop 0
 buffer_load_dwordx4 v10, s[60:63], s77 offen lds
 s_add_u32 s77, s77, 131072
 s_add_u32 m0, s71, 17408
 s_nop 0
 buffer_load_dwordx4 v10, s[56:59], s76 offen lds
 s_add_u32 s76, s76, 131072
 s_add_u32 m0, s71, 25600
 s_nop 0
 buffer_load_dwordx4 v10, s[60:63], s77 offen lds
 s_add_u32 s77, s77, 131072
 s_add_u32 m0, s71, 18432
 s_nop 0
 buffer_load_dwordx4 v10, s[56:59], s76 offen lds
 s_add_u32 s76, s76, 131072
 s_add_u32 m0, s71, 26624
 s_nop 0
 buffer_load_dwordx4 v10, s[60:63], s77 offen lds
 s_add_u32 s77, s77, 131072
 s_add_u32 m0, s71, 19456
 s_nop 0
 buffer_load_dwordx4 v10, s[56:59], s76 offen lds
 s_add_u32 s76, s76, 131072
 s_add_u32 m0, s71, 27648
 s_nop 0
 buffer_load_dwordx4 v10, s[60:63], s77 offen lds
 s_add_u32 s77, s77, 131072
 s_add_u32 m0, s71, 20480
 s_nop 0
 buffer_load_dwordx4 v10, s[56:59], s76 offen lds
 s_add_u32 s76, s76, 131072
 s_add_u32 m0, s71, 28672
 s_nop 0
 buffer_load_dwordx4 v10, s[60:63], s77 offen lds
 s_add_u32 s77, s77, 131072
 s_add_u32 m0, s71, 21504
 s_nop 0
 buffer_load_dwordx4 v10, s[56:59], s76 offen lds
 s_add_u32 s76, s76, 131072
 s_add_u32 m0, s71, 29696
 s_nop 0
 buffer_load_dwordx4 v10, s[60:63], s77 offen lds
 s_add_u32 s77, s77, 131072
 s_add_u32 m0, s71, 22528
 s_nop 0
 buffer_load_dwordx4 v10, s[56:59], s76 offen lds
 s_add_u32 s76, s76, 131072
 s_add_u32 m0, s71, 30720
 s_nop 0
 buffer_load_dwordx4 v10, s[60:63], s77 offen lds
 s_add_u32 s77, s77, 131072
 s_add_u32 m0, s71, 23552
 s_nop 0
 buffer_load_dwordx4 v10, s[56:59], s76 offen lds
 s_add_u32 s76, s76, 131072
 s_add_u32 m0, s71, 31744
 s_nop 0
 buffer_load_dwordx4 v10, s[60:63], s77 offen lds
 s_add_u32 s77, s77, 131072
 s_waitcnt vmcnt(16)
 ds_read_b64_tr_b16 a[0:1], v9 offset:0
 ds_read_b64_tr_b16 a[2:3], v9 offset:256
 ds_read_b64_tr_b16 a[4:5], v9 offset:8192
 ds_read_b64_tr_b16 a[6:7], v9 offset:8448
 ds_read_b64_tr_b16 a[8:9], v9 offset:1024
 ds_read_b64_tr_b16 a[10:11], v9 offset:1280
 ds_read_b64_tr_b16 a[12:13], v9 offset:9216
 ds_read_b64_tr_b16 a[14:15], v9 offset:9472
 ds_read_b64_tr_b16 a[16:17], v9 offset:2048
 ds_read_b64_tr_b16 a[18:19], v9 offset:2304
 ds_read_b64_tr_b16 a[20:21], v9 offset:10240
 ds_read_b64_tr_b16 a[22:23], v9 offset:10496
 ds_read_b64_tr_b16 a[24:25], v9 offset:3072
 ds_read_b64_tr_b16 a[26:27], v9 offset:3328
 ds_read_b64_tr_b16 a[28:29], v9 offset:11264
 ds_read_b64_tr_b16 a[30:31], v9 offset:11520
 ds_read_b64_tr_b16 a[32:33], v9 offset:4096
 ds_read_b64_tr_b16 a[34:35], v9 offset:4352
 ds_read_b64_tr_b16 a[36:37], v9 offset:12288
 ds_read_b64_tr_b16 a[38:39], v9 offset:12544
 ds_read_b64_tr_b16 a[40:41], v9 offset:5120
 ds_read_b64_tr_b16 a[42:43], v9 offset:5376
 ds_read_b64_tr_b16 a[44:45], v9 offset:13312
 ds_read_b64_tr_b16 a[46:47], v9 offset:13568
 ds_read_b64_tr_b16 a[48:49], v9 offset:6144
 ds_read_b64_tr_b16 a[50:51], v9 offset:6400
 ds_read_b64_tr_b16 a[52:53], v9 offset:14336
 ds_read_b64_tr_b16 a[54:55], v9 offset:14592
 ds_read_b64_tr_b16 a[56:57], v9 offset:7168
 ds_read_b64_tr_b16 a[58:59], v9 offset:7424
 ds_read_b64_tr_b16 a[60:61], v9 offset:15360
 ds_read_b64_tr_b16 a[62:63], v9 offset:15616
 s_waitcnt lgkmcnt(0)
 s_add_u32 m0, s71, 0
 s_nop 0
 buffer_load_dwordx4 v10, s[56:59], s76 offen lds
 s_add_u32 s76, s76, 131072
 s_add_u32 m0, s71, 8192
 s_nop 0
 buffer_load_dwordx4 v10, s[60:63], s77 offen lds
 s_add_u32 s77, s77, 131072
 s_add_u32 m0, s71, 1024
 s_nop 0
 buffer_load_dwordx4 v10, s[56:59], s76 offen lds
 s_add_u32 s76, s76, 131072
 s_add_u32 m0, s71, 9216
 s_nop 0
 buffer_load_dwordx4 v10, s[60:63], s77 offen lds
 s_add_u32 s77, s77, 131072
 s_add_u32 m0, s71, 2048
 s_nop 0
 buffer_load_dwordx4 v10, s[56:59], s76 offen lds
 s_add_u32 s76, s76, 131072
 s_add_u32 m0, s71, 10240
 s_nop 0
 buffer_load_dwordx4 v10, s[60:63], s77 offen lds
 s_add_u32 s77, s77, 131072
 s_add_u32 m0, s71, 3072
 s_nop 0
 buffer_load_dwordx4 v10, s[56:59], s76 offen lds
 s_add_u32 s76, s76, 131072
 s_add_u32 m0, s71, 11264
 s_nop 0
 buffer_load_dwordx4 v10, s[60:63], s77 offen lds
 s_add_u32 s77, s77, 131072
 s_add_u32 m0, s71, 4096
 s_nop 0
 buffer_load_dwordx4 v10, s[56:59], s76 offen lds
 s_add_u32 s76, s76, 131072
 s_add_u32 m0, s71, 12288
 s_nop 0
 buffer_load_dwordx4 v10, s[60:63], s77 offen lds
 s_add_u32 s77, s77, 131072
 s_add_u32 m0, s71, 5120
 s_nop 0
 buffer_load_dwordx4 v10, s[56:59], s76 offen lds
 s_add_u32 s76, s76, 131072
 s_add_u32 m0, s71, 13312
 s_nop 0
 buffer_load_dwordx4 v10, s[60:63], s77 offen lds
 s_add_u32 s77, s77, 131072
 s_add_u32 m0, s71, 6144
 s_nop 0
 buffer_load_dwordx4 v10, s[56:59], s76 offen lds
 s_add_u32 s76, s76, 131072
 s_add_u32 m0, s71, 14336
 s_nop 0
 buffer_load_dwordx4 v10, s[60:63], s77 offen lds
 s_add_u32 s77, s77, 131072
 s_add_u32 m0, s71, 7168
 s_nop 0
 buffer_load_dwordx4 v10, s[56:59], s76 offen lds
 s_add_u32 s76, s76, 131072
 s_add_u32 m0, s71, 15360
 s_nop 0
 buffer_load_dwordx4 v10, s[60:63], s77 offen lds
 s_add_u32 s77, s77, 131072
 s_waitcnt vmcnt(16)
 ds_read_b64_tr_b16 a[64:65], v9 offset:16384
 ds_read_b64_tr_b16 a[66:67], v9 offset:16640
 ds_read_b64_tr_b16 a[68:69], v9 offset:24576
 ds_read_b64_tr_b16 a[70:71], v9 offset:24832
 ds_read_b64_tr_b16 a[72:73], v9 offset:17408
 ds_read_b64_tr_b16 a[74:75], v9 offset:17664
 ds_read_b64_tr_b16 a[76:77], v9 offset:25600
 ds_read_b64_tr_b16 a[78:79], v9 offset:25856
 ds_read_b64_tr_b16 a[80:81], v9 offset:18432
 ds_read_b64_tr_b16 a[82:83], v9 offset:18688
 ds_read_b64_tr_b16 a[84:85], v9 offset:26624
 ds_read_b64_tr_b16 a[86:87], v9 offset:26880
 ds_read_b64_tr_b16 a[88:89], v9 offset:19456
 ds_read_b64_tr_b16 a[90:91], v9 offset:19712
 ds_read_b64_tr_b16 a[92:93], v9 offset:27648
 ds_read_b64_tr_b16 a[94:95], v9 offset:27904
 ds_read_b64_tr_b16 a[96:97], v9 offset:20480
 ds_read_b64_tr_b16 a[98:99], v9 offset:20736
 ds_read_b64_tr_b16 a[100:101], v9 offset:28672
 ds_read_b64_tr_b16 a[102:103], v9 offset:28928
 ds_read_b64_tr_b16 a[104:105], v9 offset:21504
 ds_read_b64_tr_b16 a[106:107], v9 offset:21760
 ds_read_b64_tr_b16 a[108:109], v9 offset:29696
 ds_read_b64_tr_b16 a[110:111], v9 offset:29952
 ds_read_b64_tr_b16 a[112:113], v9 offset:22528
 ds_read_b64_tr_b16 a[114:115], v9 offset:22784
 ds_read_b64_tr_b16 a[116:117], v9 offset:30720
 ds_read_b64_tr_b16 a[118:119], v9 offset:30976
 ds_read_b64_tr_b16 a[120:121], v9 offset:23552
 ds_read_b64_tr_b16 a[122:123], v9 offset:23808
 ds_read_b64_tr_b16 a[124:125], v9 offset:31744
 ds_read_b64_tr_b16 a[126:127], v9 offset:32000
 s_waitcnt lgkmcnt(0)
 s_add_u32 m0, s71, 16384
 s_nop 0
 buffer_load_dwordx4 v10, s[56:59], s76 offen lds
 s_add_u32 s76, s76, 131072
 s_add_u32 m0, s71, 24576
 s_nop 0
 buffer_load_dwordx4 v10, s[60:63], s77 offen lds
 s_add_u32 s77, s77, 131072
 s_add_u32 m0, s71, 17408
 s_nop 0
 buffer_load_dwordx4 v10, s[56:59], s76 offen lds
 s_add_u32 s76, s76, 131072
 s_add_u32 m0, s71, 25600
 s_nop 0
 buffer_load_dwordx4 v10, s[60:63], s77 offen lds
 s_add_u32 s77, s77, 131072
 s_add_u32 m0, s71, 18432
 s_nop 0
 buffer_load_dwordx4 v10, s[56:59], s76 offen lds
 s_add_u32 s76, s76, 131072
 s_add_u32 m0, s71, 26624
 s_nop 0
 buffer_load_dwordx4 v10, s[60:63], s77 offen lds
 s_add_u32 s77, s77, 131072
 s_add_u32 m0, s71, 19456
 s_nop 0
 buffer_load_dwordx4 v10, s[56:59], s76 offen lds
 s_add_u32 s76, s76, 131072
 s_add_u32 m0, s71, 27648
 s_nop 0
 buffer_load_dwordx4 v10, s[60:63], s77 offen lds
 s_add_u32 s77, s77, 131072
 s_add_u32 m0, s71, 20480
 s_nop 0
 buffer_load_dwordx4 v10, s[56:59], s76 offen lds
 s_add_u32 s76, s76, 131072
 s_add_u32 m0, s71, 28672
 s_nop 0
 buffer_load_dwordx4 v10, s[60:63], s77 offen lds
 s_add_u32 s77, s77, 131072
 s_add_u32 m0, s71, 21504
 s_nop 0
 buffer_load_dwordx4 v10, s[56:59], s76 offen lds
 s_add_u32 s76, s76, 131072
 s_add_u32 m0, s71, 29696
 s_nop 0
 buffer_load_dwordx4 v10, s[60:63], s77 offen lds
 s_add_u32 s77, s77, 131072
 s_add_u32 m0, s71, 22528
 s_nop 0
 buffer_load_dwordx4 v10, s[56:59], s76 offen lds
 s_add_u32 s76, s76, 131072
 s_add_u32 m0, s71, 30720
 s_nop 0
 buffer_load_dwordx4 v10, s[60:63], s77 offen lds
 s_add_u32 s77, s77, 131072
 s_add_u32 m0, s71, 23552
 s_nop 0
 buffer_load_dwordx4 v10, s[56:59], s76 offen lds
 s_add_u32 s76, s76, 131072
 s_add_u32 m0, s71, 31744
 s_nop 0
 buffer_load_dwordx4 v10, s[60:63], s77 offen lds
 s_add_u32 s77, s77, 131072
 s_waitcnt vmcnt(16)
 ds_read_b64_tr_b16 a[128:129], v9 offset:0
 ds_read_b64_tr_b16 a[130:131], v9 offset:256
 ds_read_b64_tr_b16 a[132:133], v9 offset:8192
 ds_read_b64_tr_b16 a[134:135], v9 offset:8448
 ds_read_b64_tr_b16 a[136:137], v9 offset:1024
 ds_read_b64_tr_b16 a[138:139], v9 offset:1280
 ds_read_b64_tr_b16 a[140:141], v9 offset:9216
 ds_read_b64_tr_b16 a[142:143], v9 offset:9472
 ds_read_b64_tr_b16 a[144:145], v9 offset:2048
 ds_read_b64_tr_b16 a[146:147], v9 offset:2304
 ds_read_b64_tr_b16 a[148:149], v9 offset:10240
 ds_read_b64_tr_b16 a[150:151], v9 offset:10496
 ds_read_b64_tr_b16 a[152:153], v9 offset:3072
 ds_read_b64_tr_b16 a[154:155], v9 offset:3328
 ds_read_b64_tr_b16 a[156:157], v9 offset:11264
 ds_read_b64_tr_b16 a[158:159], v9 offset:11520
 ds_read_b64_tr_b16 a[160:161], v9 offset:4096
 ds_read_b64_tr_b16 a[162:163], v9 offset:4352
 ds_read_b64_tr_b16 a[164:165], v9 offset:12288
 ds_read_b64_tr_b16 a[166:167], v9 offset:12544
 ds_read_b64_tr_b16 a[168:169], v9 offset:5120
 ds_read_b64_tr_b16 a[170:171], v9 offset:5376
 ds_read_b64_tr_b16 a[172:173], v9 offset:13312
 ds_read_b64_tr_b16 a[174:175], v9 offset:13568
 ds_read_b64_tr_b16 a[176:177], v9 offset:6144
 ds_read_b64_tr_b16 a[178:179], v9 offset:6400
 ds_read_b64_tr_b16 a[180:181], v9 offset:14336
 ds_read_b64_tr_b16 a[182:183], v9 offset:14592
 ds_read_b64_tr_b16 a[184:185], v9 offset:7168
 ds_read_b64_tr_b16 a[186:187], v9 offset:7424
 ds_read_b64_tr_b16 a[188:189], v9 offset:15360
 ds_read_b64_tr_b16 a[190:191], v9 offset:15616
 s_waitcnt lgkmcnt(0)
 s_waitcnt vmcnt(0)
 ds_read_b64_tr_b16 a[192:193], v9 offset:16384
 ds_read_b64_tr_b16 a[194:195], v9 offset:16640
 ds_read_b64_tr_b16 a[196:197], v9 offset:24576
 ds_read_b64_tr_b16 a[198:199], v9 offset:24832
 ds_read_b64_tr_b16 a[200:201], v9 offset:17408
 ds_read_b64_tr_b16 a[202:203], v9 offset:17664
 ds_read_b64_tr_b16 a[204:205], v9 offset:25600
 ds_read_b64_tr_b16 a[206:207], v9 offset:25856
 ds_read_b64_tr_b16 a[208:209], v9 offset:18432
 ds_read_b64_tr_b16 a[210:211], v9 offset:18688
 ds_read_b64_tr_b16 a[212:213], v9 offset:26624
 ds_read_b64_tr_b16 a[214:215], v9 offset:26880
 ds_read_b64_tr_b16 a[216:217], v9 offset:19456
 ds_read_b64_tr_b16 a[218:219], v9 offset:19712
 ds_read_b64_tr_b16 a[220:221], v9 offset:27648
 ds_read_b64_tr_b16 a[222:223], v9 offset:27904
 ds_read_b64_tr_b16 a[224:225], v9 offset:20480
 ds_read_b64_tr_b16 a[226:227], v9 offset:20736
 ds_read_b64_tr_b16 a[228:229], v9 offset:28672
 ds_read_b64_tr_b16 a[230:231], v9 offset:28928
 ds_read_b64_tr_b16 a[232:233], v9 offset:21504
 ds_read_b64_tr_b16 a[234:235], v9 offset:21760
 ds_read_b64_tr_b16 a[236:237], v9 offset:29696
 ds_read_b64_tr_b16 a[238:239], v9 offset:29952
 ds_read_b64_tr_b16 a[240:241], v9 offset:22528
 ds_read_b64_tr_b16 a[242:243], v9 offset:22784
 ds_read_b64_tr_b16 a[244:245], v9 offset:30720
 ds_read_b64_tr_b16 a[246:247], v9 offset:30976
 ds_read_b64_tr_b16 a[248:249], v9 offset:23552
 ds_read_b64_tr_b16 a[250:251], v9 offset:23808
 ds_read_b64_tr_b16 a[252:253], v9 offset:31744
 ds_read_b64_tr_b16 a[254:255], v9 offset:32000
 s_waitcnt lgkmcnt(0)
 s_barrier
 v_and_b32 v5, 31, v1
 s_movk_i32 s70, 1040
 v_mul_lo_u32 v5, v5, s70
 v_lshrrev_b32 v6, 5, v1
 v_lshl_add_u32 v3, v6, 4, v5
 v_lshrrev_b32 v5, 5, v1
 v_and_b32 v6, 7, v1
 v_lshlrev_b32 v6, 4, v6
 v_lshl_add_u32 v11, v5, 7, v6
 v_and_b32 v6, 31, v1
 v_lshlrev_b32 v7, 4, v6
 v_lshl_add_u32 v7, v5, 3, v7
 v_add_u32 v12, 8388608, v7
 v_lshlrev_b32 v7, 2, v5
 v_sub_u32 v59, v6, v7
 s_lshl_b32 s70, s3, 12
 s_add_u32 s70, s70, 66560
 v_add_u32 v13, s70, v2
 v_xor_b32 v14, 0x1000, v13
 s_xor_b32 s70, s3, 1
 s_lshl_b32 s70, s70, 12
 s_add_u32 s70, s70, 66560
 v_add_u32 v14, s70, v2
 v_mov_b32 v8, 0xff7fffff
 v_cmp_le_i32 vcc, 0, v59
 s_nop 1
 v_cndmask_b32 v16, v8, 0, vcc
 v_cmp_le_i32 vcc, 1, v59
 s_nop 1
 v_cndmask_b32 v17, v8, 0, vcc
 v_cmp_le_i32 vcc, 2, v59
 s_nop 1
 v_cndmask_b32 v18, v8, 0, vcc
 v_cmp_le_i32 vcc, 3, v59
 s_nop 1
 v_cndmask_b32 v19, v8, 0, vcc
 v_cmp_le_i32 vcc, 8, v59
 s_nop 1
 v_cndmask_b32 v20, v8, 0, vcc
 v_cmp_le_i32 vcc, 9, v59
 s_nop 1
 v_cndmask_b32 v21, v8, 0, vcc
 v_cmp_le_i32 vcc, 10, v59
 s_nop 1
 v_cndmask_b32 v22, v8, 0, vcc
 v_cmp_le_i32 vcc, 11, v59
 s_nop 1
 v_cndmask_b32 v23, v8, 0, vcc
 v_cmp_le_i32 vcc, 16, v59
 s_nop 1
 v_cndmask_b32 v24, v8, 0, vcc
 v_cmp_le_i32 vcc, 17, v59
 s_nop 1
 v_cndmask_b32 v25, v8, 0, vcc
 v_cmp_le_i32 vcc, 18, v59
 s_nop 1
 v_cndmask_b32 v26, v8, 0, vcc
 v_cmp_le_i32 vcc, 19, v59
 s_nop 1
 v_cndmask_b32 v27, v8, 0, vcc
 v_cmp_le_i32 vcc, 24, v59
 s_nop 1
 v_cndmask_b32 v28, v8, 0, vcc
 v_cmp_le_i32 vcc, 25, v59
 s_nop 1
 v_cndmask_b32 v29, v8, 0, vcc
 v_cmp_le_i32 vcc, 26, v59
 s_nop 1
 v_cndmask_b32 v30, v8, 0, vcc
 v_cmp_le_i32 vcc, 27, v59
 s_nop 1
 v_cndmask_b32 v31, v8, 0, vcc
 v_add_u32 v60, 82944, v2
 ds_write_b128 v60, v[16:19] offset:0
 ds_write_b128 v60, v[20:23] offset:1024
 ds_write_b128 v60, v[24:27] offset:2048
 ds_write_b128 v60, v[28:31] offset:3072
 s_waitcnt lgkmcnt(0)
 v_mov_b32 v50, 0
 v_mov_b32 v51, 0
 v_mov_b32 v54, 0
 v_mov_b32 v55, 0
 s_mov_b32 s82, 0x3e0293ee
 s_mov_b32 s83, 0x3e0293ee
 v_mov_b32 v10, 0
 v_mov_b32 v0, 1
 s_lshl_b32 s98, s64, 2
 s_add_u32 s98, s98, s3
 s_lshl_b32 s98, s98, 2
 v_and_b32 v5, 7, v1
 v_lshlrev_b32 v5, 4, v5
 s_lshl_b32 s71, s64, 7
 v_add_u32 v56, s71, v5
 s_mov_b32 exec_lo, 0xff
 s_mov_b32 exec_hi, 0
 v_add_u32 v56, 204800, v56
 s_mov_b32 exec_lo, 0xff00
 s_mov_b32 exec_hi, 0
 v_add_u32 v56, 337920, v56
 s_mov_b32 exec_lo, 0xff0000
 s_mov_b32 exec_hi, 0
 v_add_u32 v56, 471040, v56
 s_mov_b32 exec_lo, 0xff000000
 s_mov_b32 exec_hi, 0
 v_add_u32 v56, 604160, v56
 s_mov_b64 exec, -1
 v_mov_b32 v15, v56
 s_mov_b32 s86, 64
 s_mov_b32 s88, 0
 s_mov_b32 s87, 64
 s_mov_b32 s89, 0
 s_mov_b32 s69, 0
 s_mov_b32 s95, 163824
 s_mov_b32 s92, 0x200000
qa_idle:
 s_cmp_lg_u32 s3, 0
 s_cbranch_scc1 qp_137
 s_mov_b32 exec_hi, 0
 s_min_u32 s70, s6, 63
 s_lshl_b32 s70, s70, 11
 s_mov_b32 exec_lo, 0xff
 v_add_u32 v15, s70, v56
 s_min_u32 s70, s7, 63
 s_lshl_b32 s70, s70, 11
 s_mov_b32 exec_lo, 0xff00
 v_add_u32 v15, s70, v56
 s_cmp_lt_u32 s86, 64
 s_cselect_b32 s70, s86, s6
 s_min_u32 s70, s70, 63
 s_lshl_b32 s70, s70, 11
 s_mov_b32 exec_lo, 0xff0000
 v_add_u32 v15, s70, v56
 s_cmp_lt_u32 s87, 64
 s_cselect_b32 s70, s87, s7
 s_min_u32 s70, s70, 63
 s_lshl_b32 s70, s70, 11
 s_mov_b32 exec_lo, 0xff000000
 v_add_u32 v15, s70, v56
 s_mov_b32 exec_lo, -1
 buffer_load_dword v62, v15, s[52:55], 0 offen sc1
 s_mov_b64 exec, -1
qp_137:
 s_waitcnt vmcnt(0)
 s_cmp_eq_u32 s69, 0
 s_cbranch_scc1 fp_138
 s_mov_b64 exec, 1
 buffer_store_dword v0, v10, s[52:55], s69 offen sc1
 s_mov_b64 exec, -1
 s_mov_b32 s69, 0
fp_138:
qa_sched:
 s_cmp_lg_u32 s3, 0
 s_cbranch_scc1 pb_139
 v_cmp_eq_u32 s[74:75], 1, v62
 s_mov_b32 s70, 0
 s_bfe_u32 s71, s74, 0x80000
 s_cmp_eq_u32 s71, 0xff
 s_cselect_b32 s71, 1, 0
 s_or_b32 s70, s70, s71
 s_bfe_u32 s71, s74, 0x80008
 s_cmp_eq_u32 s71, 0xff
 s_cselect_b32 s71, 2, 0
 s_or_b32 s70, s70, s71
 s_bfe_u32 s71, s74, 0x80010
 s_cmp_eq_u32 s71, 0xff
 s_cselect_b32 s71, 4, 0
 s_or_b32 s70, s70, s71
 s_bfe_u32 s71, s74, 0x80018
 s_cmp_eq_u32 s71, 0xff
 s_cselect_b32 s71, 8, 0
 s_or_b32 s70, s70, s71
 v_mov_b32 v5, s70
 v_mov_b32 v6, s95
 ds_write_b32 v6, v5
pb_139:
 v_mov_b32 v6, s95
 s_xor_b32 s95, s95, 4
 s_waitcnt lgkmcnt(0)
 s_barrier
 ds_read_b32 v61, v6
 s_waitcnt lgkmcnt(0)
 v_readfirstlane_b32 s94, v61
qa_disp:
 s_cmp_ge_u32 s86, 64
 s_cbranch_scc1 cb_140
 s_bitcmp1_b32 s94, 2
 s_cbranch_scc1 qa_B0
cb_140:
 s_cmp_ge_u32 s87, 64
 s_cbranch_scc1 cb_141
 s_bitcmp1_b32 s94, 3
 s_cbranch_scc1 qa_B1
cb_141:
 s_bitcmp1_b32 s94, 0
 s_cbranch_scc0 tq_142
 s_cmp_lg_u32 s88, 0
 s_cbranch_scc1 tq_142
 s_cmp_ge_u32 s6, 64
 s_cbranch_scc1 tq_142
 s_lshl_b32 s81, s6, 15
 s_add_u32 s81, s81, 1818624
 s_mov_b32 s78, 0
 s_mul_i32 s96, s3, 8320
 s_add_u32 s96, s96, s78
 s_lshl_b32 s97, s3, 13
 s_add_u32 s97, s97, s81
 s_sub_u32 s97, s97, 1024
 s_add_u32 m0, s96, 0
 s_add_u32 s97, s97, 1024
 buffer_load_dwordx4 v2, s[52:55], s97 offen sc1 lds
 s_add_u32 m0, s96, 1040
 s_add_u32 s97, s97, 1024
 buffer_load_dwordx4 v2, s[52:55], s97 offen sc1 lds
 s_add_u32 m0, s96, 2080
 s_add_u32 s97, s97, 1024
 buffer_load_dwordx4 v2, s[52:55], s97 offen sc1 lds
 s_add_u32 m0, s96, 3120
 s_add_u32 s97, s97, 1024
 buffer_load_dwordx4 v2, s[52:55], s97 offen sc1 lds
 s_add_u32 m0, s96, 4160
 s_add_u32 s97, s97, 1024
 buffer_load_dwordx4 v2, s[52:55], s97 offen sc1 lds
 s_add_u32 m0, s96, 5200
 s_add_u32 s97, s97, 1024
 buffer_load_dwordx4 v2, s[52:55], s97 offen sc1 lds
 s_add_u32 m0, s96, 6240
 s_add_u32 s97, s97, 1024
 buffer_load_dwordx4 v2, s[52:55], s97 offen sc1 lds
 s_add_u32 m0, s96, 7280
 s_add_u32 s97, s97, 1024
 buffer_load_dwordx4 v2, s[52:55], s97 offen sc1 lds
 s_mov_b32 s88, 1
 s_waitcnt vmcnt(0)
tq_142:
 s_bitcmp1_b32 s94, 1
 s_cbranch_scc0 tq_143
 s_cmp_lg_u32 s89, 0
 s_cbranch_scc1 tq_143
 s_cmp_ge_u32 s7, 64
 s_cbranch_scc1 tq_143
 s_lshl_b32 s81, s7, 15
 s_add_u32 s81, s81, 3915776
 s_mov_b32 s78, 33280
 s_mul_i32 s96, s3, 8320
 s_add_u32 s96, s96, s78
 s_lshl_b32 s97, s3, 13
 s_add_u32 s97, s97, s81
 s_sub_u32 s97, s97, 1024
 s_add_u32 m0, s96, 0
 s_add_u32 s97, s97, 1024
 buffer_load_dwordx4 v2, s[52:55], s97 offen sc1 lds
 s_add_u32 m0, s96, 1040
 s_add_u32 s97, s97, 1024
 buffer_load_dwordx4 v2, s[52:55], s97 offen sc1 lds
 s_add_u32 m0, s96, 2080
 s_add_u32 s97, s97, 1024
 buffer_load_dwordx4 v2, s[52:55], s97 offen sc1 lds
 s_add_u32 m0, s96, 3120
 s_add_u32 s97, s97, 1024
 buffer_load_dwordx4 v2, s[52:55], s97 offen sc1 lds
 s_add_u32 m0, s96, 4160
 s_add_u32 s97, s97, 1024
 buffer_load_dwordx4 v2, s[52:55], s97 offen sc1 lds
 s_add_u32 m0, s96, 5200
 s_add_u32 s97, s97, 1024
 buffer_load_dwordx4 v2, s[52:55], s97 offen sc1 lds
 s_add_u32 m0, s96, 6240
 s_add_u32 s97, s97, 1024
 buffer_load_dwordx4 v2, s[52:55], s97 offen sc1 lds
 s_add_u32 m0, s96, 7280
 s_add_u32 s97, s97, 1024
 buffer_load_dwordx4 v2, s[52:55], s97 offen sc1 lds
 s_mov_b32 s89, 1
 s_waitcnt vmcnt(0)
tq_143:
 s_cmp_lt_u32 s86, 64
 s_cbranch_scc1 ca_144
 s_cmp_lg_u32 s88, 0
 s_cbranch_scc1 qa_A0
ca_144:
 s_cmp_lt_u32 s87, 64
 s_cbranch_scc1 ca_145
 s_cmp_lg_u32 s89, 0
 s_cbranch_scc1 qa_A1
ca_145:
 s_min_u32 s70, s6, s7
 s_min_u32 s71, s86, s87
 s_min_u32 s70, s70, s71
 s_cmp_lt_u32 s70, 64
 s_cbranch_scc1 qa_more
 s_waitcnt vmcnt(0)
 s_cmp_eq_u32 s69, 0
 s_cbranch_scc1 fp_146
 s_mov_b64 exec, 1
 buffer_store_dword v0, v10, s[52:55], s69 offen sc1
 s_mov_b64 exec, -1
 s_mov_b32 s69, 0
fp_146:
 s_endpgm
qa_more:
 s_sub_u32 s92, s92, 1
 s_cmp_lg_u32 s92, 0
 s_cbranch_scc1 qa_idle
 s_endpgm
qa_A0:
 s_bitcmp1_b32 s94, 2
 s_cselect_b32 s70, s87, 0
 s_cmp_ge_u32 s70, 64
 s_cselect_b64 vcc, -1, 0
 s_cselect_b32 s86, 64, s6
 s_cbranch_scc1 fu_147
 s_waitcnt vmcnt(0)
 s_cmp_eq_u32 s69, 0
 s_cbranch_scc1 fp_148
 s_mov_b64 exec, 1
 buffer_store_dword v0, v10, s[52:55], s69 offen sc1
 s_mov_b64 exec, -1
 s_mov_b32 s69, 0
fp_148:
fu_147:
 s_barrier
 ds_read_b128 v[160:163], v60 offset:0
 ds_read_b128 v[164:167], v60 offset:1024
 ds_read_b128 v[168:171], v60 offset:2048
 ds_read_b128 v[172:175], v60 offset:3072
 ds_read_b128 v[16:19], v3 offset:0
 ds_read_b128 v[20:23], v3 offset:32
 ds_read_b128 v[24:27], v3 offset:64
 ds_read_b128 v[28:31], v3 offset:96
 ds_read_b128 v[32:35], v3 offset:128
 ds_read_b128 v[36:39], v3 offset:160
 ds_read_b128 v[40:43], v3 offset:192
 s_waitcnt lgkmcnt(6)
 v_mfma_f32_32x32x16_bf16 v[64:79], a[0:3], v[16:19], 0
 v_mfma_f32_32x32x16_bf16 v[80:95], a[4:7], v[16:19], 0
 s_lshl_b32 s90, s6, 5
 s_add_u32 s90, s90, s84
 s_lshl_b32 s90, s90, 13
 s_lshl_b32 s73, s85, 12
 s_add_u32 s90, s90, s73
 s_xor_b32 s91, s90, 4096
 ds_read_b128 v[44:47], v3 offset:224
 s_waitcnt lgkmcnt(6)
 v_mfma_f32_32x32x16_bf16 v[64:79], a[8:11], v[20:23], v[64:79]
 v_mfma_f32_32x32x16_bf16 v[80:95], a[12:15], v[20:23], v[80:95]
 s_mov_b32 s67, s6
 s_add_u32 s6, s6, 2
 ds_read_b128 v[16:19], v3 offset:256
 s_waitcnt lgkmcnt(6)
 v_mfma_f32_32x32x16_bf16 v[64:79], a[16:19], v[24:27], v[64:79]
 v_mfma_f32_32x32x16_bf16 v[80:95], a[20:23], v[24:27], v[80:95]
 s_mov_b32 s88, 0
 s_add_u32 s70, s90, 6012928
 s_add_u32 s71, s91, 6012928
 s_add_u32 s72, s90, 39567360
 s_lshr_b32 s73, s90, 2
 s_add_u32 s73, s73, 73121792
 s_xor_b32 s74, s73, 1024
 s_add_u32 s80, s90, 89899008
 ds_read_b128 v[20:23], v3 offset:288
 s_waitcnt lgkmcnt(6)
 v_mfma_f32_32x32x16_bf16 v[64:79], a[24:27], v[28:31], v[64:79]
 v_mfma_f32_32x32x16_bf16 v[80:95], a[28:31], v[28:31], v[80:95]
 buffer_load_dwordx4 v[96:99], v2, s[52:55], s70 offen offset:0 sc1
 ds_read_b128 v[24:27], v3 offset:320
 s_waitcnt lgkmcnt(6)
 v_mfma_f32_32x32x16_bf16 v[64:79], a[32:35], v[32:35], v[64:79]
 v_mfma_f32_32x32x16_bf16 v[80:95], a[36:39], v[32:35], v[80:95]
 buffer_load_dwordx4 v[100:103], v2, s[52:55], s70 offen offset:1024 sc1
 ds_read_b128 v[28:31], v3 offset:352
 s_waitcnt lgkmcnt(6)
 v_mfma_f32_32x32x16_bf16 v[64:79], a[40:43], v[36:39], v[64:79]
 v_mfma_f32_32x32x16_bf16 v[80:95], a[44:47], v[36:39], v[80:95]
 buffer_load_dwordx4 v[104:107], v2, s[52:55], s70 offen offset:2048 sc1
 ds_read_b128 v[32:35], v3 offset:384
 s_waitcnt lgkmcnt(6)
 v_mfma_f32_32x32x16_bf16 v[64:79], a[48:51], v[40:43], v[64:79]
 v_mfma_f32_32x32x16_bf16 v[80:95], a[52:55], v[40:43], v[80:95]
 buffer_load_dwordx4 v[108:111], v2, s[52:55], s70 offen offset:3072 sc1
 ds_read_b128 v[36:39], v3 offset:416
 s_waitcnt lgkmcnt(6)
 v_mfma_f32_32x32x16_bf16 v[64:79], a[56:59], v[44:47], v[64:79]
 v_mfma_f32_32x32x16_bf16 v[80:95], a[60:63], v[44:47], v[80:95]
 buffer_load_dwordx4 v[112:115], v2, s[52:55], s71 offen offset:0 sc1
 ds_read_b128 v[40:43], v3 offset:448
 s_waitcnt lgkmcnt(6)
 v_mfma_f32_32x32x16_bf16 v[64:79], a[64:67], v[16:19], v[64:79]
 v_mfma_f32_32x32x16_bf16 v[80:95], a[68:71], v[16:19], v[80:95]
 buffer_load_dwordx4 v[116:119], v2, s[52:55], s71 offen offset:1024 sc1
 ds_read_b128 v[44:47], v3 offset:480
 s_waitcnt lgkmcnt(6)
 v_mfma_f32_32x32x16_bf16 v[64:79], a[72:75], v[20:23], v[64:79]
 v_mfma_f32_32x32x16_bf16 v[80:95], a[76:79], v[20:23], v[80:95]
 buffer_load_dwordx4 v[120:123], v2, s[52:55], s71 offen offset:2048 sc1
 ds_read_b128 v[16:19], v3 offset:512
 s_waitcnt lgkmcnt(6)
 v_mfma_f32_32x32x16_bf16 v[64:79], a[80:83], v[24:27], v[64:79]
 v_mfma_f32_32x32x16_bf16 v[80:95], a[84:87], v[24:27], v[80:95]
 buffer_load_dwordx4 v[124:127], v2, s[52:55], s71 offen offset:3072 sc1
 ds_read_b128 v[20:23], v3 offset:544
 s_waitcnt lgkmcnt(6)
 v_mfma_f32_32x32x16_bf16 v[64:79], a[88:91], v[28:31], v[64:79]
 v_mfma_f32_32x32x16_bf16 v[80:95], a[92:95], v[28:31], v[80:95]
 buffer_load_dwordx4 v[176:179], v2, s[52:55], s72 offen offset:0 sc1
 ds_read_b128 v[24:27], v3 offset:576
 s_waitcnt lgkmcnt(6)
 v_mfma_f32_32x32x16_bf16 v[64:79], a[96:99], v[32:35], v[64:79]
 v_mfma_f32_32x32x16_bf16 v[80:95], a[100:103], v[32:35], v[80:95]
 buffer_load_dwordx4 v[180:183], v2, s[52:55], s72 offen offset:1024 sc1
 ds_read_b128 v[28:31], v3 offset:608
 s_waitcnt lgkmcnt(6)
 v_mfma_f32_32x32x16_bf16 v[64:79], a[104:107], v[36:39], v[64:79]
 v_mfma_f32_32x32x16_bf16 v[80:95], a[108:111], v[36:39], v[80:95]
 buffer_load_dwordx4 v[184:187], v2, s[52:55], s72 offen offset:2048 sc1
 ds_read_b128 v[32:35], v3 offset:640
 s_waitcnt lgkmcnt(6)
 v_mfma_f32_32x32x16_bf16 v[64:79], a[112:115], v[40:43], v[64:79]
 v_mfma_f32_32x32x16_bf16 v[80:95], a[116:119], v[40:43], v[80:95]
 buffer_load_dwordx4 v[188:191], v2, s[52:55], s72 offen offset:3072 sc1
 ds_read_b128 v[36:39], v3 offset:672
 s_waitcnt lgkmcnt(6)
 v_mfma_f32_32x32x16_bf16 v[64:79], a[120:123], v[44:47], v[64:79]
 v_mfma_f32_32x32x16_bf16 v[80:95], a[124:127], v[44:47], v[80:95]
 s_cbranch_vccz fx_149
 buffer_load_dwordx4 v[192:195], v11, s[52:55], s73 offen offset:0 sc1
 buffer_load_dwordx4 v[196:199], v11, s[52:55], s73 offen offset:256 sc1
fx_149:
 ds_read_b128 v[40:43], v3 offset:704
 s_waitcnt lgkmcnt(6)
 v_mfma_f32_32x32x16_bf16 v[64:79], a[128:131], v[16:19], v[64:79]
 v_mfma_f32_32x32x16_bf16 v[80:95], a[132:135], v[16:19], v[80:95]
 s_cbranch_vccz fx_150
 buffer_load_dwordx4 v[200:203], v11, s[52:55], s73 offen offset:512 sc1
 buffer_load_dwordx4 v[204:207], v11, s[52:55], s73 offen offset:768 sc1
fx_150:
 ds_read_b128 v[44:47], v3 offset:736
 s_waitcnt lgkmcnt(6)
 v_mfma_f32_32x32x16_bf16 v[64:79], a[136:139], v[20:23], v[64:79]
 v_mfma_f32_32x32x16_bf16 v[80:95], a[140:143], v[20:23], v[80:95]
 s_cbranch_vccz fx_151
 buffer_load_dwordx4 v[208:211], v11, s[52:55], s74 offen offset:0 sc1
 buffer_load_dwordx4 v[212:215], v11, s[52:55], s74 offen offset:256 sc1
fx_151:
 ds_read_b128 v[16:19], v3 offset:768
 s_waitcnt lgkmcnt(6)
 v_mfma_f32_32x32x16_bf16 v[64:79], a[144:147], v[24:27], v[64:79]
 v_mfma_f32_32x32x16_bf16 v[80:95], a[148:151], v[24:27], v[80:95]
 s_cbranch_vccz fx_152
 buffer_load_dwordx4 v[216:219], v11, s[52:55], s74 offen offset:512 sc1
 buffer_load_dwordx4 v[220:223], v11, s[52:55], s74 offen offset:768 sc1
fx_152:
 ds_read_b128 v[20:23], v3 offset:800
 s_waitcnt lgkmcnt(6)
 v_mfma_f32_32x32x16_bf16 v[64:79], a[152:155], v[28:31], v[64:79]
 v_mfma_f32_32x32x16_bf16 v[80:95], a[156:159], v[28:31], v[80:95]
 s_cbranch_vccz fx_153
 buffer_load_dwordx2 v[48:49], v12, s[52:55], s73 offen offset:0 sc1
 buffer_load_dwordx2 v[52:53], v12, s[52:55], s73 offen offset:512 sc1
fx_153:
 ds_read_b128 v[24:27], v3 offset:832
 s_waitcnt lgkmcnt(6)
 v_mfma_f32_32x32x16_bf16 v[64:79], a[160:163], v[32:35], v[64:79]
 v_mfma_f32_32x32x16_bf16 v[80:95], a[164:167], v[32:35], v[80:95]
 s_cmp_lg_u32 s3, 0
 s_cbranch_scc1 qp_154
 s_mov_b32 exec_hi, 0
 s_min_u32 s70, s6, 63
 s_lshl_b32 s70, s70, 11
 s_mov_b32 exec_lo, 0xff
 v_add_u32 v15, s70, v56
 s_min_u32 s70, s7, 63
 s_lshl_b32 s70, s70, 11
 s_mov_b32 exec_lo, 0xff00
 v_add_u32 v15, s70, v56
 s_cmp_lt_u32 s86, 64
 s_cselect_b32 s70, s86, s6
 s_min_u32 s70, s70, 63
 s_lshl_b32 s70, s70, 11
 s_mov_b32 exec_lo, 0xff0000
 v_add_u32 v15, s70, v56
 s_cmp_lt_u32 s87, 64
 s_cselect_b32 s70, s87, s7
 s_min_u32 s70, s70, 63
 s_lshl_b32 s70, s70, 11
 s_mov_b32 exec_lo, 0xff000000
 v_add_u32 v15, s70, v56
 s_mov_b32 exec_lo, -1
 buffer_load_dword v62, v15, s[52:55], 0 offen sc1
 s_mov_b64 exec, -1
qp_154:
 ds_read_b128 v[28:31], v3 offset:864
 s_waitcnt lgkmcnt(6)
 v_mfma_f32_32x32x16_bf16 v[64:79], a[168:171], v[36:39], v[64:79]
 v_mfma_f32_32x32x16_bf16 v[80:95], a[172:175], v[36:39], v[80:95]
 ds_read_b128 v[32:35], v3 offset:896
 s_waitcnt lgkmcnt(6)
 v_mfma_f32_32x32x16_bf16 v[64:79], a[176:179], v[40:43], v[64:79]
 v_mfma_f32_32x32x16_bf16 v[80:95], a[180:183], v[40:43], v[80:95]
 ds_read_b128 v[36:39], v3 offset:928
 s_waitcnt lgkmcnt(6)
 v_mfma_f32_32x32x16_bf16 v[64:79], a[184:187], v[44:47], v[64:79]
 v_mfma_f32_32x32x16_bf16 v[80:95], a[188:191], v[44:47], v[80:95]
 ds_read_b128 v[40:43], v3 offset:960
 s_waitcnt lgkmcnt(6)
 v_mfma_f32_32x32x16_bf16 v[64:79], a[192:195], v[16:19], v[64:79]
 v_mfma_f32_32x32x16_bf16 v[80:95], a[196:199], v[16:19], v[80:95]
 ds_read_b128 v[44:47], v3 offset:992
 s_waitcnt lgkmcnt(6)
 v_mfma_f32_32x32x16_bf16 v[64:79], a[200:203], v[20:23], v[64:79]
 v_mfma_f32_32x32x16_bf16 v[80:95], a[204:207], v[20:23], v[80:95]
 s_waitcnt lgkmcnt(5)
 v_mfma_f32_32x32x16_bf16 v[64:79], a[208:211], v[24:27], v[64:79]
 v_mfma_f32_32x32x16_bf16 v[80:95], a[212:215], v[24:27], v[80:95]
 s_waitcnt lgkmcnt(4)
 v_mfma_f32_32x32x16_bf16 v[64:79], a[216:219], v[28:31], v[64:79]
 v_mfma_f32_32x32x16_bf16 v[80:95], a[220:223], v[28:31], v[80:95]
 s_waitcnt lgkmcnt(3)
 v_mfma_f32_32x32x16_bf16 v[64:79], a[224:227], v[32:35], v[64:79]
 v_mfma_f32_32x32x16_bf16 v[80:95], a[228:231], v[32:35], v[80:95]
 s_waitcnt lgkmcnt(2)
 v_mfma_f32_32x32x16_bf16 v[64:79], a[232:235], v[36:39], v[64:79]
 v_mfma_f32_32x32x16_bf16 v[80:95], a[236:239], v[36:39], v[80:95]
 s_waitcnt lgkmcnt(1)
 v_mfma_f32_32x32x16_bf16 v[64:79], a[240:243], v[40:43], v[64:79]
 v_mfma_f32_32x32x16_bf16 v[80:95], a[244:247], v[40:43], v[80:95]
 s_waitcnt vmcnt(0)
 s_cmp_eq_u32 s69, 0
 s_cbranch_scc1 fp_155
 s_mov_b64 exec, 1
 buffer_store_dword v0, v10, s[52:55], s69 offen sc1
 s_mov_b64 exec, -1
 s_mov_b32 s69, 0
fp_155:
 s_cmp_lg_u32 s3, 0
 s_cbranch_scc1 pb_156
 v_cmp_eq_u32 s[74:75], 1, v62
 s_mov_b32 s70, 0
 s_bfe_u32 s71, s74, 0x80000
 s_cmp_eq_u32 s71, 0xff
 s_cselect_b32 s71, 1, 0
 s_or_b32 s70, s70, s71
 s_bfe_u32 s71, s74, 0x80008
 s_cmp_eq_u32 s71, 0xff
 s_cselect_b32 s71, 2, 0
 s_or_b32 s70, s70, s71
 s_bfe_u32 s71, s74, 0x80010
 s_cmp_eq_u32 s71, 0xff
 s_cselect_b32 s71, 4, 0
 s_or_b32 s70, s70, s71
 s_bfe_u32 s71, s74, 0x80018
 s_cmp_eq_u32 s71, 0xff
 s_cselect_b32 s71, 8, 0
 s_or_b32 s70, s70, s71
 v_mov_b32 v5, s70
 v_mov_b32 v6, s95
 ds_write_b32 v6, v5
pb_156:
 v_mov_b32 v6, s95
 s_xor_b32 s95, s95, 4
 s_waitcnt lgkmcnt(0)
 v_mfma_f32_32x32x16_bf16 v[64:79], a[248:251], v[44:47], v[64:79]
 v_mfma_f32_32x32x16_bf16 v[80:95], a[252:255], v[44:47], v[80:95]
 s_nop 10
 v_cvt_pk_bf16_f32 v128, v64, v65
 v_cvt_pk_bf16_f32 v129, v66, v67
 v_cvt_pk_bf16_f32 v130, v68, v69
 v_cvt_pk_bf16_f32 v131, v70, v71
 ds_write_b128 v13, v[128:131] offset:0
 v_cvt_pk_bf16_f32 v132, v72, v73
 v_cvt_pk_bf16_f32 v133, v74, v75
 v_cvt_pk_bf16_f32 v134, v76, v77
 v_cvt_pk_bf16_f32 v135, v78, v79
 ds_write_b128 v13, v[132:135] offset:1024
 v_mfma_f32_32x32x16_bf16 v[160:175], v[96:99], v[128:131], v[160:175]
 v_cvt_pk_bf16_f32 v136, v80, v81
 v_cvt_pk_bf16_f32 v137, v82, v83
 v_cvt_pk_bf16_f32 v138, v84, v85
 v_cvt_pk_bf16_f32 v139, v86, v87
 ds_write_b128 v13, v[136:139] offset:2048
 v_mfma_f32_32x32x16_bf16 v[160:175], v[100:103], v[132:135], v[160:175]
 v_cvt_pk_bf16_f32 v140, v88, v89
 v_cvt_pk_bf16_f32 v141, v90, v91
 v_cvt_pk_bf16_f32 v142, v92, v93
 v_cvt_pk_bf16_f32 v143, v94, v95
 ds_write_b128 v13, v[140:143] offset:3072
 v_mfma_f32_32x32x16_bf16 v[160:175], v[104:107], v[136:139], v[160:175]
 s_waitcnt lgkmcnt(0)
 s_barrier
 ds_read_b32 v61, v6
 ds_read_b128 v[144:147], v14 offset:0
 ds_read_b128 v[148:151], v14 offset:1024
 ds_read_b128 v[152:155], v14 offset:2048
 ds_read_b128 v[156:159], v14 offset:3072
 v_mfma_f32_32x32x16_bf16 v[160:175], v[108:111], v[140:143], v[160:175]
 s_waitcnt lgkmcnt(3)
 v_mfma_f32_32x32x16_bf16 v[160:175], v[112:115], v[144:147], v[160:175]
 s_waitcnt lgkmcnt(2)
 v_mfma_f32_32x32x16_bf16 v[160:175], v[116:119], v[148:151], v[160:175]
 s_waitcnt lgkmcnt(1)
 v_mfma_f32_32x32x16_bf16 v[160:175], v[120:123], v[152:155], v[160:175]
 s_waitcnt lgkmcnt(0)
 v_mfma_f32_32x32x16_bf16 v[160:175], v[124:127], v[156:159], v[160:175]
 v_readfirstlane_b32 s94, v61
 s_cbranch_vccz qa_disp
 s_cmp_lt_u32 s6, 64
 s_cselect_b32 s70, s94, 0
 s_bfe_u32 s88, s70, 0x10000
 s_lshl_b32 s81, s6, 15
 s_add_u32 s81, s81, 1818624
 s_mov_b32 s78, 0
 s_mul_i32 s96, s3, 8320
 s_add_u32 s96, s96, s78
 s_lshl_b32 s97, s3, 13
 s_add_u32 s97, s97, s81
 s_sub_u32 s97, s97, 1024
 v_mfma_f32_32x32x16_bf16 v[64:79], v[192:195], v[128:131], 0
 s_cmp_eq_u32 s88, 0
 s_cbranch_scc1 fd_157
 s_add_u32 m0, s96, 0
 s_add_u32 s97, s97, 1024
 buffer_load_dwordx4 v2, s[52:55], s97 offen sc1 lds
fd_157:
 v_mfma_f32_32x32x16_bf16 v[64:79], v[196:199], v[132:135], v[64:79]
 s_cmp_eq_u32 s88, 0
 s_cbranch_scc1 fd_158
 s_add_u32 m0, s96, 1040
 s_add_u32 s97, s97, 1024
 buffer_load_dwordx4 v2, s[52:55], s97 offen sc1 lds
fd_158:
 v_mfma_f32_32x32x16_bf16 v[64:79], v[200:203], v[136:139], v[64:79]
 s_cmp_eq_u32 s88, 0
 s_cbranch_scc1 fd_159
 s_add_u32 m0, s96, 2080
 s_add_u32 s97, s97, 1024
 buffer_load_dwordx4 v2, s[52:55], s97 offen sc1 lds
fd_159:
 v_mfma_f32_32x32x16_bf16 v[64:79], v[204:207], v[140:143], v[64:79]
 s_cmp_eq_u32 s88, 0
 s_cbranch_scc1 fd_160
 s_add_u32 m0, s96, 3120
 s_add_u32 s97, s97, 1024
 buffer_load_dwordx4 v2, s[52:55], s97 offen sc1 lds
fd_160:
 v_mfma_f32_32x32x16_bf16 v[64:79], v[208:211], v[144:147], v[64:79]
 s_cmp_eq_u32 s88, 0
 s_cbranch_scc1 fd_161
 s_add_u32 m0, s96, 4160
 s_add_u32 s97, s97, 1024
 buffer_load_dwordx4 v2, s[52:55], s97 offen sc1 lds
fd_161:
 v_mfma_f32_32x32x16_bf16 v[64:79], v[212:215], v[148:151], v[64:79]
 s_cmp_eq_u32 s88, 0
 s_cbranch_scc1 fd_162
 s_add_u32 m0, s96, 5200
 s_add_u32 s97, s97, 1024
 buffer_load_dwordx4 v2, s[52:55], s97 offen sc1 lds
fd_162:
 v_mfma_f32_32x32x16_bf16 v[64:79], v[216:219], v[152:155], v[64:79]
 s_cmp_eq_u32 s88, 0
 s_cbranch_scc1 fd_163
 s_add_u32 m0, s96, 6240
 s_add_u32 s97, s97, 1024
 buffer_load_dwordx4 v2, s[52:55], s97 offen sc1 lds
fd_163:
 v_mfma_f32_32x32x16_bf16 v[64:79], v[220:223], v[156:159], v[64:79]
 s_cmp_eq_u32 s88, 0
 s_cbranch_scc1 fd_164
 s_add_u32 m0, s96, 7280
 s_add_u32 s97, s97, 1024
 buffer_load_dwordx4 v2, s[52:55], s97 offen sc1 lds
fd_164:
 s_nop 3
 v_max3_f32 v5, v160, v161, v162
 v_max3_f32 v6, v163, v164, v165
 v_max3_f32 v5, v5, v166, v167
 v_max3_f32 v6, v6, v168, v169
 v_max3_f32 v5, v5, v170, v171
 v_max3_f32 v6, v6, v172, v173
 v_max3_f32 v5, v5, v174, v175
 v_max_f32 v5, v5, v6
 s_branch qa_Bt0
qa_B0:
 s_mov_b64 vcc, 0
 s_lshl_b32 s90, s86, 5
 s_add_u32 s90, s90, s84
 s_lshl_b32 s90, s90, 13
 s_lshl_b32 s73, s85, 12
 s_add_u32 s90, s90, s73
 s_xor_b32 s91, s90, 4096
 s_mov_b32 s67, s86
 s_mov_b32 s86, 64
 s_lshr_b32 s70, s90, 2
 s_add_u32 s70, s70, 73121792
 s_lshr_b32 s71, s91, 2
 s_add_u32 s71, s71, 73121792
 buffer_load_dwordx4 v[96:99], v11, s[52:55], s70 offen offset:0 sc1
 buffer_load_dwordx4 v[100:103], v11, s[52:55], s70 offen offset:256 sc1
 buffer_load_dwordx4 v[104:107], v11, s[52:55], s70 offen offset:512 sc1
 buffer_load_dwordx4 v[108:111], v11, s[52:55], s70 offen offset:768 sc1
 buffer_load_dwordx4 v[112:115], v11, s[52:55], s71 offen offset:0 sc1
 buffer_load_dwordx4 v[116:119], v11, s[52:55], s71 offen offset:256 sc1
 buffer_load_dwordx4 v[120:123], v11, s[52:55], s71 offen offset:512 sc1
 buffer_load_dwordx4 v[124:127], v11, s[52:55], s71 offen offset:768 sc1
 buffer_load_dwordx2 v[48:49], v12, s[52:55], s70 offen offset:0 sc1
 buffer_load_dwordx2 v[52:53], v12, s[52:55], s70 offen offset:512 sc1
 s_add_u32 s80, s90, 89899008
 v_max3_f32 v5, v160, v161, v162
 v_max3_f32 v6, v163, v164, v165
 v_max3_f32 v5, v5, v166, v167
 v_max3_f32 v6, v6, v168, v169
 v_max3_f32 v5, v5, v170, v171
 v_max3_f32 v6, v6, v172, v173
 v_max3_f32 v5, v5, v174, v175
 v_max_f32 v5, v5, v6
 s_waitcnt vmcnt(9)
 v_mfma_f32_32x32x16_bf16 v[64:79], v[96:99], v[128:131], 0
 s_waitcnt vmcnt(8)
 v_mfma_f32_32x32x16_bf16 v[64:79], v[100:103], v[132:135], v[64:79]
 s_waitcnt vmcnt(7)
 v_mfma_f32_32x32x16_bf16 v[64:79], v[104:107], v[136:139], v[64:79]
 s_waitcnt vmcnt(6)
 v_mfma_f32_32x32x16_bf16 v[64:79], v[108:111], v[140:143], v[64:79]
 s_waitcnt vmcnt(5)
 v_mfma_f32_32x32x16_bf16 v[64:79], v[112:115], v[144:147], v[64:79]
 s_waitcnt vmcnt(4)
 v_mfma_f32_32x32x16_bf16 v[64:79], v[116:119], v[148:151], v[64:79]
 s_waitcnt vmcnt(3)
 v_mfma_f32_32x32x16_bf16 v[64:79], v[120:123], v[152:155], v[64:79]
 s_waitcnt vmcnt(2)
 v_mfma_f32_32x32x16_bf16 v[64:79], v[124:127], v[156:159], v[64:79]
 s_waitcnt vmcnt(0)
 s_cmp_eq_u32 s69, 0
 s_cbranch_scc1 fp_165
 s_mov_b64 exec, 1
 buffer_store_dword v0, v10, s[52:55], s69 offen sc1
 s_mov_b64 exec, -1
 s_mov_b32 s69, 0
fp_165:
 s_bitcmp1_b32 s94, 0
 s_cbranch_scc0 tq_166
 s_cmp_lg_u32 s88, 0
 s_cbranch_scc1 tq_166
 s_cmp_ge_u32 s6, 64
 s_cbranch_scc1 tq_166
 s_lshl_b32 s81, s6, 15
 s_add_u32 s81, s81, 1818624
 s_mov_b32 s78, 0
 s_mul_i32 s96, s3, 8320
 s_add_u32 s96, s96, s78
 s_lshl_b32 s97, s3, 13
 s_add_u32 s97, s97, s81
 s_sub_u32 s97, s97, 1024
 s_add_u32 m0, s96, 0
 s_add_u32 s97, s97, 1024
 buffer_load_dwordx4 v2, s[52:55], s97 offen sc1 lds
 s_add_u32 m0, s96, 1040
 s_add_u32 s97, s97, 1024
 buffer_load_dwordx4 v2, s[52:55], s97 offen sc1 lds
 s_add_u32 m0, s96, 2080
 s_add_u32 s97, s97, 1024
 buffer_load_dwordx4 v2, s[52:55], s97 offen sc1 lds
 s_add_u32 m0, s96, 3120
 s_add_u32 s97, s97, 1024
 buffer_load_dwordx4 v2, s[52:55], s97 offen sc1 lds
 s_add_u32 m0, s96, 4160
 s_add_u32 s97, s97, 1024
 buffer_load_dwordx4 v2, s[52:55], s97 offen sc1 lds
 s_add_u32 m0, s96, 5200
 s_add_u32 s97, s97, 1024
 buffer_load_dwordx4 v2, s[52:55], s97 offen sc1 lds
 s_add_u32 m0, s96, 6240
 s_add_u32 s97, s97, 1024
 buffer_load_dwordx4 v2, s[52:55], s97 offen sc1 lds
 s_add_u32 m0, s96, 7280
 s_add_u32 s97, s97, 1024
 buffer_load_dwordx4 v2, s[52:55], s97 offen sc1 lds
 s_mov_b32 s88, 1
tq_166:
 s_bitcmp1_b32 s94, 1
 s_cbranch_scc0 tq_167
 s_cmp_lg_u32 s89, 0
 s_cbranch_scc1 tq_167
 s_cmp_ge_u32 s7, 64
 s_cbranch_scc1 tq_167
 s_lshl_b32 s81, s7, 15
 s_add_u32 s81, s81, 3915776
 s_mov_b32 s78, 33280
 s_mul_i32 s96, s3, 8320
 s_add_u32 s96, s96, s78
 s_lshl_b32 s97, s3, 13
 s_add_u32 s97, s97, s81
 s_sub_u32 s97, s97, 1024
 s_add_u32 m0, s96, 0
 s_add_u32 s97, s97, 1024
 buffer_load_dwordx4 v2, s[52:55], s97 offen sc1 lds
 s_add_u32 m0, s96, 1040
 s_add_u32 s97, s97, 1024
 buffer_load_dwordx4 v2, s[52:55], s97 offen sc1 lds
 s_add_u32 m0, s96, 2080
 s_add_u32 s97, s97, 1024
 buffer_load_dwordx4 v2, s[52:55], s97 offen sc1 lds
 s_add_u32 m0, s96, 3120
 s_add_u32 s97, s97, 1024
 buffer_load_dwordx4 v2, s[52:55], s97 offen sc1 lds
 s_add_u32 m0, s96, 4160
 s_add_u32 s97, s97, 1024
 buffer_load_dwordx4 v2, s[52:55], s97 offen sc1 lds
 s_add_u32 m0, s96, 5200
 s_add_u32 s97, s97, 1024
 buffer_load_dwordx4 v2, s[52:55], s97 offen sc1 lds
 s_add_u32 m0, s96, 6240
 s_add_u32 s97, s97, 1024
 buffer_load_dwordx4 v2, s[52:55], s97 offen sc1 lds
 s_add_u32 m0, s96, 7280
 s_add_u32 s97, s97, 1024
 buffer_load_dwordx4 v2, s[52:55], s97 offen sc1 lds
 s_mov_b32 s89, 1
tq_167:
 s_cmp_lg_u32 s3, 0
 s_cbranch_scc1 qp_168
 s_mov_b32 exec_hi, 0
 s_min_u32 s70, s6, 63
 s_lshl_b32 s70, s70, 11
 s_mov_b32 exec_lo, 0xff
 v_add_u32 v15, s70, v56
 s_min_u32 s70, s7, 63
 s_lshl_b32 s70, s70, 11
 s_mov_b32 exec_lo, 0xff00
 v_add_u32 v15, s70, v56
 s_cmp_lt_u32 s86, 64
 s_cselect_b32 s70, s86, s6
 s_min_u32 s70, s70, 63
 s_lshl_b32 s70, s70, 11
 s_mov_b32 exec_lo, 0xff0000
 v_add_u32 v15, s70, v56
 s_cmp_lt_u32 s87, 64
 s_cselect_b32 s70, s87, s7
 s_min_u32 s70, s70, 63
 s_lshl_b32 s70, s70, 11
 s_mov_b32 exec_lo, 0xff000000
 v_add_u32 v15, s70, v56
 s_mov_b32 exec_lo, -1
 buffer_load_dword v62, v15, s[52:55], 0 offen sc1
 s_mov_b64 exec, -1
qp_168:
 s_nop 7
qa_Bt0:
 v_max3_f32 v5, v5, v64, v65
 v_max3_f32 v5, v5, v66, v67
 v_mov_b32 v6, v5
 s_nop 1
 v_permlane32_swap_b32 v5, v6
 s_nop 0
 v_max_f32 v6, v5, v6
 v_mul_f32 v6, s82, v6
 v_pk_fma_f32 v[16:17], v[160:161], s[82:83], v[6:7] op_sel_hi:[1,1,0] neg_lo:[0,0,1] neg_hi:[0,0,1]
 v_pk_fma_f32 v[18:19], v[162:163], s[82:83], v[6:7] op_sel_hi:[1,1,0] neg_lo:[0,0,1] neg_hi:[0,0,1]
 v_pk_fma_f32 v[20:21], v[164:165], s[82:83], v[6:7] op_sel_hi:[1,1,0] neg_lo:[0,0,1] neg_hi:[0,0,1]
 v_pk_fma_f32 v[22:23], v[166:167], s[82:83], v[6:7] op_sel_hi:[1,1,0] neg_lo:[0,0,1] neg_hi:[0,0,1]
 v_pk_fma_f32 v[24:25], v[168:169], s[82:83], v[6:7] op_sel_hi:[1,1,0] neg_lo:[0,0,1] neg_hi:[0,0,1]
 v_pk_fma_f32 v[26:27], v[170:171], s[82:83], v[6:7] op_sel_hi:[1,1,0] neg_lo:[0,0,1] neg_hi:[0,0,1]
 v_pk_fma_f32 v[28:29], v[172:173], s[82:83], v[6:7] op_sel_hi:[1,1,0] neg_lo:[0,0,1] neg_hi:[0,0,1]
 v_pk_fma_f32 v[30:31], v[174:175], s[82:83], v[6:7] op_sel_hi:[1,1,0] neg_lo:[0,0,1] neg_hi:[0,0,1]
 v_pk_fma_f32 v[32:33], v[64:65], s[82:83], v[6:7] op_sel_hi:[1,1,0] neg_lo:[0,0,1] neg_hi:[0,0,1]
 v_pk_fma_f32 v[34:35], v[66:67], s[82:83], v[6:7] op_sel_hi:[1,1,0] neg_lo:[0,0,1] neg_hi:[0,0,1]
 v_exp_f32 v16, v16
 v_exp_f32 v17, v17
 v_exp_f32 v18, v18
 v_exp_f32 v19, v19
 v_exp_f32 v20, v20
 v_exp_f32 v21, v21
 v_exp_f32 v22, v22
 v_exp_f32 v23, v23
 v_exp_f32 v24, v24
 v_exp_f32 v25, v25
 v_exp_f32 v26, v26
 v_exp_f32 v27, v27
 v_exp_f32 v28, v28
 v_exp_f32 v29, v29
 v_exp_f32 v30, v30
 v_exp_f32 v31, v31
 v_exp_f32 v32, v32
 v_exp_f32 v33, v33
 v_exp_f32 v34, v34
 v_exp_f32 v35, v35
 s_nop 0
 v_pk_add_f32 v[80:81], v[16:17], v[26:27]
 v_pk_add_f32 v[82:83], v[18:19], v[28:29]
 v_pk_add_f32 v[84:85], v[20:21], v[30:31]
 v_pk_add_f32 v[86:87], v[22:23], v[32:33]
 v_pk_add_f32 v[88:89], v[24:25], v[34:35]
 v_pk_add_f32 v[80:81], v[80:81], v[82:83]
 v_pk_add_f32 v[84:85], v[84:85], v[86:87]
 v_pk_add_f32 v[80:81], v[80:81], v[88:89]
 v_pk_add_f32 v[80:81], v[80:81], v[84:85]
 v_add_f32 v80, v80, v81
 v_mov_b32 v81, v80
 s_nop 1
 v_permlane32_swap_b32 v80, v81
 s_nop 0
 v_add_f32 v80, v80, v81
 v_rcp_f32 v80, v80
 v_mov_b64 v[46:47], 0
 v_pk_mul_f32 v[16:17], v[16:17], v[80:81] op_sel_hi:[1,0]
 v_pk_mul_f32 v[18:19], v[18:19], v[80:81] op_sel_hi:[1,0]
 v_pk_mul_f32 v[20:21], v[20:21], v[80:81] op_sel_hi:[1,0]
 v_pk_mul_f32 v[22:23], v[22:23], v[80:81] op_sel_hi:[1,0]
 v_pk_mul_f32 v[24:25], v[24:25], v[80:81] op_sel_hi:[1,0]
 v_pk_mul_f32 v[26:27], v[26:27], v[80:81] op_sel_hi:[1,0]
 v_pk_mul_f32 v[28:29], v[28:29], v[80:81] op_sel_hi:[1,0]
 v_pk_mul_f32 v[30:31], v[30:31], v[80:81] op_sel_hi:[1,0]
 v_pk_mul_f32 v[32:33], v[32:33], v[80:81] op_sel_hi:[1,0]
 v_pk_mul_f32 v[34:35], v[34:35], v[80:81] op_sel_hi:[1,0]
 v_cvt_pk_bf16_f32 v36, v16, v17
 v_cvt_pk_bf16_f32 v37, v18, v19
 v_cvt_pk_bf16_f32 v38, v20, v21
 v_cvt_pk_bf16_f32 v39, v22, v23
 v_cvt_pk_bf16_f32 v40, v24, v25
 v_cvt_pk_bf16_f32 v41, v26, v27
 v_cvt_pk_bf16_f32 v42, v28, v29
 v_cvt_pk_bf16_f32 v43, v30, v31
 v_cvt_pk_bf16_f32 v44, v32, v33
 v_cvt_pk_bf16_f32 v45, v34, v35
 s_nop 1
 v_mfma_f32_32x32x16_bf16 v[64:79], v[176:179], v[36:39], 0
 v_mfma_f32_32x32x16_bf16 v[80:95], v[184:187], v[36:39], 0
 v_mfma_f32_32x32x16_bf16 v[64:79], v[180:183], v[40:43], v[64:79]
 v_mfma_f32_32x32x16_bf16 v[80:95], v[188:191], v[40:43], v[80:95]
 v_mfma_f32_32x32x16_bf16 v[64:79], v[48:51], v[44:47], v[64:79]
 v_mfma_f32_32x32x16_bf16 v[80:95], v[52:55], v[44:47], v[80:95]
 s_mov_b32 s71, 0
 s_mul_i32 s69, s71, 65
 s_add_u32 s69, s69, s67
 s_lshl_b32 s69, s69, 8
 s_add_u32 s69, s69, 166400
 s_add_u32 s69, s69, s98
 s_nop 5
 v_cvt_pk_bf16_f32 v96, v64, v65
 v_cvt_pk_bf16_f32 v97, v66, v67
 v_cvt_pk_bf16_f32 v98, v68, v69
 v_cvt_pk_bf16_f32 v99, v70, v71
 buffer_store_dwordx4 v[96:99], v2, s[52:55], s80 offen offset:0 sc1
 v_cvt_pk_bf16_f32 v100, v72, v73
 v_cvt_pk_bf16_f32 v101, v74, v75
 v_cvt_pk_bf16_f32 v102, v76, v77
 v_cvt_pk_bf16_f32 v103, v78, v79
 buffer_store_dwordx4 v[100:103], v2, s[52:55], s80 offen offset:1024 sc1
 v_cvt_pk_bf16_f32 v104, v80, v81
 v_cvt_pk_bf16_f32 v105, v82, v83
 v_cvt_pk_bf16_f32 v106, v84, v85
 v_cvt_pk_bf16_f32 v107, v86, v87
 buffer_store_dwordx4 v[104:107], v2, s[52:55], s80 offen offset:2048 sc1
 v_cvt_pk_bf16_f32 v108, v88, v89
 v_cvt_pk_bf16_f32 v109, v90, v91
 v_cvt_pk_bf16_f32 v110, v92, v93
 v_cvt_pk_bf16_f32 v111, v94, v95
 buffer_store_dwordx4 v[108:111], v2, s[52:55], s80 offen offset:3072 sc1
 s_waitcnt vmcnt(4)
 s_cbranch_vccnz qa_disp
 s_branch qa_sched
qa_A1:
 s_bitcmp1_b32 s94, 3
 s_cselect_b32 s70, s86, 0
 s_cmp_ge_u32 s70, 64
 s_cselect_b64 vcc, -1, 0
 s_cselect_b32 s87, 64, s7
 s_cbranch_scc1 fu_169
 s_waitcnt vmcnt(0)
 s_cmp_eq_u32 s69, 0
 s_cbranch_scc1 fp_170
 s_mov_b64 exec, 1
 buffer_store_dword v0, v10, s[52:55], s69 offen sc1
 s_mov_b64 exec, -1
 s_mov_b32 s69, 0
fp_170:
fu_169:
 s_barrier
 ds_read_b128 v[224:227], v60 offset:0
 ds_read_b128 v[228:231], v60 offset:1024
 ds_read_b128 v[232:235], v60 offset:2048
 ds_read_b128 v[236:239], v60 offset:3072
 ds_read_b128 v[16:19], v3 offset:33280
 ds_read_b128 v[20:23], v3 offset:33312
 ds_read_b128 v[24:27], v3 offset:33344
 ds_read_b128 v[28:31], v3 offset:33376
 ds_read_b128 v[32:35], v3 offset:33408
 ds_read_b128 v[36:39], v3 offset:33440
 ds_read_b128 v[40:43], v3 offset:33472
 s_waitcnt lgkmcnt(6)
 v_mfma_f32_32x32x16_bf16 v[64:79], a[0:3], v[16:19], 0
 v_mfma_f32_32x32x16_bf16 v[80:95], a[4:7], v[16:19], 0
 s_lshl_b32 s90, s7, 5
 s_add_u32 s90, s90, s84
 s_lshl_b32 s90, s90, 13
 s_lshl_b32 s73, s85, 12
 s_add_u32 s90, s90, s73
 s_xor_b32 s91, s90, 4096
 ds_read_b128 v[44:47], v3 offset:33504
 s_waitcnt lgkmcnt(6)
 v_mfma_f32_32x32x16_bf16 v[64:79], a[8:11], v[20:23], v[64:79]
 v_mfma_f32_32x32x16_bf16 v[80:95], a[12:15], v[20:23], v[80:95]
 s_mov_b32 s67, s7
 s_add_u32 s70, s7, 1
 s_cmp_lt_u32 s70, 33
 s_cselect_b32 s70, s70, s66
 s_add_u32 s71, s7, 3
 s_cmp_lt_u32 s7, 33
 s_cselect_b32 s7, s70, s71
 ds_read_b128 v[16:19], v3 offset:33536
 s_waitcnt lgkmcnt(6)
 v_mfma_f32_32x32x16_bf16 v[64:79], a[16:19], v[24:27], v[64:79]
 v_mfma_f32_32x32x16_bf16 v[80:95], a[20:23], v[24:27], v[80:95]
 s_mov_b32 s89, 0
 s_add_u32 s70, s90, 22790144
 s_add_u32 s71, s91, 22790144
 s_add_u32 s72, s90, 56344576
 s_lshr_b32 s73, s90, 2
 s_add_u32 s73, s73, 77316096
 s_xor_b32 s74, s73, 1024
 s_add_u32 s80, s90, 106676224
 ds_read_b128 v[20:23], v3 offset:33568
 s_waitcnt lgkmcnt(6)
 v_mfma_f32_32x32x16_bf16 v[64:79], a[24:27], v[28:31], v[64:79]
 v_mfma_f32_32x32x16_bf16 v[80:95], a[28:31], v[28:31], v[80:95]
 buffer_load_dwordx4 v[96:99], v2, s[52:55], s70 offen offset:0 sc1
 ds_read_b128 v[24:27], v3 offset:33600
 s_waitcnt lgkmcnt(6)
 v_mfma_f32_32x32x16_bf16 v[64:79], a[32:35], v[32:35], v[64:79]
 v_mfma_f32_32x32x16_bf16 v[80:95], a[36:39], v[32:35], v[80:95]
 buffer_load_dwordx4 v[100:103], v2, s[52:55], s70 offen offset:1024 sc1
 ds_read_b128 v[28:31], v3 offset:33632
 s_waitcnt lgkmcnt(6)
 v_mfma_f32_32x32x16_bf16 v[64:79], a[40:43], v[36:39], v[64:79]
 v_mfma_f32_32x32x16_bf16 v[80:95], a[44:47], v[36:39], v[80:95]
 buffer_load_dwordx4 v[104:107], v2, s[52:55], s70 offen offset:2048 sc1
 ds_read_b128 v[32:35], v3 offset:33664
 s_waitcnt lgkmcnt(6)
 v_mfma_f32_32x32x16_bf16 v[64:79], a[48:51], v[40:43], v[64:79]
 v_mfma_f32_32x32x16_bf16 v[80:95], a[52:55], v[40:43], v[80:95]
 buffer_load_dwordx4 v[108:111], v2, s[52:55], s70 offen offset:3072 sc1
 ds_read_b128 v[36:39], v3 offset:33696
 s_waitcnt lgkmcnt(6)
 v_mfma_f32_32x32x16_bf16 v[64:79], a[56:59], v[44:47], v[64:79]
 v_mfma_f32_32x32x16_bf16 v[80:95], a[60:63], v[44:47], v[80:95]
 buffer_load_dwordx4 v[112:115], v2, s[52:55], s71 offen offset:0 sc1
 ds_read_b128 v[40:43], v3 offset:33728
 s_waitcnt lgkmcnt(6)
 v_mfma_f32_32x32x16_bf16 v[64:79], a[64:67], v[16:19], v[64:79]
 v_mfma_f32_32x32x16_bf16 v[80:95], a[68:71], v[16:19], v[80:95]
 buffer_load_dwordx4 v[116:119], v2, s[52:55], s71 offen offset:1024 sc1
 ds_read_b128 v[44:47], v3 offset:33760
 s_waitcnt lgkmcnt(6)
 v_mfma_f32_32x32x16_bf16 v[64:79], a[72:75], v[20:23], v[64:79]
 v_mfma_f32_32x32x16_bf16 v[80:95], a[76:79], v[20:23], v[80:95]
 buffer_load_dwordx4 v[120:123], v2, s[52:55], s71 offen offset:2048 sc1
 ds_read_b128 v[16:19], v3 offset:33792
 s_waitcnt lgkmcnt(6)
 v_mfma_f32_32x32x16_bf16 v[64:79], a[80:83], v[24:27], v[64:79]
 v_mfma_f32_32x32x16_bf16 v[80:95], a[84:87], v[24:27], v[80:95]
 buffer_load_dwordx4 v[124:127], v2, s[52:55], s71 offen offset:3072 sc1
 ds_read_b128 v[20:23], v3 offset:33824
 s_waitcnt lgkmcnt(6)
 v_mfma_f32_32x32x16_bf16 v[64:79], a[88:91], v[28:31], v[64:79]
 v_mfma_f32_32x32x16_bf16 v[80:95], a[92:95], v[28:31], v[80:95]
 buffer_load_dwordx4 v[240:243], v2, s[52:55], s72 offen offset:0 sc1
 ds_read_b128 v[24:27], v3 offset:33856
 s_waitcnt lgkmcnt(6)
 v_mfma_f32_32x32x16_bf16 v[64:79], a[96:99], v[32:35], v[64:79]
 v_mfma_f32_32x32x16_bf16 v[80:95], a[100:103], v[32:35], v[80:95]
 buffer_load_dwordx4 v[244:247], v2, s[52:55], s72 offen offset:1024 sc1
 ds_read_b128 v[28:31], v3 offset:33888
 s_waitcnt lgkmcnt(6)
 v_mfma_f32_32x32x16_bf16 v[64:79], a[104:107], v[36:39], v[64:79]
 v_mfma_f32_32x32x16_bf16 v[80:95], a[108:111], v[36:39], v[80:95]
 buffer_load_dwordx4 v[248:251], v2, s[52:55], s72 offen offset:2048 sc1
 ds_read_b128 v[32:35], v3 offset:33920
 s_waitcnt lgkmcnt(6)
 v_mfma_f32_32x32x16_bf16 v[64:79], a[112:115], v[40:43], v[64:79]
 v_mfma_f32_32x32x16_bf16 v[80:95], a[116:119], v[40:43], v[80:95]
 buffer_load_dwordx4 v[252:255], v2, s[52:55], s72 offen offset:3072 sc1
 ds_read_b128 v[36:39], v3 offset:33952
 s_waitcnt lgkmcnt(6)
 v_mfma_f32_32x32x16_bf16 v[64:79], a[120:123], v[44:47], v[64:79]
 v_mfma_f32_32x32x16_bf16 v[80:95], a[124:127], v[44:47], v[80:95]
 s_cbranch_vccz fx_171
 buffer_load_dwordx4 v[128:131], v11, s[52:55], s73 offen offset:0 sc1
 buffer_load_dwordx4 v[132:135], v11, s[52:55], s73 offen offset:256 sc1
fx_171:
 ds_read_b128 v[40:43], v3 offset:33984
 s_waitcnt lgkmcnt(6)
 v_mfma_f32_32x32x16_bf16 v[64:79], a[128:131], v[16:19], v[64:79]
 v_mfma_f32_32x32x16_bf16 v[80:95], a[132:135], v[16:19], v[80:95]
 s_cbranch_vccz fx_172
 buffer_load_dwordx4 v[136:139], v11, s[52:55], s73 offen offset:512 sc1
 buffer_load_dwordx4 v[140:143], v11, s[52:55], s73 offen offset:768 sc1
fx_172:
 ds_read_b128 v[44:47], v3 offset:34016
 s_waitcnt lgkmcnt(6)
 v_mfma_f32_32x32x16_bf16 v[64:79], a[136:139], v[20:23], v[64:79]
 v_mfma_f32_32x32x16_bf16 v[80:95], a[140:143], v[20:23], v[80:95]
 s_cbranch_vccz fx_173
 buffer_load_dwordx4 v[144:147], v11, s[52:55], s74 offen offset:0 sc1
 buffer_load_dwordx4 v[148:151], v11, s[52:55], s74 offen offset:256 sc1
fx_173:
 ds_read_b128 v[16:19], v3 offset:34048
 s_waitcnt lgkmcnt(6)
 v_mfma_f32_32x32x16_bf16 v[64:79], a[144:147], v[24:27], v[64:79]
 v_mfma_f32_32x32x16_bf16 v[80:95], a[148:151], v[24:27], v[80:95]
 s_cbranch_vccz fx_174
 buffer_load_dwordx4 v[152:155], v11, s[52:55], s74 offen offset:512 sc1
 buffer_load_dwordx4 v[156:159], v11, s[52:55], s74 offen offset:768 sc1
fx_174:
 ds_read_b128 v[20:23], v3 offset:34080
 s_waitcnt lgkmcnt(6)
 v_mfma_f32_32x32x16_bf16 v[64:79], a[152:155], v[28:31], v[64:79]
 v_mfma_f32_32x32x16_bf16 v[80:95], a[156:159], v[28:31], v[80:95]
 s_cbranch_vccz fx_175
 buffer_load_dwordx2 v[48:49], v12, s[52:55], s73 offen offset:0 sc1
 buffer_load_dwordx2 v[52:53], v12, s[52:55], s73 offen offset:512 sc1
fx_175:
 ds_read_b128 v[24:27], v3 offset:34112
 s_waitcnt lgkmcnt(6)
 v_mfma_f32_32x32x16_bf16 v[64:79], a[160:163], v[32:35], v[64:79]
 v_mfma_f32_32x32x16_bf16 v[80:95], a[164:167], v[32:35], v[80:95]
 s_cmp_lg_u32 s3, 0
 s_cbranch_scc1 qp_176
 s_mov_b32 exec_hi, 0
 s_min_u32 s70, s6, 63
 s_lshl_b32 s70, s70, 11
 s_mov_b32 exec_lo, 0xff
 v_add_u32 v15, s70, v56
 s_min_u32 s70, s7, 63
 s_lshl_b32 s70, s70, 11
 s_mov_b32 exec_lo, 0xff00
 v_add_u32 v15, s70, v56
 s_cmp_lt_u32 s86, 64
 s_cselect_b32 s70, s86, s6
 s_min_u32 s70, s70, 63
 s_lshl_b32 s70, s70, 11
 s_mov_b32 exec_lo, 0xff0000
 v_add_u32 v15, s70, v56
 s_cmp_lt_u32 s87, 64
 s_cselect_b32 s70, s87, s7
 s_min_u32 s70, s70, 63
 s_lshl_b32 s70, s70, 11
 s_mov_b32 exec_lo, 0xff000000
 v_add_u32 v15, s70, v56
 s_mov_b32 exec_lo, -1
 buffer_load_dword v62, v15, s[52:55], 0 offen sc1
 s_mov_b64 exec, -1
qp_176:
 ds_read_b128 v[28:31], v3 offset:34144
 s_waitcnt lgkmcnt(6)
 v_mfma_f32_32x32x16_bf16 v[64:79], a[168:171], v[36:39], v[64:79]
 v_mfma_f32_32x32x16_bf16 v[80:95], a[172:175], v[36:39], v[80:95]
 ds_read_b128 v[32:35], v3 offset:34176
 s_waitcnt lgkmcnt(6)
 v_mfma_f32_32x32x16_bf16 v[64:79], a[176:179], v[40:43], v[64:79]
 v_mfma_f32_32x32x16_bf16 v[80:95], a[180:183], v[40:43], v[80:95]
 ds_read_b128 v[36:39], v3 offset:34208
 s_waitcnt lgkmcnt(6)
 v_mfma_f32_32x32x16_bf16 v[64:79], a[184:187], v[44:47], v[64:79]
 v_mfma_f32_32x32x16_bf16 v[80:95], a[188:191], v[44:47], v[80:95]
 ds_read_b128 v[40:43], v3 offset:34240
 s_waitcnt lgkmcnt(6)
 v_mfma_f32_32x32x16_bf16 v[64:79], a[192:195], v[16:19], v[64:79]
 v_mfma_f32_32x32x16_bf16 v[80:95], a[196:199], v[16:19], v[80:95]
 ds_read_b128 v[44:47], v3 offset:34272
 s_waitcnt lgkmcnt(6)
 v_mfma_f32_32x32x16_bf16 v[64:79], a[200:203], v[20:23], v[64:79]
 v_mfma_f32_32x32x16_bf16 v[80:95], a[204:207], v[20:23], v[80:95]
 s_waitcnt lgkmcnt(5)
 v_mfma_f32_32x32x16_bf16 v[64:79], a[208:211], v[24:27], v[64:79]
 v_mfma_f32_32x32x16_bf16 v[80:95], a[212:215], v[24:27], v[80:95]
 s_waitcnt lgkmcnt(4)
 v_mfma_f32_32x32x16_bf16 v[64:79], a[216:219], v[28:31], v[64:79]
 v_mfma_f32_32x32x16_bf16 v[80:95], a[220:223], v[28:31], v[80:95]
 s_waitcnt lgkmcnt(3)
 v_mfma_f32_32x32x16_bf16 v[64:79], a[224:227], v[32:35], v[64:79]
 v_mfma_f32_32x32x16_bf16 v[80:95], a[228:231], v[32:35], v[80:95]
 s_waitcnt lgkmcnt(2)
 v_mfma_f32_32x32x16_bf16 v[64:79], a[232:235], v[36:39], v[64:79]
 v_mfma_f32_32x32x16_bf16 v[80:95], a[236:239], v[36:39], v[80:95]
 s_waitcnt lgkmcnt(1)
 v_mfma_f32_32x32x16_bf16 v[64:79], a[240:243], v[40:43], v[64:79]
 v_mfma_f32_32x32x16_bf16 v[80:95], a[244:247], v[40:43], v[80:95]
 s_waitcnt vmcnt(0)
 s_cmp_eq_u32 s69, 0
 s_cbranch_scc1 fp_177
 s_mov_b64 exec, 1
 buffer_store_dword v0, v10, s[52:55], s69 offen sc1
 s_mov_b64 exec, -1
 s_mov_b32 s69, 0
fp_177:
 s_cmp_lg_u32 s3, 0
 s_cbranch_scc1 pb_178
 v_cmp_eq_u32 s[74:75], 1, v62
 s_mov_b32 s70, 0
 s_bfe_u32 s71, s74, 0x80000
 s_cmp_eq_u32 s71, 0xff
 s_cselect_b32 s71, 1, 0
 s_or_b32 s70, s70, s71
 s_bfe_u32 s71, s74, 0x80008
 s_cmp_eq_u32 s71, 0xff
 s_cselect_b32 s71, 2, 0
 s_or_b32 s70, s70, s71
 s_bfe_u32 s71, s74, 0x80010
 s_cmp_eq_u32 s71, 0xff
 s_cselect_b32 s71, 4, 0
 s_or_b32 s70, s70, s71
 s_bfe_u32 s71, s74, 0x80018
 s_cmp_eq_u32 s71, 0xff
 s_cselect_b32 s71, 8, 0
 s_or_b32 s70, s70, s71
 v_mov_b32 v5, s70
 v_mov_b32 v6, s95
 ds_write_b32 v6, v5
pb_178:
 v_mov_b32 v6, s95
 s_xor_b32 s95, s95, 4
 s_waitcnt lgkmcnt(0)
 v_mfma_f32_32x32x16_bf16 v[64:79], a[248:251], v[44:47], v[64:79]
 v_mfma_f32_32x32x16_bf16 v[80:95], a[252:255], v[44:47], v[80:95]
 s_nop 10
 v_cvt_pk_bf16_f32 v192, v64, v65
 v_cvt_pk_bf16_f32 v193, v66, v67
 v_cvt_pk_bf16_f32 v194, v68, v69
 v_cvt_pk_bf16_f32 v195, v70, v71
 ds_write_b128 v13, v[192:195] offset:0
 v_cvt_pk_bf16_f32 v196, v72, v73
 v_cvt_pk_bf16_f32 v197, v74, v75
 v_cvt_pk_bf16_f32 v198, v76, v77
 v_cvt_pk_bf16_f32 v199, v78, v79
 ds_write_b128 v13, v[196:199] offset:1024
 v_mfma_f32_32x32x16_bf16 v[224:239], v[96:99], v[192:195], v[224:239]
 v_cvt_pk_bf16_f32 v200, v80, v81
 v_cvt_pk_bf16_f32 v201, v82, v83
 v_cvt_pk_bf16_f32 v202, v84, v85
 v_cvt_pk_bf16_f32 v203, v86, v87
 ds_write_b128 v13, v[200:203] offset:2048
 v_mfma_f32_32x32x16_bf16 v[224:239], v[100:103], v[196:199], v[224:239]
 v_cvt_pk_bf16_f32 v204, v88, v89
 v_cvt_pk_bf16_f32 v205, v90, v91
 v_cvt_pk_bf16_f32 v206, v92, v93
 v_cvt_pk_bf16_f32 v207, v94, v95
 ds_write_b128 v13, v[204:207] offset:3072
 v_mfma_f32_32x32x16_bf16 v[224:239], v[104:107], v[200:203], v[224:239]
 s_waitcnt lgkmcnt(0)
 s_barrier
 ds_read_b32 v61, v6
 ds_read_b128 v[208:211], v14 offset:0
 ds_read_b128 v[212:215], v14 offset:1024
 ds_read_b128 v[216:219], v14 offset:2048
 ds_read_b128 v[220:223], v14 offset:3072
 v_mfma_f32_32x32x16_bf16 v[224:239], v[108:111], v[204:207], v[224:239]
 s_waitcnt lgkmcnt(3)
 v_mfma_f32_32x32x16_bf16 v[224:239], v[112:115], v[208:211], v[224:239]
 s_waitcnt lgkmcnt(2)
 v_mfma_f32_32x32x16_bf16 v[224:239], v[116:119], v[212:215], v[224:239]
 s_waitcnt lgkmcnt(1)
 v_mfma_f32_32x32x16_bf16 v[224:239], v[120:123], v[216:219], v[224:239]
 s_waitcnt lgkmcnt(0)
 v_mfma_f32_32x32x16_bf16 v[224:239], v[124:127], v[220:223], v[224:239]
 v_readfirstlane_b32 s94, v61
 s_cbranch_vccz qa_disp
 s_cmp_lt_u32 s7, 64
 s_cselect_b32 s70, s94, 0
 s_bfe_u32 s89, s70, 0x10001
 s_lshl_b32 s81, s7, 15
 s_add_u32 s81, s81, 3915776
 s_mov_b32 s78, 33280
 s_mul_i32 s96, s3, 8320
 s_add_u32 s96, s96, s78
 s_lshl_b32 s97, s3, 13
 s_add_u32 s97, s97, s81
 s_sub_u32 s97, s97, 1024
 v_mfma_f32_32x32x16_bf16 v[64:79], v[128:131], v[192:195], 0
 s_cmp_eq_u32 s89, 0
 s_cbranch_scc1 fd_179
 s_add_u32 m0, s96, 0
 s_add_u32 s97, s97, 1024
 buffer_load_dwordx4 v2, s[52:55], s97 offen sc1 lds
fd_179:
 v_mfma_f32_32x32x16_bf16 v[64:79], v[132:135], v[196:199], v[64:79]
 s_cmp_eq_u32 s89, 0
 s_cbranch_scc1 fd_180
 s_add_u32 m0, s96, 1040
 s_add_u32 s97, s97, 1024
 buffer_load_dwordx4 v2, s[52:55], s97 offen sc1 lds
fd_180:
 v_mfma_f32_32x32x16_bf16 v[64:79], v[136:139], v[200:203], v[64:79]
 s_cmp_eq_u32 s89, 0
 s_cbranch_scc1 fd_181
 s_add_u32 m0, s96, 2080
 s_add_u32 s97, s97, 1024
 buffer_load_dwordx4 v2, s[52:55], s97 offen sc1 lds
fd_181:
 v_mfma_f32_32x32x16_bf16 v[64:79], v[140:143], v[204:207], v[64:79]
 s_cmp_eq_u32 s89, 0
 s_cbranch_scc1 fd_182
 s_add_u32 m0, s96, 3120
 s_add_u32 s97, s97, 1024
 buffer_load_dwordx4 v2, s[52:55], s97 offen sc1 lds
fd_182:
 v_mfma_f32_32x32x16_bf16 v[64:79], v[144:147], v[208:211], v[64:79]
 s_cmp_eq_u32 s89, 0
 s_cbranch_scc1 fd_183
 s_add_u32 m0, s96, 4160
 s_add_u32 s97, s97, 1024
 buffer_load_dwordx4 v2, s[52:55], s97 offen sc1 lds
fd_183:
 v_mfma_f32_32x32x16_bf16 v[64:79], v[148:151], v[212:215], v[64:79]
 s_cmp_eq_u32 s89, 0
 s_cbranch_scc1 fd_184
 s_add_u32 m0, s96, 5200
 s_add_u32 s97, s97, 1024
 buffer_load_dwordx4 v2, s[52:55], s97 offen sc1 lds
fd_184:
 v_mfma_f32_32x32x16_bf16 v[64:79], v[152:155], v[216:219], v[64:79]
 s_cmp_eq_u32 s89, 0
 s_cbranch_scc1 fd_185
 s_add_u32 m0, s96, 6240
 s_add_u32 s97, s97, 1024
 buffer_load_dwordx4 v2, s[52:55], s97 offen sc1 lds
fd_185:
 v_mfma_f32_32x32x16_bf16 v[64:79], v[156:159], v[220:223], v[64:79]
 s_cmp_eq_u32 s89, 0
 s_cbranch_scc1 fd_186
 s_add_u32 m0, s96, 7280
 s_add_u32 s97, s97, 1024
 buffer_load_dwordx4 v2, s[52:55], s97 offen sc1 lds
fd_186:
 s_nop 3
 v_max3_f32 v5, v224, v225, v226
 v_max3_f32 v6, v227, v228, v229
 v_max3_f32 v5, v5, v230, v231
 v_max3_f32 v6, v6, v232, v233
 v_max3_f32 v5, v5, v234, v235
 v_max3_f32 v6, v6, v236, v237
 v_max3_f32 v5, v5, v238, v239
 v_max_f32 v5, v5, v6
 s_branch qa_Bt1
qa_B1:
 s_mov_b64 vcc, 0
 s_lshl_b32 s90, s87, 5
 s_add_u32 s90, s90, s84
 s_lshl_b32 s90, s90, 13
 s_lshl_b32 s73, s85, 12
 s_add_u32 s90, s90, s73
 s_xor_b32 s91, s90, 4096
 s_mov_b32 s67, s87
 s_mov_b32 s87, 64
 s_lshr_b32 s70, s90, 2
 s_add_u32 s70, s70, 77316096
 s_lshr_b32 s71, s91, 2
 s_add_u32 s71, s71, 77316096
 buffer_load_dwordx4 v[96:99], v11, s[52:55], s70 offen offset:0 sc1
 buffer_load_dwordx4 v[100:103], v11, s[52:55], s70 offen offset:256 sc1
 buffer_load_dwordx4 v[104:107], v11, s[52:55], s70 offen offset:512 sc1
 buffer_load_dwordx4 v[108:111], v11, s[52:55], s70 offen offset:768 sc1
 buffer_load_dwordx4 v[112:115], v11, s[52:55], s71 offen offset:0 sc1
 buffer_load_dwordx4 v[116:119], v11, s[52:55], s71 offen offset:256 sc1
 buffer_load_dwordx4 v[120:123], v11, s[52:55], s71 offen offset:512 sc1
 buffer_load_dwordx4 v[124:127], v11, s[52:55], s71 offen offset:768 sc1
 buffer_load_dwordx2 v[48:49], v12, s[52:55], s70 offen offset:0 sc1
 buffer_load_dwordx2 v[52:53], v12, s[52:55], s70 offen offset:512 sc1
 s_add_u32 s80, s90, 106676224
 v_max3_f32 v5, v224, v225, v226
 v_max3_f32 v6, v227, v228, v229
 v_max3_f32 v5, v5, v230, v231
 v_max3_f32 v6, v6, v232, v233
 v_max3_f32 v5, v5, v234, v235
 v_max3_f32 v6, v6, v236, v237
 v_max3_f32 v5, v5, v238, v239
 v_max_f32 v5, v5, v6
 s_waitcnt vmcnt(9)
 v_mfma_f32_32x32x16_bf16 v[64:79], v[96:99], v[192:195], 0
 s_waitcnt vmcnt(8)
 v_mfma_f32_32x32x16_bf16 v[64:79], v[100:103], v[196:199], v[64:79]
 s_waitcnt vmcnt(7)
 v_mfma_f32_32x32x16_bf16 v[64:79], v[104:107], v[200:203], v[64:79]
 s_waitcnt vmcnt(6)
 v_mfma_f32_32x32x16_bf16 v[64:79], v[108:111], v[204:207], v[64:79]
 s_waitcnt vmcnt(5)
 v_mfma_f32_32x32x16_bf16 v[64:79], v[112:115], v[208:211], v[64:79]
 s_waitcnt vmcnt(4)
 v_mfma_f32_32x32x16_bf16 v[64:79], v[116:119], v[212:215], v[64:79]
 s_waitcnt vmcnt(3)
 v_mfma_f32_32x32x16_bf16 v[64:79], v[120:123], v[216:219], v[64:79]
 s_waitcnt vmcnt(2)
 v_mfma_f32_32x32x16_bf16 v[64:79], v[124:127], v[220:223], v[64:79]
 s_waitcnt vmcnt(0)
 s_cmp_eq_u32 s69, 0
 s_cbranch_scc1 fp_187
 s_mov_b64 exec, 1
 buffer_store_dword v0, v10, s[52:55], s69 offen sc1
 s_mov_b64 exec, -1
 s_mov_b32 s69, 0
fp_187:
 s_bitcmp1_b32 s94, 0
 s_cbranch_scc0 tq_188
 s_cmp_lg_u32 s88, 0
 s_cbranch_scc1 tq_188
 s_cmp_ge_u32 s6, 64
 s_cbranch_scc1 tq_188
 s_lshl_b32 s81, s6, 15
 s_add_u32 s81, s81, 1818624
 s_mov_b32 s78, 0
 s_mul_i32 s96, s3, 8320
 s_add_u32 s96, s96, s78
 s_lshl_b32 s97, s3, 13
 s_add_u32 s97, s97, s81
 s_sub_u32 s97, s97, 1024
 s_add_u32 m0, s96, 0
 s_add_u32 s97, s97, 1024
 buffer_load_dwordx4 v2, s[52:55], s97 offen sc1 lds
 s_add_u32 m0, s96, 1040
 s_add_u32 s97, s97, 1024
 buffer_load_dwordx4 v2, s[52:55], s97 offen sc1 lds
 s_add_u32 m0, s96, 2080
 s_add_u32 s97, s97, 1024
 buffer_load_dwordx4 v2, s[52:55], s97 offen sc1 lds
 s_add_u32 m0, s96, 3120
 s_add_u32 s97, s97, 1024
 buffer_load_dwordx4 v2, s[52:55], s97 offen sc1 lds
 s_add_u32 m0, s96, 4160
 s_add_u32 s97, s97, 1024
 buffer_load_dwordx4 v2, s[52:55], s97 offen sc1 lds
 s_add_u32 m0, s96, 5200
 s_add_u32 s97, s97, 1024
 buffer_load_dwordx4 v2, s[52:55], s97 offen sc1 lds
 s_add_u32 m0, s96, 6240
 s_add_u32 s97, s97, 1024
 buffer_load_dwordx4 v2, s[52:55], s97 offen sc1 lds
 s_add_u32 m0, s96, 7280
 s_add_u32 s97, s97, 1024
 buffer_load_dwordx4 v2, s[52:55], s97 offen sc1 lds
 s_mov_b32 s88, 1
tq_188:
 s_bitcmp1_b32 s94, 1
 s_cbranch_scc0 tq_189
 s_cmp_lg_u32 s89, 0
 s_cbranch_scc1 tq_189
 s_cmp_ge_u32 s7, 64
 s_cbranch_scc1 tq_189
 s_lshl_b32 s81, s7, 15
 s_add_u32 s81, s81, 3915776
 s_mov_b32 s78, 33280
 s_mul_i32 s96, s3, 8320
 s_add_u32 s96, s96, s78
 s_lshl_b32 s97, s3, 13
 s_add_u32 s97, s97, s81
 s_sub_u32 s97, s97, 1024
 s_add_u32 m0, s96, 0
 s_add_u32 s97, s97, 1024
 buffer_load_dwordx4 v2, s[52:55], s97 offen sc1 lds
 s_add_u32 m0, s96, 1040
 s_add_u32 s97, s97, 1024
 buffer_load_dwordx4 v2, s[52:55], s97 offen sc1 lds
 s_add_u32 m0, s96, 2080
 s_add_u32 s97, s97, 1024
 buffer_load_dwordx4 v2, s[52:55], s97 offen sc1 lds
 s_add_u32 m0, s96, 3120
 s_add_u32 s97, s97, 1024
 buffer_load_dwordx4 v2, s[52:55], s97 offen sc1 lds
 s_add_u32 m0, s96, 4160
 s_add_u32 s97, s97, 1024
 buffer_load_dwordx4 v2, s[52:55], s97 offen sc1 lds
 s_add_u32 m0, s96, 5200
 s_add_u32 s97, s97, 1024
 buffer_load_dwordx4 v2, s[52:55], s97 offen sc1 lds
 s_add_u32 m0, s96, 6240
 s_add_u32 s97, s97, 1024
 buffer_load_dwordx4 v2, s[52:55], s97 offen sc1 lds
 s_add_u32 m0, s96, 7280
 s_add_u32 s97, s97, 1024
 buffer_load_dwordx4 v2, s[52:55], s97 offen sc1 lds
 s_mov_b32 s89, 1
tq_189:
 s_cmp_lg_u32 s3, 0
 s_cbranch_scc1 qp_190
 s_mov_b32 exec_hi, 0
 s_min_u32 s70, s6, 63
 s_lshl_b32 s70, s70, 11
 s_mov_b32 exec_lo, 0xff
 v_add_u32 v15, s70, v56
 s_min_u32 s70, s7, 63
 s_lshl_b32 s70, s70, 11
 s_mov_b32 exec_lo, 0xff00
 v_add_u32 v15, s70, v56
 s_cmp_lt_u32 s86, 64
 s_cselect_b32 s70, s86, s6
 s_min_u32 s70, s70, 63
 s_lshl_b32 s70, s70, 11
 s_mov_b32 exec_lo, 0xff0000
 v_add_u32 v15, s70, v56
 s_cmp_lt_u32 s87, 64
 s_cselect_b32 s70, s87, s7
 s_min_u32 s70, s70, 63
 s_lshl_b32 s70, s70, 11
 s_mov_b32 exec_lo, 0xff000000
 v_add_u32 v15, s70, v56
 s_mov_b32 exec_lo, -1
 buffer_load_dword v62, v15, s[52:55], 0 offen sc1
 s_mov_b64 exec, -1
qp_190:
 s_nop 7
qa_Bt1:
 v_max3_f32 v5, v5, v64, v65
 v_max3_f32 v5, v5, v66, v67
 v_mov_b32 v6, v5
 s_nop 1
 v_permlane32_swap_b32 v5, v6
 s_nop 0
 v_max_f32 v6, v5, v6
 v_mul_f32 v6, s82, v6
 v_pk_fma_f32 v[16:17], v[224:225], s[82:83], v[6:7] op_sel_hi:[1,1,0] neg_lo:[0,0,1] neg_hi:[0,0,1]
 v_pk_fma_f32 v[18:19], v[226:227], s[82:83], v[6:7] op_sel_hi:[1,1,0] neg_lo:[0,0,1] neg_hi:[0,0,1]
 v_pk_fma_f32 v[20:21], v[228:229], s[82:83], v[6:7] op_sel_hi:[1,1,0] neg_lo:[0,0,1] neg_hi:[0,0,1]
 v_pk_fma_f32 v[22:23], v[230:231], s[82:83], v[6:7] op_sel_hi:[1,1,0] neg_lo:[0,0,1] neg_hi:[0,0,1]
 v_pk_fma_f32 v[24:25], v[232:233], s[82:83], v[6:7] op_sel_hi:[1,1,0] neg_lo:[0,0,1] neg_hi:[0,0,1]
 v_pk_fma_f32 v[26:27], v[234:235], s[82:83], v[6:7] op_sel_hi:[1,1,0] neg_lo:[0,0,1] neg_hi:[0,0,1]
 v_pk_fma_f32 v[28:29], v[236:237], s[82:83], v[6:7] op_sel_hi:[1,1,0] neg_lo:[0,0,1] neg_hi:[0,0,1]
 v_pk_fma_f32 v[30:31], v[238:239], s[82:83], v[6:7] op_sel_hi:[1,1,0] neg_lo:[0,0,1] neg_hi:[0,0,1]
 v_pk_fma_f32 v[32:33], v[64:65], s[82:83], v[6:7] op_sel_hi:[1,1,0] neg_lo:[0,0,1] neg_hi:[0,0,1]
 v_pk_fma_f32 v[34:35], v[66:67], s[82:83], v[6:7] op_sel_hi:[1,1,0] neg_lo:[0,0,1] neg_hi:[0,0,1]
 v_exp_f32 v16, v16
 v_exp_f32 v17, v17
 v_exp_f32 v18, v18
 v_exp_f32 v19, v19
 v_exp_f32 v20, v20
 v_exp_f32 v21, v21
 v_exp_f32 v22, v22
 v_exp_f32 v23, v23
 v_exp_f32 v24, v24
 v_exp_f32 v25, v25
 v_exp_f32 v26, v26
 v_exp_f32 v27, v27
 v_exp_f32 v28, v28
 v_exp_f32 v29, v29
 v_exp_f32 v30, v30
 v_exp_f32 v31, v31
 v_exp_f32 v32, v32
 v_exp_f32 v33, v33
 v_exp_f32 v34, v34
 v_exp_f32 v35, v35
 s_nop 0
 v_pk_add_f32 v[80:81], v[16:17], v[26:27]
 v_pk_add_f32 v[82:83], v[18:19], v[28:29]
 v_pk_add_f32 v[84:85], v[20:21], v[30:31]
 v_pk_add_f32 v[86:87], v[22:23], v[32:33]
 v_pk_add_f32 v[88:89], v[24:25], v[34:35]
 v_pk_add_f32 v[80:81], v[80:81], v[82:83]
 v_pk_add_f32 v[84:85], v[84:85], v[86:87]
 v_pk_add_f32 v[80:81], v[80:81], v[88:89]
 v_pk_add_f32 v[80:81], v[80:81], v[84:85]
 v_add_f32 v80, v80, v81
 v_mov_b32 v81, v80
 s_nop 1
 v_permlane32_swap_b32 v80, v81
 s_nop 0
 v_add_f32 v80, v80, v81
 v_rcp_f32 v80, v80
 v_mov_b64 v[46:47], 0
 v_pk_mul_f32 v[16:17], v[16:17], v[80:81] op_sel_hi:[1,0]
 v_pk_mul_f32 v[18:19], v[18:19], v[80:81] op_sel_hi:[1,0]
 v_pk_mul_f32 v[20:21], v[20:21], v[80:81] op_sel_hi:[1,0]
 v_pk_mul_f32 v[22:23], v[22:23], v[80:81] op_sel_hi:[1,0]
 v_pk_mul_f32 v[24:25], v[24:25], v[80:81] op_sel_hi:[1,0]
 v_pk_mul_f32 v[26:27], v[26:27], v[80:81] op_sel_hi:[1,0]
 v_pk_mul_f32 v[28:29], v[28:29], v[80:81] op_sel_hi:[1,0]
 v_pk_mul_f32 v[30:31], v[30:31], v[80:81] op_sel_hi:[1,0]
 v_pk_mul_f32 v[32:33], v[32:33], v[80:81] op_sel_hi:[1,0]
 v_pk_mul_f32 v[34:35], v[34:35], v[80:81] op_sel_hi:[1,0]
 v_cvt_pk_bf16_f32 v36, v16, v17
 v_cvt_pk_bf16_f32 v37, v18, v19
 v_cvt_pk_bf16_f32 v38, v20, v21
 v_cvt_pk_bf16_f32 v39, v22, v23
 v_cvt_pk_bf16_f32 v40, v24, v25
 v_cvt_pk_bf16_f32 v41, v26, v27
 v_cvt_pk_bf16_f32 v42, v28, v29
 v_cvt_pk_bf16_f32 v43, v30, v31
 v_cvt_pk_bf16_f32 v44, v32, v33
 v_cvt_pk_bf16_f32 v45, v34, v35
 s_nop 1
 v_mfma_f32_32x32x16_bf16 v[64:79], v[240:243], v[36:39], 0
 v_mfma_f32_32x32x16_bf16 v[80:95], v[248:251], v[36:39], 0
 v_mfma_f32_32x32x16_bf16 v[64:79], v[244:247], v[40:43], v[64:79]
 v_mfma_f32_32x32x16_bf16 v[80:95], v[252:255], v[40:43], v[80:95]
 v_mfma_f32_32x32x16_bf16 v[64:79], v[48:51], v[44:47], v[64:79]
 v_mfma_f32_32x32x16_bf16 v[80:95], v[52:55], v[44:47], v[80:95]
 s_mov_b32 s71, 1
 s_mul_i32 s69, s71, 65
 s_add_u32 s69, s69, s67
 s_lshl_b32 s69, s69, 8
 s_add_u32 s69, s69, 166400
 s_add_u32 s69, s69, s98
 s_nop 5
 v_cvt_pk_bf16_f32 v96, v64, v65
 v_cvt_pk_bf16_f32 v97, v66, v67
 v_cvt_pk_bf16_f32 v98, v68, v69
 v_cvt_pk_bf16_f32 v99, v70, v71
 buffer_store_dwordx4 v[96:99], v2, s[52:55], s80 offen offset:0 sc1
 v_cvt_pk_bf16_f32 v100, v72, v73
 v_cvt_pk_bf16_f32 v101, v74, v75
 v_cvt_pk_bf16_f32 v102, v76, v77
 v_cvt_pk_bf16_f32 v103, v78, v79
 buffer_store_dwordx4 v[100:103], v2, s[52:55], s80 offen offset:1024 sc1
 v_cvt_pk_bf16_f32 v104, v80, v81
 v_cvt_pk_bf16_f32 v105, v82, v83
 v_cvt_pk_bf16_f32 v106, v84, v85
 v_cvt_pk_bf16_f32 v107, v86, v87
 buffer_store_dwordx4 v[104:107], v2, s[52:55], s80 offen offset:2048 sc1
 v_cvt_pk_bf16_f32 v108, v88, v89
 v_cvt_pk_bf16_f32 v109, v90, v91
 v_cvt_pk_bf16_f32 v110, v92, v93
 v_cvt_pk_bf16_f32 v111, v94, v95
 buffer_store_dwordx4 v[108:111], v2, s[52:55], s80 offen offset:3072 sc1
 s_waitcnt vmcnt(4)
 s_cbranch_vccnz qa_disp
 s_branch qa_sched
role_wo:
 s_mov_b32 s56, s28
 s_mov_b32 s57, s29
 s_mov_b32 s58, 4194304
 s_mov_b32 s59, 0x00020000
 s_mov_b32 s60, s28
 s_mov_b32 s61, s29
 s_mov_b32 s62, 4194304
 s_mov_b32 s63, 0x00020000
 s_lshr_b32 s82, s64, 2
 s_and_b32 s70, s64, 3
 s_lshl_b32 s76, s82, 20
 s_lshl_b32 s70, s70, 8
 s_add_u32 s76, s76, s70
 s_lshl_b32 s70, s3, 6
 s_add_u32 s76, s76, s70
 s_add_u32 s77, s76, 524288
 v_lshrrev_b32 v5, 2, v1
 s_mov_b32 s70, 1024
 v_mul_lo_u32 v5, v5, s70
 v_and_b32 v6, 3, v1
 v_lshl_add_u32 v10, v6, 4, v5
 v_lshrrev_b32 v5, 5, v1
 v_lshlrev_b32 v5, 8, v5
 v_bfe_u32 v7, v1, 2, 2
 v_lshl_add_u32 v5, v7, 6, v5
 v_bfe_u32 v7, v1, 4, 1
 v_lshl_add_u32 v5, v7, 5, v5
 v_and_b32 v7, 1, v1
 v_lshl_add_u32 v5, v7, 4, v5
 v_bfe_u32 v7, v1, 1, 1
 v_lshl_add_u32 v5, v7, 3, v5
 s_lshl_b32 s71, s3, 15
 v_add_u32 v9, s71, v5
 s_add_u32 m0, s71, 0
 s_nop 0
 buffer_load_dwordx4 v10, s[56:59], s76 offen lds
 s_add_u32 s76, s76, 16384
 s_add_u32 m0, s71, 8192
 s_nop 0
 buffer_load_dwordx4 v10, s[60:63], s77 offen lds
 s_add_u32 s77, s77, 16384
 s_add_u32 m0, s71, 1024
 s_nop 0
 buffer_load_dwordx4 v10, s[56:59], s76 offen lds
 s_add_u32 s76, s76, 16384
 s_add_u32 m0, s71, 9216
 s_nop 0
 buffer_load_dwordx4 v10, s[60:63], s77 offen lds
 s_add_u32 s77, s77, 16384
 s_add_u32 m0, s71, 2048
 s_nop 0
 buffer_load_dwordx4 v10, s[56:59], s76 offen lds
 s_add_u32 s76, s76, 16384
 s_add_u32 m0, s71, 10240
 s_nop 0
 buffer_load_dwordx4 v10, s[60:63], s77 offen lds
 s_add_u32 s77, s77, 16384
 s_add_u32 m0, s71, 3072
 s_nop 0
 buffer_load_dwordx4 v10, s[56:59], s76 offen lds
 s_add_u32 s76, s76, 16384
 s_add_u32 m0, s71, 11264
 s_nop 0
 buffer_load_dwordx4 v10, s[60:63], s77 offen lds
 s_add_u32 s77, s77, 16384
 s_add_u32 m0, s71, 4096
 s_nop 0
 buffer_load_dwordx4 v10, s[56:59], s76 offen lds
 s_add_u32 s76, s76, 16384
 s_add_u32 m0, s71, 12288
 s_nop 0
 buffer_load_dwordx4 v10, s[60:63], s77 offen lds
 s_add_u32 s77, s77, 16384
 s_add_u32 m0, s71, 5120
 s_nop 0
 buffer_load_dwordx4 v10, s[56:59], s76 offen lds
 s_add_u32 s76, s76, 16384
 s_add_u32 m0, s71, 13312
 s_nop 0
 buffer_load_dwordx4 v10, s[60:63], s77 offen lds
 s_add_u32 s77, s77, 16384
 s_add_u32 m0, s71, 6144
 s_nop 0
 buffer_load_dwordx4 v10, s[56:59], s76 offen lds
 s_add_u32 s76, s76, 16384
 s_add_u32 m0, s71, 14336
 s_nop 0
 buffer_load_dwordx4 v10, s[60:63], s77 offen lds
 s_add_u32 s77, s77, 16384
 s_add_u32 m0, s71, 7168
 s_nop 0
 buffer_load_dwordx4 v10, s[56:59], s76 offen lds
 s_add_u32 s76, s76, 16384
 s_add_u32 m0, s71, 15360
 s_nop 0
 buffer_load_dwordx4 v10, s[60:63], s77 offen lds
 s_add_u32 s77, s77, 16384
 s_add_u32 m0, s71, 16384
 s_nop 0
 buffer_load_dwordx4 v10, s[56:59], s76 offen lds
 s_add_u32 s76, s76, 16384
 s_add_u32 m0, s71, 24576
 s_nop 0
 buffer_load_dwordx4 v10, s[60:63], s77 offen lds
 s_add_u32 s77, s77, 16384
 s_add_u32 m0, s71, 17408
 s_nop 0
 buffer_load_dwordx4 v10, s[56:59], s76 offen lds
 s_add_u32 s76, s76, 16384
 s_add_u32 m0, s71, 25600
 s_nop 0
 buffer_load_dwordx4 v10, s[60:63], s77 offen lds
 s_add_u32 s77, s77, 16384
 s_add_u32 m0, s71, 18432
 s_nop 0
 buffer_load_dwordx4 v10, s[56:59], s76 offen lds
 s_add_u32 s76, s76, 16384
 s_add_u32 m0, s71, 26624
 s_nop 0
 buffer_load_dwordx4 v10, s[60:63], s77 offen lds
 s_add_u32 s77, s77, 16384
 s_add_u32 m0, s71, 19456
 s_nop 0
 buffer_load_dwordx4 v10, s[56:59], s76 offen lds
 s_add_u32 s76, s76, 16384
 s_add_u32 m0, s71, 27648
 s_nop 0
 buffer_load_dwordx4 v10, s[60:63], s77 offen lds
 s_add_u32 s77, s77, 16384
 s_add_u32 m0, s71, 20480
 s_nop 0
 buffer_load_dwordx4 v10, s[56:59], s76 offen lds
 s_add_u32 s76, s76, 16384
 s_add_u32 m0, s71, 28672
 s_nop 0
 buffer_load_dwordx4 v10, s[60:63], s77 offen lds
 s_add_u32 s77, s77, 16384
 s_add_u32 m0, s71, 21504
 s_nop 0
 buffer_load_dwordx4 v10, s[56:59], s76 offen lds
 s_add_u32 s76, s76, 16384
 s_add_u32 m0, s71, 29696
 s_nop 0
 buffer_load_dwordx4 v10, s[60:63], s77 offen lds
 s_add_u32 s77, s77, 16384
 s_add_u32 m0, s71, 22528
 s_nop 0
 buffer_load_dwordx4 v10, s[56:59], s76 offen lds
 s_add_u32 s76, s76, 16384
 s_add_u32 m0, s71, 30720
 s_nop 0
 buffer_load_dwordx4 v10, s[60:63], s77 offen lds
 s_add_u32 s77, s77, 16384
 s_add_u32 m0, s71, 23552
 s_nop 0
 buffer_load_dwordx4 v10, s[56:59], s76 offen lds
 s_add_u32 s76, s76, 16384
 s_add_u32 m0, s71, 31744
 s_nop 0
 buffer_load_dwordx4 v10, s[60:63], s77 offen lds
 s_add_u32 s77, s77, 16384
 s_waitcnt vmcnt(16)
 ds_read_b64_tr_b16 a[0:1], v9 offset:0
 ds_read_b64_tr_b16 a[2:3], v9 offset:512
 ds_read_b64_tr_b16 a[4:5], v9 offset:8192
 ds_read_b64_tr_b16 a[6:7], v9 offset:8704
 ds_read_b64_tr_b16 a[8:9], v9 offset:1024
 ds_read_b64_tr_b16 a[10:11], v9 offset:1536
 ds_read_b64_tr_b16 a[12:13], v9 offset:9216
 ds_read_b64_tr_b16 a[14:15], v9 offset:9728
 ds_read_b64_tr_b16 a[16:17], v9 offset:2048
 ds_read_b64_tr_b16 a[18:19], v9 offset:2560
 ds_read_b64_tr_b16 a[20:21], v9 offset:10240
 ds_read_b64_tr_b16 a[22:23], v9 offset:10752
 ds_read_b64_tr_b16 a[24:25], v9 offset:3072
 ds_read_b64_tr_b16 a[26:27], v9 offset:3584
 ds_read_b64_tr_b16 a[28:29], v9 offset:11264
 ds_read_b64_tr_b16 a[30:31], v9 offset:11776
 ds_read_b64_tr_b16 a[32:33], v9 offset:4096
 ds_read_b64_tr_b16 a[34:35], v9 offset:4608
 ds_read_b64_tr_b16 a[36:37], v9 offset:12288
 ds_read_b64_tr_b16 a[38:39], v9 offset:12800
 ds_read_b64_tr_b16 a[40:41], v9 offset:5120
 ds_read_b64_tr_b16 a[42:43], v9 offset:5632
 ds_read_b64_tr_b16 a[44:45], v9 offset:13312
 ds_read_b64_tr_b16 a[46:47], v9 offset:13824
 ds_read_b64_tr_b16 a[48:49], v9 offset:6144
 ds_read_b64_tr_b16 a[50:51], v9 offset:6656
 ds_read_b64_tr_b16 a[52:53], v9 offset:14336
 ds_read_b64_tr_b16 a[54:55], v9 offset:14848
 ds_read_b64_tr_b16 a[56:57], v9 offset:7168
 ds_read_b64_tr_b16 a[58:59], v9 offset:7680
 ds_read_b64_tr_b16 a[60:61], v9 offset:15360
 ds_read_b64_tr_b16 a[62:63], v9 offset:15872
 s_waitcnt lgkmcnt(0)
 s_add_u32 m0, s71, 0
 s_nop 0
 buffer_load_dwordx4 v10, s[56:59], s76 offen lds
 s_add_u32 s76, s76, 16384
 s_add_u32 m0, s71, 8192
 s_nop 0
 buffer_load_dwordx4 v10, s[60:63], s77 offen lds
 s_add_u32 s77, s77, 16384
 s_add_u32 m0, s71, 1024
 s_nop 0
 buffer_load_dwordx4 v10, s[56:59], s76 offen lds
 s_add_u32 s76, s76, 16384
 s_add_u32 m0, s71, 9216
 s_nop 0
 buffer_load_dwordx4 v10, s[60:63], s77 offen lds
 s_add_u32 s77, s77, 16384
 s_add_u32 m0, s71, 2048
 s_nop 0
 buffer_load_dwordx4 v10, s[56:59], s76 offen lds
 s_add_u32 s76, s76, 16384
 s_add_u32 m0, s71, 10240
 s_nop 0
 buffer_load_dwordx4 v10, s[60:63], s77 offen lds
 s_add_u32 s77, s77, 16384
 s_add_u32 m0, s71, 3072
 s_nop 0
 buffer_load_dwordx4 v10, s[56:59], s76 offen lds
 s_add_u32 s76, s76, 16384
 s_add_u32 m0, s71, 11264
 s_nop 0
 buffer_load_dwordx4 v10, s[60:63], s77 offen lds
 s_add_u32 s77, s77, 16384
 s_add_u32 m0, s71, 4096
 s_nop 0
 buffer_load_dwordx4 v10, s[56:59], s76 offen lds
 s_add_u32 s76, s76, 16384
 s_add_u32 m0, s71, 12288
 s_nop 0
 buffer_load_dwordx4 v10, s[60:63], s77 offen lds
 s_add_u32 s77, s77, 16384
 s_add_u32 m0, s71, 5120
 s_nop 0
 buffer_load_dwordx4 v10, s[56:59], s76 offen lds
 s_add_u32 s76, s76, 16384
 s_add_u32 m0, s71, 13312
 s_nop 0
 buffer_load_dwordx4 v10, s[60:63], s77 offen lds
 s_add_u32 s77, s77, 16384
 s_add_u32 m0, s71, 6144
 s_nop 0
 buffer_load_dwordx4 v10, s[56:59], s76 offen lds
 s_add_u32 s76, s76, 16384
 s_add_u32 m0, s71, 14336
 s_nop 0
 buffer_load_dwordx4 v10, s[60:63], s77 offen lds
 s_add_u32 s77, s77, 16384
 s_add_u32 m0, s71, 7168
 s_nop 0
 buffer_load_dwordx4 v10, s[56:59], s76 offen lds
 s_add_u32 s76, s76, 16384
 s_add_u32 m0, s71, 15360
 s_nop 0
 buffer_load_dwordx4 v10, s[60:63], s77 offen lds
 s_add_u32 s77, s77, 16384
 s_waitcnt vmcnt(16)
 ds_read_b64_tr_b16 a[64:65], v9 offset:16384
 ds_read_b64_tr_b16 a[66:67], v9 offset:16896
 ds_read_b64_tr_b16 a[68:69], v9 offset:24576
 ds_read_b64_tr_b16 a[70:71], v9 offset:25088
 ds_read_b64_tr_b16 a[72:73], v9 offset:17408
 ds_read_b64_tr_b16 a[74:75], v9 offset:17920
 ds_read_b64_tr_b16 a[76:77], v9 offset:25600
 ds_read_b64_tr_b16 a[78:79], v9 offset:26112
 ds_read_b64_tr_b16 a[80:81], v9 offset:18432
 ds_read_b64_tr_b16 a[82:83], v9 offset:18944
 ds_read_b64_tr_b16 a[84:85], v9 offset:26624
 ds_read_b64_tr_b16 a[86:87], v9 offset:27136
 ds_read_b64_tr_b16 a[88:89], v9 offset:19456
 ds_read_b64_tr_b16 a[90:91], v9 offset:19968
 ds_read_b64_tr_b16 a[92:93], v9 offset:27648
 ds_read_b64_tr_b16 a[94:95], v9 offset:28160
 ds_read_b64_tr_b16 a[96:97], v9 offset:20480
 ds_read_b64_tr_b16 a[98:99], v9 offset:20992
 ds_read_b64_tr_b16 a[100:101], v9 offset:28672
 ds_read_b64_tr_b16 a[102:103], v9 offset:29184
 ds_read_b64_tr_b16 a[104:105], v9 offset:21504
 ds_read_b64_tr_b16 a[106:107], v9 offset:22016
 ds_read_b64_tr_b16 a[108:109], v9 offset:29696
 ds_read_b64_tr_b16 a[110:111], v9 offset:30208
 ds_read_b64_tr_b16 a[112:113], v9 offset:22528
 ds_read_b64_tr_b16 a[114:115], v9 offset:23040
 ds_read_b64_tr_b16 a[116:117], v9 offset:30720
 ds_read_b64_tr_b16 a[118:119], v9 offset:31232
 ds_read_b64_tr_b16 a[120:121], v9 offset:23552
 ds_read_b64_tr_b16 a[122:123], v9 offset:24064
 ds_read_b64_tr_b16 a[124:125], v9 offset:31744
 ds_read_b64_tr_b16 a[126:127], v9 offset:32256
 s_waitcnt lgkmcnt(0)
 s_add_u32 m0, s71, 16384
 s_nop 0
 buffer_load_dwordx4 v10, s[56:59], s76 offen lds
 s_add_u32 s76, s76, 16384
 s_add_u32 m0, s71, 24576
 s_nop 0
 buffer_load_dwordx4 v10, s[60:63], s77 offen lds
 s_add_u32 s77, s77, 16384
 s_add_u32 m0, s71, 17408
 s_nop 0
 buffer_load_dwordx4 v10, s[56:59], s76 offen lds
 s_add_u32 s76, s76, 16384
 s_add_u32 m0, s71, 25600
 s_nop 0
 buffer_load_dwordx4 v10, s[60:63], s77 offen lds
 s_add_u32 s77, s77, 16384
 s_add_u32 m0, s71, 18432
 s_nop 0
 buffer_load_dwordx4 v10, s[56:59], s76 offen lds
 s_add_u32 s76, s76, 16384
 s_add_u32 m0, s71, 26624
 s_nop 0
 buffer_load_dwordx4 v10, s[60:63], s77 offen lds
 s_add_u32 s77, s77, 16384
 s_add_u32 m0, s71, 19456
 s_nop 0
 buffer_load_dwordx4 v10, s[56:59], s76 offen lds
 s_add_u32 s76, s76, 16384
 s_add_u32 m0, s71, 27648
 s_nop 0
 buffer_load_dwordx4 v10, s[60:63], s77 offen lds
 s_add_u32 s77, s77, 16384
 s_add_u32 m0, s71, 20480
 s_nop 0
 buffer_load_dwordx4 v10, s[56:59], s76 offen lds
 s_add_u32 s76, s76, 16384
 s_add_u32 m0, s71, 28672
 s_nop 0
 buffer_load_dwordx4 v10, s[60:63], s77 offen lds
 s_add_u32 s77, s77, 16384
 s_add_u32 m0, s71, 21504
 s_nop 0
 buffer_load_dwordx4 v10, s[56:59], s76 offen lds
 s_add_u32 s76, s76, 16384
 s_add_u32 m0, s71, 29696
 s_nop 0
 buffer_load_dwordx4 v10, s[60:63], s77 offen lds
 s_add_u32 s77, s77, 16384
 s_add_u32 m0, s71, 22528
 s_nop 0
 buffer_load_dwordx4 v10, s[56:59], s76 offen lds
 s_add_u32 s76, s76, 16384
 s_add_u32 m0, s71, 30720
 s_nop 0
 buffer_load_dwordx4 v10, s[60:63], s77 offen lds
 s_add_u32 s77, s77, 16384
 s_add_u32 m0, s71, 23552
 s_nop 0
 buffer_load_dwordx4 v10, s[56:59], s76 offen lds
 s_add_u32 s76, s76, 16384
 s_add_u32 m0, s71, 31744
 s_nop 0
 buffer_load_dwordx4 v10, s[60:63], s77 offen lds
 s_add_u32 s77, s77, 16384
 s_waitcnt vmcnt(16)
 ds_read_b64_tr_b16 a[128:129], v9 offset:0
 ds_read_b64_tr_b16 a[130:131], v9 offset:512
 ds_read_b64_tr_b16 a[132:133], v9 offset:8192
 ds_read_b64_tr_b16 a[134:135], v9 offset:8704
 ds_read_b64_tr_b16 a[136:137], v9 offset:1024
 ds_read_b64_tr_b16 a[138:139], v9 offset:1536
 ds_read_b64_tr_b16 a[140:141], v9 offset:9216
 ds_read_b64_tr_b16 a[142:143], v9 offset:9728
 ds_read_b64_tr_b16 a[144:145], v9 offset:2048
 ds_read_b64_tr_b16 a[146:147], v9 offset:2560
 ds_read_b64_tr_b16 a[148:149], v9 offset:10240
 ds_read_b64_tr_b16 a[150:151], v9 offset:10752
 ds_read_b64_tr_b16 a[152:153], v9 offset:3072
 ds_read_b64_tr_b16 a[154:155], v9 offset:3584
 ds_read_b64_tr_b16 a[156:157], v9 offset:11264
 ds_read_b64_tr_b16 a[158:159], v9 offset:11776
 ds_read_b64_tr_b16 a[160:161], v9 offset:4096
 ds_read_b64_tr_b16 a[162:163], v9 offset:4608
 ds_read_b64_tr_b16 a[164:165], v9 offset:12288
 ds_read_b64_tr_b16 a[166:167], v9 offset:12800
 ds_read_b64_tr_b16 a[168:169], v9 offset:5120
 ds_read_b64_tr_b16 a[170:171], v9 offset:5632
 ds_read_b64_tr_b16 a[172:173], v9 offset:13312
 ds_read_b64_tr_b16 a[174:175], v9 offset:13824
 ds_read_b64_tr_b16 a[176:177], v9 offset:6144
 ds_read_b64_tr_b16 a[178:179], v9 offset:6656
 ds_read_b64_tr_b16 a[180:181], v9 offset:14336
 ds_read_b64_tr_b16 a[182:183], v9 offset:14848
 ds_read_b64_tr_b16 a[184:185], v9 offset:7168
 ds_read_b64_tr_b16 a[186:187], v9 offset:7680
 ds_read_b64_tr_b16 a[188:189], v9 offset:15360
 ds_read_b64_tr_b16 a[190:191], v9 offset:15872
 s_waitcnt lgkmcnt(0)
 s_waitcnt vmcnt(0)
 ds_read_b64_tr_b16 a[192:193], v9 offset:16384
 ds_read_b64_tr_b16 a[194:195], v9 offset:16896
 ds_read_b64_tr_b16 a[196:197], v9 offset:24576
 ds_read_b64_tr_b16 a[198:199], v9 offset:25088
 ds_read_b64_tr_b16 a[200:201], v9 offset:17408
 ds_read_b64_tr_b16 a[202:203], v9 offset:17920
 ds_read_b64_tr_b16 a[204:205], v9 offset:25600
 ds_read_b64_tr_b16 a[206:207], v9 offset:26112
 ds_read_b64_tr_b16 a[208:209], v9 offset:18432
 ds_read_b64_tr_b16 a[210:211], v9 offset:18944
 ds_read_b64_tr_b16 a[212:213], v9 offset:26624
 ds_read_b64_tr_b16 a[214:215], v9 offset:27136
 ds_read_b64_tr_b16 a[216:217], v9 offset:19456
 ds_read_b64_tr_b16 a[218:219], v9 offset:19968
 ds_read_b64_tr_b16 a[220:221], v9 offset:27648
 ds_read_b64_tr_b16 a[222:223], v9 offset:28160
 ds_read_b64_tr_b16 a[224:225], v9 offset:20480
 ds_read_b64_tr_b16 a[226:227], v9 offset:20992
 ds_read_b64_tr_b16 a[228:229], v9 offset:28672
 ds_read_b64_tr_b16 a[230:231], v9 offset:29184
 ds_read_b64_tr_b16 a[232:233], v9 offset:21504
 ds_read_b64_tr_b16 a[234:235], v9 offset:22016
 ds_read_b64_tr_b16 a[236:237], v9 offset:29696
 ds_read_b64_tr_b16 a[238:239], v9 offset:30208
 ds_read_b64_tr_b16 a[240:241], v9 offset:22528
 ds_read_b64_tr_b16 a[242:243], v9 offset:23040
 ds_read_b64_tr_b16 a[244:245], v9 offset:30720
 ds_read_b64_tr_b16 a[246:247], v9 offset:31232
 ds_read_b64_tr_b16 a[248:249], v9 offset:23552
 ds_read_b64_tr_b16 a[250:251], v9 offset:24064
 ds_read_b64_tr_b16 a[252:253], v9 offset:31744
 ds_read_b64_tr_b16 a[254:255], v9 offset:32256
 s_waitcnt lgkmcnt(0)
 s_barrier
 v_mov_b32 v3, v2
 v_and_b32 v5, 31, v1
 v_lshlrev_b32 v5, 5, v5
 v_lshrrev_b32 v6, 5, v1
 v_lshl_add_u32 v4, v6, 4, v5
 s_lshl_b32 s75, s82, 6
 v_and_b32 v5, 31, v1
 v_lshrrev_b32 v6, 5, v1
 v_lshlrev_b32 v7, 1, v5
 v_cmp_gt_u32 vcc, 16, v7
 v_add_u32 v8, 1, v7
 s_mov_b32 s70, 16640
 v_cndmask_b32 v57, 0, 1, vcc
 v_cndmask_b32 v5, 0, v5, vcc
 v_cmp_gt_u32 vcc, 16, v8
 v_mul_lo_u32 v6, v6, s70
 v_lshl_add_u32 v6, v5, 3, v6
 v_cndmask_b32 v58, 0, 1, vcc
 v_add_u32 v56, 166400, v6
 v_add_u32 v56, s75, v56
 s_mov_b32 s87, 0xff
 v_mov_b32 v62, 0
 v_mov_b32 v63, 0
 s_lshl_b32 s98, s64, 2
 s_add_u32 s98, s98, s3
 s_lshl_b32 s98, s98, 2
 v_mov_b32 v10, 0
 v_mov_b32 v0, 1
 v_add_u32 v12, 65536, v3
 s_mov_b32 s95, 163824
 s_branch wo_sched0
wo_pro0:
 s_mov_b32 s90, 0
 ds_read_b128 v[16:19], v3 offset:0
 ds_read_b128 v[20:23], v3 offset:1024
 ds_read_b128 v[24:27], v3 offset:2048
 ds_read_b128 v[28:31], v3 offset:3072
 ds_read_b128 v[32:35], v3 offset:4096
 ds_read_b128 v[36:39], v3 offset:5120
 s_cmp_ge_u32 s94, 2
 s_cbranch_scc1 wo_plain0
wo_run0:
 s_cmp_lt_u32 s94, 2
 s_cselect_b64 vcc, -1, 0
 ds_read_b128 v[40:43], v3 offset:6144
 s_waitcnt lgkmcnt(6)
 v_mfma_f32_32x32x16_bf16 v[64:79], a[0:3], v[16:19], 0
 s_mov_b32 s68, s4
 s_mov_b32 s67, s5
 s_mov_b32 s88, s6
 s_mov_b32 s89, s7
 ds_read_b128 v[44:47], v3 offset:7168
 s_waitcnt lgkmcnt(6)
 v_mfma_f32_32x32x16_bf16 v[64:79], a[8:11], v[20:23], v[64:79]
 s_add_u32 s88, s88, 2
 s_add_u32 s70, s89, 1
 s_cmp_lt_u32 s70, 39
 s_cselect_b32 s70, s70, s66
 ds_read_b128 v[16:19], v3 offset:8192
 s_waitcnt lgkmcnt(6)
 v_mfma_f32_32x32x16_bf16 v[64:79], a[16:19], v[24:27], v[64:79]
 s_add_u32 s71, s89, 3
 s_cmp_lt_u32 s89, 39
 s_cselect_b32 s89, s70, s71
 s_and_b32 s4, s94, 1
 s_barrier
 ds_read_b128 v[20:23], v3 offset:9216
 s_waitcnt lgkmcnt(6)
 v_mfma_f32_32x32x16_bf16 v[64:79], a[24:27], v[28:31], v[64:79]
 s_cmp_eq_u32 s94, 0
 s_cselect_b32 s5, s6, s7
 s_cselect_b32 s6, s88, s6
 s_cmp_eq_u32 s94, 1
 s_cselect_b32 s7, s89, s7
 ds_read_b128 v[24:27], v3 offset:10240
 s_waitcnt lgkmcnt(6)
 v_mfma_f32_32x32x16_bf16 v[64:79], a[32:35], v[32:35], v[64:79]
 s_mov_b32 s78, 65536
 s_mul_i32 s81, s4, 16777216
 s_add_u32 s81, s81, 89899008
 s_lshl_b32 s70, s5, 18
 ds_read_b128 v[28:31], v3 offset:11264
 s_waitcnt lgkmcnt(6)
 v_mfma_f32_32x32x16_bf16 v[64:79], a[40:43], v[36:39], v[64:79]
 s_add_u32 s81, s81, s70
 s_lshl_b32 s70, s82, 16
 s_add_u32 s81, s81, s70
 s_mul_i32 s97, s3, 16384
 ds_read_b128 v[32:35], v3 offset:12288
 s_waitcnt lgkmcnt(6)
 v_mfma_f32_32x32x16_bf16 v[64:79], a[48:51], v[40:43], v[64:79]
 s_min_u32 s97, s97, 49152
 s_add_u32 s96, s97, s78
 s_add_u32 s97, s97, s81
 s_sub_u32 s97, s97, 4096
 ds_read_b128 v[36:39], v3 offset:13312
 s_waitcnt lgkmcnt(6)
 v_mfma_f32_32x32x16_bf16 v[64:79], a[56:59], v[44:47], v[64:79]
 s_cbranch_vccz g_191
 s_add_u32 m0, s96, 0
 s_add_u32 s97, s97, 4096
 buffer_load_dwordx4 v2, s[52:55], s97 offen offset:0 sc1 lds
g_191:
 ds_read_b128 v[40:43], v3 offset:14336
 s_waitcnt lgkmcnt(6)
 v_mfma_f32_32x32x16_bf16 v[64:79], a[64:67], v[16:19], v[64:79]
 s_bitcmp1_b32 s90, 0
 s_cbranch_scc0 g_192
 v_cvt_pk_bf16_f32 v128, v96, v97
 v_cvt_pk_bf16_f32 v129, v98, v99
 v_cvt_pk_bf16_f32 v130, v100, v101
 v_cvt_pk_bf16_f32 v131, v102, v103
 buffer_store_dwordx4 v[128:131], v4, s[52:55], s91 offen offset:0 sc1
g_192:
 ds_read_b128 v[44:47], v3 offset:15360
 s_waitcnt lgkmcnt(6)
 v_mfma_f32_32x32x16_bf16 v[64:79], a[72:75], v[20:23], v[64:79]
 s_cbranch_vccz g_193
 buffer_load_dwordx4 v2, s[52:55], s97 offen offset:1024 sc1 lds
g_193:
 ds_read_b128 v[16:19], v3 offset:16384
 s_waitcnt lgkmcnt(6)
 v_mfma_f32_32x32x16_bf16 v[64:79], a[80:83], v[24:27], v[64:79]
 s_bitcmp1_b32 s90, 0
 s_cbranch_scc0 g_194
 v_cvt_pk_bf16_f32 v132, v104, v105
 v_cvt_pk_bf16_f32 v133, v106, v107
 v_cvt_pk_bf16_f32 v134, v108, v109
 v_cvt_pk_bf16_f32 v135, v110, v111
 buffer_store_dwordx4 v[132:135], v4, s[52:55], s91 offen offset:1024 sc1
g_194:
 ds_read_b128 v[20:23], v3 offset:17408
 s_waitcnt lgkmcnt(6)
 v_mfma_f32_32x32x16_bf16 v[64:79], a[88:91], v[28:31], v[64:79]
 s_cbranch_vccz g_195
 buffer_load_dwordx4 v2, s[52:55], s97 offen offset:2048 sc1 lds
g_195:
 ds_read_b128 v[24:27], v3 offset:18432
 s_waitcnt lgkmcnt(6)
 v_mfma_f32_32x32x16_bf16 v[64:79], a[96:99], v[32:35], v[64:79]
 s_cbranch_vccz g_196
 buffer_load_dwordx4 v2, s[52:55], s97 offen offset:3072 sc1 lds
g_196:
 ds_read_b128 v[28:31], v3 offset:19456
 s_waitcnt lgkmcnt(6)
 v_mfma_f32_32x32x16_bf16 v[64:79], a[104:107], v[36:39], v[64:79]
 s_cbranch_vccz g_197
 s_add_u32 m0, s96, 4096
 s_add_u32 s97, s97, 4096
 buffer_load_dwordx4 v2, s[52:55], s97 offen offset:0 sc1 lds
g_197:
 ds_read_b128 v[32:35], v3 offset:20480
 s_waitcnt lgkmcnt(6)
 v_mfma_f32_32x32x16_bf16 v[64:79], a[112:115], v[40:43], v[64:79]
 s_cbranch_vccz g_198
 buffer_load_dwordx4 v2, s[52:55], s97 offen offset:1024 sc1 lds
g_198:
 ds_read_b128 v[36:39], v3 offset:21504
 s_waitcnt lgkmcnt(6)
 v_mfma_f32_32x32x16_bf16 v[64:79], a[120:123], v[44:47], v[64:79]
 s_cbranch_vccz g_199
 buffer_load_dwordx4 v2, s[52:55], s97 offen offset:2048 sc1 lds
g_199:
 ds_read_b128 v[40:43], v3 offset:22528
 s_waitcnt lgkmcnt(6)
 v_mfma_f32_32x32x16_bf16 v[64:79], a[128:131], v[16:19], v[64:79]
 s_cbranch_vccz g_200
 buffer_load_dwordx4 v2, s[52:55], s97 offen offset:3072 sc1 lds
g_200:
 ds_read_b128 v[44:47], v3 offset:23552
 s_waitcnt lgkmcnt(6)
 v_mfma_f32_32x32x16_bf16 v[64:79], a[136:139], v[20:23], v[64:79]
 s_cbranch_vccz g_201
 s_add_u32 m0, s96, 8192
 s_add_u32 s97, s97, 4096
 buffer_load_dwordx4 v2, s[52:55], s97 offen offset:0 sc1 lds
g_201:
 ds_read_b128 v[16:19], v3 offset:24576
 s_waitcnt lgkmcnt(6)
 v_mfma_f32_32x32x16_bf16 v[64:79], a[144:147], v[24:27], v[64:79]
 s_bitcmp1_b32 s90, 1
 s_cbranch_scc0 es_202
 s_cbranch_vccz es_203
 s_waitcnt vmcnt(9)
 s_branch es_204
es_203:
 s_waitcnt vmcnt(0)
es_204:
 s_mov_b64 exec, 1
 buffer_store_dword v0, v10, s[52:55], s69 offen sc1
 s_mov_b64 exec, -1
es_202:
 s_cbranch_vccz g_205
 buffer_load_dwordx4 v2, s[52:55], s97 offen offset:1024 sc1 lds
g_205:
 ds_read_b128 v[20:23], v3 offset:25600
 s_waitcnt lgkmcnt(6)
 v_mfma_f32_32x32x16_bf16 v[64:79], a[152:155], v[28:31], v[64:79]
 s_cbranch_vccz g_206
 buffer_load_dwordx4 v2, s[52:55], s97 offen offset:2048 sc1 lds
g_206:
 ds_read_b128 v[24:27], v3 offset:26624
 s_waitcnt lgkmcnt(6)
 v_mfma_f32_32x32x16_bf16 v[64:79], a[160:163], v[32:35], v[64:79]
 s_cbranch_vccz g_207
 buffer_load_dwordx4 v2, s[52:55], s97 offen offset:3072 sc1 lds
g_207:
 ds_read_b128 v[28:31], v3 offset:27648
 s_waitcnt lgkmcnt(6)
 v_mfma_f32_32x32x16_bf16 v[64:79], a[168:171], v[36:39], v[64:79]
 s_cbranch_vccz g_208
 s_add_u32 m0, s96, 12288
 s_add_u32 s97, s97, 4096
 buffer_load_dwordx4 v2, s[52:55], s97 offen offset:0 sc1 lds
g_208:
 ds_read_b128 v[32:35], v3 offset:28672
 s_waitcnt lgkmcnt(6)
 v_mfma_f32_32x32x16_bf16 v[64:79], a[176:179], v[40:43], v[64:79]
 s_cbranch_vccz g_209
 buffer_load_dwordx4 v2, s[52:55], s97 offen offset:1024 sc1 lds
g_209:
 ds_read_b128 v[36:39], v3 offset:29696
 s_waitcnt lgkmcnt(6)
 v_mfma_f32_32x32x16_bf16 v[64:79], a[184:187], v[44:47], v[64:79]
 s_cbranch_vccz g_210
 buffer_load_dwordx4 v2, s[52:55], s97 offen offset:2048 sc1 lds
g_210:
 ds_read_b128 v[40:43], v3 offset:30720
 s_waitcnt lgkmcnt(6)
 v_mfma_f32_32x32x16_bf16 v[64:79], a[192:195], v[16:19], v[64:79]
 s_cbranch_vccz g_211
 buffer_load_dwordx4 v2, s[52:55], s97 offen offset:3072 sc1 lds
g_211:
 ds_read_b128 v[44:47], v3 offset:31744
 s_waitcnt lgkmcnt(6)
 v_mfma_f32_32x32x16_bf16 v[64:79], a[200:203], v[20:23], v[64:79]
 s_mul_i32 s80, s68, 8388608
 s_add_u32 s80, s80, 123453440
 s_lshl_b32 s70, s67, 17
 s_add_u32 s80, s80, s70
 ds_read_b128 v[16:19], v3 offset:32768
 s_waitcnt lgkmcnt(6)
 v_mfma_f32_32x32x16_bf16 v[64:79], a[208:211], v[24:27], v[64:79]
 s_lshl_b32 s70, s98, 9
 s_add_u32 s80, s80, s70
 s_mul_i32 s101, s68, 65
 s_add_u32 s101, s101, s67
 ds_read_b128 v[20:23], v3 offset:33792
 s_waitcnt lgkmcnt(6)
 v_mfma_f32_32x32x16_bf16 v[64:79], a[216:219], v[28:31], v[64:79]
 s_lshl_b32 s101, s101, 8
 s_add_u32 s101, s101, 66560
 s_add_u32 s101, s101, s98
 ds_read_b128 v[24:27], v3 offset:34816
 s_waitcnt lgkmcnt(6)
 v_mfma_f32_32x32x16_bf16 v[64:79], a[224:227], v[32:35], v[64:79]
 s_cmp_lg_u32 s3, 0
 s_cbranch_scc1 w0_212
 s_min_u32 s70, s6, 63
 s_min_u32 s71, s7, 63
 s_lshl_b32 s70, s70, 8
 s_lshl_b32 s71, s71, 8
 v_add_u32 v15, s70, v56
 s_mov_b32 exec_lo, 0
 v_add_u32 v15, s71, v56
 s_mov_b32 exec_lo, s87
 s_mov_b32 exec_hi, s87
 buffer_load_dwordx2 v[62:63], v15, s[52:55], 0 offen sc1
 s_mov_b64 exec, -1
w0_212:
 ds_read_b128 v[28:31], v3 offset:35840
 s_waitcnt lgkmcnt(6)
 v_mfma_f32_32x32x16_bf16 v[64:79], a[232:235], v[36:39], v[64:79]
 ds_read_b128 v[32:35], v3 offset:36864
 s_waitcnt lgkmcnt(6)
 v_mfma_f32_32x32x16_bf16 v[64:79], a[240:243], v[40:43], v[64:79]
 ds_read_b128 v[36:39], v3 offset:37888
 s_waitcnt lgkmcnt(6)
 v_mfma_f32_32x32x16_bf16 v[64:79], a[248:251], v[44:47], v[64:79]
 ds_read_b128 v[40:43], v3 offset:38912
 s_waitcnt lgkmcnt(6)
 v_mfma_f32_32x32x16_bf16 v[64:79], a[4:7], v[16:19], v[64:79]
 ds_read_b128 v[44:47], v3 offset:39936
 s_waitcnt lgkmcnt(6)
 v_mfma_f32_32x32x16_bf16 v[64:79], a[12:15], v[20:23], v[64:79]
 ds_read_b128 v[16:19], v3 offset:40960
 s_waitcnt lgkmcnt(6)
 v_mfma_f32_32x32x16_bf16 v[64:79], a[20:23], v[24:27], v[64:79]
 ds_read_b128 v[20:23], v3 offset:41984
 s_waitcnt lgkmcnt(6)
 v_mfma_f32_32x32x16_bf16 v[64:79], a[28:31], v[28:31], v[64:79]
 ds_read_b128 v[24:27], v3 offset:43008
 s_waitcnt lgkmcnt(6)
 v_mfma_f32_32x32x16_bf16 v[64:79], a[36:39], v[32:35], v[64:79]
 ds_read_b128 v[28:31], v3 offset:44032
 s_waitcnt lgkmcnt(6)
 v_mfma_f32_32x32x16_bf16 v[64:79], a[44:47], v[36:39], v[64:79]
 ds_read_b128 v[32:35], v3 offset:45056
 s_waitcnt lgkmcnt(6)
 v_mfma_f32_32x32x16_bf16 v[64:79], a[52:55], v[40:43], v[64:79]
 ds_read_b128 v[36:39], v3 offset:46080
 s_waitcnt lgkmcnt(6)
 v_mfma_f32_32x32x16_bf16 v[64:79], a[60:63], v[44:47], v[64:79]
 ds_read_b128 v[40:43], v3 offset:47104
 s_waitcnt lgkmcnt(6)
 v_mfma_f32_32x32x16_bf16 v[64:79], a[68:71], v[16:19], v[64:79]
 ds_read_b128 v[44:47], v3 offset:48128
 s_waitcnt lgkmcnt(6)
 v_mfma_f32_32x32x16_bf16 v[64:79], a[76:79], v[20:23], v[64:79]
 ds_read_b128 v[16:19], v3 offset:49152
 s_waitcnt lgkmcnt(6)
 v_mfma_f32_32x32x16_bf16 v[64:79], a[84:87], v[24:27], v[64:79]
 ds_read_b128 v[20:23], v3 offset:50176
 s_waitcnt lgkmcnt(6)
 v_mfma_f32_32x32x16_bf16 v[64:79], a[92:95], v[28:31], v[64:79]
 ds_read_b128 v[24:27], v3 offset:51200
 s_waitcnt lgkmcnt(6)
 v_mfma_f32_32x32x16_bf16 v[64:79], a[100:103], v[32:35], v[64:79]
 ds_read_b128 v[28:31], v3 offset:52224
 s_waitcnt lgkmcnt(6)
 v_mfma_f32_32x32x16_bf16 v[64:79], a[108:111], v[36:39], v[64:79]
 ds_read_b128 v[32:35], v3 offset:53248
 s_waitcnt lgkmcnt(6)
 v_mfma_f32_32x32x16_bf16 v[64:79], a[116:119], v[40:43], v[64:79]
 ds_read_b128 v[36:39], v3 offset:54272
 s_waitcnt lgkmcnt(6)
 v_mfma_f32_32x32x16_bf16 v[64:79], a[124:127], v[44:47], v[64:79]
 ds_read_b128 v[40:43], v3 offset:55296
 s_waitcnt lgkmcnt(6)
 v_mfma_f32_32x32x16_bf16 v[64:79], a[132:135], v[16:19], v[64:79]
 ds_read_b128 v[44:47], v3 offset:56320
 s_waitcnt lgkmcnt(6)
 v_mfma_f32_32x32x16_bf16 v[64:79], a[140:143], v[20:23], v[64:79]
 ds_read_b128 v[16:19], v3 offset:57344
 s_waitcnt lgkmcnt(6)
 v_mfma_f32_32x32x16_bf16 v[64:79], a[148:151], v[24:27], v[64:79]
 ds_read_b128 v[20:23], v3 offset:58368
 s_waitcnt lgkmcnt(6)
 v_mfma_f32_32x32x16_bf16 v[64:79], a[156:159], v[28:31], v[64:79]
 ds_read_b128 v[24:27], v3 offset:59392
 s_waitcnt lgkmcnt(6)
 v_mfma_f32_32x32x16_bf16 v[64:79], a[164:167], v[32:35], v[64:79]
 s_waitcnt vmcnt(0)
 s_bitcmp1_b32 s90, 0
 s_cbranch_scc0 sg_213
 s_mov_b64 exec, 1
 buffer_store_dword v0, v10, s[52:55], s69 offen sc1
 s_mov_b64 exec, -1
sg_213:
 s_cmp_lg_u32 s3, 0
 s_cbranch_scc1 w0_214
 v_cmp_ge_u32 s[72:73], v62, v57
 v_cmp_ge_u32 s[74:75], v63, v58
 s_and_b64 s[72:73], s[72:73], s[74:75]
 s_mov_b32 s70, 2
 s_cmp_lt_u32 s7, 64
 s_cselect_b32 s71, s73, 0
 s_cmp_eq_u32 s71, -1
 s_cselect_b32 s70, 1, s70
 s_cmp_lt_u32 s6, 64
 s_cselect_b32 s71, s72, 0
 s_cmp_eq_u32 s71, -1
 s_cselect_b32 s70, 0, s70
 v_mov_b32 v5, s70
 v_mov_b32 v6, s95
 ds_write_b32 v6, v5
w0_214:
 ds_read_b128 v[28:31], v3 offset:60416
 s_waitcnt lgkmcnt(6)
 v_mfma_f32_32x32x16_bf16 v[64:79], a[172:175], v[36:39], v[64:79]
 ds_read_b128 v[32:35], v3 offset:61440
 s_waitcnt lgkmcnt(6)
 v_mfma_f32_32x32x16_bf16 v[64:79], a[180:183], v[40:43], v[64:79]
 ds_read_b128 v[36:39], v3 offset:62464
 s_waitcnt lgkmcnt(6)
 v_mfma_f32_32x32x16_bf16 v[64:79], a[188:191], v[44:47], v[64:79]
 ds_read_b128 v[40:43], v3 offset:63488
 s_waitcnt lgkmcnt(6)
 v_mfma_f32_32x32x16_bf16 v[64:79], a[196:199], v[16:19], v[64:79]
 v_mov_b32 v6, s95
 s_waitcnt lgkmcnt(4)
 s_barrier
 ds_read_b32 v61, v6
 s_xor_b32 s95, s95, 4
 ds_read_b128 v[44:47], v3 offset:64512
 s_waitcnt lgkmcnt(6)
 v_mfma_f32_32x32x16_bf16 v[64:79], a[204:207], v[20:23], v[64:79]
 s_cbranch_vccz wo_tail0
 ds_read_b128 v[16:19], v12 offset:0
 s_waitcnt lgkmcnt(6)
 v_mfma_f32_32x32x16_bf16 v[64:79], a[212:215], v[24:27], v[64:79]
 ds_read_b128 v[20:23], v12 offset:1024
 s_waitcnt lgkmcnt(6)
 v_mfma_f32_32x32x16_bf16 v[64:79], a[220:223], v[28:31], v[64:79]
 ds_read_b128 v[24:27], v12 offset:2048
 s_waitcnt lgkmcnt(6)
 v_mfma_f32_32x32x16_bf16 v[64:79], a[228:231], v[32:35], v[64:79]
 ds_read_b128 v[28:31], v12 offset:3072
 s_waitcnt lgkmcnt(6)
 v_mfma_f32_32x32x16_bf16 v[64:79], a[236:239], v[36:39], v[64:79]
 ds_read_b128 v[32:35], v12 offset:4096
 s_waitcnt lgkmcnt(6)
 v_mfma_f32_32x32x16_bf16 v[64:79], a[244:247], v[40:43], v[64:79]
 s_mov_b32 s90, 1
 s_mov_b32 s91, s80
 s_mov_b32 s69, s101
 ds_read_b128 v[36:39], v12 offset:5120
 s_waitcnt lgkmcnt(6)
 v_mfma_f32_32x32x16_bf16 v[64:79], a[252:255], v[44:47], v[64:79]
 v_readfirstlane_b32 s94, v61
 s_cmp_ge_u32 s6, 64
 s_cselect_b32 s70, 0, s68
 s_cmp_lg_u32 s70, 0
 s_cbranch_scc1 wo_run1
 s_mov_b32 s90, 2
 s_nop 7
 v_cvt_pk_bf16_f32 v128, v64, v65
 v_cvt_pk_bf16_f32 v129, v66, v67
 v_cvt_pk_bf16_f32 v130, v68, v69
 v_cvt_pk_bf16_f32 v131, v70, v71
 buffer_store_dwordx4 v[128:131], v4, s[52:55], s80 offen offset:0 sc1
 v_cvt_pk_bf16_f32 v132, v72, v73
 v_cvt_pk_bf16_f32 v133, v74, v75
 v_cvt_pk_bf16_f32 v134, v76, v77
 v_cvt_pk_bf16_f32 v135, v78, v79
 buffer_store_dwordx4 v[132:135], v4, s[52:55], s80 offen offset:1024 sc1
 s_branch wo_run1
wo_plain0:
 ds_read_b128 v[40:43], v3 offset:6144
 s_waitcnt lgkmcnt(6)
 v_mfma_f32_32x32x16_bf16 v[64:79], a[0:3], v[16:19], 0
 s_mov_b32 s68, s4
 s_mov_b32 s67, s5
 s_mul_i32 s80, s68, 8388608
 s_add_u32 s80, s80, 123453440
 ds_read_b128 v[44:47], v3 offset:7168
 s_waitcnt lgkmcnt(6)
 v_mfma_f32_32x32x16_bf16 v[64:79], a[8:11], v[20:23], v[64:79]
 s_lshl_b32 s70, s67, 17
 s_add_u32 s80, s80, s70
 s_lshl_b32 s70, s98, 9
 s_add_u32 s80, s80, s70
 ds_read_b128 v[16:19], v3 offset:8192
 s_waitcnt lgkmcnt(6)
 v_mfma_f32_32x32x16_bf16 v[64:79], a[16:19], v[24:27], v[64:79]
 s_mul_i32 s101, s68, 65
 s_add_u32 s101, s101, s67
 s_lshl_b32 s101, s101, 8
 s_add_u32 s101, s101, 66560
 s_barrier
 ds_read_b128 v[20:23], v3 offset:9216
 s_waitcnt lgkmcnt(6)
 v_mfma_f32_32x32x16_bf16 v[64:79], a[24:27], v[28:31], v[64:79]
 s_add_u32 s101, s101, s98
 ds_read_b128 v[24:27], v3 offset:10240
 s_waitcnt lgkmcnt(6)
 v_mfma_f32_32x32x16_bf16 v[64:79], a[32:35], v[32:35], v[64:79]
 ds_read_b128 v[28:31], v3 offset:11264
 s_waitcnt lgkmcnt(6)
 v_mfma_f32_32x32x16_bf16 v[64:79], a[40:43], v[36:39], v[64:79]
 ds_read_b128 v[32:35], v3 offset:12288
 s_waitcnt lgkmcnt(6)
 v_mfma_f32_32x32x16_bf16 v[64:79], a[48:51], v[40:43], v[64:79]
 ds_read_b128 v[36:39], v3 offset:13312
 s_waitcnt lgkmcnt(6)
 v_mfma_f32_32x32x16_bf16 v[64:79], a[56:59], v[44:47], v[64:79]
 ds_read_b128 v[40:43], v3 offset:14336
 s_waitcnt lgkmcnt(6)
 v_mfma_f32_32x32x16_bf16 v[64:79], a[64:67], v[16:19], v[64:79]
 ds_read_b128 v[44:47], v3 offset:15360
 s_waitcnt lgkmcnt(6)
 v_mfma_f32_32x32x16_bf16 v[64:79], a[72:75], v[20:23], v[64:79]
 ds_read_b128 v[16:19], v3 offset:16384
 s_waitcnt lgkmcnt(6)
 v_mfma_f32_32x32x16_bf16 v[64:79], a[80:83], v[24:27], v[64:79]
 ds_read_b128 v[20:23], v3 offset:17408
 s_waitcnt lgkmcnt(6)
 v_mfma_f32_32x32x16_bf16 v[64:79], a[88:91], v[28:31], v[64:79]
 ds_read_b128 v[24:27], v3 offset:18432
 s_waitcnt lgkmcnt(6)
 v_mfma_f32_32x32x16_bf16 v[64:79], a[96:99], v[32:35], v[64:79]
 ds_read_b128 v[28:31], v3 offset:19456
 s_waitcnt lgkmcnt(6)
 v_mfma_f32_32x32x16_bf16 v[64:79], a[104:107], v[36:39], v[64:79]
 ds_read_b128 v[32:35], v3 offset:20480
 s_waitcnt lgkmcnt(6)
 v_mfma_f32_32x32x16_bf16 v[64:79], a[112:115], v[40:43], v[64:79]
 ds_read_b128 v[36:39], v3 offset:21504
 s_waitcnt lgkmcnt(6)
 v_mfma_f32_32x32x16_bf16 v[64:79], a[120:123], v[44:47], v[64:79]
 ds_read_b128 v[40:43], v3 offset:22528
 s_waitcnt lgkmcnt(6)
 v_mfma_f32_32x32x16_bf16 v[64:79], a[128:131], v[16:19], v[64:79]
 ds_read_b128 v[44:47], v3 offset:23552
 s_waitcnt lgkmcnt(6)
 v_mfma_f32_32x32x16_bf16 v[64:79], a[136:139], v[20:23], v[64:79]
 ds_read_b128 v[16:19], v3 offset:24576
 s_waitcnt lgkmcnt(6)
 v_mfma_f32_32x32x16_bf16 v[64:79], a[144:147], v[24:27], v[64:79]
 ds_read_b128 v[20:23], v3 offset:25600
 s_waitcnt lgkmcnt(6)
 v_mfma_f32_32x32x16_bf16 v[64:79], a[152:155], v[28:31], v[64:79]
 ds_read_b128 v[24:27], v3 offset:26624
 s_waitcnt lgkmcnt(6)
 v_mfma_f32_32x32x16_bf16 v[64:79], a[160:163], v[32:35], v[64:79]
 ds_read_b128 v[28:31], v3 offset:27648
 s_waitcnt lgkmcnt(6)
 v_mfma_f32_32x32x16_bf16 v[64:79], a[168:171], v[36:39], v[64:79]
 ds_read_b128 v[32:35], v3 offset:28672
 s_waitcnt lgkmcnt(6)
 v_mfma_f32_32x32x16_bf16 v[64:79], a[176:179], v[40:43], v[64:79]
 ds_read_b128 v[36:39], v3 offset:29696
 s_waitcnt lgkmcnt(6)
 v_mfma_f32_32x32x16_bf16 v[64:79], a[184:187], v[44:47], v[64:79]
 ds_read_b128 v[40:43], v3 offset:30720
 s_waitcnt lgkmcnt(6)
 v_mfma_f32_32x32x16_bf16 v[64:79], a[192:195], v[16:19], v[64:79]
 ds_read_b128 v[44:47], v3 offset:31744
 s_waitcnt lgkmcnt(6)
 v_mfma_f32_32x32x16_bf16 v[64:79], a[200:203], v[20:23], v[64:79]
 ds_read_b128 v[16:19], v3 offset:32768
 s_waitcnt lgkmcnt(6)
 v_mfma_f32_32x32x16_bf16 v[64:79], a[208:211], v[24:27], v[64:79]
 ds_read_b128 v[20:23], v3 offset:33792
 s_waitcnt lgkmcnt(6)
 v_mfma_f32_32x32x16_bf16 v[64:79], a[216:219], v[28:31], v[64:79]
 ds_read_b128 v[24:27], v3 offset:34816
 s_waitcnt lgkmcnt(6)
 v_mfma_f32_32x32x16_bf16 v[64:79], a[224:227], v[32:35], v[64:79]
 ds_read_b128 v[28:31], v3 offset:35840
 s_waitcnt lgkmcnt(6)
 v_mfma_f32_32x32x16_bf16 v[64:79], a[232:235], v[36:39], v[64:79]
 ds_read_b128 v[32:35], v3 offset:36864
 s_waitcnt lgkmcnt(6)
 v_mfma_f32_32x32x16_bf16 v[64:79], a[240:243], v[40:43], v[64:79]
 ds_read_b128 v[36:39], v3 offset:37888
 s_waitcnt lgkmcnt(6)
 v_mfma_f32_32x32x16_bf16 v[64:79], a[248:251], v[44:47], v[64:79]
 ds_read_b128 v[40:43], v3 offset:38912
 s_waitcnt lgkmcnt(6)
 v_mfma_f32_32x32x16_bf16 v[64:79], a[4:7], v[16:19], v[64:79]
 ds_read_b128 v[44:47], v3 offset:39936
 s_waitcnt lgkmcnt(6)
 v_mfma_f32_32x32x16_bf16 v[64:79], a[12:15], v[20:23], v[64:79]
 ds_read_b128 v[16:19], v3 offset:40960
 s_waitcnt lgkmcnt(6)
 v_mfma_f32_32x32x16_bf16 v[64:79], a[20:23], v[24:27], v[64:79]
 ds_read_b128 v[20:23], v3 offset:41984
 s_waitcnt lgkmcnt(6)
 v_mfma_f32_32x32x16_bf16 v[64:79], a[28:31], v[28:31], v[64:79]
 ds_read_b128 v[24:27], v3 offset:43008
 s_waitcnt lgkmcnt(6)
 v_mfma_f32_32x32x16_bf16 v[64:79], a[36:39], v[32:35], v[64:79]
 s_cmp_lg_u32 s3, 0
 s_cbranch_scc1 w0_215
 s_min_u32 s70, s6, 63
 s_min_u32 s71, s7, 63
 s_lshl_b32 s70, s70, 8
 s_lshl_b32 s71, s71, 8
 v_add_u32 v15, s70, v56
 s_mov_b32 exec_lo, 0
 v_add_u32 v15, s71, v56
 s_mov_b32 exec_lo, s87
 s_mov_b32 exec_hi, s87
 buffer_load_dwordx2 v[62:63], v15, s[52:55], 0 offen sc1
 s_mov_b64 exec, -1
w0_215:
 ds_read_b128 v[28:31], v3 offset:44032
 s_waitcnt lgkmcnt(6)
 v_mfma_f32_32x32x16_bf16 v[64:79], a[44:47], v[36:39], v[64:79]
 ds_read_b128 v[32:35], v3 offset:45056
 s_waitcnt lgkmcnt(6)
 v_mfma_f32_32x32x16_bf16 v[64:79], a[52:55], v[40:43], v[64:79]
 ds_read_b128 v[36:39], v3 offset:46080
 s_waitcnt lgkmcnt(6)
 v_mfma_f32_32x32x16_bf16 v[64:79], a[60:63], v[44:47], v[64:79]
 ds_read_b128 v[40:43], v3 offset:47104
 s_waitcnt lgkmcnt(6)
 v_mfma_f32_32x32x16_bf16 v[64:79], a[68:71], v[16:19], v[64:79]
 ds_read_b128 v[44:47], v3 offset:48128
 s_waitcnt lgkmcnt(6)
 v_mfma_f32_32x32x16_bf16 v[64:79], a[76:79], v[20:23], v[64:79]
 ds_read_b128 v[16:19], v3 offset:49152
 s_waitcnt lgkmcnt(6)
 v_mfma_f32_32x32x16_bf16 v[64:79], a[84:87], v[24:27], v[64:79]
 ds_read_b128 v[20:23], v3 offset:50176
 s_waitcnt lgkmcnt(6)
 v_mfma_f32_32x32x16_bf16 v[64:79], a[92:95], v[28:31], v[64:79]
 ds_read_b128 v[24:27], v3 offset:51200
 s_waitcnt lgkmcnt(6)
 v_mfma_f32_32x32x16_bf16 v[64:79], a[100:103], v[32:35], v[64:79]
 ds_read_b128 v[28:31], v3 offset:52224
 s_waitcnt lgkmcnt(6)
 v_mfma_f32_32x32x16_bf16 v[64:79], a[108:111], v[36:39], v[64:79]
 ds_read_b128 v[32:35], v3 offset:53248
 s_waitcnt lgkmcnt(6)
 v_mfma_f32_32x32x16_bf16 v[64:79], a[116:119], v[40:43], v[64:79]
 ds_read_b128 v[36:39], v3 offset:54272
 s_waitcnt lgkmcnt(6)
 v_mfma_f32_32x32x16_bf16 v[64:79], a[124:127], v[44:47], v[64:79]
 ds_read_b128 v[40:43], v3 offset:55296
 s_waitcnt lgkmcnt(6)
 v_mfma_f32_32x32x16_bf16 v[64:79], a[132:135], v[16:19], v[64:79]
 ds_read_b128 v[44:47], v3 offset:56320
 s_waitcnt lgkmcnt(6)
 v_mfma_f32_32x32x16_bf16 v[64:79], a[140:143], v[20:23], v[64:79]
 ds_read_b128 v[16:19], v3 offset:57344
 s_waitcnt lgkmcnt(6)
 v_mfma_f32_32x32x16_bf16 v[64:79], a[148:151], v[24:27], v[64:79]
 ds_read_b128 v[20:23], v3 offset:58368
 s_waitcnt lgkmcnt(6)
 v_mfma_f32_32x32x16_bf16 v[64:79], a[156:159], v[28:31], v[64:79]
 ds_read_b128 v[24:27], v3 offset:59392
 s_waitcnt lgkmcnt(6)
 v_mfma_f32_32x32x16_bf16 v[64:79], a[164:167], v[32:35], v[64:79]
 s_cmp_lg_u32 s3, 0
 s_cbranch_scc1 w0_216
 s_waitcnt vmcnt(0)
 v_cmp_ge_u32 s[72:73], v62, v57
 v_cmp_ge_u32 s[74:75], v63, v58
 s_and_b64 s[72:73], s[72:73], s[74:75]
 s_mov_b32 s70, 2
 s_cmp_lt_u32 s7, 64
 s_cselect_b32 s71, s73, 0
 s_cmp_eq_u32 s71, -1
 s_cselect_b32 s70, 1, s70
 s_cmp_lt_u32 s6, 64
 s_cselect_b32 s71, s72, 0
 s_cmp_eq_u32 s71, -1
 s_cselect_b32 s70, 0, s70
 v_mov_b32 v5, s70
 v_mov_b32 v6, s95
 ds_write_b32 v6, v5
w0_216:
 ds_read_b128 v[28:31], v3 offset:60416
 s_waitcnt lgkmcnt(6)
 v_mfma_f32_32x32x16_bf16 v[64:79], a[172:175], v[36:39], v[64:79]
 ds_read_b128 v[32:35], v3 offset:61440
 s_waitcnt lgkmcnt(6)
 v_mfma_f32_32x32x16_bf16 v[64:79], a[180:183], v[40:43], v[64:79]
 ds_read_b128 v[36:39], v3 offset:62464
 s_waitcnt lgkmcnt(6)
 v_mfma_f32_32x32x16_bf16 v[64:79], a[188:191], v[44:47], v[64:79]
 ds_read_b128 v[40:43], v3 offset:63488
 s_waitcnt lgkmcnt(6)
 v_mfma_f32_32x32x16_bf16 v[64:79], a[196:199], v[16:19], v[64:79]
 v_mov_b32 v6, s95
 s_waitcnt lgkmcnt(4)
 s_barrier
 ds_read_b32 v61, v6
 s_xor_b32 s95, s95, 4
 ds_read_b128 v[44:47], v3 offset:64512
 s_waitcnt lgkmcnt(6)
 v_mfma_f32_32x32x16_bf16 v[64:79], a[204:207], v[20:23], v[64:79]
wo_tail0:
 s_waitcnt lgkmcnt(5)
 v_mfma_f32_32x32x16_bf16 v[64:79], a[212:215], v[24:27], v[64:79]
 s_waitcnt lgkmcnt(4)
 v_mfma_f32_32x32x16_bf16 v[64:79], a[220:223], v[28:31], v[64:79]
 s_waitcnt lgkmcnt(3)
 v_mfma_f32_32x32x16_bf16 v[64:79], a[228:231], v[32:35], v[64:79]
 s_waitcnt lgkmcnt(2)
 v_mfma_f32_32x32x16_bf16 v[64:79], a[236:239], v[36:39], v[64:79]
 s_waitcnt lgkmcnt(1)
 v_mfma_f32_32x32x16_bf16 v[64:79], a[244:247], v[40:43], v[64:79]
 s_waitcnt lgkmcnt(0)
 v_mfma_f32_32x32x16_bf16 v[64:79], a[252:255], v[44:47], v[64:79]
 v_readfirstlane_b32 s94, v61
 s_mov_b32 s88, s6
 s_mov_b32 s89, s7
 s_add_u32 s88, s88, 2
 s_add_u32 s70, s89, 1
 s_cmp_lt_u32 s70, 39
 s_cselect_b32 s70, s70, s66
 s_add_u32 s71, s89, 3
 s_cmp_lt_u32 s89, 39
 s_cselect_b32 s89, s70, s71
 s_and_b32 s4, s94, 1
 s_cmp_eq_u32 s94, 0
 s_cselect_b32 s5, s6, s7
 s_cselect_b32 s6, s88, s6
 s_cmp_eq_u32 s94, 1
 s_cselect_b32 s7, s89, s7
 s_mov_b32 s78, 65536
 s_mul_i32 s81, s4, 16777216
 s_add_u32 s81, s81, 89899008
 s_lshl_b32 s70, s5, 18
 s_add_u32 s81, s81, s70
 s_lshl_b32 s70, s82, 16
 s_add_u32 s81, s81, s70
 s_mul_i32 s97, s3, 16384
 s_min_u32 s97, s97, 49152
 s_add_u32 s96, s97, s78
 s_add_u32 s97, s97, s81
 s_sub_u32 s97, s97, 4096
 v_cvt_pk_bf16_f32 v128, v64, v65
 v_cvt_pk_bf16_f32 v129, v66, v67
 v_cvt_pk_bf16_f32 v130, v68, v69
 v_cvt_pk_bf16_f32 v131, v70, v71
 buffer_store_dwordx4 v[128:131], v4, s[52:55], s80 offen offset:0 sc1
 v_cvt_pk_bf16_f32 v132, v72, v73
 v_cvt_pk_bf16_f32 v133, v74, v75
 v_cvt_pk_bf16_f32 v134, v76, v77
 v_cvt_pk_bf16_f32 v135, v78, v79
 buffer_store_dwordx4 v[132:135], v4, s[52:55], s80 offen offset:1024 sc1
 s_cmp_ge_u32 s94, 2
 s_cbranch_scc1 wo_idle0
 s_add_u32 m0, s96, 0
 s_add_u32 s97, s97, 4096
 buffer_load_dwordx4 v2, s[52:55], s97 offen offset:0 sc1 lds
 buffer_load_dwordx4 v2, s[52:55], s97 offen offset:1024 sc1 lds
 buffer_load_dwordx4 v2, s[52:55], s97 offen offset:2048 sc1 lds
 buffer_load_dwordx4 v2, s[52:55], s97 offen offset:3072 sc1 lds
 s_add_u32 m0, s96, 4096
 s_add_u32 s97, s97, 4096
 buffer_load_dwordx4 v2, s[52:55], s97 offen offset:0 sc1 lds
 buffer_load_dwordx4 v2, s[52:55], s97 offen offset:1024 sc1 lds
 buffer_load_dwordx4 v2, s[52:55], s97 offen offset:2048 sc1 lds
 buffer_load_dwordx4 v2, s[52:55], s97 offen offset:3072 sc1 lds
 s_add_u32 m0, s96, 8192
 s_add_u32 s97, s97, 4096
 buffer_load_dwordx4 v2, s[52:55], s97 offen offset:0 sc1 lds
 buffer_load_dwordx4 v2, s[52:55], s97 offen offset:1024 sc1 lds
 buffer_load_dwordx4 v2, s[52:55], s97 offen offset:2048 sc1 lds
 buffer_load_dwordx4 v2, s[52:55], s97 offen offset:3072 sc1 lds
 s_add_u32 m0, s96, 12288
 s_add_u32 s97, s97, 4096
 buffer_load_dwordx4 v2, s[52:55], s97 offen offset:0 sc1 lds
 buffer_load_dwordx4 v2, s[52:55], s97 offen offset:1024 sc1 lds
 buffer_load_dwordx4 v2, s[52:55], s97 offen offset:2048 sc1 lds
 buffer_load_dwordx4 v2, s[52:55], s97 offen offset:3072 sc1 lds
 s_waitcnt vmcnt(16)
 s_mov_b64 exec, 1
 buffer_store_dword v0, v10, s[52:55], s101 offen sc1
 s_mov_b64 exec, -1
 s_branch sc_221
wo_idle0:
 s_mov_b32 s83, 0x200000
 s_cmp_lg_u32 s3, 0
 s_cbranch_scc1 nw_223
 s_min_u32 s70, s6, 63
 s_min_u32 s71, s7, 63
 s_lshl_b32 s70, s70, 8
 s_lshl_b32 s71, s71, 8
 v_add_u32 v15, s70, v56
 s_mov_b32 exec_lo, 0
 v_add_u32 v15, s71, v56
 s_mov_b32 exec_lo, s87
 s_mov_b32 exec_hi, s87
 buffer_load_dwordx2 v[62:63], v15, s[52:55], 0 offen sc1
 s_mov_b64 exec, -1
 s_waitcnt vmcnt(1)
 s_mov_b64 exec, 1
 buffer_store_dword v0, v10, s[52:55], s101 offen sc1
 s_mov_b64 exec, -1
 s_min_u32 s70, s6, s7
 s_cmp_ge_u32 s70, 64
 s_cbranch_scc1 k_exit
 s_waitcnt vmcnt(1)
 s_branch ev_222
nw_223:
 s_waitcnt vmcnt(0)
 s_mov_b64 exec, 1
 buffer_store_dword v0, v10, s[52:55], s101 offen sc1
 s_mov_b64 exec, -1
wo_sched1:
 s_min_u32 s70, s6, s7
 s_cmp_ge_u32 s70, 64
 s_cbranch_scc1 k_exit
 s_cmp_lg_u32 s3, 0
 s_cbranch_scc1 sc_217
 s_mov_b32 s83, 0x200000
sc_218:
 s_min_u32 s70, s6, 63
 s_min_u32 s71, s7, 63
 s_lshl_b32 s70, s70, 8
 s_lshl_b32 s71, s71, 8
 v_add_u32 v15, s70, v56
 s_mov_b32 exec_lo, 0
 v_add_u32 v15, s71, v56
 s_mov_b32 exec_lo, s87
 s_mov_b32 exec_hi, s87
 buffer_load_dwordx2 v[62:63], v15, s[52:55], 0 offen sc1
 s_mov_b64 exec, -1
 s_waitcnt vmcnt(0)
ev_222:
 v_cmp_ge_u32 s[72:73], v62, v57
 v_cmp_ge_u32 s[74:75], v63, v58
 s_and_b64 s[72:73], s[72:73], s[74:75]
 s_mov_b32 s70, 2
 s_cmp_lt_u32 s7, 64
 s_cselect_b32 s71, s73, 0
 s_cmp_eq_u32 s71, -1
 s_cselect_b32 s70, 1, s70
 s_cmp_lt_u32 s6, 64
 s_cselect_b32 s71, s72, 0
 s_cmp_eq_u32 s71, -1
 s_cselect_b32 s70, 0, s70
 s_cmp_lt_u32 s70, 2
 s_cbranch_scc1 sc_219
 s_sub_u32 s83, s83, 1
 s_cmp_lg_u32 s83, 0
 s_cbranch_scc1 sc_218
 s_mov_b32 s70, 3
sc_219:
 v_mov_b32 v5, s70
 v_mov_b32 v6, 163832
 ds_write_b32 v6, v5
 s_waitcnt lgkmcnt(0)
sc_217:
 s_barrier
 v_mov_b32 v6, 163832
 ds_read_b32 v61, v6
 s_waitcnt lgkmcnt(0)
 v_readfirstlane_b32 s94, v61
 s_cmp_ge_u32 s94, 2
 s_cbranch_scc1 k_exit
 s_mov_b32 s88, s6
 s_mov_b32 s89, s7
 s_add_u32 s88, s88, 2
 s_add_u32 s70, s89, 1
 s_cmp_lt_u32 s70, 39
 s_cselect_b32 s70, s70, s66
 s_add_u32 s71, s89, 3
 s_cmp_lt_u32 s89, 39
 s_cselect_b32 s89, s70, s71
 s_and_b32 s4, s94, 1
 s_cmp_eq_u32 s94, 0
 s_cselect_b32 s5, s6, s7
 s_cselect_b32 s6, s88, s6
 s_cmp_eq_u32 s94, 1
 s_cselect_b32 s7, s89, s7
 s_mov_b32 s78, 65536
 s_mul_i32 s81, s4, 16777216
 s_add_u32 s81, s81, 89899008
 s_lshl_b32 s70, s5, 18
 s_add_u32 s81, s81, s70
 s_lshl_b32 s70, s82, 16
 s_add_u32 s81, s81, s70
 s_mul_i32 s97, s3, 16384
 s_min_u32 s97, s97, 49152
 s_add_u32 s96, s97, s78
 s_add_u32 s97, s97, s81
 s_sub_u32 s97, s97, 4096
 s_add_u32 m0, s96, 0
 s_add_u32 s97, s97, 4096
 buffer_load_dwordx4 v2, s[52:55], s97 offen offset:0 sc1 lds
 buffer_load_dwordx4 v2, s[52:55], s97 offen offset:1024 sc1 lds
 buffer_load_dwordx4 v2, s[52:55], s97 offen offset:2048 sc1 lds
 buffer_load_dwordx4 v2, s[52:55], s97 offen offset:3072 sc1 lds
 s_add_u32 m0, s96, 4096
 s_add_u32 s97, s97, 4096
 buffer_load_dwordx4 v2, s[52:55], s97 offen offset:0 sc1 lds
 buffer_load_dwordx4 v2, s[52:55], s97 offen offset:1024 sc1 lds
 buffer_load_dwordx4 v2, s[52:55], s97 offen offset:2048 sc1 lds
 buffer_load_dwordx4 v2, s[52:55], s97 offen offset:3072 sc1 lds
 s_add_u32 m0, s96, 8192
 s_add_u32 s97, s97, 4096
 buffer_load_dwordx4 v2, s[52:55], s97 offen offset:0 sc1 lds
 buffer_load_dwordx4 v2, s[52:55], s97 offen offset:1024 sc1 lds
 buffer_load_dwordx4 v2, s[52:55], s97 offen offset:2048 sc1 lds
 buffer_load_dwordx4 v2, s[52:55], s97 offen offset:3072 sc1 lds
 s_add_u32 m0, s96, 12288
 s_add_u32 s97, s97, 4096
 buffer_load_dwordx4 v2, s[52:55], s97 offen offset:0 sc1 lds
 buffer_load_dwordx4 v2, s[52:55], s97 offen offset:1024 sc1 lds
 buffer_load_dwordx4 v2, s[52:55], s97 offen offset:2048 sc1 lds
 buffer_load_dwordx4 v2, s[52:55], s97 offen offset:3072 sc1 lds
sc_221:
 s_cmp_lg_u32 s3, 0
 s_cbranch_scc1 sc_220
 s_min_u32 s70, s6, 63
 s_min_u32 s71, s7, 63
 s_lshl_b32 s70, s70, 8
 s_lshl_b32 s71, s71, 8
 v_add_u32 v15, s70, v56
 s_mov_b32 exec_lo, 0
 v_add_u32 v15, s71, v56
 s_mov_b32 exec_lo, s87
 s_mov_b32 exec_hi, s87
 buffer_load_dwordx2 v[62:63], v15, s[52:55], 0 offen sc1
 s_mov_b64 exec, -1
 s_waitcnt vmcnt(0)
 v_cmp_ge_u32 s[72:73], v62, v57
 v_cmp_ge_u32 s[74:75], v63, v58
 s_and_b64 s[72:73], s[72:73], s[74:75]
 s_mov_b32 s70, 2
 s_cmp_lt_u32 s7, 64
 s_cselect_b32 s71, s73, 0
 s_cmp_eq_u32 s71, -1
 s_cselect_b32 s70, 1, s70
 s_cmp_lt_u32 s6, 64
 s_cselect_b32 s71, s72, 0
 s_cmp_eq_u32 s71, -1
 s_cselect_b32 s70, 0, s70
 v_mov_b32 v5, s70
 v_mov_b32 v6, s95
 ds_write_b32 v6, v5
 s_waitcnt lgkmcnt(0)
sc_220:
 s_waitcnt vmcnt(0)
 v_mov_b32 v6, s95
 s_barrier
 ds_read_b32 v61, v6
 s_xor_b32 s95, s95, 4
 s_waitcnt lgkmcnt(0)
 v_readfirstlane_b32 s94, v61
 s_branch wo_pro1
wo_pro1:
 s_mov_b32 s90, 0
 ds_read_b128 v[16:19], v12 offset:0
 ds_read_b128 v[20:23], v12 offset:1024
 ds_read_b128 v[24:27], v12 offset:2048
 ds_read_b128 v[28:31], v12 offset:3072
 ds_read_b128 v[32:35], v12 offset:4096
 ds_read_b128 v[36:39], v12 offset:5120
 s_cmp_ge_u32 s94, 2
 s_cbranch_scc1 wo_plain1
wo_run1:
 s_cmp_lt_u32 s94, 2
 s_cselect_b64 vcc, -1, 0
 ds_read_b128 v[40:43], v12 offset:6144
 s_waitcnt lgkmcnt(6)
 v_mfma_f32_32x32x16_bf16 v[96:111], a[0:3], v[16:19], 0
 s_mov_b32 s68, s4
 s_mov_b32 s67, s5
 s_mov_b32 s88, s6
 s_mov_b32 s89, s7
 ds_read_b128 v[44:47], v12 offset:7168
 s_waitcnt lgkmcnt(6)
 v_mfma_f32_32x32x16_bf16 v[96:111], a[8:11], v[20:23], v[96:111]
 s_add_u32 s88, s88, 2
 s_add_u32 s70, s89, 1
 s_cmp_lt_u32 s70, 39
 s_cselect_b32 s70, s70, s66
 ds_read_b128 v[16:19], v12 offset:8192
 s_waitcnt lgkmcnt(6)
 v_mfma_f32_32x32x16_bf16 v[96:111], a[16:19], v[24:27], v[96:111]
 s_add_u32 s71, s89, 3
 s_cmp_lt_u32 s89, 39
 s_cselect_b32 s89, s70, s71
 s_and_b32 s4, s94, 1
 s_barrier
 ds_read_b128 v[20:23], v12 offset:9216
 s_waitcnt lgkmcnt(6)
 v_mfma_f32_32x32x16_bf16 v[96:111], a[24:27], v[28:31], v[96:111]
 s_cmp_eq_u32 s94, 0
 s_cselect_b32 s5, s6, s7
 s_cselect_b32 s6, s88, s6
 s_cmp_eq_u32 s94, 1
 s_cselect_b32 s7, s89, s7
 ds_read_b128 v[24:27], v12 offset:10240
 s_waitcnt lgkmcnt(6)
 v_mfma_f32_32x32x16_bf16 v[96:111], a[32:35], v[32:35], v[96:111]
 s_mov_b32 s78, 0
 s_mul_i32 s81, s4, 16777216
 s_add_u32 s81, s81, 89899008
 s_lshl_b32 s70, s5, 18
 ds_read_b128 v[28:31], v12 offset:11264
 s_waitcnt lgkmcnt(6)
 v_mfma_f32_32x32x16_bf16 v[96:111], a[40:43], v[36:39], v[96:111]
 s_add_u32 s81, s81, s70
 s_lshl_b32 s70, s82, 16
 s_add_u32 s81, s81, s70
 s_mul_i32 s97, s3, 16384
 ds_read_b128 v[32:35], v12 offset:12288
 s_waitcnt lgkmcnt(6)
 v_mfma_f32_32x32x16_bf16 v[96:111], a[48:51], v[40:43], v[96:111]
 s_min_u32 s97, s97, 49152
 s_add_u32 s96, s97, s78
 s_add_u32 s97, s97, s81
 s_sub_u32 s97, s97, 4096
 ds_read_b128 v[36:39], v12 offset:13312
 s_waitcnt lgkmcnt(6)
 v_mfma_f32_32x32x16_bf16 v[96:111], a[56:59], v[44:47], v[96:111]
 s_cbranch_vccz g_224
 s_add_u32 m0, s96, 0
 s_add_u32 s97, s97, 4096
 buffer_load_dwordx4 v2, s[52:55], s97 offen offset:0 sc1 lds
g_224:
 ds_read_b128 v[40:43], v12 offset:14336
 s_waitcnt lgkmcnt(6)
 v_mfma_f32_32x32x16_bf16 v[96:111], a[64:67], v[16:19], v[96:111]
 s_bitcmp1_b32 s90, 0
 s_cbranch_scc0 g_225
 v_cvt_pk_bf16_f32 v128, v64, v65
 v_cvt_pk_bf16_f32 v129, v66, v67
 v_cvt_pk_bf16_f32 v130, v68, v69
 v_cvt_pk_bf16_f32 v131, v70, v71
 buffer_store_dwordx4 v[128:131], v4, s[52:55], s91 offen offset:0 sc1
g_225:
 ds_read_b128 v[44:47], v12 offset:15360
 s_waitcnt lgkmcnt(6)
 v_mfma_f32_32x32x16_bf16 v[96:111], a[72:75], v[20:23], v[96:111]
 s_cbranch_vccz g_226
 buffer_load_dwordx4 v2, s[52:55], s97 offen offset:1024 sc1 lds
g_226:
 ds_read_b128 v[16:19], v12 offset:16384
 s_waitcnt lgkmcnt(6)
 v_mfma_f32_32x32x16_bf16 v[96:111], a[80:83], v[24:27], v[96:111]
 s_bitcmp1_b32 s90, 0
 s_cbranch_scc0 g_227
 v_cvt_pk_bf16_f32 v132, v72, v73
 v_cvt_pk_bf16_f32 v133, v74, v75
 v_cvt_pk_bf16_f32 v134, v76, v77
 v_cvt_pk_bf16_f32 v135, v78, v79
 buffer_store_dwordx4 v[132:135], v4, s[52:55], s91 offen offset:1024 sc1
g_227:
 ds_read_b128 v[20:23], v12 offset:17408
 s_waitcnt lgkmcnt(6)
 v_mfma_f32_32x32x16_bf16 v[96:111], a[88:91], v[28:31], v[96:111]
 s_cbranch_vccz g_228
 buffer_load_dwordx4 v2, s[52:55], s97 offen offset:2048 sc1 lds
g_228:
 ds_read_b128 v[24:27], v12 offset:18432
 s_waitcnt lgkmcnt(6)
 v_mfma_f32_32x32x16_bf16 v[96:111], a[96:99], v[32:35], v[96:111]
 s_cbranch_vccz g_229
 buffer_load_dwordx4 v2, s[52:55], s97 offen offset:3072 sc1 lds
g_229:
 ds_read_b128 v[28:31], v12 offset:19456
 s_waitcnt lgkmcnt(6)
 v_mfma_f32_32x32x16_bf16 v[96:111], a[104:107], v[36:39], v[96:111]
 s_cbranch_vccz g_230
 s_add_u32 m0, s96, 4096
 s_add_u32 s97, s97, 4096
 buffer_load_dwordx4 v2, s[52:55], s97 offen offset:0 sc1 lds
g_230:
 ds_read_b128 v[32:35], v12 offset:20480
 s_waitcnt lgkmcnt(6)
 v_mfma_f32_32x32x16_bf16 v[96:111], a[112:115], v[40:43], v[96:111]
 s_cbranch_vccz g_231
 buffer_load_dwordx4 v2, s[52:55], s97 offen offset:1024 sc1 lds
g_231:
 ds_read_b128 v[36:39], v12 offset:21504
 s_waitcnt lgkmcnt(6)
 v_mfma_f32_32x32x16_bf16 v[96:111], a[120:123], v[44:47], v[96:111]
 s_cbranch_vccz g_232
 buffer_load_dwordx4 v2, s[52:55], s97 offen offset:2048 sc1 lds
g_232:
 ds_read_b128 v[40:43], v12 offset:22528
 s_waitcnt lgkmcnt(6)
 v_mfma_f32_32x32x16_bf16 v[96:111], a[128:131], v[16:19], v[96:111]
 s_cbranch_vccz g_233
 buffer_load_dwordx4 v2, s[52:55], s97 offen offset:3072 sc1 lds
g_233:
 ds_read_b128 v[44:47], v12 offset:23552
 s_waitcnt lgkmcnt(6)
 v_mfma_f32_32x32x16_bf16 v[96:111], a[136:139], v[20:23], v[96:111]
 s_cbranch_vccz g_234
 s_add_u32 m0, s96, 8192
 s_add_u32 s97, s97, 4096
 buffer_load_dwordx4 v2, s[52:55], s97 offen offset:0 sc1 lds
g_234:
 ds_read_b128 v[16:19], v12 offset:24576
 s_waitcnt lgkmcnt(6)
 v_mfma_f32_32x32x16_bf16 v[96:111], a[144:147], v[24:27], v[96:111]
 s_bitcmp1_b32 s90, 1
 s_cbranch_scc0 es_235
 s_cbranch_vccz es_236
 s_waitcnt vmcnt(9)
 s_branch es_237
es_236:
 s_waitcnt vmcnt(0)
es_237:
 s_mov_b64 exec, 1
 buffer_store_dword v0, v10, s[52:55], s69 offen sc1
 s_mov_b64 exec, -1
es_235:
 s_cbranch_vccz g_238
 buffer_load_dwordx4 v2, s[52:55], s97 offen offset:1024 sc1 lds
g_238:
 ds_read_b128 v[20:23], v12 offset:25600
 s_waitcnt lgkmcnt(6)
 v_mfma_f32_32x32x16_bf16 v[96:111], a[152:155], v[28:31], v[96:111]
 s_cbranch_vccz g_239
 buffer_load_dwordx4 v2, s[52:55], s97 offen offset:2048 sc1 lds
g_239:
 ds_read_b128 v[24:27], v12 offset:26624
 s_waitcnt lgkmcnt(6)
 v_mfma_f32_32x32x16_bf16 v[96:111], a[160:163], v[32:35], v[96:111]
 s_cbranch_vccz g_240
 buffer_load_dwordx4 v2, s[52:55], s97 offen offset:3072 sc1 lds
g_240:
 ds_read_b128 v[28:31], v12 offset:27648
 s_waitcnt lgkmcnt(6)
 v_mfma_f32_32x32x16_bf16 v[96:111], a[168:171], v[36:39], v[96:111]
 s_cbranch_vccz g_241
 s_add_u32 m0, s96, 12288
 s_add_u32 s97, s97, 4096
 buffer_load_dwordx4 v2, s[52:55], s97 offen offset:0 sc1 lds
g_241:
 ds_read_b128 v[32:35], v12 offset:28672
 s_waitcnt lgkmcnt(6)
 v_mfma_f32_32x32x16_bf16 v[96:111], a[176:179], v[40:43], v[96:111]
 s_cbranch_vccz g_242
 buffer_load_dwordx4 v2, s[52:55], s97 offen offset:1024 sc1 lds
g_242:
 ds_read_b128 v[36:39], v12 offset:29696
 s_waitcnt lgkmcnt(6)
 v_mfma_f32_32x32x16_bf16 v[96:111], a[184:187], v[44:47], v[96:111]
 s_cbranch_vccz g_243
 buffer_load_dwordx4 v2, s[52:55], s97 offen offset:2048 sc1 lds
g_243:
 ds_read_b128 v[40:43], v12 offset:30720
 s_waitcnt lgkmcnt(6)
 v_mfma_f32_32x32x16_bf16 v[96:111], a[192:195], v[16:19], v[96:111]
 s_cbranch_vccz g_244
 buffer_load_dwordx4 v2, s[52:55], s97 offen offset:3072 sc1 lds
g_244:
 ds_read_b128 v[44:47], v12 offset:31744
 s_waitcnt lgkmcnt(6)
 v_mfma_f32_32x32x16_bf16 v[96:111], a[200:203], v[20:23], v[96:111]
 s_mul_i32 s80, s68, 8388608
 s_add_u32 s80, s80, 123453440
 s_lshl_b32 s70, s67, 17
 s_add_u32 s80, s80, s70
 ds_read_b128 v[16:19], v12 offset:32768
 s_waitcnt lgkmcnt(6)
 v_mfma_f32_32x32x16_bf16 v[96:111], a[208:211], v[24:27], v[96:111]
 s_lshl_b32 s70, s98, 9
 s_add_u32 s80, s80, s70
 s_mul_i32 s101, s68, 65
 s_add_u32 s101, s101, s67
 ds_read_b128 v[20:23], v12 offset:33792
 s_waitcnt lgkmcnt(6)
 v_mfma_f32_32x32x16_bf16 v[96:111], a[216:219], v[28:31], v[96:111]
 s_lshl_b32 s101, s101, 8
 s_add_u32 s101, s101, 66560
 s_add_u32 s101, s101, s98
 ds_read_b128 v[24:27], v12 offset:34816
 s_waitcnt lgkmcnt(6)
 v_mfma_f32_32x32x16_bf16 v[96:111], a[224:227], v[32:35], v[96:111]
 s_cmp_lg_u32 s3, 0
 s_cbranch_scc1 w0_245
 s_min_u32 s70, s6, 63
 s_min_u32 s71, s7, 63
 s_lshl_b32 s70, s70, 8
 s_lshl_b32 s71, s71, 8
 v_add_u32 v15, s70, v56
 s_mov_b32 exec_lo, 0
 v_add_u32 v15, s71, v56
 s_mov_b32 exec_lo, s87
 s_mov_b32 exec_hi, s87
 buffer_load_dwordx2 v[62:63], v15, s[52:55], 0 offen sc1
 s_mov_b64 exec, -1
w0_245:
 ds_read_b128 v[28:31], v12 offset:35840
 s_waitcnt lgkmcnt(6)
 v_mfma_f32_32x32x16_bf16 v[96:111], a[232:235], v[36:39], v[96:111]
 ds_read_b128 v[32:35], v12 offset:36864
 s_waitcnt lgkmcnt(6)
 v_mfma_f32_32x32x16_bf16 v[96:111], a[240:243], v[40:43], v[96:111]
 ds_read_b128 v[36:39], v12 offset:37888
 s_waitcnt lgkmcnt(6)
 v_mfma_f32_32x32x16_bf16 v[96:111], a[248:251], v[44:47], v[96:111]
 ds_read_b128 v[40:43], v12 offset:38912
 s_waitcnt lgkmcnt(6)
 v_mfma_f32_32x32x16_bf16 v[96:111], a[4:7], v[16:19], v[96:111]
 ds_read_b128 v[44:47], v12 offset:39936
 s_waitcnt lgkmcnt(6)
 v_mfma_f32_32x32x16_bf16 v[96:111], a[12:15], v[20:23], v[96:111]
 ds_read_b128 v[16:19], v12 offset:40960
 s_waitcnt lgkmcnt(6)
 v_mfma_f32_32x32x16_bf16 v[96:111], a[20:23], v[24:27], v[96:111]
 ds_read_b128 v[20:23], v12 offset:41984
 s_waitcnt lgkmcnt(6)
 v_mfma_f32_32x32x16_bf16 v[96:111], a[28:31], v[28:31], v[96:111]
 ds_read_b128 v[24:27], v12 offset:43008
 s_waitcnt lgkmcnt(6)
 v_mfma_f32_32x32x16_bf16 v[96:111], a[36:39], v[32:35], v[96:111]
 ds_read_b128 v[28:31], v12 offset:44032
 s_waitcnt lgkmcnt(6)
 v_mfma_f32_32x32x16_bf16 v[96:111], a[44:47], v[36:39], v[96:111]
 ds_read_b128 v[32:35], v12 offset:45056
 s_waitcnt lgkmcnt(6)
 v_mfma_f32_32x32x16_bf16 v[96:111], a[52:55], v[40:43], v[96:111]
 ds_read_b128 v[36:39], v12 offset:46080
 s_waitcnt lgkmcnt(6)
 v_mfma_f32_32x32x16_bf16 v[96:111], a[60:63], v[44:47], v[96:111]
 ds_read_b128 v[40:43], v12 offset:47104
 s_waitcnt lgkmcnt(6)
 v_mfma_f32_32x32x16_bf16 v[96:111], a[68:71], v[16:19], v[96:111]
 ds_read_b128 v[44:47], v12 offset:48128
 s_waitcnt lgkmcnt(6)
 v_mfma_f32_32x32x16_bf16 v[96:111], a[76:79], v[20:23], v[96:111]
 ds_read_b128 v[16:19], v12 offset:49152
 s_waitcnt lgkmcnt(6)
 v_mfma_f32_32x32x16_bf16 v[96:111], a[84:87], v[24:27], v[96:111]
 ds_read_b128 v[20:23], v12 offset:50176
 s_waitcnt lgkmcnt(6)
 v_mfma_f32_32x32x16_bf16 v[96:111], a[92:95], v[28:31], v[96:111]
 ds_read_b128 v[24:27], v12 offset:51200
 s_waitcnt lgkmcnt(6)
 v_mfma_f32_32x32x16_bf16 v[96:111], a[100:103], v[32:35], v[96:111]
 ds_read_b128 v[28:31], v12 offset:52224
 s_waitcnt lgkmcnt(6)
 v_mfma_f32_32x32x16_bf16 v[96:111], a[108:111], v[36:39], v[96:111]
 ds_read_b128 v[32:35], v12 offset:53248
 s_waitcnt lgkmcnt(6)
 v_mfma_f32_32x32x16_bf16 v[96:111], a[116:119], v[40:43], v[96:111]
 ds_read_b128 v[36:39], v12 offset:54272
 s_waitcnt lgkmcnt(6)
 v_mfma_f32_32x32x16_bf16 v[96:111], a[124:127], v[44:47], v[96:111]
 ds_read_b128 v[40:43], v12 offset:55296
 s_waitcnt lgkmcnt(6)
 v_mfma_f32_32x32x16_bf16 v[96:111], a[132:135], v[16:19], v[96:111]
 ds_read_b128 v[44:47], v12 offset:56320
 s_waitcnt lgkmcnt(6)
 v_mfma_f32_32x32x16_bf16 v[96:111], a[140:143], v[20:23], v[96:111]
 ds_read_b128 v[16:19], v12 offset:57344
 s_waitcnt lgkmcnt(6)
 v_mfma_f32_32x32x16_bf16 v[96:111], a[148:151], v[24:27], v[96:111]
 ds_read_b128 v[20:23], v12 offset:58368
 s_waitcnt lgkmcnt(6)
 v_mfma_f32_32x32x16_bf16 v[96:111], a[156:159], v[28:31], v[96:111]
 ds_read_b128 v[24:27], v12 offset:59392
 s_waitcnt lgkmcnt(6)
 v_mfma_f32_32x32x16_bf16 v[96:111], a[164:167], v[32:35], v[96:111]
 s_waitcnt vmcnt(0)
 s_bitcmp1_b32 s90, 0
 s_cbranch_scc0 sg_246
 s_mov_b64 exec, 1
 buffer_store_dword v0, v10, s[52:55], s69 offen sc1
 s_mov_b64 exec, -1
sg_246:
 s_cmp_lg_u32 s3, 0
 s_cbranch_scc1 w0_247
 v_cmp_ge_u32 s[72:73], v62, v57
 v_cmp_ge_u32 s[74:75], v63, v58
 s_and_b64 s[72:73], s[72:73], s[74:75]
 s_mov_b32 s70, 2
 s_cmp_lt_u32 s7, 64
 s_cselect_b32 s71, s73, 0
 s_cmp_eq_u32 s71, -1
 s_cselect_b32 s70, 1, s70
 s_cmp_lt_u32 s6, 64
 s_cselect_b32 s71, s72, 0
 s_cmp_eq_u32 s71, -1
 s_cselect_b32 s70, 0, s70
 v_mov_b32 v5, s70
 v_mov_b32 v6, s95
 ds_write_b32 v6, v5
w0_247:
 ds_read_b128 v[28:31], v12 offset:60416
 s_waitcnt lgkmcnt(6)
 v_mfma_f32_32x32x16_bf16 v[96:111], a[172:175], v[36:39], v[96:111]
 ds_read_b128 v[32:35], v12 offset:61440
 s_waitcnt lgkmcnt(6)
 v_mfma_f32_32x32x16_bf16 v[96:111], a[180:183], v[40:43], v[96:111]
 ds_read_b128 v[36:39], v12 offset:62464
 s_waitcnt lgkmcnt(6)
 v_mfma_f32_32x32x16_bf16 v[96:111], a[188:191], v[44:47], v[96:111]
 ds_read_b128 v[40:43], v12 offset:63488
 s_waitcnt lgkmcnt(6)
 v_mfma_f32_32x32x16_bf16 v[96:111], a[196:199], v[16:19], v[96:111]
 v_mov_b32 v6, s95
 s_waitcnt lgkmcnt(4)
 s_barrier
 ds_read_b32 v61, v6
 s_xor_b32 s95, s95, 4
 ds_read_b128 v[44:47], v12 offset:64512
 s_waitcnt lgkmcnt(6)
 v_mfma_f32_32x32x16_bf16 v[96:111], a[204:207], v[20:23], v[96:111]
 s_cbranch_vccz wo_tail1
 ds_read_b128 v[16:19], v3 offset:0
 s_waitcnt lgkmcnt(6)
 v_mfma_f32_32x32x16_bf16 v[96:111], a[212:215], v[24:27], v[96:111]
 ds_read_b128 v[20:23], v3 offset:1024
 s_waitcnt lgkmcnt(6)
 v_mfma_f32_32x32x16_bf16 v[96:111], a[220:223], v[28:31], v[96:111]
 ds_read_b128 v[24:27], v3 offset:2048
 s_waitcnt lgkmcnt(6)
 v_mfma_f32_32x32x16_bf16 v[96:111], a[228:231], v[32:35], v[96:111]
 ds_read_b128 v[28:31], v3 offset:3072
 s_waitcnt lgkmcnt(6)
 v_mfma_f32_32x32x16_bf16 v[96:111], a[236:239], v[36:39], v[96:111]
 ds_read_b128 v[32:35], v3 offset:4096
 s_waitcnt lgkmcnt(6)
 v_mfma_f32_32x32x16_bf16 v[96:111], a[244:247], v[40:43], v[96:111]
 s_mov_b32 s90, 1
 s_mov_b32 s91, s80
 s_mov_b32 s69, s101
 ds_read_b128 v[36:39], v3 offset:5120
 s_waitcnt lgkmcnt(6)
 v_mfma_f32_32x32x16_bf16 v[96:111], a[252:255], v[44:47], v[96:111]
 v_readfirstlane_b32 s94, v61
 s_cmp_ge_u32 s6, 64
 s_cselect_b32 s70, 0, s68
 s_cmp_lg_u32 s70, 0
 s_cbranch_scc1 wo_run0
 s_mov_b32 s90, 2
 s_nop 7
 v_cvt_pk_bf16_f32 v128, v96, v97
 v_cvt_pk_bf16_f32 v129, v98, v99
 v_cvt_pk_bf16_f32 v130, v100, v101
 v_cvt_pk_bf16_f32 v131, v102, v103
 buffer_store_dwordx4 v[128:131], v4, s[52:55], s80 offen offset:0 sc1
 v_cvt_pk_bf16_f32 v132, v104, v105
 v_cvt_pk_bf16_f32 v133, v106, v107
 v_cvt_pk_bf16_f32 v134, v108, v109
 v_cvt_pk_bf16_f32 v135, v110, v111
 buffer_store_dwordx4 v[132:135], v4, s[52:55], s80 offen offset:1024 sc1
 s_branch wo_run0
wo_plain1:
 ds_read_b128 v[40:43], v12 offset:6144
 s_waitcnt lgkmcnt(6)
 v_mfma_f32_32x32x16_bf16 v[96:111], a[0:3], v[16:19], 0
 s_mov_b32 s68, s4
 s_mov_b32 s67, s5
 s_mul_i32 s80, s68, 8388608
 s_add_u32 s80, s80, 123453440
 ds_read_b128 v[44:47], v12 offset:7168
 s_waitcnt lgkmcnt(6)
 v_mfma_f32_32x32x16_bf16 v[96:111], a[8:11], v[20:23], v[96:111]
 s_lshl_b32 s70, s67, 17
 s_add_u32 s80, s80, s70
 s_lshl_b32 s70, s98, 9
 s_add_u32 s80, s80, s70
 ds_read_b128 v[16:19], v12 offset:8192
 s_waitcnt lgkmcnt(6)
 v_mfma_f32_32x32x16_bf16 v[96:111], a[16:19], v[24:27], v[96:111]
 s_mul_i32 s101, s68, 65
 s_add_u32 s101, s101, s67
 s_lshl_b32 s101, s101, 8
 s_add_u32 s101, s101, 66560
 s_barrier
 ds_read_b128 v[20:23], v12 offset:9216
 s_waitcnt lgkmcnt(6)
 v_mfma_f32_32x32x16_bf16 v[96:111], a[24:27], v[28:31], v[96:111]
 s_add_u32 s101, s101, s98
 ds_read_b128 v[24:27], v12 offset:10240
 s_waitcnt lgkmcnt(6)
 v_mfma_f32_32x32x16_bf16 v[96:111], a[32:35], v[32:35], v[96:111]
 ds_read_b128 v[28:31], v12 offset:11264
 s_waitcnt lgkmcnt(6)
 v_mfma_f32_32x32x16_bf16 v[96:111], a[40:43], v[36:39], v[96:111]
 ds_read_b128 v[32:35], v12 offset:12288
 s_waitcnt lgkmcnt(6)
 v_mfma_f32_32x32x16_bf16 v[96:111], a[48:51], v[40:43], v[96:111]
 ds_read_b128 v[36:39], v12 offset:13312
 s_waitcnt lgkmcnt(6)
 v_mfma_f32_32x32x16_bf16 v[96:111], a[56:59], v[44:47], v[96:111]
 ds_read_b128 v[40:43], v12 offset:14336
 s_waitcnt lgkmcnt(6)
 v_mfma_f32_32x32x16_bf16 v[96:111], a[64:67], v[16:19], v[96:111]
 ds_read_b128 v[44:47], v12 offset:15360
 s_waitcnt lgkmcnt(6)
 v_mfma_f32_32x32x16_bf16 v[96:111], a[72:75], v[20:23], v[96:111]
 ds_read_b128 v[16:19], v12 offset:16384
 s_waitcnt lgkmcnt(6)
 v_mfma_f32_32x32x16_bf16 v[96:111], a[80:83], v[24:27], v[96:111]
 ds_read_b128 v[20:23], v12 offset:17408
 s_waitcnt lgkmcnt(6)
 v_mfma_f32_32x32x16_bf16 v[96:111], a[88:91], v[28:31], v[96:111]
 ds_read_b128 v[24:27], v12 offset:18432
 s_waitcnt lgkmcnt(6)
 v_mfma_f32_32x32x16_bf16 v[96:111], a[96:99], v[32:35], v[96:111]
 ds_read_b128 v[28:31], v12 offset:19456
 s_waitcnt lgkmcnt(6)
 v_mfma_f32_32x32x16_bf16 v[96:111], a[104:107], v[36:39], v[96:111]
 ds_read_b128 v[32:35], v12 offset:20480
 s_waitcnt lgkmcnt(6)
 v_mfma_f32_32x32x16_bf16 v[96:111], a[112:115], v[40:43], v[96:111]
 ds_read_b128 v[36:39], v12 offset:21504
 s_waitcnt lgkmcnt(6)
 v_mfma_f32_32x32x16_bf16 v[96:111], a[120:123], v[44:47], v[96:111]
 ds_read_b128 v[40:43], v12 offset:22528
 s_waitcnt lgkmcnt(6)
 v_mfma_f32_32x32x16_bf16 v[96:111], a[128:131], v[16:19], v[96:111]
 ds_read_b128 v[44:47], v12 offset:23552
 s_waitcnt lgkmcnt(6)
 v_mfma_f32_32x32x16_bf16 v[96:111], a[136:139], v[20:23], v[96:111]
 ds_read_b128 v[16:19], v12 offset:24576
 s_waitcnt lgkmcnt(6)
 v_mfma_f32_32x32x16_bf16 v[96:111], a[144:147], v[24:27], v[96:111]
 ds_read_b128 v[20:23], v12 offset:25600
 s_waitcnt lgkmcnt(6)
 v_mfma_f32_32x32x16_bf16 v[96:111], a[152:155], v[28:31], v[96:111]
 ds_read_b128 v[24:27], v12 offset:26624
 s_waitcnt lgkmcnt(6)
 v_mfma_f32_32x32x16_bf16 v[96:111], a[160:163], v[32:35], v[96:111]
 ds_read_b128 v[28:31], v12 offset:27648
 s_waitcnt lgkmcnt(6)
 v_mfma_f32_32x32x16_bf16 v[96:111], a[168:171], v[36:39], v[96:111]
 ds_read_b128 v[32:35], v12 offset:28672
 s_waitcnt lgkmcnt(6)
 v_mfma_f32_32x32x16_bf16 v[96:111], a[176:179], v[40:43], v[96:111]
 ds_read_b128 v[36:39], v12 offset:29696
 s_waitcnt lgkmcnt(6)
 v_mfma_f32_32x32x16_bf16 v[96:111], a[184:187], v[44:47], v[96:111]
 ds_read_b128 v[40:43], v12 offset:30720
 s_waitcnt lgkmcnt(6)
 v_mfma_f32_32x32x16_bf16 v[96:111], a[192:195], v[16:19], v[96:111]
 ds_read_b128 v[44:47], v12 offset:31744
 s_waitcnt lgkmcnt(6)
 v_mfma_f32_32x32x16_bf16 v[96:111], a[200:203], v[20:23], v[96:111]
 ds_read_b128 v[16:19], v12 offset:32768
 s_waitcnt lgkmcnt(6)
 v_mfma_f32_32x32x16_bf16 v[96:111], a[208:211], v[24:27], v[96:111]
 ds_read_b128 v[20:23], v12 offset:33792
 s_waitcnt lgkmcnt(6)
 v_mfma_f32_32x32x16_bf16 v[96:111], a[216:219], v[28:31], v[96:111]
 ds_read_b128 v[24:27], v12 offset:34816
 s_waitcnt lgkmcnt(6)
 v_mfma_f32_32x32x16_bf16 v[96:111], a[224:227], v[32:35], v[96:111]
 ds_read_b128 v[28:31], v12 offset:35840
 s_waitcnt lgkmcnt(6)
 v_mfma_f32_32x32x16_bf16 v[96:111], a[232:235], v[36:39], v[96:111]
 ds_read_b128 v[32:35], v12 offset:36864
 s_waitcnt lgkmcnt(6)
 v_mfma_f32_32x32x16_bf16 v[96:111], a[240:243], v[40:43], v[96:111]
 ds_read_b128 v[36:39], v12 offset:37888
 s_waitcnt lgkmcnt(6)
 v_mfma_f32_32x32x16_bf16 v[96:111], a[248:251], v[44:47], v[96:111]
 ds_read_b128 v[40:43], v12 offset:38912
 s_waitcnt lgkmcnt(6)
 v_mfma_f32_32x32x16_bf16 v[96:111], a[4:7], v[16:19], v[96:111]
 ds_read_b128 v[44:47], v12 offset:39936
 s_waitcnt lgkmcnt(6)
 v_mfma_f32_32x32x16_bf16 v[96:111], a[12:15], v[20:23], v[96:111]
 ds_read_b128 v[16:19], v12 offset:40960
 s_waitcnt lgkmcnt(6)
 v_mfma_f32_32x32x16_bf16 v[96:111], a[20:23], v[24:27], v[96:111]
 ds_read_b128 v[20:23], v12 offset:41984
 s_waitcnt lgkmcnt(6)
 v_mfma_f32_32x32x16_bf16 v[96:111], a[28:31], v[28:31], v[96:111]
 ds_read_b128 v[24:27], v12 offset:43008
 s_waitcnt lgkmcnt(6)
 v_mfma_f32_32x32x16_bf16 v[96:111], a[36:39], v[32:35], v[96:111]
 s_cmp_lg_u32 s3, 0
 s_cbranch_scc1 w0_248
 s_min_u32 s70, s6, 63
 s_min_u32 s71, s7, 63
 s_lshl_b32 s70, s70, 8
 s_lshl_b32 s71, s71, 8
 v_add_u32 v15, s70, v56
 s_mov_b32 exec_lo, 0
 v_add_u32 v15, s71, v56
 s_mov_b32 exec_lo, s87
 s_mov_b32 exec_hi, s87
 buffer_load_dwordx2 v[62:63], v15, s[52:55], 0 offen sc1
 s_mov_b64 exec, -1
w0_248:
 ds_read_b128 v[28:31], v12 offset:44032
 s_waitcnt lgkmcnt(6)
 v_mfma_f32_32x32x16_bf16 v[96:111], a[44:47], v[36:39], v[96:111]
 ds_read_b128 v[32:35], v12 offset:45056
 s_waitcnt lgkmcnt(6)
 v_mfma_f32_32x32x16_bf16 v[96:111], a[52:55], v[40:43], v[96:111]
 ds_read_b128 v[36:39], v12 offset:46080
 s_waitcnt lgkmcnt(6)
 v_mfma_f32_32x32x16_bf16 v[96:111], a[60:63], v[44:47], v[96:111]
 ds_read_b128 v[40:43], v12 offset:47104
 s_waitcnt lgkmcnt(6)
 v_mfma_f32_32x32x16_bf16 v[96:111], a[68:71], v[16:19], v[96:111]
 ds_read_b128 v[44:47], v12 offset:48128
 s_waitcnt lgkmcnt(6)
 v_mfma_f32_32x32x16_bf16 v[96:111], a[76:79], v[20:23], v[96:111]
 ds_read_b128 v[16:19], v12 offset:49152
 s_waitcnt lgkmcnt(6)
 v_mfma_f32_32x32x16_bf16 v[96:111], a[84:87], v[24:27], v[96:111]
 ds_read_b128 v[20:23], v12 offset:50176
 s_waitcnt lgkmcnt(6)
 v_mfma_f32_32x32x16_bf16 v[96:111], a[92:95], v[28:31], v[96:111]
 ds_read_b128 v[24:27], v12 offset:51200
 s_waitcnt lgkmcnt(6)
 v_mfma_f32_32x32x16_bf16 v[96:111], a[100:103], v[32:35], v[96:111]
 ds_read_b128 v[28:31], v12 offset:52224
 s_waitcnt lgkmcnt(6)
 v_mfma_f32_32x32x16_bf16 v[96:111], a[108:111], v[36:39], v[96:111]
 ds_read_b128 v[32:35], v12 offset:53248
 s_waitcnt lgkmcnt(6)
 v_mfma_f32_32x32x16_bf16 v[96:111], a[116:119], v[40:43], v[96:111]
 ds_read_b128 v[36:39], v12 offset:54272
 s_waitcnt lgkmcnt(6)
 v_mfma_f32_32x32x16_bf16 v[96:111], a[124:127], v[44:47], v[96:111]
 ds_read_b128 v[40:43], v12 offset:55296
 s_waitcnt lgkmcnt(6)
 v_mfma_f32_32x32x16_bf16 v[96:111], a[132:135], v[16:19], v[96:111]
 ds_read_b128 v[44:47], v12 offset:56320
 s_waitcnt lgkmcnt(6)
 v_mfma_f32_32x32x16_bf16 v[96:111], a[140:143], v[20:23], v[96:111]
 ds_read_b128 v[16:19], v12 offset:57344
 s_waitcnt lgkmcnt(6)
 v_mfma_f32_32x32x16_bf16 v[96:111], a[148:151], v[24:27], v[96:111]
 ds_read_b128 v[20:23], v12 offset:58368
 s_waitcnt lgkmcnt(6)
 v_mfma_f32_32x32x16_bf16 v[96:111], a[156:159], v[28:31], v[96:111]
 ds_read_b128 v[24:27], v12 offset:59392
 s_waitcnt lgkmcnt(6)
 v_mfma_f32_32x32x16_bf16 v[96:111], a[164:167], v[32:35], v[96:111]
 s_cmp_lg_u32 s3, 0
 s_cbranch_scc1 w0_249
 s_waitcnt vmcnt(0)
 v_cmp_ge_u32 s[72:73], v62, v57
 v_cmp_ge_u32 s[74:75], v63, v58
 s_and_b64 s[72:73], s[72:73], s[74:75]
 s_mov_b32 s70, 2
 s_cmp_lt_u32 s7, 64
 s_cselect_b32 s71, s73, 0
 s_cmp_eq_u32 s71, -1
 s_cselect_b32 s70, 1, s70
 s_cmp_lt_u32 s6, 64
 s_cselect_b32 s71, s72, 0
 s_cmp_eq_u32 s71, -1
 s_cselect_b32 s70, 0, s70
 v_mov_b32 v5, s70
 v_mov_b32 v6, s95
 ds_write_b32 v6, v5
w0_249:
 ds_read_b128 v[28:31], v12 offset:60416
 s_waitcnt lgkmcnt(6)
 v_mfma_f32_32x32x16_bf16 v[96:111], a[172:175], v[36:39], v[96:111]
 ds_read_b128 v[32:35], v12 offset:61440
 s_waitcnt lgkmcnt(6)
 v_mfma_f32_32x32x16_bf16 v[96:111], a[180:183], v[40:43], v[96:111]
 ds_read_b128 v[36:39], v12 offset:62464
 s_waitcnt lgkmcnt(6)
 v_mfma_f32_32x32x16_bf16 v[96:111], a[188:191], v[44:47], v[96:111]
 ds_read_b128 v[40:43], v12 offset:63488
 s_waitcnt lgkmcnt(6)
 v_mfma_f32_32x32x16_bf16 v[96:111], a[196:199], v[16:19], v[96:111]
 v_mov_b32 v6, s95
 s_waitcnt lgkmcnt(4)
 s_barrier
 ds_read_b32 v61, v6
 s_xor_b32 s95, s95, 4
 ds_read_b128 v[44:47], v12 offset:64512
 s_waitcnt lgkmcnt(6)
 v_mfma_f32_32x32x16_bf16 v[96:111], a[204:207], v[20:23], v[96:111]
wo_tail1:
 s_waitcnt lgkmcnt(5)
 v_mfma_f32_32x32x16_bf16 v[96:111], a[212:215], v[24:27], v[96:111]
 s_waitcnt lgkmcnt(4)
 v_mfma_f32_32x32x16_bf16 v[96:111], a[220:223], v[28:31], v[96:111]
 s_waitcnt lgkmcnt(3)
 v_mfma_f32_32x32x16_bf16 v[96:111], a[228:231], v[32:35], v[96:111]
 s_waitcnt lgkmcnt(2)
 v_mfma_f32_32x32x16_bf16 v[96:111], a[236:239], v[36:39], v[96:111]
 s_waitcnt lgkmcnt(1)
 v_mfma_f32_32x32x16_bf16 v[96:111], a[244:247], v[40:43], v[96:111]
 s_waitcnt lgkmcnt(0)
 v_mfma_f32_32x32x16_bf16 v[96:111], a[252:255], v[44:47], v[96:111]
 v_readfirstlane_b32 s94, v61
 s_mov_b32 s88, s6
 s_mov_b32 s89, s7
 s_add_u32 s88, s88, 2
 s_add_u32 s70, s89, 1
 s_cmp_lt_u32 s70, 39
 s_cselect_b32 s70, s70, s66
 s_add_u32 s71, s89, 3
 s_cmp_lt_u32 s89, 39
 s_cselect_b32 s89, s70, s71
 s_and_b32 s4, s94, 1
 s_cmp_eq_u32 s94, 0
 s_cselect_b32 s5, s6, s7
 s_cselect_b32 s6, s88, s6
 s_cmp_eq_u32 s94, 1
 s_cselect_b32 s7, s89, s7
 s_mov_b32 s78, 0
 s_mul_i32 s81, s4, 16777216
 s_add_u32 s81, s81, 89899008
 s_lshl_b32 s70, s5, 18
 s_add_u32 s81, s81, s70
 s_lshl_b32 s70, s82, 16
 s_add_u32 s81, s81, s70
 s_mul_i32 s97, s3, 16384
 s_min_u32 s97, s97, 49152
 s_add_u32 s96, s97, s78
 s_add_u32 s97, s97, s81
 s_sub_u32 s97, s97, 4096
 v_cvt_pk_bf16_f32 v128, v96, v97
 v_cvt_pk_bf16_f32 v129, v98, v99
 v_cvt_pk_bf16_f32 v130, v100, v101
 v_cvt_pk_bf16_f32 v131, v102, v103
 buffer_store_dwordx4 v[128:131], v4, s[52:55], s80 offen offset:0 sc1
 v_cvt_pk_bf16_f32 v132, v104, v105
 v_cvt_pk_bf16_f32 v133, v106, v107
 v_cvt_pk_bf16_f32 v134, v108, v109
 v_cvt_pk_bf16_f32 v135, v110, v111
 buffer_store_dwordx4 v[132:135], v4, s[52:55], s80 offen offset:1024 sc1
 s_cmp_ge_u32 s94, 2
 s_cbranch_scc1 wo_idle1
 s_add_u32 m0, s96, 0
 s_add_u32 s97, s97, 4096
 buffer_load_dwordx4 v2, s[52:55], s97 offen offset:0 sc1 lds
 buffer_load_dwordx4 v2, s[52:55], s97 offen offset:1024 sc1 lds
 buffer_load_dwordx4 v2, s[52:55], s97 offen offset:2048 sc1 lds
 buffer_load_dwordx4 v2, s[52:55], s97 offen offset:3072 sc1 lds
 s_add_u32 m0, s96, 4096
 s_add_u32 s97, s97, 4096
 buffer_load_dwordx4 v2, s[52:55], s97 offen offset:0 sc1 lds
 buffer_load_dwordx4 v2, s[52:55], s97 offen offset:1024 sc1 lds
 buffer_load_dwordx4 v2, s[52:55], s97 offen offset:2048 sc1 lds
 buffer_load_dwordx4 v2, s[52:55], s97 offen offset:3072 sc1 lds
 s_add_u32 m0, s96, 8192
 s_add_u32 s97, s97, 4096
 buffer_load_dwordx4 v2, s[52:55], s97 offen offset:0 sc1 lds
 buffer_load_dwordx4 v2, s[52:55], s97 offen offset:1024 sc1 lds
 buffer_load_dwordx4 v2, s[52:55], s97 offen offset:2048 sc1 lds
 buffer_load_dwordx4 v2, s[52:55], s97 offen offset:3072 sc1 lds
 s_add_u32 m0, s96, 12288
 s_add_u32 s97, s97, 4096
 buffer_load_dwordx4 v2, s[52:55], s97 offen offset:0 sc1 lds
 buffer_load_dwordx4 v2, s[52:55], s97 offen offset:1024 sc1 lds
 buffer_load_dwordx4 v2, s[52:55], s97 offen offset:2048 sc1 lds
 buffer_load_dwordx4 v2, s[52:55], s97 offen offset:3072 sc1 lds
 s_waitcnt vmcnt(16)
 s_mov_b64 exec, 1
 buffer_store_dword v0, v10, s[52:55], s101 offen sc1
 s_mov_b64 exec, -1
 s_branch sc_254
wo_idle1:
 s_mov_b32 s83, 0x200000
 s_cmp_lg_u32 s3, 0
 s_cbranch_scc1 nw_256
 s_min_u32 s70, s6, 63
 s_min_u32 s71, s7, 63
 s_lshl_b32 s70, s70, 8
 s_lshl_b32 s71, s71, 8
 v_add_u32 v15, s70, v56
 s_mov_b32 exec_lo, 0
 v_add_u32 v15, s71, v56
 s_mov_b32 exec_lo, s87
 s_mov_b32 exec_hi, s87
 buffer_load_dwordx2 v[62:63], v15, s[52:55], 0 offen sc1
 s_mov_b64 exec, -1
 s_waitcnt vmcnt(1)
 s_mov_b64 exec, 1
 buffer_store_dword v0, v10, s[52:55], s101 offen sc1
 s_mov_b64 exec, -1
 s_min_u32 s70, s6, s7
 s_cmp_ge_u32 s70, 64
 s_cbranch_scc1 k_exit
 s_waitcnt vmcnt(1)
 s_branch ev_255
nw_256:
 s_waitcnt vmcnt(0)
 s_mov_b64 exec, 1
 buffer_store_dword v0, v10, s[52:55], s101 offen sc1
 s_mov_b64 exec, -1
wo_sched0:
 s_min_u32 s70, s6, s7
 s_cmp_ge_u32 s70, 64
 s_cbranch_scc1 k_exit
 s_cmp_lg_u32 s3, 0
 s_cbranch_scc1 sc_250
 s_mov_b32 s83, 0x200000
sc_251:
 s_min_u32 s70, s6, 63
 s_min_u32 s71, s7, 63
 s_lshl_b32 s70, s70, 8
 s_lshl_b32 s71, s71, 8
 v_add_u32 v15, s70, v56
 s_mov_b32 exec_lo, 0
 v_add_u32 v15, s71, v56
 s_mov_b32 exec_lo, s87
 s_mov_b32 exec_hi, s87
 buffer_load_dwordx2 v[62:63], v15, s[52:55], 0 offen sc1
 s_mov_b64 exec, -1
 s_waitcnt vmcnt(0)
ev_255:
 v_cmp_ge_u32 s[72:73], v62, v57
 v_cmp_ge_u32 s[74:75], v63, v58
 s_and_b64 s[72:73], s[72:73], s[74:75]
 s_mov_b32 s70, 2
 s_cmp_lt_u32 s7, 64
 s_cselect_b32 s71, s73, 0
 s_cmp_eq_u32 s71, -1
 s_cselect_b32 s70, 1, s70
 s_cmp_lt_u32 s6, 64
 s_cselect_b32 s71, s72, 0
 s_cmp_eq_u32 s71, -1
 s_cselect_b32 s70, 0, s70
 s_cmp_lt_u32 s70, 2
 s_cbranch_scc1 sc_252
 s_sub_u32 s83, s83, 1
 s_cmp_lg_u32 s83, 0
 s_cbranch_scc1 sc_251
 s_mov_b32 s70, 3
sc_252:
 v_mov_b32 v5, s70
 v_mov_b32 v6, 163832
 ds_write_b32 v6, v5
 s_waitcnt lgkmcnt(0)
sc_250:
 s_barrier
 v_mov_b32 v6, 163832
 ds_read_b32 v61, v6
 s_waitcnt lgkmcnt(0)
 v_readfirstlane_b32 s94, v61
 s_cmp_ge_u32 s94, 2
 s_cbranch_scc1 k_exit
 s_mov_b32 s88, s6
 s_mov_b32 s89, s7
 s_add_u32 s88, s88, 2
 s_add_u32 s70, s89, 1
 s_cmp_lt_u32 s70, 39
 s_cselect_b32 s70, s70, s66
 s_add_u32 s71, s89, 3
 s_cmp_lt_u32 s89, 39
 s_cselect_b32 s89, s70, s71
 s_and_b32 s4, s94, 1
 s_cmp_eq_u32 s94, 0
 s_cselect_b32 s5, s6, s7
 s_cselect_b32 s6, s88, s6
 s_cmp_eq_u32 s94, 1
 s_cselect_b32 s7, s89, s7
 s_mov_b32 s78, 0
 s_mul_i32 s81, s4, 16777216
 s_add_u32 s81, s81, 89899008
 s_lshl_b32 s70, s5, 18
 s_add_u32 s81, s81, s70
 s_lshl_b32 s70, s82, 16
 s_add_u32 s81, s81, s70
 s_mul_i32 s97, s3, 16384
 s_min_u32 s97, s97, 49152
 s_add_u32 s96, s97, s78
 s_add_u32 s97, s97, s81
 s_sub_u32 s97, s97, 4096
 s_add_u32 m0, s96, 0
 s_add_u32 s97, s97, 4096
 buffer_load_dwordx4 v2, s[52:55], s97 offen offset:0 sc1 lds
 buffer_load_dwordx4 v2, s[52:55], s97 offen offset:1024 sc1 lds
 buffer_load_dwordx4 v2, s[52:55], s97 offen offset:2048 sc1 lds
 buffer_load_dwordx4 v2, s[52:55], s97 offen offset:3072 sc1 lds
 s_add_u32 m0, s96, 4096
 s_add_u32 s97, s97, 4096
 buffer_load_dwordx4 v2, s[52:55], s97 offen offset:0 sc1 lds
 buffer_load_dwordx4 v2, s[52:55], s97 offen offset:1024 sc1 lds
 buffer_load_dwordx4 v2, s[52:55], s97 offen offset:2048 sc1 lds
 buffer_load_dwordx4 v2, s[52:55], s97 offen offset:3072 sc1 lds
 s_add_u32 m0, s96, 8192
 s_add_u32 s97, s97, 4096
 buffer_load_dwordx4 v2, s[52:55], s97 offen offset:0 sc1 lds
 buffer_load_dwordx4 v2, s[52:55], s97 offen offset:1024 sc1 lds
 buffer_load_dwordx4 v2, s[52:55], s97 offen offset:2048 sc1 lds
 buffer_load_dwordx4 v2, s[52:55], s97 offen offset:3072 sc1 lds
 s_add_u32 m0, s96, 12288
 s_add_u32 s97, s97, 4096
 buffer_load_dwordx4 v2, s[52:55], s97 offen offset:0 sc1 lds
 buffer_load_dwordx4 v2, s[52:55], s97 offen offset:1024 sc1 lds
 buffer_load_dwordx4 v2, s[52:55], s97 offen offset:2048 sc1 lds
 buffer_load_dwordx4 v2, s[52:55], s97 offen offset:3072 sc1 lds
sc_254:
 s_cmp_lg_u32 s3, 0
 s_cbranch_scc1 sc_253
 s_min_u32 s70, s6, 63
 s_min_u32 s71, s7, 63
 s_lshl_b32 s70, s70, 8
 s_lshl_b32 s71, s71, 8
 v_add_u32 v15, s70, v56
 s_mov_b32 exec_lo, 0
 v_add_u32 v15, s71, v56
 s_mov_b32 exec_lo, s87
 s_mov_b32 exec_hi, s87
 buffer_load_dwordx2 v[62:63], v15, s[52:55], 0 offen sc1
 s_mov_b64 exec, -1
 s_waitcnt vmcnt(0)
 v_cmp_ge_u32 s[72:73], v62, v57
 v_cmp_ge_u32 s[74:75], v63, v58
 s_and_b64 s[72:73], s[72:73], s[74:75]
 s_mov_b32 s70, 2
 s_cmp_lt_u32 s7, 64
 s_cselect_b32 s71, s73, 0
 s_cmp_eq_u32 s71, -1
 s_cselect_b32 s70, 1, s70
 s_cmp_lt_u32 s6, 64
 s_cselect_b32 s71, s72, 0
 s_cmp_eq_u32 s71, -1
 s_cselect_b32 s70, 0, s70
 v_mov_b32 v5, s70
 v_mov_b32 v6, s95
 ds_write_b32 v6, v5
 s_waitcnt lgkmcnt(0)
sc_253:
 s_waitcnt vmcnt(0)
 v_mov_b32 v6, s95
 s_barrier
 ds_read_b32 v61, v6
 s_xor_b32 s95, s95, 4
 s_waitcnt lgkmcnt(0)
 v_readfirstlane_b32 s94, v61
 s_branch wo_pro0
role_up:
 s_mov_b32 s56, s32
 s_mov_b32 s57, s33
 s_mov_b32 s58, 1409024
 s_mov_b32 s59, 0x00020000
 s_mov_b32 s60, s36
 s_mov_b32 s61, s37
 s_mov_b32 s62, 1409024
 s_mov_b32 s63, 0x00020000
 s_lshl_b32 s82, s64, 2
 s_add_u32 s82, s82, s3
 s_lshl_b32 s76, s82, 6
 s_mov_b32 s77, s76
 v_lshrrev_b32 v5, 2, v1
 s_mov_b32 s70, 2752
 v_mul_lo_u32 v5, v5, s70
 v_and_b32 v6, 3, v1
 v_lshl_add_u32 v10, v6, 4, v5
 v_lshrrev_b32 v5, 5, v1
 v_lshlrev_b32 v5, 9, v5
 v_bfe_u32 v7, v1, 2, 2
 v_lshl_add_u32 v5, v7, 6, v5
 v_bfe_u32 v7, v1, 4, 1
 v_lshl_add_u32 v5, v7, 5, v5
 v_lshl_add_u32 v5, v6, 3, v5
 s_lshl_b32 s71, s3, 15
 v_add_u32 v9, s71, v5
 s_add_u32 m0, s71, 0
 s_nop 0
 buffer_load_dwordx4 v10, s[56:59], s76 offen lds
 s_add_u32 s76, s76, 44032
 s_add_u32 m0, s71, 8192
 s_nop 0
 buffer_load_dwordx4 v10, s[60:63], s77 offen lds
 s_add_u32 s77, s77, 44032
 s_add_u32 m0, s71, 1024
 s_nop 0
 buffer_load_dwordx4 v10, s[56:59], s76 offen lds
 s_add_u32 s76, s76, 44032
 s_add_u32 m0, s71, 9216
 s_nop 0
 buffer_load_dwordx4 v10, s[60:63], s77 offen lds
 s_add_u32 s77, s77, 44032
 s_add_u32 m0, s71, 2048
 s_nop 0
 buffer_load_dwordx4 v10, s[56:59], s76 offen lds
 s_add_u32 s76, s76, 44032
 s_add_u32 m0, s71, 10240
 s_nop 0
 buffer_load_dwordx4 v10, s[60:63], s77 offen lds
 s_add_u32 s77, s77, 44032
 s_add_u32 m0, s71, 3072
 s_nop 0
 buffer_load_dwordx4 v10, s[56:59], s76 offen lds
 s_add_u32 s76, s76, 44032
 s_add_u32 m0, s71, 11264
 s_nop 0
 buffer_load_dwordx4 v10, s[60:63], s77 offen lds
 s_add_u32 s77, s77, 44032
 s_add_u32 m0, s71, 4096
 s_nop 0
 buffer_load_dwordx4 v10, s[56:59], s76 offen lds
 s_add_u32 s76, s76, 44032
 s_add_u32 m0, s71, 12288
 s_nop 0
 buffer_load_dwordx4 v10, s[60:63], s77 offen lds
 s_add_u32 s77, s77, 44032
 s_add_u32 m0, s71, 5120
 s_nop 0
 buffer_load_dwordx4 v10, s[56:59], s76 offen lds
 s_add_u32 s76, s76, 44032
 s_add_u32 m0, s71, 13312
 s_nop 0
 buffer_load_dwordx4 v10, s[60:63], s77 offen lds
 s_add_u32 s77, s77, 44032
 s_add_u32 m0, s71, 6144
 s_nop 0
 buffer_load_dwordx4 v10, s[56:59], s76 offen lds
 s_add_u32 s76, s76, 44032
 s_add_u32 m0, s71, 14336
 s_nop 0
 buffer_load_dwordx4 v10, s[60:63], s77 offen lds
 s_add_u32 s77, s77, 44032
 s_add_u32 m0, s71, 7168
 s_nop 0
 buffer_load_dwordx4 v10, s[56:59], s76 offen lds
 s_add_u32 s76, s76, 44032
 s_add_u32 m0, s71, 15360
 s_nop 0
 buffer_load_dwordx4 v10, s[60:63], s77 offen lds
 s_add_u32 s77, s77, 44032
 s_add_u32 m0, s71, 16384
 s_nop 0
 buffer_load_dwordx4 v10, s[56:59], s76 offen lds
 s_add_u32 s76, s76, 44032
 s_add_u32 m0, s71, 24576
 s_nop 0
 buffer_load_dwordx4 v10, s[60:63], s77 offen lds
 s_add_u32 s77, s77, 44032
 s_add_u32 m0, s71, 17408
 s_nop 0
 buffer_load_dwordx4 v10, s[56:59], s76 offen lds
 s_add_u32 s76, s76, 44032
 s_add_u32 m0, s71, 25600
 s_nop 0
 buffer_load_dwordx4 v10, s[60:63], s77 offen lds
 s_add_u32 s77, s77, 44032
 s_add_u32 m0, s71, 18432
 s_nop 0
 buffer_load_dwordx4 v10, s[56:59], s76 offen lds
 s_add_u32 s76, s76, 44032
 s_add_u32 m0, s71, 26624
 s_nop 0
 buffer_load_dwordx4 v10, s[60:63], s77 offen lds
 s_add_u32 s77, s77, 44032
 s_add_u32 m0, s71, 19456
 s_nop 0
 buffer_load_dwordx4 v10, s[56:59], s76 offen lds
 s_add_u32 s76, s76, 44032
 s_add_u32 m0, s71, 27648
 s_nop 0
 buffer_load_dwordx4 v10, s[60:63], s77 offen lds
 s_add_u32 s77, s77, 44032
 s_add_u32 m0, s71, 20480
 s_nop 0
 buffer_load_dwordx4 v10, s[56:59], s76 offen lds
 s_add_u32 s76, s76, 44032
 s_add_u32 m0, s71, 28672
 s_nop 0
 buffer_load_dwordx4 v10, s[60:63], s77 offen lds
 s_add_u32 s77, s77, 44032
 s_add_u32 m0, s71, 21504
 s_nop 0
 buffer_load_dwordx4 v10, s[56:59], s76 offen lds
 s_add_u32 s76, s76, 44032
 s_add_u32 m0, s71, 29696
 s_nop 0
 buffer_load_dwordx4 v10, s[60:63], s77 offen lds
 s_add_u32 s77, s77, 44032
 s_add_u32 m0, s71, 22528
 s_nop 0
 buffer_load_dwordx4 v10, s[56:59], s76 offen lds
 s_add_u32 s76, s76, 44032
 s_add_u32 m0, s71, 30720
 s_nop 0
 buffer_load_dwordx4 v10, s[60:63], s77 offen lds
 s_add_u32 s77, s77, 44032
 s_add_u32 m0, s71, 23552
 s_nop 0
 buffer_load_dwordx4 v10, s[56:59], s76 offen lds
 s_add_u32 s76, s76, 44032
 s_add_u32 m0, s71, 31744
 s_nop 0
 buffer_load_dwordx4 v10, s[60:63], s77 offen lds
 s_add_u32 s77, s77, 44032
 s_waitcnt vmcnt(16)
 ds_read_b64_tr_b16 a[0:1], v9 offset:0
 ds_read_b64_tr_b16 a[2:3], v9 offset:256
 ds_read_b64_tr_b16 a[4:5], v9 offset:8192
 ds_read_b64_tr_b16 a[6:7], v9 offset:8448
 ds_read_b64_tr_b16 a[8:9], v9 offset:1024
 ds_read_b64_tr_b16 a[10:11], v9 offset:1280
 ds_read_b64_tr_b16 a[12:13], v9 offset:9216
 ds_read_b64_tr_b16 a[14:15], v9 offset:9472
 ds_read_b64_tr_b16 a[16:17], v9 offset:2048
 ds_read_b64_tr_b16 a[18:19], v9 offset:2304
 ds_read_b64_tr_b16 a[20:21], v9 offset:10240
 ds_read_b64_tr_b16 a[22:23], v9 offset:10496
 ds_read_b64_tr_b16 a[24:25], v9 offset:3072
 ds_read_b64_tr_b16 a[26:27], v9 offset:3328
 ds_read_b64_tr_b16 a[28:29], v9 offset:11264
 ds_read_b64_tr_b16 a[30:31], v9 offset:11520
 ds_read_b64_tr_b16 a[32:33], v9 offset:4096
 ds_read_b64_tr_b16 a[34:35], v9 offset:4352
 ds_read_b64_tr_b16 a[36:37], v9 offset:12288
 ds_read_b64_tr_b16 a[38:39], v9 offset:12544
 ds_read_b64_tr_b16 a[40:41], v9 offset:5120
 ds_read_b64_tr_b16 a[42:43], v9 offset:5376
 ds_read_b64_tr_b16 a[44:45], v9 offset:13312
 ds_read_b64_tr_b16 a[46:47], v9 offset:13568
 ds_read_b64_tr_b16 a[48:49], v9 offset:6144
 ds_read_b64_tr_b16 a[50:51], v9 offset:6400
 ds_read_b64_tr_b16 a[52:53], v9 offset:14336
 ds_read_b64_tr_b16 a[54:55], v9 offset:14592
 ds_read_b64_tr_b16 a[56:57], v9 offset:7168
 ds_read_b64_tr_b16 a[58:59], v9 offset:7424
 ds_read_b64_tr_b16 a[60:61], v9 offset:15360
 ds_read_b64_tr_b16 a[62:63], v9 offset:15616
 s_waitcnt lgkmcnt(0)
 s_add_u32 m0, s71, 0
 s_nop 0
 buffer_load_dwordx4 v10, s[56:59], s76 offen lds
 s_add_u32 s76, s76, 44032
 s_add_u32 m0, s71, 8192
 s_nop 0
 buffer_load_dwordx4 v10, s[60:63], s77 offen lds
 s_add_u32 s77, s77, 44032
 s_add_u32 m0, s71, 1024
 s_nop 0
 buffer_load_dwordx4 v10, s[56:59], s76 offen lds
 s_add_u32 s76, s76, 44032
 s_add_u32 m0, s71, 9216
 s_nop 0
 buffer_load_dwordx4 v10, s[60:63], s77 offen lds
 s_add_u32 s77, s77, 44032
 s_add_u32 m0, s71, 2048
 s_nop 0
 buffer_load_dwordx4 v10, s[56:59], s76 offen lds
 s_add_u32 s76, s76, 44032
 s_add_u32 m0, s71, 10240
 s_nop 0
 buffer_load_dwordx4 v10, s[60:63], s77 offen lds
 s_add_u32 s77, s77, 44032
 s_add_u32 m0, s71, 3072
 s_nop 0
 buffer_load_dwordx4 v10, s[56:59], s76 offen lds
 s_add_u32 s76, s76, 44032
 s_add_u32 m0, s71, 11264
 s_nop 0
 buffer_load_dwordx4 v10, s[60:63], s77 offen lds
 s_add_u32 s77, s77, 44032
 s_add_u32 m0, s71, 4096
 s_nop 0
 buffer_load_dwordx4 v10, s[56:59], s76 offen lds
 s_add_u32 s76, s76, 44032
 s_add_u32 m0, s71, 12288
 s_nop 0
 buffer_load_dwordx4 v10, s[60:63], s77 offen lds
 s_add_u32 s77, s77, 44032
 s_add_u32 m0, s71, 5120
 s_nop 0
 buffer_load_dwordx4 v10, s[56:59], s76 offen lds
 s_add_u32 s76, s76, 44032
 s_add_u32 m0, s71, 13312
 s_nop 0
 buffer_load_dwordx4 v10, s[60:63], s77 offen lds
 s_add_u32 s77, s77, 44032
 s_add_u32 m0, s71, 6144
 s_nop 0
 buffer_load_dwordx4 v10, s[56:59], s76 offen lds
 s_add_u32 s76, s76, 44032
 s_add_u32 m0, s71, 14336
 s_nop 0
 buffer_load_dwordx4 v10, s[60:63], s77 offen lds
 s_add_u32 s77, s77, 44032
 s_add_u32 m0, s71, 7168
 s_nop 0
 buffer_load_dwordx4 v10, s[56:59], s76 offen lds
 s_add_u32 s76, s76, 44032
 s_add_u32 m0, s71, 15360
 s_nop 0
 buffer_load_dwordx4 v10, s[60:63], s77 offen lds
 s_add_u32 s77, s77, 44032
 s_waitcnt vmcnt(16)
 ds_read_b64_tr_b16 a[64:65], v9 offset:16384
 ds_read_b64_tr_b16 a[66:67], v9 offset:16640
 ds_read_b64_tr_b16 a[68:69], v9 offset:24576
 ds_read_b64_tr_b16 a[70:71], v9 offset:24832
 ds_read_b64_tr_b16 a[72:73], v9 offset:17408
 ds_read_b64_tr_b16 a[74:75], v9 offset:17664
 ds_read_b64_tr_b16 a[76:77], v9 offset:25600
 ds_read_b64_tr_b16 a[78:79], v9 offset:25856
 ds_read_b64_tr_b16 a[80:81], v9 offset:18432
 ds_read_b64_tr_b16 a[82:83], v9 offset:18688
 ds_read_b64_tr_b16 a[84:85], v9 offset:26624
 ds_read_b64_tr_b16 a[86:87], v9 offset:26880
 ds_read_b64_tr_b16 a[88:89], v9 offset:19456
 ds_read_b64_tr_b16 a[90:91], v9 offset:19712
 ds_read_b64_tr_b16 a[92:93], v9 offset:27648
 ds_read_b64_tr_b16 a[94:95], v9 offset:27904
 ds_read_b64_tr_b16 a[96:97], v9 offset:20480
 ds_read_b64_tr_b16 a[98:99], v9 offset:20736
 ds_read_b64_tr_b16 a[100:101], v9 offset:28672
 ds_read_b64_tr_b16 a[102:103], v9 offset:28928
 ds_read_b64_tr_b16 a[104:105], v9 offset:21504
 ds_read_b64_tr_b16 a[106:107], v9 offset:21760
 ds_read_b64_tr_b16 a[108:109], v9 offset:29696
 ds_read_b64_tr_b16 a[110:111], v9 offset:29952
 ds_read_b64_tr_b16 a[112:113], v9 offset:22528
 ds_read_b64_tr_b16 a[114:115], v9 offset:22784
 ds_read_b64_tr_b16 a[116:117], v9 offset:30720
 ds_read_b64_tr_b16 a[118:119], v9 offset:30976
 ds_read_b64_tr_b16 a[120:121], v9 offset:23552
 ds_read_b64_tr_b16 a[122:123], v9 offset:23808
 ds_read_b64_tr_b16 a[124:125], v9 offset:31744
 ds_read_b64_tr_b16 a[126:127], v9 offset:32000
 s_waitcnt lgkmcnt(0)
 s_add_u32 m0, s71, 16384
 s_nop 0
 buffer_load_dwordx4 v10, s[56:59], s76 offen lds
 s_add_u32 s76, s76, 44032
 s_add_u32 m0, s71, 24576
 s_nop 0
 buffer_load_dwordx4 v10, s[60:63], s77 offen lds
 s_add_u32 s77, s77, 44032
 s_add_u32 m0, s71, 17408
 s_nop 0
 buffer_load_dwordx4 v10, s[56:59], s76 offen lds
 s_add_u32 s76, s76, 44032
 s_add_u32 m0, s71, 25600
 s_nop 0
 buffer_load_dwordx4 v10, s[60:63], s77 offen lds
 s_add_u32 s77, s77, 44032
 s_add_u32 m0, s71, 18432
 s_nop 0
 buffer_load_dwordx4 v10, s[56:59], s76 offen lds
 s_add_u32 s76, s76, 44032
 s_add_u32 m0, s71, 26624
 s_nop 0
 buffer_load_dwordx4 v10, s[60:63], s77 offen lds
 s_add_u32 s77, s77, 44032
 s_add_u32 m0, s71, 19456
 s_nop 0
 buffer_load_dwordx4 v10, s[56:59], s76 offen lds
 s_add_u32 s76, s76, 44032
 s_add_u32 m0, s71, 27648
 s_nop 0
 buffer_load_dwordx4 v10, s[60:63], s77 offen lds
 s_add_u32 s77, s77, 44032
 s_add_u32 m0, s71, 20480
 s_nop 0
 buffer_load_dwordx4 v10, s[56:59], s76 offen lds
 s_add_u32 s76, s76, 44032
 s_add_u32 m0, s71, 28672
 s_nop 0
 buffer_load_dwordx4 v10, s[60:63], s77 offen lds
 s_add_u32 s77, s77, 44032
 s_add_u32 m0, s71, 21504
 s_nop 0
 buffer_load_dwordx4 v10, s[56:59], s76 offen lds
 s_add_u32 s76, s76, 44032
 s_add_u32 m0, s71, 29696
 s_nop 0
 buffer_load_dwordx4 v10, s[60:63], s77 offen lds
 s_add_u32 s77, s77, 44032
 s_add_u32 m0, s71, 22528
 s_nop 0
 buffer_load_dwordx4 v10, s[56:59], s76 offen lds
 s_add_u32 s76, s76, 44032
 s_add_u32 m0, s71, 30720
 s_nop 0
 buffer_load_dwordx4 v10, s[60:63], s77 offen lds
 s_add_u32 s77, s77, 44032
 s_add_u32 m0, s71, 23552
 s_nop 0
 buffer_load_dwordx4 v10, s[56:59], s76 offen lds
 s_add_u32 s76, s76, 44032
 s_add_u32 m0, s71, 31744
 s_nop 0
 buffer_load_dwordx4 v10, s[60:63], s77 offen lds
 s_add_u32 s77, s77, 44032
 s_waitcnt vmcnt(16)
 ds_read_b64_tr_b16 a[128:129], v9 offset:0
 ds_read_b64_tr_b16 a[130:131], v9 offset:256
 ds_read_b64_tr_b16 a[132:133], v9 offset:8192
 ds_read_b64_tr_b16 a[134:135], v9 offset:8448
 ds_read_b64_tr_b16 a[136:137], v9 offset:1024
 ds_read_b64_tr_b16 a[138:139], v9 offset:1280
 ds_read_b64_tr_b16 a[140:141], v9 offset:9216
 ds_read_b64_tr_b16 a[142:143], v9 offset:9472
 ds_read_b64_tr_b16 a[144:145], v9 offset:2048
 ds_read_b64_tr_b16 a[146:147], v9 offset:2304
 ds_read_b64_tr_b16 a[148:149], v9 offset:10240
 ds_read_b64_tr_b16 a[150:151], v9 offset:10496
 ds_read_b64_tr_b16 a[152:153], v9 offset:3072
 ds_read_b64_tr_b16 a[154:155], v9 offset:3328
 ds_read_b64_tr_b16 a[156:157], v9 offset:11264
 ds_read_b64_tr_b16 a[158:159], v9 offset:11520
 ds_read_b64_tr_b16 a[160:161], v9 offset:4096
 ds_read_b64_tr_b16 a[162:163], v9 offset:4352
 ds_read_b64_tr_b16 a[164:165], v9 offset:12288
 ds_read_b64_tr_b16 a[166:167], v9 offset:12544
 ds_read_b64_tr_b16 a[168:169], v9 offset:5120
 ds_read_b64_tr_b16 a[170:171], v9 offset:5376
 ds_read_b64_tr_b16 a[172:173], v9 offset:13312
 ds_read_b64_tr_b16 a[174:175], v9 offset:13568
 ds_read_b64_tr_b16 a[176:177], v9 offset:6144
 ds_read_b64_tr_b16 a[178:179], v9 offset:6400
 ds_read_b64_tr_b16 a[180:181], v9 offset:14336
 ds_read_b64_tr_b16 a[182:183], v9 offset:14592
 ds_read_b64_tr_b16 a[184:185], v9 offset:7168
 ds_read_b64_tr_b16 a[186:187], v9 offset:7424
 ds_read_b64_tr_b16 a[188:189], v9 offset:15360
 ds_read_b64_tr_b16 a[190:191], v9 offset:15616
 s_waitcnt lgkmcnt(0)
 s_waitcnt vmcnt(0)
 ds_read_b64_tr_b16 a[192:193], v9 offset:16384
 ds_read_b64_tr_b16 a[194:195], v9 offset:16640
 ds_read_b64_tr_b16 a[196:197], v9 offset:24576
 ds_read_b64_tr_b16 a[198:199], v9 offset:24832
 ds_read_b64_tr_b16 a[200:201], v9 offset:17408
 ds_read_b64_tr_b16 a[202:203], v9 offset:17664
 ds_read_b64_tr_b16 a[204:205], v9 offset:25600
 ds_read_b64_tr_b16 a[206:207], v9 offset:25856
 ds_read_b64_tr_b16 a[208:209], v9 offset:18432
 ds_read_b64_tr_b16 a[210:211], v9 offset:18688
 ds_read_b64_tr_b16 a[212:213], v9 offset:26624
 ds_read_b64_tr_b16 a[214:215], v9 offset:26880
 ds_read_b64_tr_b16 a[216:217], v9 offset:19456
 ds_read_b64_tr_b16 a[218:219], v9 offset:19712
 ds_read_b64_tr_b16 a[220:221], v9 offset:27648
 ds_read_b64_tr_b16 a[222:223], v9 offset:27904
 ds_read_b64_tr_b16 a[224:225], v9 offset:20480
 ds_read_b64_tr_b16 a[226:227], v9 offset:20736
 ds_read_b64_tr_b16 a[228:229], v9 offset:28672
 ds_read_b64_tr_b16 a[230:231], v9 offset:28928
 ds_read_b64_tr_b16 a[232:233], v9 offset:21504
 ds_read_b64_tr_b16 a[234:235], v9 offset:21760
 ds_read_b64_tr_b16 a[236:237], v9 offset:29696
 ds_read_b64_tr_b16 a[238:239], v9 offset:29952
 ds_read_b64_tr_b16 a[240:241], v9 offset:22528
 ds_read_b64_tr_b16 a[242:243], v9 offset:22784
 ds_read_b64_tr_b16 a[244:245], v9 offset:30720
 ds_read_b64_tr_b16 a[246:247], v9 offset:30976
 ds_read_b64_tr_b16 a[248:249], v9 offset:23552
 ds_read_b64_tr_b16 a[250:251], v9 offset:23808
 ds_read_b64_tr_b16 a[252:253], v9 offset:31744
 ds_read_b64_tr_b16 a[254:255], v9 offset:32000
 s_waitcnt lgkmcnt(0)
 s_barrier
 v_and_b32 v5, 31, v1
 s_movk_i32 s70, 1040
 v_mul_lo_u32 v5, v5, s70
 v_lshrrev_b32 v6, 5, v1
 v_lshl_add_u32 v3, v6, 4, v5
 s_mov_b32 s84, 0xbfb8aa3b
 v_and_b32 v5, 31, v1
 v_lshrrev_b32 v6, 5, v1
 v_lshlrev_b32 v7, 1, v5
 v_cmp_gt_u32 vcc, 8, v7
 v_add_u32 v8, 1, v7
 s_mov_b32 s70, 16640
 v_cndmask_b32 v57, 0, 1, vcc
 v_cndmask_b32 v5, 0, v5, vcc
 v_cmp_gt_u32 vcc, 8, v8
 v_mul_lo_u32 v6, v6, s70
 v_lshl_add_u32 v6, v5, 3, v6
 v_cndmask_b32 v58, 0, 1, vcc
 v_add_u32 v56, 33280, v6
 s_mov_b32 s87, 0xf
 v_mov_b32 v62, 0
 v_mov_b32 v63, 0
 s_lshl_b32 s98, s64, 2
 s_add_u32 s98, s98, s3
 s_lshl_b32 s98, s98, 2
 v_mov_b32 v10, 0
 v_mov_b32 v0, 1
 v_add_u32 v12, 65536, v3
 s_mov_b32 s95, 163824
 s_branch up_sched0
up_pro0:
 s_mov_b32 s90, 0
 ds_read_b128 v[16:19], v3 offset:0
 ds_read_b128 v[20:23], v3 offset:32
 ds_read_b128 v[24:27], v3 offset:64
 ds_read_b128 v[28:31], v3 offset:96
 ds_read_b128 v[32:35], v3 offset:128
 ds_read_b128 v[36:39], v3 offset:160
 s_cmp_ge_u32 s94, 2
 s_cbranch_scc1 up_plain0
up_run0:
 s_cmp_lt_u32 s94, 2
 s_cselect_b64 vcc, -1, 0
 ds_read_b128 v[40:43], v3 offset:192
 s_waitcnt lgkmcnt(6)
 v_mfma_f32_32x32x16_bf16 v[64:79], a[0:3], v[16:19], 0
 s_mov_b32 s68, s4
 s_mov_b32 s67, s5
 s_mov_b32 s88, s6
 s_mov_b32 s89, s7
 v_mfma_f32_32x32x16_bf16 v[80:95], a[4:7], v[16:19], 0
 s_add_u32 s88, s88, 2
 s_add_u32 s70, s89, 1
 s_cmp_lt_u32 s70, 36
 s_cselect_b32 s70, s70, s66
 ds_read_b128 v[44:47], v3 offset:224
 s_waitcnt lgkmcnt(6)
 v_mfma_f32_32x32x16_bf16 v[64:79], a[8:11], v[20:23], v[64:79]
 s_add_u32 s71, s89, 4
 s_cmp_lt_u32 s89, 36
 s_cselect_b32 s89, s70, s71
 s_and_b32 s4, s94, 1
 s_barrier
 v_mfma_f32_32x32x16_bf16 v[80:95], a[12:15], v[20:23], v[80:95]
 s_cmp_eq_u32 s94, 0
 s_cselect_b32 s5, s6, s7
 s_cselect_b32 s6, s88, s6
 s_cmp_eq_u32 s94, 1
 s_cselect_b32 s7, s89, s7
 ds_read_b128 v[16:19], v3 offset:256
 s_waitcnt lgkmcnt(6)
 v_mfma_f32_32x32x16_bf16 v[64:79], a[16:19], v[24:27], v[64:79]
 s_mov_b32 s78, 65536
 s_mul_i32 s81, s4, 2097152
 s_add_u32 s81, s81, 144424960
 s_lshl_b32 s70, s5, 15
 s_bitcmp1_b32 s90, 0
 s_cbranch_scc0 g_257
 v_mul_f32 v160, s84, v96
 v_mul_f32 v161, s84, v97
 v_mul_f32 v162, s84, v98
 v_mul_f32 v163, s84, v99
 v_mul_f32 v164, s84, v100
g_257:
 v_mfma_f32_32x32x16_bf16 v[80:95], a[20:23], v[24:27], v[80:95]
 s_add_u32 s81, s81, s70
 s_mul_i32 s96, s3, 8320
 s_add_u32 s96, s96, s78
 s_lshl_b32 s97, s3, 13
 s_bitcmp1_b32 s90, 0
 s_cbranch_scc0 g_258
 v_mul_f32 v165, s84, v101
 v_mul_f32 v166, s84, v102
 v_mul_f32 v167, s84, v103
 v_exp_f32 v160, v160
 v_exp_f32 v161, v161
g_258:
 ds_read_b128 v[20:23], v3 offset:288
 s_waitcnt lgkmcnt(6)
 v_mfma_f32_32x32x16_bf16 v[64:79], a[24:27], v[28:31], v[64:79]
 s_add_u32 s97, s97, s81
 s_sub_u32 s97, s97, 1024
 s_bitcmp1_b32 s90, 0
 s_cbranch_scc0 g_259
 v_exp_f32 v162, v162
 v_exp_f32 v163, v163
 v_exp_f32 v164, v164
 v_exp_f32 v165, v165
 v_exp_f32 v166, v166
g_259:
 v_mfma_f32_32x32x16_bf16 v[80:95], a[28:31], v[28:31], v[80:95]
 s_bitcmp1_b32 s90, 0
 s_cbranch_scc0 g_260
 v_exp_f32 v167, v167
 v_mul_f32 v96, v96, v112
 v_mul_f32 v97, v97, v113
 v_mul_f32 v98, v98, v114
 v_mul_f32 v99, v99, v115
g_260:
 s_cbranch_vccz g_261
 s_add_u32 m0, s96, 0
 s_add_u32 s97, s97, 1024
 buffer_load_dwordx4 v2, s[52:55], s97 offen sc1 lds
g_261:
 ds_read_b128 v[24:27], v3 offset:320
 s_waitcnt lgkmcnt(6)
 v_mfma_f32_32x32x16_bf16 v[64:79], a[32:35], v[32:35], v[64:79]
 s_bitcmp1_b32 s90, 0
 s_cbranch_scc0 g_262
 v_mul_f32 v100, v100, v116
 v_mul_f32 v101, v101, v117
 v_mul_f32 v102, v102, v118
 v_mul_f32 v103, v103, v119
 v_add_f32 v160, 1.0, v160
g_262:
 s_cbranch_vccz g_263
 s_add_u32 m0, s96, 1040
 s_add_u32 s97, s97, 1024
 buffer_load_dwordx4 v2, s[52:55], s97 offen sc1 lds
g_263:
 v_mfma_f32_32x32x16_bf16 v[80:95], a[36:39], v[32:35], v[80:95]
 s_bitcmp1_b32 s90, 0
 s_cbranch_scc0 g_264
 v_add_f32 v161, 1.0, v161
 v_add_f32 v162, 1.0, v162
 v_add_f32 v163, 1.0, v163
 v_add_f32 v164, 1.0, v164
 v_add_f32 v165, 1.0, v165
g_264:
 s_cbranch_vccz g_265
 s_add_u32 m0, s96, 2080
 s_add_u32 s97, s97, 1024
 buffer_load_dwordx4 v2, s[52:55], s97 offen sc1 lds
g_265:
 ds_read_b128 v[28:31], v3 offset:352
 s_waitcnt lgkmcnt(6)
 v_mfma_f32_32x32x16_bf16 v[64:79], a[40:43], v[36:39], v[64:79]
 s_bitcmp1_b32 s90, 0
 s_cbranch_scc0 g_266
 v_add_f32 v166, 1.0, v166
 v_add_f32 v167, 1.0, v167
 v_rcp_f32 v160, v160
 v_rcp_f32 v161, v161
 v_rcp_f32 v162, v162
g_266:
 s_cbranch_vccz g_267
 s_add_u32 m0, s96, 3120
 s_add_u32 s97, s97, 1024
 buffer_load_dwordx4 v2, s[52:55], s97 offen sc1 lds
g_267:
 v_mfma_f32_32x32x16_bf16 v[80:95], a[44:47], v[36:39], v[80:95]
 s_bitcmp1_b32 s90, 0
 s_cbranch_scc0 g_268
 v_rcp_f32 v163, v163
 v_rcp_f32 v164, v164
 v_rcp_f32 v165, v165
 v_rcp_f32 v166, v166
 v_rcp_f32 v167, v167
g_268:
 s_cbranch_vccz g_269
 s_add_u32 m0, s96, 4160
 s_add_u32 s97, s97, 1024
 buffer_load_dwordx4 v2, s[52:55], s97 offen sc1 lds
g_269:
 ds_read_b128 v[32:35], v3 offset:384
 s_waitcnt lgkmcnt(6)
 v_mfma_f32_32x32x16_bf16 v[64:79], a[48:51], v[40:43], v[64:79]
 s_bitcmp1_b32 s90, 0
 s_cbranch_scc0 g_270
 s_nop 0
 v_mul_f32 v96, v96, v160
 v_mul_f32 v97, v97, v161
 v_mul_f32 v98, v98, v162
 v_mul_f32 v99, v99, v163
g_270:
 s_cbranch_vccz g_271
 s_add_u32 m0, s96, 5200
 s_add_u32 s97, s97, 1024
 buffer_load_dwordx4 v2, s[52:55], s97 offen sc1 lds
g_271:
 v_mfma_f32_32x32x16_bf16 v[80:95], a[52:55], v[40:43], v[80:95]
 s_bitcmp1_b32 s90, 0
 s_cbranch_scc0 g_272
 v_mul_f32 v100, v100, v164
 v_mul_f32 v101, v101, v165
 v_mul_f32 v102, v102, v166
 v_mul_f32 v103, v103, v167
 v_cvt_pk_bf16_f32 v128, v96, v97
g_272:
 s_cbranch_vccz g_273
 s_add_u32 m0, s96, 6240
 s_add_u32 s97, s97, 1024
 buffer_load_dwordx4 v2, s[52:55], s97 offen sc1 lds
g_273:
 ds_read_b128 v[36:39], v3 offset:416
 s_waitcnt lgkmcnt(6)
 v_mfma_f32_32x32x16_bf16 v[64:79], a[56:59], v[44:47], v[64:79]
 s_bitcmp1_b32 s90, 0
 s_cbranch_scc0 g_274
 v_cvt_pk_bf16_f32 v129, v98, v99
 v_cvt_pk_bf16_f32 v130, v100, v101
 v_cvt_pk_bf16_f32 v131, v102, v103
 buffer_store_dwordx4 v[128:131], v2, s[52:55], s91 offen offset:0 sc1
 v_mul_f32 v168, s84, v104
g_274:
 s_cbranch_vccz g_275
 s_add_u32 m0, s96, 7280
 s_add_u32 s97, s97, 1024
 buffer_load_dwordx4 v2, s[52:55], s97 offen sc1 lds
g_275:
 v_mfma_f32_32x32x16_bf16 v[80:95], a[60:63], v[44:47], v[80:95]
 s_bitcmp1_b32 s90, 0
 s_cbranch_scc0 g_276
 v_mul_f32 v169, s84, v105
 v_mul_f32 v170, s84, v106
 v_mul_f32 v171, s84, v107
 v_mul_f32 v172, s84, v108
 v_mul_f32 v173, s84, v109
g_276:
 ds_read_b128 v[40:43], v3 offset:448
 s_waitcnt lgkmcnt(6)
 v_mfma_f32_32x32x16_bf16 v[64:79], a[64:67], v[16:19], v[64:79]
 s_bitcmp1_b32 s90, 0
 s_cbranch_scc0 g_277
 v_mul_f32 v174, s84, v110
 v_mul_f32 v175, s84, v111
 v_exp_f32 v168, v168
 v_exp_f32 v169, v169
 v_exp_f32 v170, v170
g_277:
 v_mfma_f32_32x32x16_bf16 v[80:95], a[68:71], v[16:19], v[80:95]
 s_bitcmp1_b32 s90, 0
 s_cbranch_scc0 g_278
 v_exp_f32 v171, v171
 v_exp_f32 v172, v172
 v_exp_f32 v173, v173
 v_exp_f32 v174, v174
 v_exp_f32 v175, v175
g_278:
 ds_read_b128 v[44:47], v3 offset:480
 s_waitcnt lgkmcnt(6)
 v_mfma_f32_32x32x16_bf16 v[64:79], a[72:75], v[20:23], v[64:79]
 s_bitcmp1_b32 s90, 1
 s_cbranch_scc0 es_279
 s_cbranch_vccz es_280
 s_waitcnt vmcnt(8)
 s_branch es_281
es_280:
 s_waitcnt vmcnt(0)
es_281:
 s_mov_b64 exec, 1
 buffer_store_dword v0, v10, s[52:55], s69 offen sc1
 s_mov_b64 exec, -1
es_279:
 s_bitcmp1_b32 s90, 0
 s_cbranch_scc0 g_282
 v_mul_f32 v104, v104, v120
 v_mul_f32 v105, v105, v121
 v_mul_f32 v106, v106, v122
 v_mul_f32 v107, v107, v123
 v_mul_f32 v108, v108, v124
g_282:
 v_mfma_f32_32x32x16_bf16 v[80:95], a[76:79], v[20:23], v[80:95]
 s_bitcmp1_b32 s90, 0
 s_cbranch_scc0 g_283
 v_mul_f32 v109, v109, v125
 v_mul_f32 v110, v110, v126
 v_mul_f32 v111, v111, v127
 v_add_f32 v168, 1.0, v168
 v_add_f32 v169, 1.0, v169
g_283:
 ds_read_b128 v[16:19], v3 offset:512
 s_waitcnt lgkmcnt(6)
 v_mfma_f32_32x32x16_bf16 v[64:79], a[80:83], v[24:27], v[64:79]
 s_bitcmp1_b32 s90, 0
 s_cbranch_scc0 g_284
 v_add_f32 v170, 1.0, v170
 v_add_f32 v171, 1.0, v171
 v_add_f32 v172, 1.0, v172
 v_add_f32 v173, 1.0, v173
 v_add_f32 v174, 1.0, v174
g_284:
 v_mfma_f32_32x32x16_bf16 v[80:95], a[84:87], v[24:27], v[80:95]
 s_bitcmp1_b32 s90, 0
 s_cbranch_scc0 g_285
 v_add_f32 v175, 1.0, v175
 v_rcp_f32 v168, v168
 v_rcp_f32 v169, v169
 v_rcp_f32 v170, v170
 v_rcp_f32 v171, v171
g_285:
 ds_read_b128 v[20:23], v3 offset:544
 s_waitcnt lgkmcnt(6)
 v_mfma_f32_32x32x16_bf16 v[64:79], a[88:91], v[28:31], v[64:79]
 s_bitcmp1_b32 s90, 0
 s_cbranch_scc0 g_286
 v_rcp_f32 v172, v172
 v_rcp_f32 v173, v173
 v_rcp_f32 v174, v174
 v_rcp_f32 v175, v175
 s_nop 0
g_286:
 v_mfma_f32_32x32x16_bf16 v[80:95], a[92:95], v[28:31], v[80:95]
 s_bitcmp1_b32 s90, 0
 s_cbranch_scc0 g_287
 v_mul_f32 v104, v104, v168
 v_mul_f32 v105, v105, v169
 v_mul_f32 v106, v106, v170
 v_mul_f32 v107, v107, v171
 v_mul_f32 v108, v108, v172
g_287:
 ds_read_b128 v[24:27], v3 offset:576
 s_waitcnt lgkmcnt(6)
 v_mfma_f32_32x32x16_bf16 v[64:79], a[96:99], v[32:35], v[64:79]
 s_bitcmp1_b32 s90, 0
 s_cbranch_scc0 g_288
 v_mul_f32 v109, v109, v173
 v_mul_f32 v110, v110, v174
 v_mul_f32 v111, v111, v175
 v_cvt_pk_bf16_f32 v132, v104, v105
 v_cvt_pk_bf16_f32 v133, v106, v107
g_288:
 v_mfma_f32_32x32x16_bf16 v[80:95], a[100:103], v[32:35], v[80:95]
 s_bitcmp1_b32 s90, 0
 s_cbranch_scc0 g_289
 v_cvt_pk_bf16_f32 v134, v108, v109
 v_cvt_pk_bf16_f32 v135, v110, v111
 buffer_store_dwordx4 v[132:135], v2, s[52:55], s91 offen offset:1024 sc1
g_289:
 ds_read_b128 v[28:31], v3 offset:608
 s_waitcnt lgkmcnt(6)
 v_mfma_f32_32x32x16_bf16 v[64:79], a[104:107], v[36:39], v[64:79]
 s_mul_i32 s80, s68, 5636096
 s_add_u32 s80, s80, 148619264
 s_mul_i32 s70, s67, 88064
 s_add_u32 s80, s80, s70
 v_mfma_f32_32x32x16_bf16 v[80:95], a[108:111], v[36:39], v[80:95]
 s_lshl_b32 s70, s82, 11
 s_add_u32 s80, s80, s70
 s_cmp_ge_u32 s82, 43
 s_cselect_b32 s80, 178765824, s80
 ds_read_b128 v[32:35], v3 offset:640
 s_waitcnt lgkmcnt(6)
 v_mfma_f32_32x32x16_bf16 v[64:79], a[112:115], v[40:43], v[64:79]
 s_mul_i32 s101, s68, 65
 s_add_u32 s101, s101, s67
 s_lshl_b32 s101, s101, 8
 s_add_u32 s101, s101, 99840
 v_mfma_f32_32x32x16_bf16 v[80:95], a[116:119], v[40:43], v[80:95]
 s_add_u32 s101, s101, s98
 ds_read_b128 v[36:39], v3 offset:672
 s_waitcnt lgkmcnt(6)
 v_mfma_f32_32x32x16_bf16 v[64:79], a[120:123], v[44:47], v[64:79]
 s_cmp_lg_u32 s3, 0
 s_cbranch_scc1 w0_290
 s_min_u32 s70, s6, 63
 s_min_u32 s71, s7, 63
 s_lshl_b32 s70, s70, 8
 s_lshl_b32 s71, s71, 8
 v_add_u32 v15, s70, v56
 s_mov_b32 exec_lo, 0
 v_add_u32 v15, s71, v56
 s_mov_b32 exec_lo, s87
 s_mov_b32 exec_hi, s87
 buffer_load_dwordx2 v[62:63], v15, s[52:55], 0 offen sc1
 s_mov_b64 exec, -1
w0_290:
 v_mfma_f32_32x32x16_bf16 v[80:95], a[124:127], v[44:47], v[80:95]
 ds_read_b128 v[40:43], v3 offset:704
 s_waitcnt lgkmcnt(6)
 v_mfma_f32_32x32x16_bf16 v[64:79], a[128:131], v[16:19], v[64:79]
 v_mfma_f32_32x32x16_bf16 v[80:95], a[132:135], v[16:19], v[80:95]
 ds_read_b128 v[44:47], v3 offset:736
 s_waitcnt lgkmcnt(6)
 v_mfma_f32_32x32x16_bf16 v[64:79], a[136:139], v[20:23], v[64:79]
 v_mfma_f32_32x32x16_bf16 v[80:95], a[140:143], v[20:23], v[80:95]
 ds_read_b128 v[16:19], v3 offset:768
 s_waitcnt lgkmcnt(6)
 v_mfma_f32_32x32x16_bf16 v[64:79], a[144:147], v[24:27], v[64:79]
 v_mfma_f32_32x32x16_bf16 v[80:95], a[148:151], v[24:27], v[80:95]
 ds_read_b128 v[20:23], v3 offset:800
 s_waitcnt lgkmcnt(6)
 v_mfma_f32_32x32x16_bf16 v[64:79], a[152:155], v[28:31], v[64:79]
 v_mfma_f32_32x32x16_bf16 v[80:95], a[156:159], v[28:31], v[80:95]
 ds_read_b128 v[24:27], v3 offset:832
 s_waitcnt lgkmcnt(6)
 v_mfma_f32_32x32x16_bf16 v[64:79], a[160:163], v[32:35], v[64:79]
 v_mfma_f32_32x32x16_bf16 v[80:95], a[164:167], v[32:35], v[80:95]
 ds_read_b128 v[28:31], v3 offset:864
 s_waitcnt lgkmcnt(6)
 v_mfma_f32_32x32x16_bf16 v[64:79], a[168:171], v[36:39], v[64:79]
 v_mfma_f32_32x32x16_bf16 v[80:95], a[172:175], v[36:39], v[80:95]
 ds_read_b128 v[32:35], v3 offset:896
 s_waitcnt lgkmcnt(6)
 v_mfma_f32_32x32x16_bf16 v[64:79], a[176:179], v[40:43], v[64:79]
 s_waitcnt vmcnt(0)
 s_bitcmp1_b32 s90, 0
 s_cbranch_scc0 sg_291
 s_mov_b64 exec, 1
 buffer_store_dword v0, v10, s[52:55], s69 offen sc1
 s_mov_b64 exec, -1
sg_291:
 s_cmp_lg_u32 s3, 0
 s_cbranch_scc1 w0_292
 v_cmp_ge_u32 s[72:73], v62, v57
 v_cmp_ge_u32 s[74:75], v63, v58
 s_and_b64 s[72:73], s[72:73], s[74:75]
 s_mov_b32 s70, 2
 s_cmp_lt_u32 s7, 64
 s_cselect_b32 s71, s73, 0
 s_cmp_eq_u32 s71, -1
 s_cselect_b32 s70, 1, s70
 s_cmp_lt_u32 s6, 64
 s_cselect_b32 s71, s72, 0
 s_cmp_eq_u32 s71, -1
 s_cselect_b32 s70, 0, s70
 v_mov_b32 v5, s70
 v_mov_b32 v6, s95
 ds_write_b32 v6, v5
w0_292:
 v_mfma_f32_32x32x16_bf16 v[80:95], a[180:183], v[40:43], v[80:95]
 ds_read_b128 v[36:39], v3 offset:928
 s_waitcnt lgkmcnt(6)
 v_mfma_f32_32x32x16_bf16 v[64:79], a[184:187], v[44:47], v[64:79]
 v_mfma_f32_32x32x16_bf16 v[80:95], a[188:191], v[44:47], v[80:95]
 ds_read_b128 v[40:43], v3 offset:960
 s_waitcnt lgkmcnt(6)
 v_mfma_f32_32x32x16_bf16 v[64:79], a[192:195], v[16:19], v[64:79]
 v_mov_b32 v6, s95
 s_waitcnt lgkmcnt(2)
 s_barrier
 ds_read_b32 v61, v6
 s_xor_b32 s95, s95, 4
 v_mfma_f32_32x32x16_bf16 v[80:95], a[196:199], v[16:19], v[80:95]
 ds_read_b128 v[44:47], v3 offset:992
 s_waitcnt lgkmcnt(6)
 v_mfma_f32_32x32x16_bf16 v[64:79], a[200:203], v[20:23], v[64:79]
 v_mfma_f32_32x32x16_bf16 v[80:95], a[204:207], v[20:23], v[80:95]
 s_cbranch_vccz up_tail0
 ds_read_b128 v[16:19], v12 offset:0
 s_waitcnt lgkmcnt(6)
 v_mfma_f32_32x32x16_bf16 v[64:79], a[208:211], v[24:27], v[64:79]
 v_mfma_f32_32x32x16_bf16 v[80:95], a[212:215], v[24:27], v[80:95]
 ds_read_b128 v[20:23], v12 offset:32
 s_waitcnt lgkmcnt(6)
 v_mfma_f32_32x32x16_bf16 v[64:79], a[216:219], v[28:31], v[64:79]
 v_mfma_f32_32x32x16_bf16 v[80:95], a[220:223], v[28:31], v[80:95]
 ds_read_b128 v[24:27], v12 offset:64
 s_waitcnt lgkmcnt(6)
 v_mfma_f32_32x32x16_bf16 v[64:79], a[224:227], v[32:35], v[64:79]
 v_mfma_f32_32x32x16_bf16 v[80:95], a[228:231], v[32:35], v[80:95]
 ds_read_b128 v[28:31], v12 offset:96
 s_waitcnt lgkmcnt(6)
 v_mfma_f32_32x32x16_bf16 v[64:79], a[232:235], v[36:39], v[64:79]
 v_mfma_f32_32x32x16_bf16 v[80:95], a[236:239], v[36:39], v[80:95]
 ds_read_b128 v[32:35], v12 offset:128
 s_waitcnt lgkmcnt(6)
 v_mfma_f32_32x32x16_bf16 v[64:79], a[240:243], v[40:43], v[64:79]
 v_mfma_f32_32x32x16_bf16 v[80:95], a[244:247], v[40:43], v[80:95]
 s_mov_b32 s90, 1
 s_mov_b32 s91, s80
 s_mov_b32 s69, s101
 ds_read_b128 v[36:39], v12 offset:160
 s_waitcnt lgkmcnt(6)
 v_mfma_f32_32x32x16_bf16 v[64:79], a[248:251], v[44:47], v[64:79]
 v_mfma_f32_32x32x16_bf16 v[80:95], a[252:255], v[44:47], v[80:95]
 v_readfirstlane_b32 s94, v61
 s_cmp_ge_u32 s6, 64
 s_cselect_b32 s70, 0, s68
 s_cmp_lg_u32 s70, 0
 s_cbranch_scc1 up_run1
 s_mov_b32 s90, 2
 s_nop 7
 v_mul_f32 v160, s84, v64
 v_mul_f32 v161, s84, v65
 v_mul_f32 v162, s84, v66
 v_mul_f32 v163, s84, v67
 v_mul_f32 v164, s84, v68
 v_mul_f32 v165, s84, v69
 v_mul_f32 v166, s84, v70
 v_mul_f32 v167, s84, v71
 v_exp_f32 v160, v160
 v_exp_f32 v161, v161
 v_exp_f32 v162, v162
 v_exp_f32 v163, v163
 v_exp_f32 v164, v164
 v_exp_f32 v165, v165
 v_exp_f32 v166, v166
 v_exp_f32 v167, v167
 v_mul_f32 v64, v64, v80
 v_mul_f32 v65, v65, v81
 v_mul_f32 v66, v66, v82
 v_mul_f32 v67, v67, v83
 v_mul_f32 v68, v68, v84
 v_mul_f32 v69, v69, v85
 v_mul_f32 v70, v70, v86
 v_mul_f32 v71, v71, v87
 v_add_f32 v160, 1.0, v160
 v_add_f32 v161, 1.0, v161
 v_add_f32 v162, 1.0, v162
 v_add_f32 v163, 1.0, v163
 v_add_f32 v164, 1.0, v164
 v_add_f32 v165, 1.0, v165
 v_add_f32 v166, 1.0, v166
 v_add_f32 v167, 1.0, v167
 v_rcp_f32 v160, v160
 v_rcp_f32 v161, v161
 v_rcp_f32 v162, v162
 v_rcp_f32 v163, v163
 v_rcp_f32 v164, v164
 v_rcp_f32 v165, v165
 v_rcp_f32 v166, v166
 v_rcp_f32 v167, v167
 s_nop 0
 v_mul_f32 v64, v64, v160
 v_mul_f32 v65, v65, v161
 v_mul_f32 v66, v66, v162
 v_mul_f32 v67, v67, v163
 v_mul_f32 v68, v68, v164
 v_mul_f32 v69, v69, v165
 v_mul_f32 v70, v70, v166
 v_mul_f32 v71, v71, v167
 v_cvt_pk_bf16_f32 v128, v64, v65
 v_cvt_pk_bf16_f32 v129, v66, v67
 v_cvt_pk_bf16_f32 v130, v68, v69
 v_cvt_pk_bf16_f32 v131, v70, v71
 buffer_store_dwordx4 v[128:131], v2, s[52:55], s80 offen offset:0 sc1
 v_mul_f32 v168, s84, v72
 v_mul_f32 v169, s84, v73
 v_mul_f32 v170, s84, v74
 v_mul_f32 v171, s84, v75
 v_mul_f32 v172, s84, v76
 v_mul_f32 v173, s84, v77
 v_mul_f32 v174, s84, v78
 v_mul_f32 v175, s84, v79
 v_exp_f32 v168, v168
 v_exp_f32 v169, v169
 v_exp_f32 v170, v170
 v_exp_f32 v171, v171
 v_exp_f32 v172, v172
 v_exp_f32 v173, v173
 v_exp_f32 v174, v174
 v_exp_f32 v175, v175
 v_mul_f32 v72, v72, v88
 v_mul_f32 v73, v73, v89
 v_mul_f32 v74, v74, v90
 v_mul_f32 v75, v75, v91
 v_mul_f32 v76, v76, v92
 v_mul_f32 v77, v77, v93
 v_mul_f32 v78, v78, v94
 v_mul_f32 v79, v79, v95
 v_add_f32 v168, 1.0, v168
 v_add_f32 v169, 1.0, v169
 v_add_f32 v170, 1.0, v170
 v_add_f32 v171, 1.0, v171
 v_add_f32 v172, 1.0, v172
 v_add_f32 v173, 1.0, v173
 v_add_f32 v174, 1.0, v174
 v_add_f32 v175, 1.0, v175
 v_rcp_f32 v168, v168
 v_rcp_f32 v169, v169
 v_rcp_f32 v170, v170
 v_rcp_f32 v171, v171
 v_rcp_f32 v172, v172
 v_rcp_f32 v173, v173
 v_rcp_f32 v174, v174
 v_rcp_f32 v175, v175
 s_nop 0
 v_mul_f32 v72, v72, v168
 v_mul_f32 v73, v73, v169
 v_mul_f32 v74, v74, v170
 v_mul_f32 v75, v75, v171
 v_mul_f32 v76, v76, v172
 v_mul_f32 v77, v77, v173
 v_mul_f32 v78, v78, v174
 v_mul_f32 v79, v79, v175
 v_cvt_pk_bf16_f32 v132, v72, v73
 v_cvt_pk_bf16_f32 v133, v74, v75
 v_cvt_pk_bf16_f32 v134, v76, v77
 v_cvt_pk_bf16_f32 v135, v78, v79
 buffer_store_dwordx4 v[132:135], v2, s[52:55], s80 offen offset:1024 sc1
 s_branch up_run1
up_plain0:
 ds_read_b128 v[40:43], v3 offset:192
 s_waitcnt lgkmcnt(6)
 v_mfma_f32_32x32x16_bf16 v[64:79], a[0:3], v[16:19], 0
 s_mov_b32 s68, s4
 s_mov_b32 s67, s5
 s_mul_i32 s80, s68, 5636096
 s_add_u32 s80, s80, 148619264
 v_mfma_f32_32x32x16_bf16 v[80:95], a[4:7], v[16:19], 0
 s_mul_i32 s70, s67, 88064
 s_add_u32 s80, s80, s70
 s_lshl_b32 s70, s82, 11
 s_add_u32 s80, s80, s70
 ds_read_b128 v[44:47], v3 offset:224
 s_waitcnt lgkmcnt(6)
 v_mfma_f32_32x32x16_bf16 v[64:79], a[8:11], v[20:23], v[64:79]
 s_cmp_ge_u32 s82, 43
 s_cselect_b32 s80, 178765824, s80
 s_mul_i32 s101, s68, 65
 s_add_u32 s101, s101, s67
 s_barrier
 v_mfma_f32_32x32x16_bf16 v[80:95], a[12:15], v[20:23], v[80:95]
 s_lshl_b32 s101, s101, 8
 s_add_u32 s101, s101, 99840
 s_add_u32 s101, s101, s98
 ds_read_b128 v[16:19], v3 offset:256
 s_waitcnt lgkmcnt(6)
 v_mfma_f32_32x32x16_bf16 v[64:79], a[16:19], v[24:27], v[64:79]
 v_mfma_f32_32x32x16_bf16 v[80:95], a[20:23], v[24:27], v[80:95]
 ds_read_b128 v[20:23], v3 offset:288
 s_waitcnt lgkmcnt(6)
 v_mfma_f32_32x32x16_bf16 v[64:79], a[24:27], v[28:31], v[64:79]
 v_mfma_f32_32x32x16_bf16 v[80:95], a[28:31], v[28:31], v[80:95]
 ds_read_b128 v[24:27], v3 offset:320
 s_waitcnt lgkmcnt(6)
 v_mfma_f32_32x32x16_bf16 v[64:79], a[32:35], v[32:35], v[64:79]
 v_mfma_f32_32x32x16_bf16 v[80:95], a[36:39], v[32:35], v[80:95]
 ds_read_b128 v[28:31], v3 offset:352
 s_waitcnt lgkmcnt(6)
 v_mfma_f32_32x32x16_bf16 v[64:79], a[40:43], v[36:39], v[64:79]
 v_mfma_f32_32x32x16_bf16 v[80:95], a[44:47], v[36:39], v[80:95]
 ds_read_b128 v[32:35], v3 offset:384
 s_waitcnt lgkmcnt(6)
 v_mfma_f32_32x32x16_bf16 v[64:79], a[48:51], v[40:43], v[64:79]
 v_mfma_f32_32x32x16_bf16 v[80:95], a[52:55], v[40:43], v[80:95]
 ds_read_b128 v[36:39], v3 offset:416
 s_waitcnt lgkmcnt(6)
 v_mfma_f32_32x32x16_bf16 v[64:79], a[56:59], v[44:47], v[64:79]
 v_mfma_f32_32x32x16_bf16 v[80:95], a[60:63], v[44:47], v[80:95]
 ds_read_b128 v[40:43], v3 offset:448
 s_waitcnt lgkmcnt(6)
 v_mfma_f32_32x32x16_bf16 v[64:79], a[64:67], v[16:19], v[64:79]
 v_mfma_f32_32x32x16_bf16 v[80:95], a[68:71], v[16:19], v[80:95]
 ds_read_b128 v[44:47], v3 offset:480
 s_waitcnt lgkmcnt(6)
 v_mfma_f32_32x32x16_bf16 v[64:79], a[72:75], v[20:23], v[64:79]
 v_mfma_f32_32x32x16_bf16 v[80:95], a[76:79], v[20:23], v[80:95]
 ds_read_b128 v[16:19], v3 offset:512
 s_waitcnt lgkmcnt(6)
 v_mfma_f32_32x32x16_bf16 v[64:79], a[80:83], v[24:27], v[64:79]
 v_mfma_f32_32x32x16_bf16 v[80:95], a[84:87], v[24:27], v[80:95]
 ds_read_b128 v[20:23], v3 offset:544
 s_waitcnt lgkmcnt(6)
 v_mfma_f32_32x32x16_bf16 v[64:79], a[88:91], v[28:31], v[64:79]
 v_mfma_f32_32x32x16_bf16 v[80:95], a[92:95], v[28:31], v[80:95]
 ds_read_b128 v[24:27], v3 offset:576
 s_waitcnt lgkmcnt(6)
 v_mfma_f32_32x32x16_bf16 v[64:79], a[96:99], v[32:35], v[64:79]
 v_mfma_f32_32x32x16_bf16 v[80:95], a[100:103], v[32:35], v[80:95]
 ds_read_b128 v[28:31], v3 offset:608
 s_waitcnt lgkmcnt(6)
 v_mfma_f32_32x32x16_bf16 v[64:79], a[104:107], v[36:39], v[64:79]
 v_mfma_f32_32x32x16_bf16 v[80:95], a[108:111], v[36:39], v[80:95]
 ds_read_b128 v[32:35], v3 offset:640
 s_waitcnt lgkmcnt(6)
 v_mfma_f32_32x32x16_bf16 v[64:79], a[112:115], v[40:43], v[64:79]
 s_cmp_lg_u32 s3, 0
 s_cbranch_scc1 w0_293
 s_min_u32 s70, s6, 63
 s_min_u32 s71, s7, 63
 s_lshl_b32 s70, s70, 8
 s_lshl_b32 s71, s71, 8
 v_add_u32 v15, s70, v56
 s_mov_b32 exec_lo, 0
 v_add_u32 v15, s71, v56
 s_mov_b32 exec_lo, s87
 s_mov_b32 exec_hi, s87
 buffer_load_dwordx2 v[62:63], v15, s[52:55], 0 offen sc1
 s_mov_b64 exec, -1
w0_293:
 v_mfma_f32_32x32x16_bf16 v[80:95], a[116:119], v[40:43], v[80:95]
 ds_read_b128 v[36:39], v3 offset:672
 s_waitcnt lgkmcnt(6)
 v_mfma_f32_32x32x16_bf16 v[64:79], a[120:123], v[44:47], v[64:79]
 v_mfma_f32_32x32x16_bf16 v[80:95], a[124:127], v[44:47], v[80:95]
 ds_read_b128 v[40:43], v3 offset:704
 s_waitcnt lgkmcnt(6)
 v_mfma_f32_32x32x16_bf16 v[64:79], a[128:131], v[16:19], v[64:79]
 v_mfma_f32_32x32x16_bf16 v[80:95], a[132:135], v[16:19], v[80:95]
 ds_read_b128 v[44:47], v3 offset:736
 s_waitcnt lgkmcnt(6)
 v_mfma_f32_32x32x16_bf16 v[64:79], a[136:139], v[20:23], v[64:79]
 v_mfma_f32_32x32x16_bf16 v[80:95], a[140:143], v[20:23], v[80:95]
 ds_read_b128 v[16:19], v3 offset:768
 s_waitcnt lgkmcnt(6)
 v_mfma_f32_32x32x16_bf16 v[64:79], a[144:147], v[24:27], v[64:79]
 v_mfma_f32_32x32x16_bf16 v[80:95], a[148:151], v[24:27], v[80:95]
 ds_read_b128 v[20:23], v3 offset:800
 s_waitcnt lgkmcnt(6)
 v_mfma_f32_32x32x16_bf16 v[64:79], a[152:155], v[28:31], v[64:79]
 v_mfma_f32_32x32x16_bf16 v[80:95], a[156:159], v[28:31], v[80:95]
 ds_read_b128 v[24:27], v3 offset:832
 s_waitcnt lgkmcnt(6)
 v_mfma_f32_32x32x16_bf16 v[64:79], a[160:163], v[32:35], v[64:79]
 v_mfma_f32_32x32x16_bf16 v[80:95], a[164:167], v[32:35], v[80:95]
 ds_read_b128 v[28:31], v3 offset:864
 s_waitcnt lgkmcnt(6)
 v_mfma_f32_32x32x16_bf16 v[64:79], a[168:171], v[36:39], v[64:79]
 v_mfma_f32_32x32x16_bf16 v[80:95], a[172:175], v[36:39], v[80:95]
 ds_read_b128 v[32:35], v3 offset:896
 s_waitcnt lgkmcnt(6)
 v_mfma_f32_32x32x16_bf16 v[64:79], a[176:179], v[40:43], v[64:79]
 s_cmp_lg_u32 s3, 0
 s_cbranch_scc1 w0_294
 s_waitcnt vmcnt(0)
 v_cmp_ge_u32 s[72:73], v62, v57
 v_cmp_ge_u32 s[74:75], v63, v58
 s_and_b64 s[72:73], s[72:73], s[74:75]
 s_mov_b32 s70, 2
 s_cmp_lt_u32 s7, 64
 s_cselect_b32 s71, s73, 0
 s_cmp_eq_u32 s71, -1
 s_cselect_b32 s70, 1, s70
 s_cmp_lt_u32 s6, 64
 s_cselect_b32 s71, s72, 0
 s_cmp_eq_u32 s71, -1
 s_cselect_b32 s70, 0, s70
 v_mov_b32 v5, s70
 v_mov_b32 v6, s95
 ds_write_b32 v6, v5
w0_294:
 v_mfma_f32_32x32x16_bf16 v[80:95], a[180:183], v[40:43], v[80:95]
 ds_read_b128 v[36:39], v3 offset:928
 s_waitcnt lgkmcnt(6)
 v_mfma_f32_32x32x16_bf16 v[64:79], a[184:187], v[44:47], v[64:79]
 v_mfma_f32_32x32x16_bf16 v[80:95], a[188:191], v[44:47], v[80:95]
 ds_read_b128 v[40:43], v3 offset:960
 s_waitcnt lgkmcnt(6)
 v_mfma_f32_32x32x16_bf16 v[64:79], a[192:195], v[16:19], v[64:79]
 v_mov_b32 v6, s95
 s_waitcnt lgkmcnt(2)
 s_barrier
 ds_read_b32 v61, v6
 s_xor_b32 s95, s95, 4
 v_mfma_f32_32x32x16_bf16 v[80:95], a[196:199], v[16:19], v[80:95]
 ds_read_b128 v[44:47], v3 offset:992
 s_waitcnt lgkmcnt(6)
 v_mfma_f32_32x32x16_bf16 v[64:79], a[200:203], v[20:23], v[64:79]
 v_mfma_f32_32x32x16_bf16 v[80:95], a[204:207], v[20:23], v[80:95]
up_tail0:
 s_waitcnt lgkmcnt(5)
 v_mfma_f32_32x32x16_bf16 v[64:79], a[208:211], v[24:27], v[64:79]
 v_mfma_f32_32x32x16_bf16 v[80:95], a[212:215], v[24:27], v[80:95]
 s_waitcnt lgkmcnt(4)
 v_mfma_f32_32x32x16_bf16 v[64:79], a[216:219], v[28:31], v[64:79]
 v_mfma_f32_32x32x16_bf16 v[80:95], a[220:223], v[28:31], v[80:95]
 s_waitcnt lgkmcnt(3)
 v_mfma_f32_32x32x16_bf16 v[64:79], a[224:227], v[32:35], v[64:79]
 v_mfma_f32_32x32x16_bf16 v[80:95], a[228:231], v[32:35], v[80:95]
 s_waitcnt lgkmcnt(2)
 v_mfma_f32_32x32x16_bf16 v[64:79], a[232:235], v[36:39], v[64:79]
 v_mfma_f32_32x32x16_bf16 v[80:95], a[236:239], v[36:39], v[80:95]
 s_waitcnt lgkmcnt(1)
 v_mfma_f32_32x32x16_bf16 v[64:79], a[240:243], v[40:43], v[64:79]
 v_mfma_f32_32x32x16_bf16 v[80:95], a[244:247], v[40:43], v[80:95]
 s_waitcnt lgkmcnt(0)
 v_mfma_f32_32x32x16_bf16 v[64:79], a[248:251], v[44:47], v[64:79]
 v_mfma_f32_32x32x16_bf16 v[80:95], a[252:255], v[44:47], v[80:95]
 v_readfirstlane_b32 s94, v61
 s_mov_b32 s88, s6
 s_mov_b32 s89, s7
 s_add_u32 s88, s88, 2
 s_add_u32 s70, s89, 1
 s_cmp_lt_u32 s70, 36
 s_cselect_b32 s70, s70, s66
 s_add_u32 s71, s89, 4
 s_cmp_lt_u32 s89, 36
 s_cselect_b32 s89, s70, s71
 s_and_b32 s4, s94, 1
 s_cmp_eq_u32 s94, 0
 s_cselect_b32 s5, s6, s7
 s_cselect_b32 s6, s88, s6
 s_cmp_eq_u32 s94, 1
 s_cselect_b32 s7, s89, s7
 s_mov_b32 s78, 65536
 s_mul_i32 s81, s4, 2097152
 s_add_u32 s81, s81, 144424960
 s_lshl_b32 s70, s5, 15
 s_add_u32 s81, s81, s70
 s_mul_i32 s96, s3, 8320
 s_add_u32 s96, s96, s78
 s_lshl_b32 s97, s3, 13
 s_add_u32 s97, s97, s81
 s_sub_u32 s97, s97, 1024
 v_mul_f32 v160, s84, v64
 v_mul_f32 v161, s84, v65
 v_mul_f32 v162, s84, v66
 v_mul_f32 v163, s84, v67
 v_mul_f32 v164, s84, v68
 v_mul_f32 v165, s84, v69
 v_mul_f32 v166, s84, v70
 v_mul_f32 v167, s84, v71
 v_exp_f32 v160, v160
 v_exp_f32 v161, v161
 v_exp_f32 v162, v162
 v_exp_f32 v163, v163
 v_exp_f32 v164, v164
 v_exp_f32 v165, v165
 v_exp_f32 v166, v166
 v_exp_f32 v167, v167
 v_mul_f32 v64, v64, v80
 v_mul_f32 v65, v65, v81
 v_mul_f32 v66, v66, v82
 v_mul_f32 v67, v67, v83
 v_mul_f32 v68, v68, v84
 v_mul_f32 v69, v69, v85
 v_mul_f32 v70, v70, v86
 v_mul_f32 v71, v71, v87
 v_add_f32 v160, 1.0, v160
 v_add_f32 v161, 1.0, v161
 v_add_f32 v162, 1.0, v162
 v_add_f32 v163, 1.0, v163
 v_add_f32 v164, 1.0, v164
 v_add_f32 v165, 1.0, v165
 v_add_f32 v166, 1.0, v166
 v_add_f32 v167, 1.0, v167
 v_rcp_f32 v160, v160
 v_rcp_f32 v161, v161
 v_rcp_f32 v162, v162
 v_rcp_f32 v163, v163
 v_rcp_f32 v164, v164
 v_rcp_f32 v165, v165
 v_rcp_f32 v166, v166
 v_rcp_f32 v167, v167
 s_nop 0
 v_mul_f32 v64, v64, v160
 v_mul_f32 v65, v65, v161
 v_mul_f32 v66, v66, v162
 v_mul_f32 v67, v67, v163
 v_mul_f32 v68, v68, v164
 v_mul_f32 v69, v69, v165
 v_mul_f32 v70, v70, v166
 v_mul_f32 v71, v71, v167
 v_cvt_pk_bf16_f32 v128, v64, v65
 v_cvt_pk_bf16_f32 v129, v66, v67
 v_cvt_pk_bf16_f32 v130, v68, v69
 v_cvt_pk_bf16_f32 v131, v70, v71
 buffer_store_dwordx4 v[128:131], v2, s[52:55], s80 offen offset:0 sc1
 v_mul_f32 v168, s84, v72
 v_mul_f32 v169, s84, v73
 v_mul_f32 v170, s84, v74
 v_mul_f32 v171, s84, v75
 v_mul_f32 v172, s84, v76
 v_mul_f32 v173, s84, v77
 v_mul_f32 v174, s84, v78
 v_mul_f32 v175, s84, v79
 v_exp_f32 v168, v168
 v_exp_f32 v169, v169
 v_exp_f32 v170, v170
 v_exp_f32 v171, v171
 v_exp_f32 v172, v172
 v_exp_f32 v173, v173
 v_exp_f32 v174, v174
 v_exp_f32 v175, v175
 v_mul_f32 v72, v72, v88
 v_mul_f32 v73, v73, v89
 v_mul_f32 v74, v74, v90
 v_mul_f32 v75, v75, v91
 v_mul_f32 v76, v76, v92
 v_mul_f32 v77, v77, v93
 v_mul_f32 v78, v78, v94
 v_mul_f32 v79, v79, v95
 v_add_f32 v168, 1.0, v168
 v_add_f32 v169, 1.0, v169
 v_add_f32 v170, 1.0, v170
 v_add_f32 v171, 1.0, v171
 v_add_f32 v172, 1.0, v172
 v_add_f32 v173, 1.0, v173
 v_add_f32 v174, 1.0, v174
 v_add_f32 v175, 1.0, v175
 v_rcp_f32 v168, v168
 v_rcp_f32 v169, v169
 v_rcp_f32 v170, v170
 v_rcp_f32 v171, v171
 v_rcp_f32 v172, v172
 v_rcp_f32 v173, v173
 v_rcp_f32 v174, v174
 v_rcp_f32 v175, v175
 s_nop 0
 v_mul_f32 v72, v72, v168
 v_mul_f32 v73, v73, v169
 v_mul_f32 v74, v74, v170
 v_mul_f32 v75, v75, v171
 v_mul_f32 v76, v76, v172
 v_mul_f32 v77, v77, v173
 v_mul_f32 v78, v78, v174
 v_mul_f32 v79, v79, v175
 v_cvt_pk_bf16_f32 v132, v72, v73
 v_cvt_pk_bf16_f32 v133, v74, v75
 v_cvt_pk_bf16_f32 v134, v76, v77
 v_cvt_pk_bf16_f32 v135, v78, v79
 buffer_store_dwordx4 v[132:135], v2, s[52:55], s80 offen offset:1024 sc1
 s_cmp_ge_u32 s94, 2
 s_cbranch_scc1 up_idle0
 s_add_u32 m0, s96, 0
 s_add_u32 s97, s97, 1024
 buffer_load_dwordx4 v2, s[52:55], s97 offen sc1 lds
 s_add_u32 m0, s96, 1040
 s_add_u32 s97, s97, 1024
 buffer_load_dwordx4 v2, s[52:55], s97 offen sc1 lds
 s_add_u32 m0, s96, 2080
 s_add_u32 s97, s97, 1024
 buffer_load_dwordx4 v2, s[52:55], s97 offen sc1 lds
 s_add_u32 m0, s96, 3120
 s_add_u32 s97, s97, 1024
 buffer_load_dwordx4 v2, s[52:55], s97 offen sc1 lds
 s_add_u32 m0, s96, 4160
 s_add_u32 s97, s97, 1024
 buffer_load_dwordx4 v2, s[52:55], s97 offen sc1 lds
 s_add_u32 m0, s96, 5200
 s_add_u32 s97, s97, 1024
 buffer_load_dwordx4 v2, s[52:55], s97 offen sc1 lds
 s_add_u32 m0, s96, 6240
 s_add_u32 s97, s97, 1024
 buffer_load_dwordx4 v2, s[52:55], s97 offen sc1 lds
 s_add_u32 m0, s96, 7280
 s_add_u32 s97, s97, 1024
 buffer_load_dwordx4 v2, s[52:55], s97 offen sc1 lds
 s_waitcnt vmcnt(8)
 s_mov_b64 exec, 1
 buffer_store_dword v0, v10, s[52:55], s101 offen sc1
 s_mov_b64 exec, -1
 s_branch sc_299
up_idle0:
 s_mov_b32 s83, 0x200000
 s_cmp_lg_u32 s3, 0
 s_cbranch_scc1 nw_301
 s_min_u32 s70, s6, 63
 s_min_u32 s71, s7, 63
 s_lshl_b32 s70, s70, 8
 s_lshl_b32 s71, s71, 8
 v_add_u32 v15, s70, v56
 s_mov_b32 exec_lo, 0
 v_add_u32 v15, s71, v56
 s_mov_b32 exec_lo, s87
 s_mov_b32 exec_hi, s87
 buffer_load_dwordx2 v[62:63], v15, s[52:55], 0 offen sc1
 s_mov_b64 exec, -1
 s_waitcnt vmcnt(1)
 s_mov_b64 exec, 1
 buffer_store_dword v0, v10, s[52:55], s101 offen sc1
 s_mov_b64 exec, -1
 s_min_u32 s70, s6, s7
 s_cmp_ge_u32 s70, 64
 s_cbranch_scc1 k_exit
 s_waitcnt vmcnt(1)
 s_branch ev_300
nw_301:
 s_waitcnt vmcnt(0)
 s_mov_b64 exec, 1
 buffer_store_dword v0, v10, s[52:55], s101 offen sc1
 s_mov_b64 exec, -1
up_sched1:
 s_min_u32 s70, s6, s7
 s_cmp_ge_u32 s70, 64
 s_cbranch_scc1 k_exit
 s_cmp_lg_u32 s3, 0
 s_cbranch_scc1 sc_295
 s_mov_b32 s83, 0x200000
sc_296:
 s_min_u32 s70, s6, 63
 s_min_u32 s71, s7, 63
 s_lshl_b32 s70, s70, 8
 s_lshl_b32 s71, s71, 8
 v_add_u32 v15, s70, v56
 s_mov_b32 exec_lo, 0
 v_add_u32 v15, s71, v56
 s_mov_b32 exec_lo, s87
 s_mov_b32 exec_hi, s87
 buffer_load_dwordx2 v[62:63], v15, s[52:55], 0 offen sc1
 s_mov_b64 exec, -1
 s_waitcnt vmcnt(0)
ev_300:
 v_cmp_ge_u32 s[72:73], v62, v57
 v_cmp_ge_u32 s[74:75], v63, v58
 s_and_b64 s[72:73], s[72:73], s[74:75]
 s_mov_b32 s70, 2
 s_cmp_lt_u32 s7, 64
 s_cselect_b32 s71, s73, 0
 s_cmp_eq_u32 s71, -1
 s_cselect_b32 s70, 1, s70
 s_cmp_lt_u32 s6, 64
 s_cselect_b32 s71, s72, 0
 s_cmp_eq_u32 s71, -1
 s_cselect_b32 s70, 0, s70
 s_cmp_lt_u32 s70, 2
 s_cbranch_scc1 sc_297
 s_sub_u32 s83, s83, 1
 s_cmp_lg_u32 s83, 0
 s_cbranch_scc1 sc_296
 s_mov_b32 s70, 3
sc_297:
 v_mov_b32 v5, s70
 v_mov_b32 v6, 163832
 ds_write_b32 v6, v5
 s_waitcnt lgkmcnt(0)
sc_295:
 s_barrier
 v_mov_b32 v6, 163832
 ds_read_b32 v61, v6
 s_waitcnt lgkmcnt(0)
 v_readfirstlane_b32 s94, v61
 s_cmp_ge_u32 s94, 2
 s_cbranch_scc1 k_exit
 s_mov_b32 s88, s6
 s_mov_b32 s89, s7
 s_add_u32 s88, s88, 2
 s_add_u32 s70, s89, 1
 s_cmp_lt_u32 s70, 36
 s_cselect_b32 s70, s70, s66
 s_add_u32 s71, s89, 4
 s_cmp_lt_u32 s89, 36
 s_cselect_b32 s89, s70, s71
 s_and_b32 s4, s94, 1
 s_cmp_eq_u32 s94, 0
 s_cselect_b32 s5, s6, s7
 s_cselect_b32 s6, s88, s6
 s_cmp_eq_u32 s94, 1
 s_cselect_b32 s7, s89, s7
 s_mov_b32 s78, 65536
 s_mul_i32 s81, s4, 2097152
 s_add_u32 s81, s81, 144424960
 s_lshl_b32 s70, s5, 15
 s_add_u32 s81, s81, s70
 s_mul_i32 s96, s3, 8320
 s_add_u32 s96, s96, s78
 s_lshl_b32 s97, s3, 13
 s_add_u32 s97, s97, s81
 s_sub_u32 s97, s97, 1024
 s_add_u32 m0, s96, 0
 s_add_u32 s97, s97, 1024
 buffer_load_dwordx4 v2, s[52:55], s97 offen sc1 lds
 s_add_u32 m0, s96, 1040
 s_add_u32 s97, s97, 1024
 buffer_load_dwordx4 v2, s[52:55], s97 offen sc1 lds
 s_add_u32 m0, s96, 2080
 s_add_u32 s97, s97, 1024
 buffer_load_dwordx4 v2, s[52:55], s97 offen sc1 lds
 s_add_u32 m0, s96, 3120
 s_add_u32 s97, s97, 1024
 buffer_load_dwordx4 v2, s[52:55], s97 offen sc1 lds
 s_add_u32 m0, s96, 4160
 s_add_u32 s97, s97, 1024
 buffer_load_dwordx4 v2, s[52:55], s97 offen sc1 lds
 s_add_u32 m0, s96, 5200
 s_add_u32 s97, s97, 1024
 buffer_load_dwordx4 v2, s[52:55], s97 offen sc1 lds
 s_add_u32 m0, s96, 6240
 s_add_u32 s97, s97, 1024
 buffer_load_dwordx4 v2, s[52:55], s97 offen sc1 lds
 s_add_u32 m0, s96, 7280
 s_add_u32 s97, s97, 1024
 buffer_load_dwordx4 v2, s[52:55], s97 offen sc1 lds
sc_299:
 s_cmp_lg_u32 s3, 0
 s_cbranch_scc1 sc_298
 s_min_u32 s70, s6, 63
 s_min_u32 s71, s7, 63
 s_lshl_b32 s70, s70, 8
 s_lshl_b32 s71, s71, 8
 v_add_u32 v15, s70, v56
 s_mov_b32 exec_lo, 0
 v_add_u32 v15, s71, v56
 s_mov_b32 exec_lo, s87
 s_mov_b32 exec_hi, s87
 buffer_load_dwordx2 v[62:63], v15, s[52:55], 0 offen sc1
 s_mov_b64 exec, -1
 s_waitcnt vmcnt(0)
 v_cmp_ge_u32 s[72:73], v62, v57
 v_cmp_ge_u32 s[74:75], v63, v58
 s_and_b64 s[72:73], s[72:73], s[74:75]
 s_mov_b32 s70, 2
 s_cmp_lt_u32 s7, 64
 s_cselect_b32 s71, s73, 0
 s_cmp_eq_u32 s71, -1
 s_cselect_b32 s70, 1, s70
 s_cmp_lt_u32 s6, 64
 s_cselect_b32 s71, s72, 0
 s_cmp_eq_u32 s71, -1
 s_cselect_b32 s70, 0, s70
 v_mov_b32 v5, s70
 v_mov_b32 v6, s95
 ds_write_b32 v6, v5
 s_waitcnt lgkmcnt(0)
sc_298:
 s_waitcnt vmcnt(0)
 v_mov_b32 v6, s95
 s_barrier
 ds_read_b32 v61, v6
 s_xor_b32 s95, s95, 4
 s_waitcnt lgkmcnt(0)
 v_readfirstlane_b32 s94, v61
 s_branch up_pro1
up_pro1:
 s_mov_b32 s90, 0
 ds_read_b128 v[16:19], v12 offset:0
 ds_read_b128 v[20:23], v12 offset:32
 ds_read_b128 v[24:27], v12 offset:64
 ds_read_b128 v[28:31], v12 offset:96
 ds_read_b128 v[32:35], v12 offset:128
 ds_read_b128 v[36:39], v12 offset:160
 s_cmp_ge_u32 s94, 2
 s_cbranch_scc1 up_plain1
up_run1:
 s_cmp_lt_u32 s94, 2
 s_cselect_b64 vcc, -1, 0
 ds_read_b128 v[40:43], v12 offset:192
 s_waitcnt lgkmcnt(6)
 v_mfma_f32_32x32x16_bf16 v[96:111], a[0:3], v[16:19], 0
 s_mov_b32 s68, s4
 s_mov_b32 s67, s5
 s_mov_b32 s88, s6
 s_mov_b32 s89, s7
 v_mfma_f32_32x32x16_bf16 v[112:127], a[4:7], v[16:19], 0
 s_add_u32 s88, s88, 2
 s_add_u32 s70, s89, 1
 s_cmp_lt_u32 s70, 36
 s_cselect_b32 s70, s70, s66
 ds_read_b128 v[44:47], v12 offset:224
 s_waitcnt lgkmcnt(6)
 v_mfma_f32_32x32x16_bf16 v[96:111], a[8:11], v[20:23], v[96:111]
 s_add_u32 s71, s89, 4
 s_cmp_lt_u32 s89, 36
 s_cselect_b32 s89, s70, s71
 s_and_b32 s4, s94, 1
 s_barrier
 v_mfma_f32_32x32x16_bf16 v[112:127], a[12:15], v[20:23], v[112:127]
 s_cmp_eq_u32 s94, 0
 s_cselect_b32 s5, s6, s7
 s_cselect_b32 s6, s88, s6
 s_cmp_eq_u32 s94, 1
 s_cselect_b32 s7, s89, s7
 ds_read_b128 v[16:19], v12 offset:256
 s_waitcnt lgkmcnt(6)
 v_mfma_f32_32x32x16_bf16 v[96:111], a[16:19], v[24:27], v[96:111]
 s_mov_b32 s78, 0
 s_mul_i32 s81, s4, 2097152
 s_add_u32 s81, s81, 144424960
 s_lshl_b32 s70, s5, 15
 s_bitcmp1_b32 s90, 0
 s_cbranch_scc0 g_302
 v_mul_f32 v160, s84, v64
 v_mul_f32 v161, s84, v65
 v_mul_f32 v162, s84, v66
 v_mul_f32 v163, s84, v67
 v_mul_f32 v164, s84, v68
g_302:
 v_mfma_f32_32x32x16_bf16 v[112:127], a[20:23], v[24:27], v[112:127]
 s_add_u32 s81, s81, s70
 s_mul_i32 s96, s3, 8320
 s_add_u32 s96, s96, s78
 s_lshl_b32 s97, s3, 13
 s_bitcmp1_b32 s90, 0
 s_cbranch_scc0 g_303
 v_mul_f32 v165, s84, v69
 v_mul_f32 v166, s84, v70
 v_mul_f32 v167, s84, v71
 v_exp_f32 v160, v160
 v_exp_f32 v161, v161
g_303:
 ds_read_b128 v[20:23], v12 offset:288
 s_waitcnt lgkmcnt(6)
 v_mfma_f32_32x32x16_bf16 v[96:111], a[24:27], v[28:31], v[96:111]
 s_add_u32 s97, s97, s81
 s_sub_u32 s97, s97, 1024
 s_bitcmp1_b32 s90, 0
 s_cbranch_scc0 g_304
 v_exp_f32 v162, v162
 v_exp_f32 v163, v163
 v_exp_f32 v164, v164
 v_exp_f32 v165, v165
 v_exp_f32 v166, v166
g_304:
 v_mfma_f32_32x32x16_bf16 v[112:127], a[28:31], v[28:31], v[112:127]
 s_bitcmp1_b32 s90, 0
 s_cbranch_scc0 g_305
 v_exp_f32 v167, v167
 v_mul_f32 v64, v64, v80
 v_mul_f32 v65, v65, v81
 v_mul_f32 v66, v66, v82
 v_mul_f32 v67, v67, v83
g_305:
 s_cbranch_vccz g_306
 s_add_u32 m0, s96, 0
 s_add_u32 s97, s97, 1024
 buffer_load_dwordx4 v2, s[52:55], s97 offen sc1 lds
g_306:
 ds_read_b128 v[24:27], v12 offset:320
 s_waitcnt lgkmcnt(6)
 v_mfma_f32_32x32x16_bf16 v[96:111], a[32:35], v[32:35], v[96:111]
 s_bitcmp1_b32 s90, 0
 s_cbranch_scc0 g_307
 v_mul_f32 v68, v68, v84
 v_mul_f32 v69, v69, v85
 v_mul_f32 v70, v70, v86
 v_mul_f32 v71, v71, v87
 v_add_f32 v160, 1.0, v160
g_307:
 s_cbranch_vccz g_308
 s_add_u32 m0, s96, 1040
 s_add_u32 s97, s97, 1024
 buffer_load_dwordx4 v2, s[52:55], s97 offen sc1 lds
g_308:
 v_mfma_f32_32x32x16_bf16 v[112:127], a[36:39], v[32:35], v[112:127]
 s_bitcmp1_b32 s90, 0
 s_cbranch_scc0 g_309
 v_add_f32 v161, 1.0, v161
 v_add_f32 v162, 1.0, v162
 v_add_f32 v163, 1.0, v163
 v_add_f32 v164, 1.0, v164
 v_add_f32 v165, 1.0, v165
g_309:
 s_cbranch_vccz g_310
 s_add_u32 m0, s96, 2080
 s_add_u32 s97, s97, 1024
 buffer_load_dwordx4 v2, s[52:55], s97 offen sc1 lds
g_310:
 ds_read_b128 v[28:31], v12 offset:352
 s_waitcnt lgkmcnt(6)
 v_mfma_f32_32x32x16_bf16 v[96:111], a[40:43], v[36:39], v[96:111]
 s_bitcmp1_b32 s90, 0
 s_cbranch_scc0 g_311
 v_add_f32 v166, 1.0, v166
 v_add_f32 v167, 1.0, v167
 v_rcp_f32 v160, v160
 v_rcp_f32 v161, v161
 v_rcp_f32 v162, v162
g_311:
 s_cbranch_vccz g_312
 s_add_u32 m0, s96, 3120
 s_add_u32 s97, s97, 1024
 buffer_load_dwordx4 v2, s[52:55], s97 offen sc1 lds
g_312:
 v_mfma_f32_32x32x16_bf16 v[112:127], a[44:47], v[36:39], v[112:127]
 s_bitcmp1_b32 s90, 0
 s_cbranch_scc0 g_313
 v_rcp_f32 v163, v163
 v_rcp_f32 v164, v164
 v_rcp_f32 v165, v165
 v_rcp_f32 v166, v166
 v_rcp_f32 v167, v167
g_313:
 s_cbranch_vccz g_314
 s_add_u32 m0, s96, 4160
 s_add_u32 s97, s97, 1024
 buffer_load_dwordx4 v2, s[52:55], s97 offen sc1 lds
g_314:
 ds_read_b128 v[32:35], v12 offset:384
 s_waitcnt lgkmcnt(6)
 v_mfma_f32_32x32x16_bf16 v[96:111], a[48:51], v[40:43], v[96:111]
 s_bitcmp1_b32 s90, 0
 s_cbranch_scc0 g_315
 s_nop 0
 v_mul_f32 v64, v64, v160
 v_mul_f32 v65, v65, v161
 v_mul_f32 v66, v66, v162
 v_mul_f32 v67, v67, v163
g_315:
 s_cbranch_vccz g_316
 s_add_u32 m0, s96, 5200
 s_add_u32 s97, s97, 1024
 buffer_load_dwordx4 v2, s[52:55], s97 offen sc1 lds
g_316:
 v_mfma_f32_32x32x16_bf16 v[112:127], a[52:55], v[40:43], v[112:127]
 s_bitcmp1_b32 s90, 0
 s_cbranch_scc0 g_317
 v_mul_f32 v68, v68, v164
 v_mul_f32 v69, v69, v165
 v_mul_f32 v70, v70, v166
 v_mul_f32 v71, v71, v167
 v_cvt_pk_bf16_f32 v128, v64, v65
g_317:
 s_cbranch_vccz g_318
 s_add_u32 m0, s96, 6240
 s_add_u32 s97, s97, 1024
 buffer_load_dwordx4 v2, s[52:55], s97 offen sc1 lds
g_318:
 ds_read_b128 v[36:39], v12 offset:416
 s_waitcnt lgkmcnt(6)
 v_mfma_f32_32x32x16_bf16 v[96:111], a[56:59], v[44:47], v[96:111]
 s_bitcmp1_b32 s90, 0
 s_cbranch_scc0 g_319
 v_cvt_pk_bf16_f32 v129, v66, v67
 v_cvt_pk_bf16_f32 v130, v68, v69
 v_cvt_pk_bf16_f32 v131, v70, v71
 buffer_store_dwordx4 v[128:131], v2, s[52:55], s91 offen offset:0 sc1
 v_mul_f32 v168, s84, v72
g_319:
 s_cbranch_vccz g_320
 s_add_u32 m0, s96, 7280
 s_add_u32 s97, s97, 1024
 buffer_load_dwordx4 v2, s[52:55], s97 offen sc1 lds
g_320:
 v_mfma_f32_32x32x16_bf16 v[112:127], a[60:63], v[44:47], v[112:127]
 s_bitcmp1_b32 s90, 0
 s_cbranch_scc0 g_321
 v_mul_f32 v169, s84, v73
 v_mul_f32 v170, s84, v74
 v_mul_f32 v171, s84, v75
 v_mul_f32 v172, s84, v76
 v_mul_f32 v173, s84, v77
g_321:
 ds_read_b128 v[40:43], v12 offset:448
 s_waitcnt lgkmcnt(6)
 v_mfma_f32_32x32x16_bf16 v[96:111], a[64:67], v[16:19], v[96:111]
 s_bitcmp1_b32 s90, 0
 s_cbranch_scc0 g_322
 v_mul_f32 v174, s84, v78
 v_mul_f32 v175, s84, v79
 v_exp_f32 v168, v168
 v_exp_f32 v169, v169
 v_exp_f32 v170, v170
g_322:
 v_mfma_f32_32x32x16_bf16 v[112:127], a[68:71], v[16:19], v[112:127]
 s_bitcmp1_b32 s90, 0
 s_cbranch_scc0 g_323
 v_exp_f32 v171, v171
 v_exp_f32 v172, v172
 v_exp_f32 v173, v173
 v_exp_f32 v174, v174
 v_exp_f32 v175, v175
g_323:
 ds_read_b128 v[44:47], v12 offset:480
 s_waitcnt lgkmcnt(6)
 v_mfma_f32_32x32x16_bf16 v[96:111], a[72:75], v[20:23], v[96:111]
 s_bitcmp1_b32 s90, 1
 s_cbranch_scc0 es_324
 s_cbranch_vccz es_325
 s_waitcnt vmcnt(8)
 s_branch es_326
es_325:
 s_waitcnt vmcnt(0)
es_326:
 s_mov_b64 exec, 1
 buffer_store_dword v0, v10, s[52:55], s69 offen sc1
 s_mov_b64 exec, -1
es_324:
 s_bitcmp1_b32 s90, 0
 s_cbranch_scc0 g_327
 v_mul_f32 v72, v72, v88
 v_mul_f32 v73, v73, v89
 v_mul_f32 v74, v74, v90
 v_mul_f32 v75, v75, v91
 v_mul_f32 v76, v76, v92
g_327:
 v_mfma_f32_32x32x16_bf16 v[112:127], a[76:79], v[20:23], v[112:127]
 s_bitcmp1_b32 s90, 0
 s_cbranch_scc0 g_328
 v_mul_f32 v77, v77, v93
 v_mul_f32 v78, v78, v94
 v_mul_f32 v79, v79, v95
 v_add_f32 v168, 1.0, v168
 v_add_f32 v169, 1.0, v169
g_328:
 ds_read_b128 v[16:19], v12 offset:512
 s_waitcnt lgkmcnt(6)
 v_mfma_f32_32x32x16_bf16 v[96:111], a[80:83], v[24:27], v[96:111]
 s_bitcmp1_b32 s90, 0
 s_cbranch_scc0 g_329
 v_add_f32 v170, 1.0, v170
 v_add_f32 v171, 1.0, v171
 v_add_f32 v172, 1.0, v172
 v_add_f32 v173, 1.0, v173
 v_add_f32 v174, 1.0, v174
g_329:
 v_mfma_f32_32x32x16_bf16 v[112:127], a[84:87], v[24:27], v[112:127]
 s_bitcmp1_b32 s90, 0
 s_cbranch_scc0 g_330
 v_add_f32 v175, 1.0, v175
 v_rcp_f32 v168, v168
 v_rcp_f32 v169, v169
 v_rcp_f32 v170, v170
 v_rcp_f32 v171, v171
g_330:
 ds_read_b128 v[20:23], v12 offset:544
 s_waitcnt lgkmcnt(6)
 v_mfma_f32_32x32x16_bf16 v[96:111], a[88:91], v[28:31], v[96:111]
 s_bitcmp1_b32 s90, 0
 s_cbranch_scc0 g_331
 v_rcp_f32 v172, v172
 v_rcp_f32 v173, v173
 v_rcp_f32 v174, v174
 v_rcp_f32 v175, v175
 s_nop 0
g_331:
 v_mfma_f32_32x32x16_bf16 v[112:127], a[92:95], v[28:31], v[112:127]
 s_bitcmp1_b32 s90, 0
 s_cbranch_scc0 g_332
 v_mul_f32 v72, v72, v168
 v_mul_f32 v73, v73, v169
 v_mul_f32 v74, v74, v170
 v_mul_f32 v75, v75, v171
 v_mul_f32 v76, v76, v172
g_332:
 ds_read_b128 v[24:27], v12 offset:576
 s_waitcnt lgkmcnt(6)
 v_mfma_f32_32x32x16_bf16 v[96:111], a[96:99], v[32:35], v[96:111]
 s_bitcmp1_b32 s90, 0
 s_cbranch_scc0 g_333
 v_mul_f32 v77, v77, v173
 v_mul_f32 v78, v78, v174
 v_mul_f32 v79, v79, v175
 v_cvt_pk_bf16_f32 v132, v72, v73
 v_cvt_pk_bf16_f32 v133, v74, v75
g_333:
 v_mfma_f32_32x32x16_bf16 v[112:127], a[100:103], v[32:35], v[112:127]
 s_bitcmp1_b32 s90, 0
 s_cbranch_scc0 g_334
 v_cvt_pk_bf16_f32 v134, v76, v77
 v_cvt_pk_bf16_f32 v135, v78, v79
 buffer_store_dwordx4 v[132:135], v2, s[52:55], s91 offen offset:1024 sc1
g_334:
 ds_read_b128 v[28:31], v12 offset:608
 s_waitcnt lgkmcnt(6)
 v_mfma_f32_32x32x16_bf16 v[96:111], a[104:107], v[36:39], v[96:111]
 s_mul_i32 s80, s68, 5636096
 s_add_u32 s80, s80, 148619264
 s_mul_i32 s70, s67, 88064
 s_add_u32 s80, s80, s70
 v_mfma_f32_32x32x16_bf16 v[112:127], a[108:111], v[36:39], v[112:127]
 s_lshl_b32 s70, s82, 11
 s_add_u32 s80, s80, s70
 s_cmp_ge_u32 s82, 43
 s_cselect_b32 s80, 178765824, s80
 ds_read_b128 v[32:35], v12 offset:640
 s_waitcnt lgkmcnt(6)
 v_mfma_f32_32x32x16_bf16 v[96:111], a[112:115], v[40:43], v[96:111]
 s_mul_i32 s101, s68, 65
 s_add_u32 s101, s101, s67
 s_lshl_b32 s101, s101, 8
 s_add_u32 s101, s101, 99840
 v_mfma_f32_32x32x16_bf16 v[112:127], a[116:119], v[40:43], v[112:127]
 s_add_u32 s101, s101, s98
 ds_read_b128 v[36:39], v12 offset:672
 s_waitcnt lgkmcnt(6)
 v_mfma_f32_32x32x16_bf16 v[96:111], a[120:123], v[44:47], v[96:111]
 s_cmp_lg_u32 s3, 0
 s_cbranch_scc1 w0_335
 s_min_u32 s70, s6, 63
 s_min_u32 s71, s7, 63
 s_lshl_b32 s70, s70, 8
 s_lshl_b32 s71, s71, 8
 v_add_u32 v15, s70, v56
 s_mov_b32 exec_lo, 0
 v_add_u32 v15, s71, v56
 s_mov_b32 exec_lo, s87
 s_mov_b32 exec_hi, s87
 buffer_load_dwordx2 v[62:63], v15, s[52:55], 0 offen sc1
 s_mov_b64 exec, -1
w0_335:
 v_mfma_f32_32x32x16_bf16 v[112:127], a[124:127], v[44:47], v[112:127]
 ds_read_b128 v[40:43], v12 offset:704
 s_waitcnt lgkmcnt(6)
 v_mfma_f32_32x32x16_bf16 v[96:111], a[128:131], v[16:19], v[96:111]
 v_mfma_f32_32x32x16_bf16 v[112:127], a[132:135], v[16:19], v[112:127]
 ds_read_b128 v[44:47], v12 offset:736
 s_waitcnt lgkmcnt(6)
 v_mfma_f32_32x32x16_bf16 v[96:111], a[136:139], v[20:23], v[96:111]
 v_mfma_f32_32x32x16_bf16 v[112:127], a[140:143], v[20:23], v[112:127]
 ds_read_b128 v[16:19], v12 offset:768
 s_waitcnt lgkmcnt(6)
 v_mfma_f32_32x32x16_bf16 v[96:111], a[144:147], v[24:27], v[96:111]
 v_mfma_f32_32x32x16_bf16 v[112:127], a[148:151], v[24:27], v[112:127]
 ds_read_b128 v[20:23], v12 offset:800
 s_waitcnt lgkmcnt(6)
 v_mfma_f32_32x32x16_bf16 v[96:111], a[152:155], v[28:31], v[96:111]
 v_mfma_f32_32x32x16_bf16 v[112:127], a[156:159], v[28:31], v[112:127]
 ds_read_b128 v[24:27], v12 offset:832
 s_waitcnt lgkmcnt(6)
 v_mfma_f32_32x32x16_bf16 v[96:111], a[160:163], v[32:35], v[96:111]
 v_mfma_f32_32x32x16_bf16 v[112:127], a[164:167], v[32:35], v[112:127]
 ds_read_b128 v[28:31], v12 offset:864
 s_waitcnt lgkmcnt(6)
 v_mfma_f32_32x32x16_bf16 v[96:111], a[168:171], v[36:39], v[96:111]
 v_mfma_f32_32x32x16_bf16 v[112:127], a[172:175], v[36:39], v[112:127]
 ds_read_b128 v[32:35], v12 offset:896
 s_waitcnt lgkmcnt(6)
 v_mfma_f32_32x32x16_bf16 v[96:111], a[176:179], v[40:43], v[96:111]
 s_waitcnt vmcnt(0)
 s_bitcmp1_b32 s90, 0
 s_cbranch_scc0 sg_336
 s_mov_b64 exec, 1
 buffer_store_dword v0, v10, s[52:55], s69 offen sc1
 s_mov_b64 exec, -1
sg_336:
 s_cmp_lg_u32 s3, 0
 s_cbranch_scc1 w0_337
 v_cmp_ge_u32 s[72:73], v62, v57
 v_cmp_ge_u32 s[74:75], v63, v58
 s_and_b64 s[72:73], s[72:73], s[74:75]
 s_mov_b32 s70, 2
 s_cmp_lt_u32 s7, 64
 s_cselect_b32 s71, s73, 0
 s_cmp_eq_u32 s71, -1
 s_cselect_b32 s70, 1, s70
 s_cmp_lt_u32 s6, 64
 s_cselect_b32 s71, s72, 0
 s_cmp_eq_u32 s71, -1
 s_cselect_b32 s70, 0, s70
 v_mov_b32 v5, s70
 v_mov_b32 v6, s95
 ds_write_b32 v6, v5
w0_337:
 v_mfma_f32_32x32x16_bf16 v[112:127], a[180:183], v[40:43], v[112:127]
 ds_read_b128 v[36:39], v12 offset:928
 s_waitcnt lgkmcnt(6)
 v_mfma_f32_32x32x16_bf16 v[96:111], a[184:187], v[44:47], v[96:111]
 v_mfma_f32_32x32x16_bf16 v[112:127], a[188:191], v[44:47], v[112:127]
 ds_read_b128 v[40:43], v12 offset:960
 s_waitcnt lgkmcnt(6)
 v_mfma_f32_32x32x16_bf16 v[96:111], a[192:195], v[16:19], v[96:111]
 v_mov_b32 v6, s95
 s_waitcnt lgkmcnt(2)
 s_barrier
 ds_read_b32 v61, v6
 s_xor_b32 s95, s95, 4
 v_mfma_f32_32x32x16_bf16 v[112:127], a[196:199], v[16:19], v[112:127]
 ds_read_b128 v[44:47], v12 offset:992
 s_waitcnt lgkmcnt(6)
 v_mfma_f32_32x32x16_bf16 v[96:111], a[200:203], v[20:23], v[96:111]
 v_mfma_f32_32x32x16_bf16 v[112:127], a[204:207], v[20:23], v[112:127]
 s_cbranch_vccz up_tail1
 ds_read_b128 v[16:19], v3 offset:0
 s_waitcnt lgkmcnt(6)
 v_mfma_f32_32x32x16_bf16 v[96:111], a[208:211], v[24:27], v[96:111]
 v_mfma_f32_32x32x16_bf16 v[112:127], a[212:215], v[24:27], v[112:127]
 ds_read_b128 v[20:23], v3 offset:32
 s_waitcnt lgkmcnt(6)
 v_mfma_f32_32x32x16_bf16 v[96:111], a[216:219], v[28:31], v[96:111]
 v_mfma_f32_32x32x16_bf16 v[112:127], a[220:223], v[28:31], v[112:127]
 ds_read_b128 v[24:27], v3 offset:64
 s_waitcnt lgkmcnt(6)
 v_mfma_f32_32x32x16_bf16 v[96:111], a[224:227], v[32:35], v[96:111]
 v_mfma_f32_32x32x16_bf16 v[112:127], a[228:231], v[32:35], v[112:127]
 ds_read_b128 v[28:31], v3 offset:96
 s_waitcnt lgkmcnt(6)
 v_mfma_f32_32x32x16_bf16 v[96:111], a[232:235], v[36:39], v[96:111]
 v_mfma_f32_32x32x16_bf16 v[112:127], a[236:239], v[36:39], v[112:127]
 ds_read_b128 v[32:35], v3 offset:128
 s_waitcnt lgkmcnt(6)
 v_mfma_f32_32x32x16_bf16 v[96:111], a[240:243], v[40:43], v[96:111]
 v_mfma_f32_32x32x16_bf16 v[112:127], a[244:247], v[40:43], v[112:127]
 s_mov_b32 s90, 1
 s_mov_b32 s91, s80
 s_mov_b32 s69, s101
 ds_read_b128 v[36:39], v3 offset:160
 s_waitcnt lgkmcnt(6)
 v_mfma_f32_32x32x16_bf16 v[96:111], a[248:251], v[44:47], v[96:111]
 v_mfma_f32_32x32x16_bf16 v[112:127], a[252:255], v[44:47], v[112:127]
 v_readfirstlane_b32 s94, v61
 s_cmp_ge_u32 s6, 64
 s_cselect_b32 s70, 0, s68
 s_cmp_lg_u32 s70, 0
 s_cbranch_scc1 up_run0
 s_mov_b32 s90, 2
 s_nop 7
 v_mul_f32 v160, s84, v96
 v_mul_f32 v161, s84, v97
 v_mul_f32 v162, s84, v98
 v_mul_f32 v163, s84, v99
 v_mul_f32 v164, s84, v100
 v_mul_f32 v165, s84, v101
 v_mul_f32 v166, s84, v102
 v_mul_f32 v167, s84, v103
 v_exp_f32 v160, v160
 v_exp_f32 v161, v161
 v_exp_f32 v162, v162
 v_exp_f32 v163, v163
 v_exp_f32 v164, v164
 v_exp_f32 v165, v165
 v_exp_f32 v166, v166
 v_exp_f32 v167, v167
 v_mul_f32 v96, v96, v112
 v_mul_f32 v97, v97, v113
 v_mul_f32 v98, v98, v114
 v_mul_f32 v99, v99, v115
 v_mul_f32 v100, v100, v116
 v_mul_f32 v101, v101, v117
 v_mul_f32 v102, v102, v118
 v_mul_f32 v103, v103, v119
 v_add_f32 v160, 1.0, v160
 v_add_f32 v161, 1.0, v161
 v_add_f32 v162, 1.0, v162
 v_add_f32 v163, 1.0, v163
 v_add_f32 v164, 1.0, v164
 v_add_f32 v165, 1.0, v165
 v_add_f32 v166, 1.0, v166
 v_add_f32 v167, 1.0, v167
 v_rcp_f32 v160, v160
 v_rcp_f32 v161, v161
 v_rcp_f32 v162, v162
 v_rcp_f32 v163, v163
 v_rcp_f32 v164, v164
 v_rcp_f32 v165, v165
 v_rcp_f32 v166, v166
 v_rcp_f32 v167, v167
 s_nop 0
 v_mul_f32 v96, v96, v160
 v_mul_f32 v97, v97, v161
 v_mul_f32 v98, v98, v162
 v_mul_f32 v99, v99, v163
 v_mul_f32 v100, v100, v164
 v_mul_f32 v101, v101, v165
 v_mul_f32 v102, v102, v166
 v_mul_f32 v103, v103, v167
 v_cvt_pk_bf16_f32 v128, v96, v97
 v_cvt_pk_bf16_f32 v129, v98, v99
 v_cvt_pk_bf16_f32 v130, v100, v101
 v_cvt_pk_bf16_f32 v131, v102, v103
 buffer_store_dwordx4 v[128:131], v2, s[52:55], s80 offen offset:0 sc1
 v_mul_f32 v168, s84, v104
 v_mul_f32 v169, s84, v105
 v_mul_f32 v170, s84, v106
 v_mul_f32 v171, s84, v107
 v_mul_f32 v172, s84, v108
 v_mul_f32 v173, s84, v109
 v_mul_f32 v174, s84, v110
 v_mul_f32 v175, s84, v111
 v_exp_f32 v168, v168
 v_exp_f32 v169, v169
 v_exp_f32 v170, v170
 v_exp_f32 v171, v171
 v_exp_f32 v172, v172
 v_exp_f32 v173, v173
 v_exp_f32 v174, v174
 v_exp_f32 v175, v175
 v_mul_f32 v104, v104, v120
 v_mul_f32 v105, v105, v121
 v_mul_f32 v106, v106, v122
 v_mul_f32 v107, v107, v123
 v_mul_f32 v108, v108, v124
 v_mul_f32 v109, v109, v125
 v_mul_f32 v110, v110, v126
 v_mul_f32 v111, v111, v127
 v_add_f32 v168, 1.0, v168
 v_add_f32 v169, 1.0, v169
 v_add_f32 v170, 1.0, v170
 v_add_f32 v171, 1.0, v171
 v_add_f32 v172, 1.0, v172
 v_add_f32 v173, 1.0, v173
 v_add_f32 v174, 1.0, v174
 v_add_f32 v175, 1.0, v175
 v_rcp_f32 v168, v168
 v_rcp_f32 v169, v169
 v_rcp_f32 v170, v170
 v_rcp_f32 v171, v171
 v_rcp_f32 v172, v172
 v_rcp_f32 v173, v173
 v_rcp_f32 v174, v174
 v_rcp_f32 v175, v175
 s_nop 0
 v_mul_f32 v104, v104, v168
 v_mul_f32 v105, v105, v169
 v_mul_f32 v106, v106, v170
 v_mul_f32 v107, v107, v171
 v_mul_f32 v108, v108, v172
 v_mul_f32 v109, v109, v173
 v_mul_f32 v110, v110, v174
 v_mul_f32 v111, v111, v175
 v_cvt_pk_bf16_f32 v132, v104, v105
 v_cvt_pk_bf16_f32 v133, v106, v107
 v_cvt_pk_bf16_f32 v134, v108, v109
 v_cvt_pk_bf16_f32 v135, v110, v111
 buffer_store_dwordx4 v[132:135], v2, s[52:55], s80 offen offset:1024 sc1
 s_branch up_run0
up_plain1:
 ds_read_b128 v[40:43], v12 offset:192
 s_waitcnt lgkmcnt(6)
 v_mfma_f32_32x32x16_bf16 v[96:111], a[0:3], v[16:19], 0
 s_mov_b32 s68, s4
 s_mov_b32 s67, s5
 s_mul_i32 s80, s68, 5636096
 s_add_u32 s80, s80, 148619264
 v_mfma_f32_32x32x16_bf16 v[112:127], a[4:7], v[16:19], 0
 s_mul_i32 s70, s67, 88064
 s_add_u32 s80, s80, s70
 s_lshl_b32 s70, s82, 11
 s_add_u32 s80, s80, s70
 ds_read_b128 v[44:47], v12 offset:224
 s_waitcnt lgkmcnt(6)
 v_mfma_f32_32x32x16_bf16 v[96:111], a[8:11], v[20:23], v[96:111]
 s_cmp_ge_u32 s82, 43
 s_cselect_b32 s80, 178765824, s80
 s_mul_i32 s101, s68, 65
 s_add_u32 s101, s101, s67
 s_barrier
 v_mfma_f32_32x32x16_bf16 v[112:127], a[12:15], v[20:23], v[112:127]
 s_lshl_b32 s101, s101, 8
 s_add_u32 s101, s101, 99840
 s_add_u32 s101, s101, s98
 ds_read_b128 v[16:19], v12 offset:256
 s_waitcnt lgkmcnt(6)
 v_mfma_f32_32x32x16_bf16 v[96:111], a[16:19], v[24:27], v[96:111]
 v_mfma_f32_32x32x16_bf16 v[112:127], a[20:23], v[24:27], v[112:127]
 ds_read_b128 v[20:23], v12 offset:288
 s_waitcnt lgkmcnt(6)
 v_mfma_f32_32x32x16_bf16 v[96:111], a[24:27], v[28:31], v[96:111]
 v_mfma_f32_32x32x16_bf16 v[112:127], a[28:31], v[28:31], v[112:127]
 ds_read_b128 v[24:27], v12 offset:320
 s_waitcnt lgkmcnt(6)
 v_mfma_f32_32x32x16_bf16 v[96:111], a[32:35], v[32:35], v[96:111]
 v_mfma_f32_32x32x16_bf16 v[112:127], a[36:39], v[32:35], v[112:127]
 ds_read_b128 v[28:31], v12 offset:352
 s_waitcnt lgkmcnt(6)
 v_mfma_f32_32x32x16_bf16 v[96:111], a[40:43], v[36:39], v[96:111]
 v_mfma_f32_32x32x16_bf16 v[112:127], a[44:47], v[36:39], v[112:127]
 ds_read_b128 v[32:35], v12 offset:384
 s_waitcnt lgkmcnt(6)
 v_mfma_f32_32x32x16_bf16 v[96:111], a[48:51], v[40:43], v[96:111]
 v_mfma_f32_32x32x16_bf16 v[112:127], a[52:55], v[40:43], v[112:127]
 ds_read_b128 v[36:39], v12 offset:416
 s_waitcnt lgkmcnt(6)
 v_mfma_f32_32x32x16_bf16 v[96:111], a[56:59], v[44:47], v[96:111]
 v_mfma_f32_32x32x16_bf16 v[112:127], a[60:63], v[44:47], v[112:127]
 ds_read_b128 v[40:43], v12 offset:448
 s_waitcnt lgkmcnt(6)
 v_mfma_f32_32x32x16_bf16 v[96:111], a[64:67], v[16:19], v[96:111]
 v_mfma_f32_32x32x16_bf16 v[112:127], a[68:71], v[16:19], v[112:127]
 ds_read_b128 v[44:47], v12 offset:480
 s_waitcnt lgkmcnt(6)
 v_mfma_f32_32x32x16_bf16 v[96:111], a[72:75], v[20:23], v[96:111]
 v_mfma_f32_32x32x16_bf16 v[112:127], a[76:79], v[20:23], v[112:127]
 ds_read_b128 v[16:19], v12 offset:512
 s_waitcnt lgkmcnt(6)
 v_mfma_f32_32x32x16_bf16 v[96:111], a[80:83], v[24:27], v[96:111]
 v_mfma_f32_32x32x16_bf16 v[112:127], a[84:87], v[24:27], v[112:127]
 ds_read_b128 v[20:23], v12 offset:544
 s_waitcnt lgkmcnt(6)
 v_mfma_f32_32x32x16_bf16 v[96:111], a[88:91], v[28:31], v[96:111]
 v_mfma_f32_32x32x16_bf16 v[112:127], a[92:95], v[28:31], v[112:127]
 ds_read_b128 v[24:27], v12 offset:576
 s_waitcnt lgkmcnt(6)
 v_mfma_f32_32x32x16_bf16 v[96:111], a[96:99], v[32:35], v[96:111]
 v_mfma_f32_32x32x16_bf16 v[112:127], a[100:103], v[32:35], v[112:127]
 ds_read_b128 v[28:31], v12 offset:608
 s_waitcnt lgkmcnt(6)
 v_mfma_f32_32x32x16_bf16 v[96:111], a[104:107], v[36:39], v[96:111]
 v_mfma_f32_32x32x16_bf16 v[112:127], a[108:111], v[36:39], v[112:127]
 ds_read_b128 v[32:35], v12 offset:640
 s_waitcnt lgkmcnt(6)
 v_mfma_f32_32x32x16_bf16 v[96:111], a[112:115], v[40:43], v[96:111]
 s_cmp_lg_u32 s3, 0
 s_cbranch_scc1 w0_338
 s_min_u32 s70, s6, 63
 s_min_u32 s71, s7, 63
 s_lshl_b32 s70, s70, 8
 s_lshl_b32 s71, s71, 8
 v_add_u32 v15, s70, v56
 s_mov_b32 exec_lo, 0
 v_add_u32 v15, s71, v56
 s_mov_b32 exec_lo, s87
 s_mov_b32 exec_hi, s87
 buffer_load_dwordx2 v[62:63], v15, s[52:55], 0 offen sc1
 s_mov_b64 exec, -1
w0_338:
 v_mfma_f32_32x32x16_bf16 v[112:127], a[116:119], v[40:43], v[112:127]
 ds_read_b128 v[36:39], v12 offset:672
 s_waitcnt lgkmcnt(6)
 v_mfma_f32_32x32x16_bf16 v[96:111], a[120:123], v[44:47], v[96:111]
 v_mfma_f32_32x32x16_bf16 v[112:127], a[124:127], v[44:47], v[112:127]
 ds_read_b128 v[40:43], v12 offset:704
 s_waitcnt lgkmcnt(6)
 v_mfma_f32_32x32x16_bf16 v[96:111], a[128:131], v[16:19], v[96:111]
 v_mfma_f32_32x32x16_bf16 v[112:127], a[132:135], v[16:19], v[112:127]
 ds_read_b128 v[44:47], v12 offset:736
 s_waitcnt lgkmcnt(6)
 v_mfma_f32_32x32x16_bf16 v[96:111], a[136:139], v[20:23], v[96:111]
 v_mfma_f32_32x32x16_bf16 v[112:127], a[140:143], v[20:23], v[112:127]
 ds_read_b128 v[16:19], v12 offset:768
 s_waitcnt lgkmcnt(6)
 v_mfma_f32_32x32x16_bf16 v[96:111], a[144:147], v[24:27], v[96:111]
 v_mfma_f32_32x32x16_bf16 v[112:127], a[148:151], v[24:27], v[112:127]
 ds_read_b128 v[20:23], v12 offset:800
 s_waitcnt lgkmcnt(6)
 v_mfma_f32_32x32x16_bf16 v[96:111], a[152:155], v[28:31], v[96:111]
 v_mfma_f32_32x32x16_bf16 v[112:127], a[156:159], v[28:31], v[112:127]
 ds_read_b128 v[24:27], v12 offset:832
 s_waitcnt lgkmcnt(6)
 v_mfma_f32_32x32x16_bf16 v[96:111], a[160:163], v[32:35], v[96:111]
 v_mfma_f32_32x32x16_bf16 v[112:127], a[164:167], v[32:35], v[112:127]
 ds_read_b128 v[28:31], v12 offset:864
 s_waitcnt lgkmcnt(6)
 v_mfma_f32_32x32x16_bf16 v[96:111], a[168:171], v[36:39], v[96:111]
 v_mfma_f32_32x32x16_bf16 v[112:127], a[172:175], v[36:39], v[112:127]
 ds_read_b128 v[32:35], v12 offset:896
 s_waitcnt lgkmcnt(6)
 v_mfma_f32_32x32x16_bf16 v[96:111], a[176:179], v[40:43], v[96:111]
 s_cmp_lg_u32 s3, 0
 s_cbranch_scc1 w0_339
 s_waitcnt vmcnt(0)
 v_cmp_ge_u32 s[72:73], v62, v57
 v_cmp_ge_u32 s[74:75], v63, v58
 s_and_b64 s[72:73], s[72:73], s[74:75]
 s_mov_b32 s70, 2
 s_cmp_lt_u32 s7, 64
 s_cselect_b32 s71, s73, 0
 s_cmp_eq_u32 s71, -1
 s_cselect_b32 s70, 1, s70
 s_cmp_lt_u32 s6, 64
 s_cselect_b32 s71, s72, 0
 s_cmp_eq_u32 s71, -1
 s_cselect_b32 s70, 0, s70
 v_mov_b32 v5, s70
 v_mov_b32 v6, s95
 ds_write_b32 v6, v5
w0_339:
 v_mfma_f32_32x32x16_bf16 v[112:127], a[180:183], v[40:43], v[112:127]
 ds_read_b128 v[36:39], v12 offset:928
 s_waitcnt lgkmcnt(6)
 v_mfma_f32_32x32x16_bf16 v[96:111], a[184:187], v[44:47], v[96:111]
 v_mfma_f32_32x32x16_bf16 v[112:127], a[188:191], v[44:47], v[112:127]
 ds_read_b128 v[40:43], v12 offset:960
 s_waitcnt lgkmcnt(6)
 v_mfma_f32_32x32x16_bf16 v[96:111], a[192:195], v[16:19], v[96:111]
 v_mov_b32 v6, s95
 s_waitcnt lgkmcnt(2)
 s_barrier
 ds_read_b32 v61, v6
 s_xor_b32 s95, s95, 4
 v_mfma_f32_32x32x16_bf16 v[112:127], a[196:199], v[16:19], v[112:127]
 ds_read_b128 v[44:47], v12 offset:992
 s_waitcnt lgkmcnt(6)
 v_mfma_f32_32x32x16_bf16 v[96:111], a[200:203], v[20:23], v[96:111]
 v_mfma_f32_32x32x16_bf16 v[112:127], a[204:207], v[20:23], v[112:127]
up_tail1:
 s_waitcnt lgkmcnt(5)
 v_mfma_f32_32x32x16_bf16 v[96:111], a[208:211], v[24:27], v[96:111]
 v_mfma_f32_32x32x16_bf16 v[112:127], a[212:215], v[24:27], v[112:127]
 s_waitcnt lgkmcnt(4)
 v_mfma_f32_32x32x16_bf16 v[96:111], a[216:219], v[28:31], v[96:111]
 v_mfma_f32_32x32x16_bf16 v[112:127], a[220:223], v[28:31], v[112:127]
 s_waitcnt lgkmcnt(3)
 v_mfma_f32_32x32x16_bf16 v[96:111], a[224:227], v[32:35], v[96:111]
 v_mfma_f32_32x32x16_bf16 v[112:127], a[228:231], v[32:35], v[112:127]
 s_waitcnt lgkmcnt(2)
 v_mfma_f32_32x32x16_bf16 v[96:111], a[232:235], v[36:39], v[96:111]
 v_mfma_f32_32x32x16_bf16 v[112:127], a[236:239], v[36:39], v[112:127]
 s_waitcnt lgkmcnt(1)
 v_mfma_f32_32x32x16_bf16 v[96:111], a[240:243], v[40:43], v[96:111]
 v_mfma_f32_32x32x16_bf16 v[112:127], a[244:247], v[40:43], v[112:127]
 s_waitcnt lgkmcnt(0)
 v_mfma_f32_32x32x16_bf16 v[96:111], a[248:251], v[44:47], v[96:111]
 v_mfma_f32_32x32x16_bf16 v[112:127], a[252:255], v[44:47], v[112:127]
 v_readfirstlane_b32 s94, v61
 s_mov_b32 s88, s6
 s_mov_b32 s89, s7
 s_add_u32 s88, s88, 2
 s_add_u32 s70, s89, 1
 s_cmp_lt_u32 s70, 36
 s_cselect_b32 s70, s70, s66
 s_add_u32 s71, s89, 4
 s_cmp_lt_u32 s89, 36
 s_cselect_b32 s89, s70, s71
 s_and_b32 s4, s94, 1
 s_cmp_eq_u32 s94, 0
 s_cselect_b32 s5, s6, s7
 s_cselect_b32 s6, s88, s6
 s_cmp_eq_u32 s94, 1
 s_cselect_b32 s7, s89, s7
 s_mov_b32 s78, 0
 s_mul_i32 s81, s4, 2097152
 s_add_u32 s81, s81, 144424960
 s_lshl_b32 s70, s5, 15
 s_add_u32 s81, s81, s70
 s_mul_i32 s96, s3, 8320
 s_add_u32 s96, s96, s78
 s_lshl_b32 s97, s3, 13
 s_add_u32 s97, s97, s81
 s_sub_u32 s97, s97, 1024
 v_mul_f32 v160, s84, v96
 v_mul_f32 v161, s84, v97
 v_mul_f32 v162, s84, v98
 v_mul_f32 v163, s84, v99
 v_mul_f32 v164, s84, v100
 v_mul_f32 v165, s84, v101
 v_mul_f32 v166, s84, v102
 v_mul_f32 v167, s84, v103
 v_exp_f32 v160, v160
 v_exp_f32 v161, v161
 v_exp_f32 v162, v162
 v_exp_f32 v163, v163
 v_exp_f32 v164, v164
 v_exp_f32 v165, v165
 v_exp_f32 v166, v166
 v_exp_f32 v167, v167
 v_mul_f32 v96, v96, v112
 v_mul_f32 v97, v97, v113
 v_mul_f32 v98, v98, v114
 v_mul_f32 v99, v99, v115
 v_mul_f32 v100, v100, v116
 v_mul_f32 v101, v101, v117
 v_mul_f32 v102, v102, v118
 v_mul_f32 v103, v103, v119
 v_add_f32 v160, 1.0, v160
 v_add_f32 v161, 1.0, v161
 v_add_f32 v162, 1.0, v162
 v_add_f32 v163, 1.0, v163
 v_add_f32 v164, 1.0, v164
 v_add_f32 v165, 1.0, v165
 v_add_f32 v166, 1.0, v166
 v_add_f32 v167, 1.0, v167
 v_rcp_f32 v160, v160
 v_rcp_f32 v161, v161
 v_rcp_f32 v162, v162
 v_rcp_f32 v163, v163
 v_rcp_f32 v164, v164
 v_rcp_f32 v165, v165
 v_rcp_f32 v166, v166
 v_rcp_f32 v167, v167
 s_nop 0
 v_mul_f32 v96, v96, v160
 v_mul_f32 v97, v97, v161
 v_mul_f32 v98, v98, v162
 v_mul_f32 v99, v99, v163
 v_mul_f32 v100, v100, v164
 v_mul_f32 v101, v101, v165
 v_mul_f32 v102, v102, v166
 v_mul_f32 v103, v103, v167
 v_cvt_pk_bf16_f32 v128, v96, v97
 v_cvt_pk_bf16_f32 v129, v98, v99
 v_cvt_pk_bf16_f32 v130, v100, v101
 v_cvt_pk_bf16_f32 v131, v102, v103
 buffer_store_dwordx4 v[128:131], v2, s[52:55], s80 offen offset:0 sc1
 v_mul_f32 v168, s84, v104
 v_mul_f32 v169, s84, v105
 v_mul_f32 v170, s84, v106
 v_mul_f32 v171, s84, v107
 v_mul_f32 v172, s84, v108
 v_mul_f32 v173, s84, v109
 v_mul_f32 v174, s84, v110
 v_mul_f32 v175, s84, v111
 v_exp_f32 v168, v168
 v_exp_f32 v169, v169
 v_exp_f32 v170, v170
 v_exp_f32 v171, v171
 v_exp_f32 v172, v172
 v_exp_f32 v173, v173
 v_exp_f32 v174, v174
 v_exp_f32 v175, v175
 v_mul_f32 v104, v104, v120
 v_mul_f32 v105, v105, v121
 v_mul_f32 v106, v106, v122
 v_mul_f32 v107, v107, v123
 v_mul_f32 v108, v108, v124
 v_mul_f32 v109, v109, v125
 v_mul_f32 v110, v110, v126
 v_mul_f32 v111, v111, v127
 v_add_f32 v168, 1.0, v168
 v_add_f32 v169, 1.0, v169
 v_add_f32 v170, 1.0, v170
 v_add_f32 v171, 1.0, v171
 v_add_f32 v172, 1.0, v172
 v_add_f32 v173, 1.0, v173
 v_add_f32 v174, 1.0, v174
 v_add_f32 v175, 1.0, v175
 v_rcp_f32 v168, v168
 v_rcp_f32 v169, v169
 v_rcp_f32 v170, v170
 v_rcp_f32 v171, v171
 v_rcp_f32 v172, v172
 v_rcp_f32 v173, v173
 v_rcp_f32 v174, v174
 v_rcp_f32 v175, v175
 s_nop 0
 v_mul_f32 v104, v104, v168
 v_mul_f32 v105, v105, v169
 v_mul_f32 v106, v106, v170
 v_mul_f32 v107, v107, v171
 v_mul_f32 v108, v108, v172
 v_mul_f32 v109, v109, v173
 v_mul_f32 v110, v110, v174
 v_mul_f32 v111, v111, v175
 v_cvt_pk_bf16_f32 v132, v104, v105
 v_cvt_pk_bf16_f32 v133, v106, v107
 v_cvt_pk_bf16_f32 v134, v108, v109
 v_cvt_pk_bf16_f32 v135, v110, v111
 buffer_store_dwordx4 v[132:135], v2, s[52:55], s80 offen offset:1024 sc1
 s_cmp_ge_u32 s94, 2
 s_cbranch_scc1 up_idle1
 s_add_u32 m0, s96, 0
 s_add_u32 s97, s97, 1024
 buffer_load_dwordx4 v2, s[52:55], s97 offen sc1 lds
 s_add_u32 m0, s96, 1040
 s_add_u32 s97, s97, 1024
 buffer_load_dwordx4 v2, s[52:55], s97 offen sc1 lds
 s_add_u32 m0, s96, 2080
 s_add_u32 s97, s97, 1024
 buffer_load_dwordx4 v2, s[52:55], s97 offen sc1 lds
 s_add_u32 m0, s96, 3120
 s_add_u32 s97, s97, 1024
 buffer_load_dwordx4 v2, s[52:55], s97 offen sc1 lds
 s_add_u32 m0, s96, 4160
 s_add_u32 s97, s97, 1024
 buffer_load_dwordx4 v2, s[52:55], s97 offen sc1 lds
 s_add_u32 m0, s96, 5200
 s_add_u32 s97, s97, 1024
 buffer_load_dwordx4 v2, s[52:55], s97 offen sc1 lds
 s_add_u32 m0, s96, 6240
 s_add_u32 s97, s97, 1024
 buffer_load_dwordx4 v2, s[52:55], s97 offen sc1 lds
 s_add_u32 m0, s96, 7280
 s_add_u32 s97, s97, 1024
 buffer_load_dwordx4 v2, s[52:55], s97 offen sc1 lds
 s_waitcnt vmcnt(8)
 s_mov_b64 exec, 1
 buffer_store_dword v0, v10, s[52:55], s101 offen sc1
 s_mov_b64 exec, -1
 s_branch sc_344
up_idle1:
 s_mov_b32 s83, 0x200000
 s_cmp_lg_u32 s3, 0
 s_cbranch_scc1 nw_346
 s_min_u32 s70, s6, 63
 s_min_u32 s71, s7, 63
 s_lshl_b32 s70, s70, 8
 s_lshl_b32 s71, s71, 8
 v_add_u32 v15, s70, v56
 s_mov_b32 exec_lo, 0
 v_add_u32 v15, s71, v56
 s_mov_b32 exec_lo, s87
 s_mov_b32 exec_hi, s87
 buffer_load_dwordx2 v[62:63], v15, s[52:55], 0 offen sc1
 s_mov_b64 exec, -1
 s_waitcnt vmcnt(1)
 s_mov_b64 exec, 1
 buffer_store_dword v0, v10, s[52:55], s101 offen sc1
 s_mov_b64 exec, -1
 s_min_u32 s70, s6, s7
 s_cmp_ge_u32 s70, 64
 s_cbranch_scc1 k_exit
 s_waitcnt vmcnt(1)
 s_branch ev_345
nw_346:
 s_waitcnt vmcnt(0)
 s_mov_b64 exec, 1
 buffer_store_dword v0, v10, s[52:55], s101 offen sc1
 s_mov_b64 exec, -1
up_sched0:
 s_min_u32 s70, s6, s7
 s_cmp_ge_u32 s70, 64
 s_cbranch_scc1 k_exit
 s_cmp_lg_u32 s3, 0
 s_cbranch_scc1 sc_340
 s_mov_b32 s83, 0x200000
sc_341:
 s_min_u32 s70, s6, 63
 s_min_u32 s71, s7, 63
 s_lshl_b32 s70, s70, 8
 s_lshl_b32 s71, s71, 8
 v_add_u32 v15, s70, v56
 s_mov_b32 exec_lo, 0
 v_add_u32 v15, s71, v56
 s_mov_b32 exec_lo, s87
 s_mov_b32 exec_hi, s87
 buffer_load_dwordx2 v[62:63], v15, s[52:55], 0 offen sc1
 s_mov_b64 exec, -1
 s_waitcnt vmcnt(0)
ev_345:
 v_cmp_ge_u32 s[72:73], v62, v57
 v_cmp_ge_u32 s[74:75], v63, v58
 s_and_b64 s[72:73], s[72:73], s[74:75]
 s_mov_b32 s70, 2
 s_cmp_lt_u32 s7, 64
 s_cselect_b32 s71, s73, 0
 s_cmp_eq_u32 s71, -1
 s_cselect_b32 s70, 1, s70
 s_cmp_lt_u32 s6, 64
 s_cselect_b32 s71, s72, 0
 s_cmp_eq_u32 s71, -1
 s_cselect_b32 s70, 0, s70
 s_cmp_lt_u32 s70, 2
 s_cbranch_scc1 sc_342
 s_sub_u32 s83, s83, 1
 s_cmp_lg_u32 s83, 0
 s_cbranch_scc1 sc_341
 s_mov_b32 s70, 3
sc_342:
 v_mov_b32 v5, s70
 v_mov_b32 v6, 163832
 ds_write_b32 v6, v5
 s_waitcnt lgkmcnt(0)
sc_340:
 s_barrier
 v_mov_b32 v6, 163832
 ds_read_b32 v61, v6
 s_waitcnt lgkmcnt(0)
 v_readfirstlane_b32 s94, v61
 s_cmp_ge_u32 s94, 2
 s_cbranch_scc1 k_exit
 s_mov_b32 s88, s6
 s_mov_b32 s89, s7
 s_add_u32 s88, s88, 2
 s_add_u32 s70, s89, 1
 s_cmp_lt_u32 s70, 36
 s_cselect_b32 s70, s70, s66
 s_add_u32 s71, s89, 4
 s_cmp_lt_u32 s89, 36
 s_cselect_b32 s89, s70, s71
 s_and_b32 s4, s94, 1
 s_cmp_eq_u32 s94, 0
 s_cselect_b32 s5, s6, s7
 s_cselect_b32 s6, s88, s6
 s_cmp_eq_u32 s94, 1
 s_cselect_b32 s7, s89, s7
 s_mov_b32 s78, 0
 s_mul_i32 s81, s4, 2097152
 s_add_u32 s81, s81, 144424960
 s_lshl_b32 s70, s5, 15
 s_add_u32 s81, s81, s70
 s_mul_i32 s96, s3, 8320
 s_add_u32 s96, s96, s78
 s_lshl_b32 s97, s3, 13
 s_add_u32 s97, s97, s81
 s_sub_u32 s97, s97, 1024
 s_add_u32 m0, s96, 0
 s_add_u32 s97, s97, 1024
 buffer_load_dwordx4 v2, s[52:55], s97 offen sc1 lds
 s_add_u32 m0, s96, 1040
 s_add_u32 s97, s97, 1024
 buffer_load_dwordx4 v2, s[52:55], s97 offen sc1 lds
 s_add_u32 m0, s96, 2080
 s_add_u32 s97, s97, 1024
 buffer_load_dwordx4 v2, s[52:55], s97 offen sc1 lds
 s_add_u32 m0, s96, 3120
 s_add_u32 s97, s97, 1024
 buffer_load_dwordx4 v2, s[52:55], s97 offen sc1 lds
 s_add_u32 m0, s96, 4160
 s_add_u32 s97, s97, 1024
 buffer_load_dwordx4 v2, s[52:55], s97 offen sc1 lds
 s_add_u32 m0, s96, 5200
 s_add_u32 s97, s97, 1024
 buffer_load_dwordx4 v2, s[52:55], s97 offen sc1 lds
 s_add_u32 m0, s96, 6240
 s_add_u32 s97, s97, 1024
 buffer_load_dwordx4 v2, s[52:55], s97 offen sc1 lds
 s_add_u32 m0, s96, 7280
 s_add_u32 s97, s97, 1024
 buffer_load_dwordx4 v2, s[52:55], s97 offen sc1 lds
sc_344:
 s_cmp_lg_u32 s3, 0
 s_cbranch_scc1 sc_343
 s_min_u32 s70, s6, 63
 s_min_u32 s71, s7, 63
 s_lshl_b32 s70, s70, 8
 s_lshl_b32 s71, s71, 8
 v_add_u32 v15, s70, v56
 s_mov_b32 exec_lo, 0
 v_add_u32 v15, s71, v56
 s_mov_b32 exec_lo, s87
 s_mov_b32 exec_hi, s87
 buffer_load_dwordx2 v[62:63], v15, s[52:55], 0 offen sc1
 s_mov_b64 exec, -1
 s_waitcnt vmcnt(0)
 v_cmp_ge_u32 s[72:73], v62, v57
 v_cmp_ge_u32 s[74:75], v63, v58
 s_and_b64 s[72:73], s[72:73], s[74:75]
 s_mov_b32 s70, 2
 s_cmp_lt_u32 s7, 64
 s_cselect_b32 s71, s73, 0
 s_cmp_eq_u32 s71, -1
 s_cselect_b32 s70, 1, s70
 s_cmp_lt_u32 s6, 64
 s_cselect_b32 s71, s72, 0
 s_cmp_eq_u32 s71, -1
 s_cselect_b32 s70, 0, s70
 v_mov_b32 v5, s70
 v_mov_b32 v6, s95
 ds_write_b32 v6, v5
 s_waitcnt lgkmcnt(0)
sc_343:
 s_waitcnt vmcnt(0)
 v_mov_b32 v6, s95
 s_barrier
 ds_read_b32 v61, v6
 s_xor_b32 s95, s95, 4
 s_waitcnt lgkmcnt(0)
 v_readfirstlane_b32 s94, v61
 s_branch up_pro0
role_down:
 s_mov_b32 s56, s40
 s_mov_b32 s57, s41
 s_mov_b32 s58, 1409024
 s_mov_b32 s59, 0x00020000
 s_mov_b32 s60, s40
 s_mov_b32 s61, s41
 s_mov_b32 s62, 1409024
 s_mov_b32 s63, 0x00020000
 s_lshr_b32 s82, s64, 1
 s_mul_i32 s76, s82, 704512
 s_and_b32 s70, s64, 1
 s_lshl_b32 s70, s70, 9
 s_add_u32 s76, s76, s70
 s_lshl_b32 s70, s3, 7
 s_add_u32 s76, s76, s70
 s_add_u32 s77, s76, 64
 v_lshrrev_b32 v5, 2, v1
 s_mov_b32 s70, 1024
 v_mul_lo_u32 v5, v5, s70
 v_and_b32 v6, 3, v1
 v_lshl_add_u32 v10, v6, 4, v5
 v_lshrrev_b32 v5, 5, v1
 v_lshlrev_b32 v5, 8, v5
 v_bfe_u32 v7, v1, 2, 2
 v_lshl_add_u32 v5, v7, 6, v5
 v_bfe_u32 v7, v1, 4, 1
 v_lshl_add_u32 v5, v7, 5, v5
 v_and_b32 v7, 1, v1
 v_lshl_add_u32 v5, v7, 4, v5
 v_bfe_u32 v7, v1, 1, 1
 v_lshl_add_u32 v5, v7, 3, v5
 s_lshl_b32 s71, s3, 15
 v_add_u32 v9, s71, v5
 s_add_u32 m0, s71, 0
 s_nop 0
 buffer_load_dwordx4 v10, s[56:59], s76 offen lds
 s_add_u32 s76, s76, 16384
 s_add_u32 m0, s71, 8192
 s_nop 0
 buffer_load_dwordx4 v10, s[60:63], s77 offen lds
 s_add_u32 s77, s77, 16384
 s_add_u32 m0, s71, 1024
 s_nop 0
 buffer_load_dwordx4 v10, s[56:59], s76 offen lds
 s_add_u32 s76, s76, 16384
 s_add_u32 m0, s71, 9216
 s_nop 0
 buffer_load_dwordx4 v10, s[60:63], s77 offen lds
 s_add_u32 s77, s77, 16384
 s_add_u32 m0, s71, 2048
 s_nop 0
 buffer_load_dwordx4 v10, s[56:59], s76 offen lds
 s_add_u32 s76, s76, 16384
 s_add_u32 m0, s71, 10240
 s_nop 0
 buffer_load_dwordx4 v10, s[60:63], s77 offen lds
 s_add_u32 s77, s77, 16384
 s_add_u32 m0, s71, 3072
 s_nop 0
 buffer_load_dwordx4 v10, s[56:59], s76 offen lds
 s_add_u32 s76, s76, 16384
 s_add_u32 m0, s71, 11264
 s_nop 0
 buffer_load_dwordx4 v10, s[60:63], s77 offen lds
 s_add_u32 s77, s77, 16384
 s_add_u32 m0, s71, 4096
 s_nop 0
 buffer_load_dwordx4 v10, s[56:59], s76 offen lds
 s_add_u32 s76, s76, 16384
 s_add_u32 m0, s71, 12288
 s_nop 0
 buffer_load_dwordx4 v10, s[60:63], s77 offen lds
 s_add_u32 s77, s77, 16384
 s_add_u32 m0, s71, 5120
 s_nop 0
 buffer_load_dwordx4 v10, s[56:59], s76 offen lds
 s_add_u32 s76, s76, 16384
 s_add_u32 m0, s71, 13312
 s_nop 0
 buffer_load_dwordx4 v10, s[60:63], s77 offen lds
 s_add_u32 s77, s77, 16384
 s_add_u32 m0, s71, 6144
 s_nop 0
 buffer_load_dwordx4 v10, s[56:59], s76 offen lds
 s_add_u32 s76, s76, 16384
 s_add_u32 m0, s71, 14336
 s_nop 0
 buffer_load_dwordx4 v10, s[60:63], s77 offen lds
 s_add_u32 s77, s77, 16384
 s_add_u32 m0, s71, 7168
 s_nop 0
 buffer_load_dwordx4 v10, s[56:59], s76 offen lds
 s_add_u32 s76, s76, 16384
 s_add_u32 m0, s71, 15360
 s_nop 0
 buffer_load_dwordx4 v10, s[60:63], s77 offen lds
 s_add_u32 s77, s77, 16384
 s_add_u32 m0, s71, 16384
 s_nop 0
 buffer_load_dwordx4 v10, s[56:59], s76 offen lds
 s_add_u32 s76, s76, 16384
 s_add_u32 m0, s71, 24576
 s_nop 0
 buffer_load_dwordx4 v10, s[60:63], s77 offen lds
 s_add_u32 s77, s77, 16384
 s_add_u32 m0, s71, 17408
 s_nop 0
 buffer_load_dwordx4 v10, s[56:59], s76 offen lds
 s_add_u32 s76, s76, 16384
 s_add_u32 m0, s71, 25600
 s_nop 0
 buffer_load_dwordx4 v10, s[60:63], s77 offen lds
 s_add_u32 s77, s77, 16384
 s_add_u32 m0, s71, 18432
 s_nop 0
 buffer_load_dwordx4 v10, s[56:59], s76 offen lds
 s_add_u32 s76, s76, 16384
 s_add_u32 m0, s71, 26624
 s_nop 0
 buffer_load_dwordx4 v10, s[60:63], s77 offen lds
 s_add_u32 s77, s77, 16384
 s_add_u32 m0, s71, 19456
 s_nop 0
 buffer_load_dwordx4 v10, s[56:59], s76 offen lds
 s_add_u32 s76, s76, 16384
 s_add_u32 m0, s71, 27648
 s_nop 0
 buffer_load_dwordx4 v10, s[60:63], s77 offen lds
 s_add_u32 s77, s77, 16384
 s_add_u32 m0, s71, 20480
 s_nop 0
 buffer_load_dwordx4 v10, s[56:59], s76 offen lds
 s_add_u32 s76, s76, 16384
 s_add_u32 m0, s71, 28672
 s_nop 0
 buffer_load_dwordx4 v10, s[60:63], s77 offen lds
 s_add_u32 s77, s77, 16384
 s_add_u32 m0, s71, 21504
 s_nop 0
 buffer_load_dwordx4 v10, s[56:59], s76 offen lds
 s_add_u32 s76, s76, 16384
 s_add_u32 m0, s71, 29696
 s_nop 0
 buffer_load_dwordx4 v10, s[60:63], s77 offen lds
 s_add_u32 s77, s77, 16384
 s_add_u32 m0, s71, 22528
 s_nop 0
 buffer_load_dwordx4 v10, s[56:59], s76 offen lds
 s_add_u32 s76, s76, 16384
 s_add_u32 m0, s71, 30720
 s_nop 0
 buffer_load_dwordx4 v10, s[60:63], s77 offen lds
 s_add_u32 s77, s77, 16384
 s_add_u32 m0, s71, 23552
 s_nop 0
 buffer_load_dwordx4 v10, s[56:59], s76 offen lds
 s_add_u32 s76, s76, 16384
 s_add_u32 m0, s71, 31744
 s_nop 0
 buffer_load_dwordx4 v10, s[60:63], s77 offen lds
 s_add_u32 s77, s77, 16384
 s_waitcnt vmcnt(16)
 ds_read_b64_tr_b16 a[0:1], v9 offset:0
 ds_read_b64_tr_b16 a[2:3], v9 offset:512
 ds_read_b64_tr_b16 a[4:5], v9 offset:8192
 ds_read_b64_tr_b16 a[6:7], v9 offset:8704
 ds_read_b64_tr_b16 a[8:9], v9 offset:1024
 ds_read_b64_tr_b16 a[10:11], v9 offset:1536
 ds_read_b64_tr_b16 a[12:13], v9 offset:9216
 ds_read_b64_tr_b16 a[14:15], v9 offset:9728
 ds_read_b64_tr_b16 a[16:17], v9 offset:2048
 ds_read_b64_tr_b16 a[18:19], v9 offset:2560
 ds_read_b64_tr_b16 a[20:21], v9 offset:10240
 ds_read_b64_tr_b16 a[22:23], v9 offset:10752
 ds_read_b64_tr_b16 a[24:25], v9 offset:3072
 ds_read_b64_tr_b16 a[26:27], v9 offset:3584
 ds_read_b64_tr_b16 a[28:29], v9 offset:11264
 ds_read_b64_tr_b16 a[30:31], v9 offset:11776
 ds_read_b64_tr_b16 a[32:33], v9 offset:4096
 ds_read_b64_tr_b16 a[34:35], v9 offset:4608
 ds_read_b64_tr_b16 a[36:37], v9 offset:12288
 ds_read_b64_tr_b16 a[38:39], v9 offset:12800
 ds_read_b64_tr_b16 a[40:41], v9 offset:5120
 ds_read_b64_tr_b16 a[42:43], v9 offset:5632
 ds_read_b64_tr_b16 a[44:45], v9 offset:13312
 ds_read_b64_tr_b16 a[46:47], v9 offset:13824
 ds_read_b64_tr_b16 a[48:49], v9 offset:6144
 ds_read_b64_tr_b16 a[50:51], v9 offset:6656
 ds_read_b64_tr_b16 a[52:53], v9 offset:14336
 ds_read_b64_tr_b16 a[54:55], v9 offset:14848
 ds_read_b64_tr_b16 a[56:57], v9 offset:7168
 ds_read_b64_tr_b16 a[58:59], v9 offset:7680
 ds_read_b64_tr_b16 a[60:61], v9 offset:15360
 ds_read_b64_tr_b16 a[62:63], v9 offset:15872
 s_waitcnt lgkmcnt(0)
 s_add_u32 m0, s71, 0
 s_nop 0
 buffer_load_dwordx4 v10, s[56:59], s76 offen lds
 s_add_u32 s76, s76, 16384
 s_add_u32 m0, s71, 8192
 s_nop 0
 buffer_load_dwordx4 v10, s[60:63], s77 offen lds
 s_add_u32 s77, s77, 16384
 s_add_u32 m0, s71, 1024
 s_nop 0
 buffer_load_dwordx4 v10, s[56:59], s76 offen lds
 s_add_u32 s76, s76, 16384
 s_add_u32 m0, s71, 9216
 s_nop 0
 buffer_load_dwordx4 v10, s[60:63], s77 offen lds
 s_add_u32 s77, s77, 16384
 s_add_u32 m0, s71, 2048
 s_nop 0
 buffer_load_dwordx4 v10, s[56:59], s76 offen lds
 s_add_u32 s76, s76, 16384
 s_add_u32 m0, s71, 10240
 s_nop 0
 buffer_load_dwordx4 v10, s[60:63], s77 offen lds
 s_add_u32 s77, s77, 16384
 s_add_u32 m0, s71, 3072
 s_nop 0
 buffer_load_dwordx4 v10, s[56:59], s76 offen lds
 s_add_u32 s76, s76, 16384
 s_add_u32 m0, s71, 11264
 s_nop 0
 buffer_load_dwordx4 v10, s[60:63], s77 offen lds
 s_add_u32 s77, s77, 16384
 s_add_u32 m0, s71, 4096
 s_nop 0
 buffer_load_dwordx4 v10, s[56:59], s76 offen lds
 s_add_u32 s76, s76, 16384
 s_add_u32 m0, s71, 12288
 s_nop 0
 buffer_load_dwordx4 v10, s[60:63], s77 offen lds
 s_add_u32 s77, s77, 16384
 s_add_u32 m0, s71, 5120
 s_nop 0
 buffer_load_dwordx4 v10, s[56:59], s76 offen lds
 s_add_u32 s76, s76, 16384
 s_add_u32 m0, s71, 13312
 s_nop 0
 buffer_load_dwordx4 v10, s[60:63], s77 offen lds
 s_add_u32 s77, s77, 16384
 s_add_u32 m0, s71, 6144
 s_nop 0
 buffer_load_dwordx4 v10, s[56:59], s76 offen lds
 s_add_u32 s76, s76, 16384
 s_add_u32 m0, s71, 14336
 s_nop 0
 buffer_load_dwordx4 v10, s[60:63], s77 offen lds
 s_add_u32 s77, s77, 16384
 s_add_u32 m0, s71, 7168
 s_nop 0
 buffer_load_dwordx4 v10, s[56:59], s76 offen lds
 s_add_u32 s76, s76, 16384
 s_add_u32 m0, s71, 15360
 s_nop 0
 buffer_load_dwordx4 v10, s[60:63], s77 offen lds
 s_add_u32 s77, s77, 16384
 s_waitcnt vmcnt(16)
 ds_read_b64_tr_b16 a[64:65], v9 offset:16384
 ds_read_b64_tr_b16 a[66:67], v9 offset:16896
 ds_read_b64_tr_b16 a[68:69], v9 offset:24576
 ds_read_b64_tr_b16 a[70:71], v9 offset:25088
 ds_read_b64_tr_b16 a[72:73], v9 offset:17408
 ds_read_b64_tr_b16 a[74:75], v9 offset:17920
 ds_read_b64_tr_b16 a[76:77], v9 offset:25600
 ds_read_b64_tr_b16 a[78:79], v9 offset:26112
 ds_read_b64_tr_b16 a[80:81], v9 offset:18432
 ds_read_b64_tr_b16 a[82:83], v9 offset:18944
 ds_read_b64_tr_b16 a[84:85], v9 offset:26624
 ds_read_b64_tr_b16 a[86:87], v9 offset:27136
 ds_read_b64_tr_b16 a[88:89], v9 offset:19456
 ds_read_b64_tr_b16 a[90:91], v9 offset:19968
 ds_read_b64_tr_b16 a[92:93], v9 offset:27648
 ds_read_b64_tr_b16 a[94:95], v9 offset:28160
 ds_read_b64_tr_b16 a[96:97], v9 offset:20480
 ds_read_b64_tr_b16 a[98:99], v9 offset:20992
 ds_read_b64_tr_b16 a[100:101], v9 offset:28672
 ds_read_b64_tr_b16 a[102:103], v9 offset:29184
 ds_read_b64_tr_b16 a[104:105], v9 offset:21504
 ds_read_b64_tr_b16 a[106:107], v9 offset:22016
 ds_read_b64_tr_b16 a[108:109], v9 offset:29696
 ds_read_b64_tr_b16 a[110:111], v9 offset:30208
 ds_read_b64_tr_b16 a[112:113], v9 offset:22528
 ds_read_b64_tr_b16 a[114:115], v9 offset:23040
 ds_read_b64_tr_b16 a[116:117], v9 offset:30720
 ds_read_b64_tr_b16 a[118:119], v9 offset:31232
 ds_read_b64_tr_b16 a[120:121], v9 offset:23552
 ds_read_b64_tr_b16 a[122:123], v9 offset:24064
 ds_read_b64_tr_b16 a[124:125], v9 offset:31744
 ds_read_b64_tr_b16 a[126:127], v9 offset:32256
 s_waitcnt lgkmcnt(0)
 s_add_u32 m0, s71, 16384
 s_nop 0
 buffer_load_dwordx4 v10, s[56:59], s76 offen lds
 s_add_u32 s76, s76, 16384
 s_add_u32 m0, s71, 24576
 s_nop 0
 buffer_load_dwordx4 v10, s[60:63], s77 offen lds
 s_add_u32 s77, s77, 16384
 s_add_u32 m0, s71, 17408
 s_nop 0
 buffer_load_dwordx4 v10, s[56:59], s76 offen lds
 s_add_u32 s76, s76, 16384
 s_add_u32 m0, s71, 25600
 s_nop 0
 buffer_load_dwordx4 v10, s[60:63], s77 offen lds
 s_add_u32 s77, s77, 16384
 s_add_u32 m0, s71, 18432
 s_nop 0
 buffer_load_dwordx4 v10, s[56:59], s76 offen lds
 s_add_u32 s76, s76, 16384
 s_add_u32 m0, s71, 26624
 s_nop 0
 buffer_load_dwordx4 v10, s[60:63], s77 offen lds
 s_add_u32 s77, s77, 16384
 s_add_u32 m0, s71, 19456
 s_nop 0
 buffer_load_dwordx4 v10, s[56:59], s76 offen lds
 s_add_u32 s76, s76, 16384
 s_add_u32 m0, s71, 27648
 s_nop 0
 buffer_load_dwordx4 v10, s[60:63], s77 offen lds
 s_add_u32 s77, s77, 16384
 s_add_u32 m0, s71, 20480
 s_nop 0
 buffer_load_dwordx4 v10, s[56:59], s76 offen lds
 s_add_u32 s76, s76, 16384
 s_add_u32 m0, s71, 28672
 s_nop 0
 buffer_load_dwordx4 v10, s[60:63], s77 offen lds
 s_add_u32 s77, s77, 16384
 s_add_u32 m0, s71, 21504
 s_nop 0
 buffer_load_dwordx4 v10, s[56:59], s76 offen lds
 s_add_u32 s76, s76, 16384
 s_add_u32 m0, s71, 29696
 s_nop 0
 buffer_load_dwordx4 v10, s[60:63], s77 offen lds
 s_add_u32 s77, s77, 16384
 s_add_u32 m0, s71, 22528
 s_nop 0
 buffer_load_dwordx4 v10, s[56:59], s76 offen lds
 s_add_u32 s76, s76, 16384
 s_add_u32 m0, s71, 30720
 s_nop 0
 buffer_load_dwordx4 v10, s[60:63], s77 offen lds
 s_add_u32 s77, s77, 16384
 s_add_u32 m0, s71, 23552
 s_nop 0
 buffer_load_dwordx4 v10, s[56:59], s76 offen lds
 s_add_u32 s76, s76, 16384
 s_add_u32 m0, s71, 31744
 s_nop 0
 buffer_load_dwordx4 v10, s[60:63], s77 offen lds
 s_add_u32 s77, s77, 16384
 s_waitcnt vmcnt(16)
 ds_read_b64_tr_b16 a[128:129], v9 offset:0
 ds_read_b64_tr_b16 a[130:131], v9 offset:512
 ds_read_b64_tr_b16 a[132:133], v9 offset:8192
 ds_read_b64_tr_b16 a[134:135], v9 offset:8704
 ds_read_b64_tr_b16 a[136:137], v9 offset:1024
 ds_read_b64_tr_b16 a[138:139], v9 offset:1536
 ds_read_b64_tr_b16 a[140:141], v9 offset:9216
 ds_read_b64_tr_b16 a[142:143], v9 offset:9728
 ds_read_b64_tr_b16 a[144:145], v9 offset:2048
 ds_read_b64_tr_b16 a[146:147], v9 offset:2560
 ds_read_b64_tr_b16 a[148:149], v9 offset:10240
 ds_read_b64_tr_b16 a[150:151], v9 offset:10752
 ds_read_b64_tr_b16 a[152:153], v9 offset:3072
 ds_read_b64_tr_b16 a[154:155], v9 offset:3584
 ds_read_b64_tr_b16 a[156:157], v9 offset:11264
 ds_read_b64_tr_b16 a[158:159], v9 offset:11776
 ds_read_b64_tr_b16 a[160:161], v9 offset:4096
 ds_read_b64_tr_b16 a[162:163], v9 offset:4608
 ds_read_b64_tr_b16 a[164:165], v9 offset:12288
 ds_read_b64_tr_b16 a[166:167], v9 offset:12800
 ds_read_b64_tr_b16 a[168:169], v9 offset:5120
 ds_read_b64_tr_b16 a[170:171], v9 offset:5632
 ds_read_b64_tr_b16 a[172:173], v9 offset:13312
 ds_read_b64_tr_b16 a[174:175], v9 offset:13824
 ds_read_b64_tr_b16 a[176:177], v9 offset:6144
 ds_read_b64_tr_b16 a[178:179], v9 offset:6656
 ds_read_b64_tr_b16 a[180:181], v9 offset:14336
 ds_read_b64_tr_b16 a[182:183], v9 offset:14848
 ds_read_b64_tr_b16 a[184:185], v9 offset:7168
 ds_read_b64_tr_b16 a[186:187], v9 offset:7680
 ds_read_b64_tr_b16 a[188:189], v9 offset:15360
 ds_read_b64_tr_b16 a[190:191], v9 offset:15872
 s_waitcnt lgkmcnt(0)
 s_add_u32 m0, s71, 0
 s_nop 0
 buffer_load_dwordx4 v10, s[56:59], s76 offen lds
 s_add_u32 s76, s76, 16384
 s_add_u32 m0, s71, 8192
 s_nop 0
 buffer_load_dwordx4 v10, s[60:63], s77 offen lds
 s_add_u32 s77, s77, 16384
 s_add_u32 m0, s71, 1024
 s_nop 0
 buffer_load_dwordx4 v10, s[56:59], s76 offen lds
 s_add_u32 s76, s76, 16384
 s_add_u32 m0, s71, 9216
 s_nop 0
 buffer_load_dwordx4 v10, s[60:63], s77 offen lds
 s_add_u32 s77, s77, 16384
 s_add_u32 m0, s71, 2048
 s_nop 0
 buffer_load_dwordx4 v10, s[56:59], s76 offen lds
 s_add_u32 s76, s76, 16384
 s_add_u32 m0, s71, 10240
 s_nop 0
 buffer_load_dwordx4 v10, s[60:63], s77 offen lds
 s_add_u32 s77, s77, 16384
 s_add_u32 m0, s71, 3072
 s_nop 0
 buffer_load_dwordx4 v10, s[56:59], s76 offen lds
 s_add_u32 s76, s76, 16384
 s_add_u32 m0, s71, 11264
 s_nop 0
 buffer_load_dwordx4 v10, s[60:63], s77 offen lds
 s_add_u32 s77, s77, 16384
 s_add_u32 m0, s71, 4096
 s_nop 0
 buffer_load_dwordx4 v10, s[56:59], s76 offen lds
 s_add_u32 s76, s76, 16384
 s_add_u32 m0, s71, 12288
 s_nop 0
 buffer_load_dwordx4 v10, s[60:63], s77 offen lds
 s_add_u32 s77, s77, 16384
 s_add_u32 m0, s71, 5120
 s_nop 0
 buffer_load_dwordx4 v10, s[56:59], s76 offen lds
 s_add_u32 s76, s76, 16384
 s_add_u32 m0, s71, 13312
 s_nop 0
 buffer_load_dwordx4 v10, s[60:63], s77 offen lds
 s_add_u32 s77, s77, 16384
 s_add_u32 m0, s71, 6144
 s_nop 0
 buffer_load_dwordx4 v10, s[56:59], s76 offen lds
 s_add_u32 s76, s76, 16384
 s_add_u32 m0, s71, 14336
 s_nop 0
 buffer_load_dwordx4 v10, s[60:63], s77 offen lds
 s_add_u32 s77, s77, 16384
 s_add_u32 m0, s71, 7168
 s_nop 0
 buffer_load_dwordx4 v10, s[56:59], s76 offen lds
 s_add_u32 s76, s76, 16384
 s_add_u32 m0, s71, 15360
 s_nop 0
 buffer_load_dwordx4 v10, s[60:63], s77 offen lds
 s_add_u32 s77, s77, 16384
 s_waitcnt vmcnt(16)
 ds_read_b64_tr_b16 a[192:193], v9 offset:16384
 ds_read_b64_tr_b16 a[194:195], v9 offset:16896
 ds_read_b64_tr_b16 a[196:197], v9 offset:24576
 ds_read_b64_tr_b16 a[198:199], v9 offset:25088
 ds_read_b64_tr_b16 a[200:201], v9 offset:17408
 ds_read_b64_tr_b16 a[202:203], v9 offset:17920
 ds_read_b64_tr_b16 a[204:205], v9 offset:25600
 ds_read_b64_tr_b16 a[206:207], v9 offset:26112
 ds_read_b64_tr_b16 a[208:209], v9 offset:18432
 ds_read_b64_tr_b16 a[210:211], v9 offset:18944
 ds_read_b64_tr_b16 a[212:213], v9 offset:26624
 ds_read_b64_tr_b16 a[214:215], v9 offset:27136
 ds_read_b64_tr_b16 a[216:217], v9 offset:19456
 ds_read_b64_tr_b16 a[218:219], v9 offset:19968
 ds_read_b64_tr_b16 a[220:221], v9 offset:27648
 ds_read_b64_tr_b16 a[222:223], v9 offset:28160
 ds_read_b64_tr_b16 a[224:225], v9 offset:20480
 ds_read_b64_tr_b16 a[226:227], v9 offset:20992
 ds_read_b64_tr_b16 a[228:229], v9 offset:28672
 ds_read_b64_tr_b16 a[230:231], v9 offset:29184
 ds_read_b64_tr_b16 a[232:233], v9 offset:21504
 ds_read_b64_tr_b16 a[234:235], v9 offset:22016
 ds_read_b64_tr_b16 a[236:237], v9 offset:29696
 ds_read_b64_tr_b16 a[238:239], v9 offset:30208
 ds_read_b64_tr_b16 a[240:241], v9 offset:22528
 ds_read_b64_tr_b16 a[242:243], v9 offset:23040
 ds_read_b64_tr_b16 a[244:245], v9 offset:30720
 ds_read_b64_tr_b16 a[246:247], v9 offset:31232
 ds_read_b64_tr_b16 a[248:249], v9 offset:23552
 ds_read_b64_tr_b16 a[250:251], v9 offset:24064
 ds_read_b64_tr_b16 a[252:253], v9 offset:31744
 ds_read_b64_tr_b16 a[254:255], v9 offset:32256
 s_waitcnt lgkmcnt(0)
 s_add_u32 m0, s71, 16384
 s_nop 0
 buffer_load_dwordx4 v10, s[56:59], s76 offen lds
 s_add_u32 s76, s76, 16384
 s_add_u32 m0, s71, 24576
 s_nop 0
 buffer_load_dwordx4 v10, s[60:63], s77 offen lds
 s_add_u32 s77, s77, 16384
 s_add_u32 m0, s71, 17408
 s_nop 0
 buffer_load_dwordx4 v10, s[56:59], s76 offen lds
 s_add_u32 s76, s76, 16384
 s_add_u32 m0, s71, 25600
 s_nop 0
 buffer_load_dwordx4 v10, s[60:63], s77 offen lds
 s_add_u32 s77, s77, 16384
 s_add_u32 m0, s71, 18432
 s_nop 0
 buffer_load_dwordx4 v10, s[56:59], s76 offen lds
 s_add_u32 s76, s76, 16384
 s_add_u32 m0, s71, 26624
 s_nop 0
 buffer_load_dwordx4 v10, s[60:63], s77 offen lds
 s_add_u32 s77, s77, 16384
 s_waitcnt vmcnt(6)
 ds_read_b64_tr_b16 v[168:169], v9 offset:0
 ds_read_b64_tr_b16 v[170:171], v9 offset:512
 ds_read_b64_tr_b16 v[172:173], v9 offset:8192
 ds_read_b64_tr_b16 v[174:175], v9 offset:8704
 ds_read_b64_tr_b16 v[176:177], v9 offset:1024
 ds_read_b64_tr_b16 v[178:179], v9 offset:1536
 ds_read_b64_tr_b16 v[180:181], v9 offset:9216
 ds_read_b64_tr_b16 v[182:183], v9 offset:9728
 ds_read_b64_tr_b16 v[184:185], v9 offset:2048
 ds_read_b64_tr_b16 v[186:187], v9 offset:2560
 ds_read_b64_tr_b16 v[188:189], v9 offset:10240
 ds_read_b64_tr_b16 v[190:191], v9 offset:10752
 ds_read_b64_tr_b16 v[192:193], v9 offset:3072
 ds_read_b64_tr_b16 v[194:195], v9 offset:3584
 ds_read_b64_tr_b16 v[196:197], v9 offset:11264
 ds_read_b64_tr_b16 v[198:199], v9 offset:11776
 ds_read_b64_tr_b16 v[200:201], v9 offset:4096
 ds_read_b64_tr_b16 v[202:203], v9 offset:4608
 ds_read_b64_tr_b16 v[204:205], v9 offset:12288
 ds_read_b64_tr_b16 v[206:207], v9 offset:12800
 ds_read_b64_tr_b16 v[208:209], v9 offset:5120
 ds_read_b64_tr_b16 v[210:211], v9 offset:5632
 ds_read_b64_tr_b16 v[212:213], v9 offset:13312
 ds_read_b64_tr_b16 v[214:215], v9 offset:13824
 ds_read_b64_tr_b16 v[216:217], v9 offset:6144
 ds_read_b64_tr_b16 v[218:219], v9 offset:6656
 ds_read_b64_tr_b16 v[220:221], v9 offset:14336
 ds_read_b64_tr_b16 v[222:223], v9 offset:14848
 ds_read_b64_tr_b16 v[224:225], v9 offset:7168
 ds_read_b64_tr_b16 v[226:227], v9 offset:7680
 ds_read_b64_tr_b16 v[228:229], v9 offset:15360
 ds_read_b64_tr_b16 v[230:231], v9 offset:15872
 s_waitcnt lgkmcnt(0)
 s_waitcnt vmcnt(0)
 ds_read_b64_tr_b16 v[232:233], v9 offset:16384
 ds_read_b64_tr_b16 v[234:235], v9 offset:16896
 ds_read_b64_tr_b16 v[236:237], v9 offset:24576
 ds_read_b64_tr_b16 v[238:239], v9 offset:25088
 ds_read_b64_tr_b16 v[240:241], v9 offset:17408
 ds_read_b64_tr_b16 v[242:243], v9 offset:17920
 ds_read_b64_tr_b16 v[244:245], v9 offset:25600
 ds_read_b64_tr_b16 v[246:247], v9 offset:26112
 ds_read_b64_tr_b16 v[248:249], v9 offset:18432
 ds_read_b64_tr_b16 v[250:251], v9 offset:18944
 ds_read_b64_tr_b16 v[252:253], v9 offset:26624
 ds_read_b64_tr_b16 v[254:255], v9 offset:27136
 s_waitcnt lgkmcnt(0)
 s_barrier
 v_mov_b32 v3, v2
 v_and_b32 v5, 31, v1
 v_lshlrev_b32 v5, 5, v5
 v_lshrrev_b32 v6, 5, v1
 v_lshl_add_u32 v4, v6, 4, v5
 v_add_u32 v11, 4096, v4
 v_and_b32 v5, 31, v1
 v_lshrrev_b32 v6, 5, v1
 v_lshlrev_b32 v7, 1, v5
 v_cmp_gt_u32 vcc, 43, v7
 v_add_u32 v8, 1, v7
 s_mov_b32 s70, 16640
 v_cndmask_b32 v57, 0, 1, vcc
 v_cndmask_b32 v5, 0, v5, vcc
 v_cmp_gt_u32 vcc, 43, v8
 v_mul_lo_u32 v6, v6, s70
 v_lshl_add_u32 v6, v5, 3, v6
 v_cndmask_b32 v58, 0, 1, vcc
 v_add_u32 v56, 99840, v6
 s_mov_b32 s87, 0x3fffff
 v_mov_b32 v62, 0
 v_mov_b32 v63, 0
 s_lshl_b32 s98, s64, 2
 s_add_u32 s98, s98, s3
 s_lshl_b32 s98, s98, 2
 v_mov_b32 v10, 0
 v_mov_b32 v0, 1
 v_add_u32 v12, 65536, v3
 s_mov_b32 s95, 163824
 s_branch down_sched0
down_pro0:
 s_mov_b32 s90, 0
 ds_read_b128 v[16:19], v3 offset:0
 ds_read_b128 v[20:23], v3 offset:1024
 ds_read_b128 v[24:27], v3 offset:2048
 ds_read_b128 v[28:31], v3 offset:3072
 ds_read_b128 v[32:35], v3 offset:4096
 ds_read_b128 v[36:39], v3 offset:5120
 s_cmp_ge_u32 s94, 2
 s_cbranch_scc1 down_plain0
down_run0:
 s_cmp_lt_u32 s94, 2
 s_cselect_b64 vcc, -1, 0
 ds_read_b128 v[40:43], v3 offset:6144
 s_waitcnt lgkmcnt(6)
 v_mfma_f32_32x32x16_bf16 v[64:79], a[0:3], v[16:19], 0
 s_mov_b32 s68, s4
 s_mov_b32 s67, s5
 s_mov_b32 s88, s6
 s_mov_b32 s89, s7
 v_mfma_f32_32x32x16_bf16 v[80:95], a[4:7], v[16:19], 0
 s_add_u32 s88, s88, 2
 s_add_u32 s70, s89, 1
 s_cmp_lt_u32 s70, 30
 s_cselect_b32 s70, s70, s66
 ds_read_b128 v[44:47], v3 offset:7168
 s_waitcnt lgkmcnt(6)
 v_mfma_f32_32x32x16_bf16 v[64:79], a[8:11], v[20:23], v[64:79]
 s_add_u32 s71, s89, 6
 s_cmp_lt_u32 s89, 30
 s_cselect_b32 s89, s70, s71
 s_and_b32 s4, s94, 1
 s_barrier
 v_mfma_f32_32x32x16_bf16 v[80:95], a[12:15], v[20:23], v[80:95]
 s_cmp_eq_u32 s94, 0
 s_cselect_b32 s5, s6, s7
 s_cselect_b32 s6, s88, s6
 s_cmp_eq_u32 s94, 1
 s_cselect_b32 s7, s89, s7
 ds_read_b128 v[16:19], v3 offset:8192
 s_waitcnt lgkmcnt(6)
 v_mfma_f32_32x32x16_bf16 v[64:79], a[16:19], v[24:27], v[64:79]
 s_mov_b32 s78, 65536
 s_mul_i32 s81, s4, 5636096
 s_add_u32 s81, s81, 148619264
 s_mul_i32 s70, s5, 88064
 s_bitcmp1_b32 s90, 0
 s_cbranch_scc0 g_347
 buffer_store_dwordx4 v[96:99], v4, s[52:55], s91 offen offset:0 sc1
g_347:
 v_mfma_f32_32x32x16_bf16 v[80:95], a[20:23], v[24:27], v[80:95]
 s_add_u32 s81, s81, s70
 s_mul_i32 s70, s82, 44032
 s_add_u32 s81, s81, s70
 s_mul_i32 s97, s3, 11264
 s_bitcmp1_b32 s90, 0
 s_cbranch_scc0 g_348
 buffer_store_dwordx4 v[100:103], v4, s[52:55], s91 offen offset:1024 sc1
g_348:
 ds_read_b128 v[20:23], v3 offset:9216
 s_waitcnt lgkmcnt(6)
 v_mfma_f32_32x32x16_bf16 v[64:79], a[24:27], v[28:31], v[64:79]
 s_min_u32 s97, s97, 32768
 s_add_u32 s96, s97, s78
 s_add_u32 s97, s97, s81
 s_sub_u32 s97, s97, 4096
 s_bitcmp1_b32 s90, 0
 s_cbranch_scc0 g_349
 buffer_store_dwordx4 v[104:107], v4, s[52:55], s91 offen offset:2048 sc1
g_349:
 v_mfma_f32_32x32x16_bf16 v[80:95], a[28:31], v[28:31], v[80:95]
 s_bitcmp1_b32 s90, 0
 s_cbranch_scc0 g_350
 buffer_store_dwordx4 v[108:111], v4, s[52:55], s91 offen offset:3072 sc1
g_350:
 s_cbranch_vccz g_351
 s_add_u32 m0, s96, 0
 s_add_u32 s97, s97, 4096
 buffer_load_dwordx4 v2, s[52:55], s97 offen offset:0 sc1 lds
g_351:
 ds_read_b128 v[24:27], v3 offset:10240
 s_waitcnt lgkmcnt(6)
 v_mfma_f32_32x32x16_bf16 v[64:79], a[32:35], v[32:35], v[64:79]
 s_bitcmp1_b32 s90, 0
 s_cbranch_scc0 g_352
 buffer_store_dwordx4 v[112:115], v11, s[52:55], s91 offen offset:0 sc1
g_352:
 s_cbranch_vccz g_353
 buffer_load_dwordx4 v2, s[52:55], s97 offen offset:1024 sc1 lds
g_353:
 v_mfma_f32_32x32x16_bf16 v[80:95], a[36:39], v[32:35], v[80:95]
 s_bitcmp1_b32 s90, 0
 s_cbranch_scc0 g_354
 buffer_store_dwordx4 v[116:119], v11, s[52:55], s91 offen offset:1024 sc1
g_354:
 s_cbranch_vccz g_355
 buffer_load_dwordx4 v2, s[52:55], s97 offen offset:2048 sc1 lds
g_355:
 ds_read_b128 v[28:31], v3 offset:11264
 s_waitcnt lgkmcnt(6)
 v_mfma_f32_32x32x16_bf16 v[64:79], a[40:43], v[36:39], v[64:79]
 s_bitcmp1_b32 s90, 0
 s_cbranch_scc0 g_356
 buffer_store_dwordx4 v[120:123], v11, s[52:55], s91 offen offset:2048 sc1
g_356:
 s_cbranch_vccz g_357
 buffer_load_dwordx4 v2, s[52:55], s97 offen offset:3072 sc1 lds
g_357:
 v_mfma_f32_32x32x16_bf16 v[80:95], a[44:47], v[36:39], v[80:95]
 s_bitcmp1_b32 s90, 0
 s_cbranch_scc0 g_358
 buffer_store_dwordx4 v[124:127], v11, s[52:55], s91 offen offset:3072 sc1
g_358:
 s_cbranch_vccz g_359
 s_add_u32 m0, s96, 4096
 s_add_u32 s97, s97, 4096
 buffer_load_dwordx4 v2, s[52:55], s97 offen offset:0 sc1 lds
g_359:
 ds_read_b128 v[32:35], v3 offset:12288
 s_waitcnt lgkmcnt(6)
 v_mfma_f32_32x32x16_bf16 v[64:79], a[48:51], v[40:43], v[64:79]
 s_cbranch_vccz g_360
 buffer_load_dwordx4 v2, s[52:55], s97 offen offset:1024 sc1 lds
g_360:
 v_mfma_f32_32x32x16_bf16 v[80:95], a[52:55], v[40:43], v[80:95]
 s_cbranch_vccz g_361
 buffer_load_dwordx4 v2, s[52:55], s97 offen offset:2048 sc1 lds
g_361:
 ds_read_b128 v[36:39], v3 offset:13312
 s_waitcnt lgkmcnt(6)
 v_mfma_f32_32x32x16_bf16 v[64:79], a[56:59], v[44:47], v[64:79]
 s_cbranch_vccz g_362
 buffer_load_dwordx4 v2, s[52:55], s97 offen offset:3072 sc1 lds
g_362:
 v_mfma_f32_32x32x16_bf16 v[80:95], a[60:63], v[44:47], v[80:95]
 s_cbranch_vccz g_363
 s_add_u32 m0, s96, 8192
 s_add_u32 s97, s97, 4096
 buffer_load_dwordx4 v2, s[52:55], s97 offen offset:0 sc1 lds
g_363:
 ds_read_b128 v[40:43], v3 offset:14336
 s_waitcnt lgkmcnt(6)
 v_mfma_f32_32x32x16_bf16 v[64:79], a[64:67], v[16:19], v[64:79]
 s_cbranch_vccz g_364
 buffer_load_dwordx4 v2, s[52:55], s97 offen offset:1024 sc1 lds
g_364:
 v_mfma_f32_32x32x16_bf16 v[80:95], a[68:71], v[16:19], v[80:95]
 s_cbranch_vccz g_365
 buffer_load_dwordx4 v2, s[52:55], s97 offen offset:2048 sc1 lds
g_365:
 ds_read_b128 v[44:47], v3 offset:15360
 s_waitcnt lgkmcnt(6)
 v_mfma_f32_32x32x16_bf16 v[64:79], a[72:75], v[20:23], v[64:79]
 s_bitcmp1_b32 s90, 1
 s_cbranch_scc0 es_366
 s_cbranch_vccz es_367
 s_waitcnt vmcnt(11)
 s_branch es_368
es_367:
 s_waitcnt vmcnt(0)
es_368:
 s_mov_b64 exec, 1
 buffer_store_dword v0, v10, s[52:55], s69 offen sc1
 s_mov_b64 exec, -1
es_366:
 s_mul_i32 s80, s68, 8388608
 s_add_u32 s80, s80, 159891456
 s_lshl_b32 s70, s67, 17
 s_add_u32 s80, s80, s70
 v_mfma_f32_32x32x16_bf16 v[80:95], a[76:79], v[20:23], v[80:95]
 s_lshl_b32 s70, s98, 11
 s_add_u32 s80, s80, s70
 s_mul_i32 s101, s68, 65
 s_add_u32 s101, s101, s67
 ds_read_b128 v[16:19], v3 offset:16384
 s_waitcnt lgkmcnt(6)
 v_mfma_f32_32x32x16_bf16 v[64:79], a[80:83], v[24:27], v[64:79]
 s_lshl_b32 s101, s101, 8
 s_add_u32 s101, s101, 133120
 s_add_u32 s101, s101, s98
 v_mfma_f32_32x32x16_bf16 v[80:95], a[84:87], v[24:27], v[80:95]
 s_cmp_lg_u32 s3, 0
 s_cbranch_scc1 w0_369
 s_min_u32 s70, s6, 63
 s_min_u32 s71, s7, 63
 s_lshl_b32 s70, s70, 8
 s_lshl_b32 s71, s71, 8
 v_add_u32 v15, s70, v56
 s_mov_b32 exec_lo, 0
 v_add_u32 v15, s71, v56
 s_mov_b32 exec_lo, s87
 s_mov_b32 exec_hi, s87
 buffer_load_dwordx2 v[62:63], v15, s[52:55], 0 offen sc1
 s_mov_b64 exec, -1
w0_369:
 ds_read_b128 v[20:23], v3 offset:17408
 s_waitcnt lgkmcnt(6)
 v_mfma_f32_32x32x16_bf16 v[64:79], a[88:91], v[28:31], v[64:79]
 v_mfma_f32_32x32x16_bf16 v[80:95], a[92:95], v[28:31], v[80:95]
 ds_read_b128 v[24:27], v3 offset:18432
 s_waitcnt lgkmcnt(6)
 v_mfma_f32_32x32x16_bf16 v[64:79], a[96:99], v[32:35], v[64:79]
 v_mfma_f32_32x32x16_bf16 v[80:95], a[100:103], v[32:35], v[80:95]
 ds_read_b128 v[28:31], v3 offset:19456
 s_waitcnt lgkmcnt(6)
 v_mfma_f32_32x32x16_bf16 v[64:79], a[104:107], v[36:39], v[64:79]
 v_mfma_f32_32x32x16_bf16 v[80:95], a[108:111], v[36:39], v[80:95]
 ds_read_b128 v[32:35], v3 offset:20480
 s_waitcnt lgkmcnt(6)
 v_mfma_f32_32x32x16_bf16 v[64:79], a[112:115], v[40:43], v[64:79]
 v_mfma_f32_32x32x16_bf16 v[80:95], a[116:119], v[40:43], v[80:95]
 ds_read_b128 v[36:39], v3 offset:21504
 s_waitcnt lgkmcnt(6)
 v_mfma_f32_32x32x16_bf16 v[64:79], a[120:123], v[44:47], v[64:79]
 v_mfma_f32_32x32x16_bf16 v[80:95], a[124:127], v[44:47], v[80:95]
 ds_read_b128 v[40:43], v3 offset:22528
 s_waitcnt lgkmcnt(6)
 v_mfma_f32_32x32x16_bf16 v[64:79], a[128:131], v[16:19], v[64:79]
 v_mfma_f32_32x32x16_bf16 v[80:95], a[132:135], v[16:19], v[80:95]
 ds_read_b128 v[44:47], v3 offset:23552
 s_waitcnt lgkmcnt(6)
 v_mfma_f32_32x32x16_bf16 v[64:79], a[136:139], v[20:23], v[64:79]
 v_mfma_f32_32x32x16_bf16 v[80:95], a[140:143], v[20:23], v[80:95]
 ds_read_b128 v[16:19], v3 offset:24576
 s_waitcnt lgkmcnt(6)
 v_mfma_f32_32x32x16_bf16 v[64:79], a[144:147], v[24:27], v[64:79]
 v_mfma_f32_32x32x16_bf16 v[80:95], a[148:151], v[24:27], v[80:95]
 ds_read_b128 v[20:23], v3 offset:25600
 s_waitcnt lgkmcnt(6)
 v_mfma_f32_32x32x16_bf16 v[64:79], a[152:155], v[28:31], v[64:79]
 v_mfma_f32_32x32x16_bf16 v[80:95], a[156:159], v[28:31], v[80:95]
 ds_read_b128 v[24:27], v3 offset:26624
 s_waitcnt lgkmcnt(6)
 v_mfma_f32_32x32x16_bf16 v[64:79], a[160:163], v[32:35], v[64:79]
 v_mfma_f32_32x32x16_bf16 v[80:95], a[164:167], v[32:35], v[80:95]
 ds_read_b128 v[28:31], v3 offset:27648
 s_waitcnt lgkmcnt(6)
 v_mfma_f32_32x32x16_bf16 v[64:79], a[168:171], v[36:39], v[64:79]
 v_mfma_f32_32x32x16_bf16 v[80:95], a[172:175], v[36:39], v[80:95]
 ds_read_b128 v[32:35], v3 offset:28672
 s_waitcnt lgkmcnt(6)
 v_mfma_f32_32x32x16_bf16 v[64:79], a[176:179], v[40:43], v[64:79]
 v_mfma_f32_32x32x16_bf16 v[80:95], a[180:183], v[40:43], v[80:95]
 ds_read_b128 v[36:39], v3 offset:29696
 s_waitcnt lgkmcnt(6)
 v_mfma_f32_32x32x16_bf16 v[64:79], a[184:187], v[44:47], v[64:79]
 v_mfma_f32_32x32x16_bf16 v[80:95], a[188:191], v[44:47], v[80:95]
 ds_read_b128 v[40:43], v3 offset:30720
 s_waitcnt lgkmcnt(6)
 v_mfma_f32_32x32x16_bf16 v[64:79], a[192:195], v[16:19], v[64:79]
 v_mfma_f32_32x32x16_bf16 v[80:95], a[196:199], v[16:19], v[80:95]
 ds_read_b128 v[44:47], v3 offset:31744
 s_waitcnt lgkmcnt(6)
 v_mfma_f32_32x32x16_bf16 v[64:79], a[200:203], v[20:23], v[64:79]
 v_mfma_f32_32x32x16_bf16 v[80:95], a[204:207], v[20:23], v[80:95]
 ds_read_b128 v[16:19], v3 offset:32768
 s_waitcnt lgkmcnt(6)
 v_mfma_f32_32x32x16_bf16 v[64:79], a[208:211], v[24:27], v[64:79]
 v_mfma_f32_32x32x16_bf16 v[80:95], a[212:215], v[24:27], v[80:95]
 ds_read_b128 v[20:23], v3 offset:33792
 s_waitcnt lgkmcnt(6)
 v_mfma_f32_32x32x16_bf16 v[64:79], a[216:219], v[28:31], v[64:79]
 v_mfma_f32_32x32x16_bf16 v[80:95], a[220:223], v[28:31], v[80:95]
 ds_read_b128 v[24:27], v3 offset:34816
 s_waitcnt lgkmcnt(6)
 v_mfma_f32_32x32x16_bf16 v[64:79], a[224:227], v[32:35], v[64:79]
 v_mfma_f32_32x32x16_bf16 v[80:95], a[228:231], v[32:35], v[80:95]
 ds_read_b128 v[28:31], v3 offset:35840
 s_waitcnt lgkmcnt(6)
 v_mfma_f32_32x32x16_bf16 v[64:79], a[232:235], v[36:39], v[64:79]
 v_mfma_f32_32x32x16_bf16 v[80:95], a[236:239], v[36:39], v[80:95]
 ds_read_b128 v[32:35], v3 offset:36864
 s_waitcnt lgkmcnt(6)
 v_mfma_f32_32x32x16_bf16 v[64:79], a[240:243], v[40:43], v[64:79]
 v_mfma_f32_32x32x16_bf16 v[80:95], a[244:247], v[40:43], v[80:95]
 ds_read_b128 v[36:39], v3 offset:37888
 s_waitcnt lgkmcnt(6)
 v_mfma_f32_32x32x16_bf16 v[64:79], a[248:251], v[44:47], v[64:79]
 v_mfma_f32_32x32x16_bf16 v[80:95], a[252:255], v[44:47], v[80:95]
 ds_read_b128 v[40:43], v3 offset:38912
 s_waitcnt lgkmcnt(6)
 v_mfma_f32_32x32x16_bf16 v[64:79], v[168:171], v[16:19], v[64:79]
 v_mfma_f32_32x32x16_bf16 v[80:95], v[172:175], v[16:19], v[80:95]
 ds_read_b128 v[44:47], v3 offset:39936
 s_waitcnt lgkmcnt(6)
 v_mfma_f32_32x32x16_bf16 v[64:79], v[176:179], v[20:23], v[64:79]
 s_waitcnt vmcnt(0)
 s_bitcmp1_b32 s90, 0
 s_cbranch_scc0 sg_370
 s_mov_b64 exec, 1
 buffer_store_dword v0, v10, s[52:55], s69 offen sc1
 s_mov_b64 exec, -1
sg_370:
 s_cmp_lg_u32 s3, 0
 s_cbranch_scc1 w0_371
 v_cmp_ge_u32 s[72:73], v62, v57
 v_cmp_ge_u32 s[74:75], v63, v58
 s_and_b64 s[72:73], s[72:73], s[74:75]
 s_mov_b32 s70, 2
 s_cmp_lt_u32 s7, 64
 s_cselect_b32 s71, s73, 0
 s_cmp_eq_u32 s71, -1
 s_cselect_b32 s70, 1, s70
 s_cmp_lt_u32 s6, 64
 s_cselect_b32 s71, s72, 0
 s_cmp_eq_u32 s71, -1
 s_cselect_b32 s70, 0, s70
 v_mov_b32 v5, s70
 v_mov_b32 v6, s95
 ds_write_b32 v6, v5
w0_371:
 v_mfma_f32_32x32x16_bf16 v[80:95], v[180:183], v[20:23], v[80:95]
 ds_read_b128 v[16:19], v3 offset:40960
 s_waitcnt lgkmcnt(6)
 v_mfma_f32_32x32x16_bf16 v[64:79], v[184:187], v[24:27], v[64:79]
 v_mfma_f32_32x32x16_bf16 v[80:95], v[188:191], v[24:27], v[80:95]
 ds_read_b128 v[20:23], v3 offset:41984
 s_waitcnt lgkmcnt(6)
 v_mfma_f32_32x32x16_bf16 v[64:79], v[192:195], v[28:31], v[64:79]
 v_mov_b32 v6, s95
 s_waitcnt lgkmcnt(2)
 s_barrier
 ds_read_b32 v61, v6
 s_xor_b32 s95, s95, 4
 v_mfma_f32_32x32x16_bf16 v[80:95], v[196:199], v[28:31], v[80:95]
 ds_read_b128 v[24:27], v3 offset:43008
 s_waitcnt lgkmcnt(6)
 v_mfma_f32_32x32x16_bf16 v[64:79], v[200:203], v[32:35], v[64:79]
 v_mfma_f32_32x32x16_bf16 v[80:95], v[204:207], v[32:35], v[80:95]
 s_cbranch_vccz down_tail0
 ds_read_b128 v[28:31], v12 offset:0
 s_waitcnt lgkmcnt(6)
 v_mfma_f32_32x32x16_bf16 v[64:79], v[208:211], v[36:39], v[64:79]
 v_mfma_f32_32x32x16_bf16 v[80:95], v[212:215], v[36:39], v[80:95]
 ds_read_b128 v[32:35], v12 offset:1024
 s_waitcnt lgkmcnt(6)
 v_mfma_f32_32x32x16_bf16 v[64:79], v[216:219], v[40:43], v[64:79]
 v_mfma_f32_32x32x16_bf16 v[80:95], v[220:223], v[40:43], v[80:95]
 ds_read_b128 v[36:39], v12 offset:2048
 s_waitcnt lgkmcnt(6)
 v_mfma_f32_32x32x16_bf16 v[64:79], v[224:227], v[44:47], v[64:79]
 v_mfma_f32_32x32x16_bf16 v[80:95], v[228:231], v[44:47], v[80:95]
 ds_read_b128 v[40:43], v12 offset:3072
 s_waitcnt lgkmcnt(6)
 v_mfma_f32_32x32x16_bf16 v[64:79], v[232:235], v[16:19], v[64:79]
 v_mfma_f32_32x32x16_bf16 v[80:95], v[236:239], v[16:19], v[80:95]
 ds_read_b128 v[44:47], v12 offset:4096
 s_waitcnt lgkmcnt(6)
 v_mfma_f32_32x32x16_bf16 v[64:79], v[240:243], v[20:23], v[64:79]
 v_mfma_f32_32x32x16_bf16 v[80:95], v[244:247], v[20:23], v[80:95]
 s_mov_b32 s90, 1
 s_mov_b32 s91, s80
 s_mov_b32 s69, s101
 ds_read_b128 v[16:19], v12 offset:5120
 s_waitcnt lgkmcnt(6)
 v_mfma_f32_32x32x16_bf16 v[64:79], v[248:251], v[24:27], v[64:79]
 v_mfma_f32_32x32x16_bf16 v[80:95], v[252:255], v[24:27], v[80:95]
 v_readfirstlane_b32 s94, v61
 s_cmp_ge_u32 s6, 64
 s_cselect_b32 s70, 0, s68
 s_cmp_lg_u32 s70, 0
 s_cbranch_scc1 down_run1
 s_mov_b32 s90, 2
 s_nop 7
 buffer_store_dwordx4 v[64:67], v4, s[52:55], s80 offen offset:0 sc1
 buffer_store_dwordx4 v[68:71], v4, s[52:55], s80 offen offset:1024 sc1
 buffer_store_dwordx4 v[72:75], v4, s[52:55], s80 offen offset:2048 sc1
 buffer_store_dwordx4 v[76:79], v4, s[52:55], s80 offen offset:3072 sc1
 buffer_store_dwordx4 v[80:83], v11, s[52:55], s80 offen offset:0 sc1
 buffer_store_dwordx4 v[84:87], v11, s[52:55], s80 offen offset:1024 sc1
 buffer_store_dwordx4 v[88:91], v11, s[52:55], s80 offen offset:2048 sc1
 buffer_store_dwordx4 v[92:95], v11, s[52:55], s80 offen offset:3072 sc1
 s_branch down_run1
down_plain0:
 ds_read_b128 v[40:43], v3 offset:6144
 s_waitcnt lgkmcnt(6)
 v_mfma_f32_32x32x16_bf16 v[64:79], a[0:3], v[16:19], 0
 s_mov_b32 s68, s4
 s_mov_b32 s67, s5
 s_mul_i32 s80, s68, 8388608
 s_add_u32 s80, s80, 159891456
 v_mfma_f32_32x32x16_bf16 v[80:95], a[4:7], v[16:19], 0
 s_lshl_b32 s70, s67, 17
 s_add_u32 s80, s80, s70
 s_lshl_b32 s70, s98, 11
 s_add_u32 s80, s80, s70
 ds_read_b128 v[44:47], v3 offset:7168
 s_waitcnt lgkmcnt(6)
 v_mfma_f32_32x32x16_bf16 v[64:79], a[8:11], v[20:23], v[64:79]
 s_mul_i32 s101, s68, 65
 s_add_u32 s101, s101, s67
 s_lshl_b32 s101, s101, 8
 s_add_u32 s101, s101, 133120
 s_barrier
 v_mfma_f32_32x32x16_bf16 v[80:95], a[12:15], v[20:23], v[80:95]
 s_add_u32 s101, s101, s98
 ds_read_b128 v[16:19], v3 offset:8192
 s_waitcnt lgkmcnt(6)
 v_mfma_f32_32x32x16_bf16 v[64:79], a[16:19], v[24:27], v[64:79]
 v_mfma_f32_32x32x16_bf16 v[80:95], a[20:23], v[24:27], v[80:95]
 ds_read_b128 v[20:23], v3 offset:9216
 s_waitcnt lgkmcnt(6)
 v_mfma_f32_32x32x16_bf16 v[64:79], a[24:27], v[28:31], v[64:79]
 v_mfma_f32_32x32x16_bf16 v[80:95], a[28:31], v[28:31], v[80:95]
 ds_read_b128 v[24:27], v3 offset:10240
 s_waitcnt lgkmcnt(6)
 v_mfma_f32_32x32x16_bf16 v[64:79], a[32:35], v[32:35], v[64:79]
 v_mfma_f32_32x32x16_bf16 v[80:95], a[36:39], v[32:35], v[80:95]
 ds_read_b128 v[28:31], v3 offset:11264
 s_waitcnt lgkmcnt(6)
 v_mfma_f32_32x32x16_bf16 v[64:79], a[40:43], v[36:39], v[64:79]
 v_mfma_f32_32x32x16_bf16 v[80:95], a[44:47], v[36:39], v[80:95]
 ds_read_b128 v[32:35], v3 offset:12288
 s_waitcnt lgkmcnt(6)
 v_mfma_f32_32x32x16_bf16 v[64:79], a[48:51], v[40:43], v[64:79]
 v_mfma_f32_32x32x16_bf16 v[80:95], a[52:55], v[40:43], v[80:95]
 ds_read_b128 v[36:39], v3 offset:13312
 s_waitcnt lgkmcnt(6)
 v_mfma_f32_32x32x16_bf16 v[64:79], a[56:59], v[44:47], v[64:79]
 v_mfma_f32_32x32x16_bf16 v[80:95], a[60:63], v[44:47], v[80:95]
 ds_read_b128 v[40:43], v3 offset:14336
 s_waitcnt lgkmcnt(6)
 v_mfma_f32_32x32x16_bf16 v[64:79], a[64:67], v[16:19], v[64:79]
 v_mfma_f32_32x32x16_bf16 v[80:95], a[68:71], v[16:19], v[80:95]
 ds_read_b128 v[44:47], v3 offset:15360
 s_waitcnt lgkmcnt(6)
 v_mfma_f32_32x32x16_bf16 v[64:79], a[72:75], v[20:23], v[64:79]
 v_mfma_f32_32x32x16_bf16 v[80:95], a[76:79], v[20:23], v[80:95]
 ds_read_b128 v[16:19], v3 offset:16384
 s_waitcnt lgkmcnt(6)
 v_mfma_f32_32x32x16_bf16 v[64:79], a[80:83], v[24:27], v[64:79]
 v_mfma_f32_32x32x16_bf16 v[80:95], a[84:87], v[24:27], v[80:95]
 ds_read_b128 v[20:23], v3 offset:17408
 s_waitcnt lgkmcnt(6)
 v_mfma_f32_32x32x16_bf16 v[64:79], a[88:91], v[28:31], v[64:79]
 v_mfma_f32_32x32x16_bf16 v[80:95], a[92:95], v[28:31], v[80:95]
 ds_read_b128 v[24:27], v3 offset:18432
 s_waitcnt lgkmcnt(6)
 v_mfma_f32_32x32x16_bf16 v[64:79], a[96:99], v[32:35], v[64:79]
 v_mfma_f32_32x32x16_bf16 v[80:95], a[100:103], v[32:35], v[80:95]
 ds_read_b128 v[28:31], v3 offset:19456
 s_waitcnt lgkmcnt(6)
 v_mfma_f32_32x32x16_bf16 v[64:79], a[104:107], v[36:39], v[64:79]
 v_mfma_f32_32x32x16_bf16 v[80:95], a[108:111], v[36:39], v[80:95]
 ds_read_b128 v[32:35], v3 offset:20480
 s_waitcnt lgkmcnt(6)
 v_mfma_f32_32x32x16_bf16 v[64:79], a[112:115], v[40:43], v[64:79]
 v_mfma_f32_32x32x16_bf16 v[80:95], a[116:119], v[40:43], v[80:95]
 ds_read_b128 v[36:39], v3 offset:21504
 s_waitcnt lgkmcnt(6)
 v_mfma_f32_32x32x16_bf16 v[64:79], a[120:123], v[44:47], v[64:79]
 v_mfma_f32_32x32x16_bf16 v[80:95], a[124:127], v[44:47], v[80:95]
 ds_read_b128 v[40:43], v3 offset:22528
 s_waitcnt lgkmcnt(6)
 v_mfma_f32_32x32x16_bf16 v[64:79], a[128:131], v[16:19], v[64:79]
 v_mfma_f32_32x32x16_bf16 v[80:95], a[132:135], v[16:19], v[80:95]
 ds_read_b128 v[44:47], v3 offset:23552
 s_waitcnt lgkmcnt(6)
 v_mfma_f32_32x32x16_bf16 v[64:79], a[136:139], v[20:23], v[64:79]
 v_mfma_f32_32x32x16_bf16 v[80:95], a[140:143], v[20:23], v[80:95]
 ds_read_b128 v[16:19], v3 offset:24576
 s_waitcnt lgkmcnt(6)
 v_mfma_f32_32x32x16_bf16 v[64:79], a[144:147], v[24:27], v[64:79]
 v_mfma_f32_32x32x16_bf16 v[80:95], a[148:151], v[24:27], v[80:95]
 ds_read_b128 v[20:23], v3 offset:25600
 s_waitcnt lgkmcnt(6)
 v_mfma_f32_32x32x16_bf16 v[64:79], a[152:155], v[28:31], v[64:79]
 v_mfma_f32_32x32x16_bf16 v[80:95], a[156:159], v[28:31], v[80:95]
 ds_read_b128 v[24:27], v3 offset:26624
 s_waitcnt lgkmcnt(6)
 v_mfma_f32_32x32x16_bf16 v[64:79], a[160:163], v[32:35], v[64:79]
 v_mfma_f32_32x32x16_bf16 v[80:95], a[164:167], v[32:35], v[80:95]
 ds_read_b128 v[28:31], v3 offset:27648
 s_waitcnt lgkmcnt(6)
 v_mfma_f32_32x32x16_bf16 v[64:79], a[168:171], v[36:39], v[64:79]
 v_mfma_f32_32x32x16_bf16 v[80:95], a[172:175], v[36:39], v[80:95]
 ds_read_b128 v[32:35], v3 offset:28672
 s_waitcnt lgkmcnt(6)
 v_mfma_f32_32x32x16_bf16 v[64:79], a[176:179], v[40:43], v[64:79]
 v_mfma_f32_32x32x16_bf16 v[80:95], a[180:183], v[40:43], v[80:95]
 ds_read_b128 v[36:39], v3 offset:29696
 s_waitcnt lgkmcnt(6)
 v_mfma_f32_32x32x16_bf16 v[64:79], a[184:187], v[44:47], v[64:79]
 v_mfma_f32_32x32x16_bf16 v[80:95], a[188:191], v[44:47], v[80:95]
 ds_read_b128 v[40:43], v3 offset:30720
 s_waitcnt lgkmcnt(6)
 v_mfma_f32_32x32x16_bf16 v[64:79], a[192:195], v[16:19], v[64:79]
 v_mfma_f32_32x32x16_bf16 v[80:95], a[196:199], v[16:19], v[80:95]
 ds_read_b128 v[44:47], v3 offset:31744
 s_waitcnt lgkmcnt(6)
 v_mfma_f32_32x32x16_bf16 v[64:79], a[200:203], v[20:23], v[64:79]
 s_cmp_lg_u32 s3, 0
 s_cbranch_scc1 w0_372
 s_min_u32 s70, s6, 63
 s_min_u32 s71, s7, 63
 s_lshl_b32 s70, s70, 8
 s_lshl_b32 s71, s71, 8
 v_add_u32 v15, s70, v56
 s_mov_b32 exec_lo, 0
 v_add_u32 v15, s71, v56
 s_mov_b32 exec_lo, s87
 s_mov_b32 exec_hi, s87
 buffer_load_dwordx2 v[62:63], v15, s[52:55], 0 offen sc1
 s_mov_b64 exec, -1
w0_372:
 v_mfma_f32_32x32x16_bf16 v[80:95], a[204:207], v[20:23], v[80:95]
 ds_read_b128 v[16:19], v3 offset:32768
 s_waitcnt lgkmcnt(6)
 v_mfma_f32_32x32x16_bf16 v[64:79], a[208:211], v[24:27], v[64:79]
 v_mfma_f32_32x32x16_bf16 v[80:95], a[212:215], v[24:27], v[80:95]
 ds_read_b128 v[20:23], v3 offset:33792
 s_waitcnt lgkmcnt(6)
 v_mfma_f32_32x32x16_bf16 v[64:79], a[216:219], v[28:31], v[64:79]
 v_mfma_f32_32x32x16_bf16 v[80:95], a[220:223], v[28:31], v[80:95]
 ds_read_b128 v[24:27], v3 offset:34816
 s_waitcnt lgkmcnt(6)
 v_mfma_f32_32x32x16_bf16 v[64:79], a[224:227], v[32:35], v[64:79]
 v_mfma_f32_32x32x16_bf16 v[80:95], a[228:231], v[32:35], v[80:95]
 ds_read_b128 v[28:31], v3 offset:35840
 s_waitcnt lgkmcnt(6)
 v_mfma_f32_32x32x16_bf16 v[64:79], a[232:235], v[36:39], v[64:79]
 v_mfma_f32_32x32x16_bf16 v[80:95], a[236:239], v[36:39], v[80:95]
 ds_read_b128 v[32:35], v3 offset:36864
 s_waitcnt lgkmcnt(6)
 v_mfma_f32_32x32x16_bf16 v[64:79], a[240:243], v[40:43], v[64:79]
 v_mfma_f32_32x32x16_bf16 v[80:95], a[244:247], v[40:43], v[80:95]
 ds_read_b128 v[36:39], v3 offset:37888
 s_waitcnt lgkmcnt(6)
 v_mfma_f32_32x32x16_bf16 v[64:79], a[248:251], v[44:47], v[64:79]
 v_mfma_f32_32x32x16_bf16 v[80:95], a[252:255], v[44:47], v[80:95]
 ds_read_b128 v[40:43], v3 offset:38912
 s_waitcnt lgkmcnt(6)
 v_mfma_f32_32x32x16_bf16 v[64:79], v[168:171], v[16:19], v[64:79]
 v_mfma_f32_32x32x16_bf16 v[80:95], v[172:175], v[16:19], v[80:95]
 ds_read_b128 v[44:47], v3 offset:39936
 s_waitcnt lgkmcnt(6)
 v_mfma_f32_32x32x16_bf16 v[64:79], v[176:179], v[20:23], v[64:79]
 s_cmp_lg_u32 s3, 0
 s_cbranch_scc1 w0_373
 s_waitcnt vmcnt(0)
 v_cmp_ge_u32 s[72:73], v62, v57
 v_cmp_ge_u32 s[74:75], v63, v58
 s_and_b64 s[72:73], s[72:73], s[74:75]
 s_mov_b32 s70, 2
 s_cmp_lt_u32 s7, 64
 s_cselect_b32 s71, s73, 0
 s_cmp_eq_u32 s71, -1
 s_cselect_b32 s70, 1, s70
 s_cmp_lt_u32 s6, 64
 s_cselect_b32 s71, s72, 0
 s_cmp_eq_u32 s71, -1
 s_cselect_b32 s70, 0, s70
 v_mov_b32 v5, s70
 v_mov_b32 v6, s95
 ds_write_b32 v6, v5
w0_373:
 v_mfma_f32_32x32x16_bf16 v[80:95], v[180:183], v[20:23], v[80:95]
 ds_read_b128 v[16:19], v3 offset:40960
 s_waitcnt lgkmcnt(6)
 v_mfma_f32_32x32x16_bf16 v[64:79], v[184:187], v[24:27], v[64:79]
 v_mfma_f32_32x32x16_bf16 v[80:95], v[188:191], v[24:27], v[80:95]
 ds_read_b128 v[20:23], v3 offset:41984
 s_waitcnt lgkmcnt(6)
 v_mfma_f32_32x32x16_bf16 v[64:79], v[192:195], v[28:31], v[64:79]
 v_mov_b32 v6, s95
 s_waitcnt lgkmcnt(2)
 s_barrier
 ds_read_b32 v61, v6
 s_xor_b32 s95, s95, 4
 v_mfma_f32_32x32x16_bf16 v[80:95], v[196:199], v[28:31], v[80:95]
 ds_read_b128 v[24:27], v3 offset:43008
 s_waitcnt lgkmcnt(6)
 v_mfma_f32_32x32x16_bf16 v[64:79], v[200:203], v[32:35], v[64:79]
 v_mfma_f32_32x32x16_bf16 v[80:95], v[204:207], v[32:35], v[80:95]
down_tail0:
 s_waitcnt lgkmcnt(5)
 v_mfma_f32_32x32x16_bf16 v[64:79], v[208:211], v[36:39], v[64:79]
 v_mfma_f32_32x32x16_bf16 v[80:95], v[212:215], v[36:39], v[80:95]
 s_waitcnt lgkmcnt(4)
 v_mfma_f32_32x32x16_bf16 v[64:79], v[216:219], v[40:43], v[64:79]
 v_mfma_f32_32x32x16_bf16 v[80:95], v[220:223], v[40:43], v[80:95]
 s_waitcnt lgkmcnt(3)
 v_mfma_f32_32x32x16_bf16 v[64:79], v[224:227], v[44:47], v[64:79]
 v_mfma_f32_32x32x16_bf16 v[80:95], v[228:231], v[44:47], v[80:95]
 s_waitcnt lgkmcnt(2)
 v_mfma_f32_32x32x16_bf16 v[64:79], v[232:235], v[16:19], v[64:79]
 v_mfma_f32_32x32x16_bf16 v[80:95], v[236:239], v[16:19], v[80:95]
 s_waitcnt lgkmcnt(1)
 v_mfma_f32_32x32x16_bf16 v[64:79], v[240:243], v[20:23], v[64:79]
 v_mfma_f32_32x32x16_bf16 v[80:95], v[244:247], v[20:23], v[80:95]
 s_waitcnt lgkmcnt(0)
 v_mfma_f32_32x32x16_bf16 v[64:79], v[248:251], v[24:27], v[64:79]
 v_mfma_f32_32x32x16_bf16 v[80:95], v[252:255], v[24:27], v[80:95]
 v_readfirstlane_b32 s94, v61
 s_mov_b32 s88, s6
 s_mov_b32 s89, s7
 s_add_u32 s88, s88, 2
 s_add_u32 s70, s89, 1
 s_cmp_lt_u32 s70, 30
 s_cselect_b32 s70, s70, s66
 s_add_u32 s71, s89, 6
 s_cmp_lt_u32 s89, 30
 s_cselect_b32 s89, s70, s71
 s_and_b32 s4, s94, 1
 s_cmp_eq_u32 s94, 0
 s_cselect_b32 s5, s6, s7
 s_cselect_b32 s6, s88, s6
 s_cmp_eq_u32 s94, 1
 s_cselect_b32 s7, s89, s7
 s_mov_b32 s78, 65536
 s_mul_i32 s81, s4, 5636096
 s_add_u32 s81, s81, 148619264
 s_mul_i32 s70, s5, 88064
 s_add_u32 s81, s81, s70
 s_mul_i32 s70, s82, 44032
 s_add_u32 s81, s81, s70
 s_mul_i32 s97, s3, 11264
 s_min_u32 s97, s97, 32768
 s_add_u32 s96, s97, s78
 s_add_u32 s97, s97, s81
 s_sub_u32 s97, s97, 4096
 buffer_store_dwordx4 v[64:67], v4, s[52:55], s80 offen offset:0 sc1
 buffer_store_dwordx4 v[68:71], v4, s[52:55], s80 offen offset:1024 sc1
 buffer_store_dwordx4 v[72:75], v4, s[52:55], s80 offen offset:2048 sc1
 buffer_store_dwordx4 v[76:79], v4, s[52:55], s80 offen offset:3072 sc1
 buffer_store_dwordx4 v[80:83], v11, s[52:55], s80 offen offset:0 sc1
 buffer_store_dwordx4 v[84:87], v11, s[52:55], s80 offen offset:1024 sc1
 buffer_store_dwordx4 v[88:91], v11, s[52:55], s80 offen offset:2048 sc1
 buffer_store_dwordx4 v[92:95], v11, s[52:55], s80 offen offset:3072 sc1
 s_cmp_ge_u32 s94, 2
 s_cbranch_scc1 down_idle0
 s_add_u32 m0, s96, 0
 s_add_u32 s97, s97, 4096
 buffer_load_dwordx4 v2, s[52:55], s97 offen offset:0 sc1 lds
 buffer_load_dwordx4 v2, s[52:55], s97 offen offset:1024 sc1 lds
 buffer_load_dwordx4 v2, s[52:55], s97 offen offset:2048 sc1 lds
 buffer_load_dwordx4 v2, s[52:55], s97 offen offset:3072 sc1 lds
 s_add_u32 m0, s96, 4096
 s_add_u32 s97, s97, 4096
 buffer_load_dwordx4 v2, s[52:55], s97 offen offset:0 sc1 lds
 buffer_load_dwordx4 v2, s[52:55], s97 offen offset:1024 sc1 lds
 buffer_load_dwordx4 v2, s[52:55], s97 offen offset:2048 sc1 lds
 buffer_load_dwordx4 v2, s[52:55], s97 offen offset:3072 sc1 lds
 s_add_u32 m0, s96, 8192
 s_add_u32 s97, s97, 4096
 buffer_load_dwordx4 v2, s[52:55], s97 offen offset:0 sc1 lds
 buffer_load_dwordx4 v2, s[52:55], s97 offen offset:1024 sc1 lds
 buffer_load_dwordx4 v2, s[52:55], s97 offen offset:2048 sc1 lds
 s_waitcnt vmcnt(11)
 s_mov_b64 exec, 1
 buffer_store_dword v0, v10, s[52:55], s101 offen sc1
 s_mov_b64 exec, -1
 s_branch sc_378
down_idle0:
 s_mov_b32 s83, 0x200000
 s_cmp_lg_u32 s3, 0
 s_cbranch_scc1 nw_380
 s_min_u32 s70, s6, 63
 s_min_u32 s71, s7, 63
 s_lshl_b32 s70, s70, 8
 s_lshl_b32 s71, s71, 8
 v_add_u32 v15, s70, v56
 s_mov_b32 exec_lo, 0
 v_add_u32 v15, s71, v56
 s_mov_b32 exec_lo, s87
 s_mov_b32 exec_hi, s87
 buffer_load_dwordx2 v[62:63], v15, s[52:55], 0 offen sc1
 s_mov_b64 exec, -1
 s_waitcnt vmcnt(1)
 s_mov_b64 exec, 1
 buffer_store_dword v0, v10, s[52:55], s101 offen sc1
 s_mov_b64 exec, -1
 s_min_u32 s70, s6, s7
 s_cmp_ge_u32 s70, 64
 s_cbranch_scc1 k_exit
 s_waitcnt vmcnt(1)
 s_branch ev_379
nw_380:
 s_waitcnt vmcnt(0)
 s_mov_b64 exec, 1
 buffer_store_dword v0, v10, s[52:55], s101 offen sc1
 s_mov_b64 exec, -1
down_sched1:
 s_min_u32 s70, s6, s7
 s_cmp_ge_u32 s70, 64
 s_cbranch_scc1 k_exit
 s_cmp_lg_u32 s3, 0
 s_cbranch_scc1 sc_374
 s_mov_b32 s83, 0x200000
sc_375:
 s_min_u32 s70, s6, 63
 s_min_u32 s71, s7, 63
 s_lshl_b32 s70, s70, 8
 s_lshl_b32 s71, s71, 8
 v_add_u32 v15, s70, v56
 s_mov_b32 exec_lo, 0
 v_add_u32 v15, s71, v56
 s_mov_b32 exec_lo, s87
 s_mov_b32 exec_hi, s87
 buffer_load_dwordx2 v[62:63], v15, s[52:55], 0 offen sc1
 s_mov_b64 exec, -1
 s_waitcnt vmcnt(0)
ev_379:
 v_cmp_ge_u32 s[72:73], v62, v57
 v_cmp_ge_u32 s[74:75], v63, v58
 s_and_b64 s[72:73], s[72:73], s[74:75]
 s_mov_b32 s70, 2
 s_cmp_lt_u32 s7, 64
 s_cselect_b32 s71, s73, 0
 s_cmp_eq_u32 s71, -1
 s_cselect_b32 s70, 1, s70
 s_cmp_lt_u32 s6, 64
 s_cselect_b32 s71, s72, 0
 s_cmp_eq_u32 s71, -1
 s_cselect_b32 s70, 0, s70
 s_cmp_lt_u32 s70, 2
 s_cbranch_scc1 sc_376
 s_sub_u32 s83, s83, 1
 s_cmp_lg_u32 s83, 0
 s_cbranch_scc1 sc_375
 s_mov_b32 s70, 3
sc_376:
 v_mov_b32 v5, s70
 v_mov_b32 v6, 163832
 ds_write_b32 v6, v5
 s_waitcnt lgkmcnt(0)
sc_374:
 s_barrier
 v_mov_b32 v6, 163832
 ds_read_b32 v61, v6
 s_waitcnt lgkmcnt(0)
 v_readfirstlane_b32 s94, v61
 s_cmp_ge_u32 s94, 2
 s_cbranch_scc1 k_exit
 s_mov_b32 s88, s6
 s_mov_b32 s89, s7
 s_add_u32 s88, s88, 2
 s_add_u32 s70, s89, 1
 s_cmp_lt_u32 s70, 30
 s_cselect_b32 s70, s70, s66
 s_add_u32 s71, s89, 6
 s_cmp_lt_u32 s89, 30
 s_cselect_b32 s89, s70, s71
 s_and_b32 s4, s94, 1
 s_cmp_eq_u32 s94, 0
 s_cselect_b32 s5, s6, s7
 s_cselect_b32 s6, s88, s6
 s_cmp_eq_u32 s94, 1
 s_cselect_b32 s7, s89, s7
 s_mov_b32 s78, 65536
 s_mul_i32 s81, s4, 5636096
 s_add_u32 s81, s81, 148619264
 s_mul_i32 s70, s5, 88064
 s_add_u32 s81, s81, s70
 s_mul_i32 s70, s82, 44032
 s_add_u32 s81, s81, s70
 s_mul_i32 s97, s3, 11264
 s_min_u32 s97, s97, 32768
 s_add_u32 s96, s97, s78
 s_add_u32 s97, s97, s81
 s_sub_u32 s97, s97, 4096
 s_add_u32 m0, s96, 0
 s_add_u32 s97, s97, 4096
 buffer_load_dwordx4 v2, s[52:55], s97 offen offset:0 sc1 lds
 buffer_load_dwordx4 v2, s[52:55], s97 offen offset:1024 sc1 lds
 buffer_load_dwordx4 v2, s[52:55], s97 offen offset:2048 sc1 lds
 buffer_load_dwordx4 v2, s[52:55], s97 offen offset:3072 sc1 lds
 s_add_u32 m0, s96, 4096
 s_add_u32 s97, s97, 4096
 buffer_load_dwordx4 v2, s[52:55], s97 offen offset:0 sc1 lds
 buffer_load_dwordx4 v2, s[52:55], s97 offen offset:1024 sc1 lds
 buffer_load_dwordx4 v2, s[52:55], s97 offen offset:2048 sc1 lds
 buffer_load_dwordx4 v2, s[52:55], s97 offen offset:3072 sc1 lds
 s_add_u32 m0, s96, 8192
 s_add_u32 s97, s97, 4096
 buffer_load_dwordx4 v2, s[52:55], s97 offen offset:0 sc1 lds
 buffer_load_dwordx4 v2, s[52:55], s97 offen offset:1024 sc1 lds
 buffer_load_dwordx4 v2, s[52:55], s97 offen offset:2048 sc1 lds
sc_378:
 s_cmp_lg_u32 s3, 0
 s_cbranch_scc1 sc_377
 s_min_u32 s70, s6, 63
 s_min_u32 s71, s7, 63
 s_lshl_b32 s70, s70, 8
 s_lshl_b32 s71, s71, 8
 v_add_u32 v15, s70, v56
 s_mov_b32 exec_lo, 0
 v_add_u32 v15, s71, v56
 s_mov_b32 exec_lo, s87
 s_mov_b32 exec_hi, s87
 buffer_load_dwordx2 v[62:63], v15, s[52:55], 0 offen sc1
 s_mov_b64 exec, -1
 s_waitcnt vmcnt(0)
 v_cmp_ge_u32 s[72:73], v62, v57
 v_cmp_ge_u32 s[74:75], v63, v58
 s_and_b64 s[72:73], s[72:73], s[74:75]
 s_mov_b32 s70, 2
 s_cmp_lt_u32 s7, 64
 s_cselect_b32 s71, s73, 0
 s_cmp_eq_u32 s71, -1
 s_cselect_b32 s70, 1, s70
 s_cmp_lt_u32 s6, 64
 s_cselect_b32 s71, s72, 0
 s_cmp_eq_u32 s71, -1
 s_cselect_b32 s70, 0, s70
 v_mov_b32 v5, s70
 v_mov_b32 v6, s95
 ds_write_b32 v6, v5
 s_waitcnt lgkmcnt(0)
sc_377:
 s_waitcnt vmcnt(0)
 v_mov_b32 v6, s95
 s_barrier
 ds_read_b32 v61, v6
 s_xor_b32 s95, s95, 4
 s_waitcnt lgkmcnt(0)
 v_readfirstlane_b32 s94, v61
 s_branch down_pro1
down_pro1:
 s_mov_b32 s90, 0
 ds_read_b128 v[28:31], v12 offset:0
 ds_read_b128 v[32:35], v12 offset:1024
 ds_read_b128 v[36:39], v12 offset:2048
 ds_read_b128 v[40:43], v12 offset:3072
 ds_read_b128 v[44:47], v12 offset:4096
 ds_read_b128 v[16:19], v12 offset:5120
 s_cmp_ge_u32 s94, 2
 s_cbranch_scc1 down_plain1
down_run1:
 s_cmp_lt_u32 s94, 2
 s_cselect_b64 vcc, -1, 0
 ds_read_b128 v[20:23], v12 offset:6144
 s_waitcnt lgkmcnt(6)
 v_mfma_f32_32x32x16_bf16 v[96:111], a[0:3], v[28:31], 0
 s_mov_b32 s68, s4
 s_mov_b32 s67, s5
 s_mov_b32 s88, s6
 s_mov_b32 s89, s7
 v_mfma_f32_32x32x16_bf16 v[112:127], a[4:7], v[28:31], 0
 s_add_u32 s88, s88, 2
 s_add_u32 s70, s89, 1
 s_cmp_lt_u32 s70, 30
 s_cselect_b32 s70, s70, s66
 ds_read_b128 v[24:27], v12 offset:7168
 s_waitcnt lgkmcnt(6)
 v_mfma_f32_32x32x16_bf16 v[96:111], a[8:11], v[32:35], v[96:111]
 s_add_u32 s71, s89, 6
 s_cmp_lt_u32 s89, 30
 s_cselect_b32 s89, s70, s71
 s_and_b32 s4, s94, 1
 s_barrier
 v_mfma_f32_32x32x16_bf16 v[112:127], a[12:15], v[32:35], v[112:127]
 s_cmp_eq_u32 s94, 0
 s_cselect_b32 s5, s6, s7
 s_cselect_b32 s6, s88, s6
 s_cmp_eq_u32 s94, 1
 s_cselect_b32 s7, s89, s7
 ds_read_b128 v[28:31], v12 offset:8192
 s_waitcnt lgkmcnt(6)
 v_mfma_f32_32x32x16_bf16 v[96:111], a[16:19], v[36:39], v[96:111]
 s_mov_b32 s78, 0
 s_mul_i32 s81, s4, 5636096
 s_add_u32 s81, s81, 148619264
 s_mul_i32 s70, s5, 88064
 s_bitcmp1_b32 s90, 0
 s_cbranch_scc0 g_381
 buffer_store_dwordx4 v[64:67], v4, s[52:55], s91 offen offset:0 sc1
g_381:
 v_mfma_f32_32x32x16_bf16 v[112:127], a[20:23], v[36:39], v[112:127]
 s_add_u32 s81, s81, s70
 s_mul_i32 s70, s82, 44032
 s_add_u32 s81, s81, s70
 s_mul_i32 s97, s3, 11264
 s_bitcmp1_b32 s90, 0
 s_cbranch_scc0 g_382
 buffer_store_dwordx4 v[68:71], v4, s[52:55], s91 offen offset:1024 sc1
g_382:
 ds_read_b128 v[32:35], v12 offset:9216
 s_waitcnt lgkmcnt(6)
 v_mfma_f32_32x32x16_bf16 v[96:111], a[24:27], v[40:43], v[96:111]
 s_min_u32 s97, s97, 32768
 s_add_u32 s96, s97, s78
 s_add_u32 s97, s97, s81
 s_sub_u32 s97, s97, 4096
 s_bitcmp1_b32 s90, 0
 s_cbranch_scc0 g_383
 buffer_store_dwordx4 v[72:75], v4, s[52:55], s91 offen offset:2048 sc1
g_383:
 v_mfma_f32_32x32x16_bf16 v[112:127], a[28:31], v[40:43], v[112:127]
 s_bitcmp1_b32 s90, 0
 s_cbranch_scc0 g_384
 buffer_store_dwordx4 v[76:79], v4, s[52:55], s91 offen offset:3072 sc1
g_384:
 s_cbranch_vccz g_385
 s_add_u32 m0, s96, 0
 s_add_u32 s97, s97, 4096
 buffer_load_dwordx4 v2, s[52:55], s97 offen offset:0 sc1 lds
g_385:
 ds_read_b128 v[36:39], v12 offset:10240
 s_waitcnt lgkmcnt(6)
 v_mfma_f32_32x32x16_bf16 v[96:111], a[32:35], v[44:47], v[96:111]
 s_bitcmp1_b32 s90, 0
 s_cbranch_scc0 g_386
 buffer_store_dwordx4 v[80:83], v11, s[52:55], s91 offen offset:0 sc1
g_386:
 s_cbranch_vccz g_387
 buffer_load_dwordx4 v2, s[52:55], s97 offen offset:1024 sc1 lds
g_387:
 v_mfma_f32_32x32x16_bf16 v[112:127], a[36:39], v[44:47], v[112:127]
 s_bitcmp1_b32 s90, 0
 s_cbranch_scc0 g_388
 buffer_store_dwordx4 v[84:87], v11, s[52:55], s91 offen offset:1024 sc1
g_388:
 s_cbranch_vccz g_389
 buffer_load_dwordx4 v2, s[52:55], s97 offen offset:2048 sc1 lds
g_389:
 ds_read_b128 v[40:43], v12 offset:11264
 s_waitcnt lgkmcnt(6)
 v_mfma_f32_32x32x16_bf16 v[96:111], a[40:43], v[16:19], v[96:111]
 s_bitcmp1_b32 s90, 0
 s_cbranch_scc0 g_390
 buffer_store_dwordx4 v[88:91], v11, s[52:55], s91 offen offset:2048 sc1
g_390:
 s_cbranch_vccz g_391
 buffer_load_dwordx4 v2, s[52:55], s97 offen offset:3072 sc1 lds
g_391:
 v_mfma_f32_32x32x16_bf16 v[112:127], a[44:47], v[16:19], v[112:127]
 s_bitcmp1_b32 s90, 0
 s_cbranch_scc0 g_392
 buffer_store_dwordx4 v[92:95], v11, s[52:55], s91 offen offset:3072 sc1
g_392:
 s_cbranch_vccz g_393
 s_add_u32 m0, s96, 4096
 s_add_u32 s97, s97, 4096
 buffer_load_dwordx4 v2, s[52:55], s97 offen offset:0 sc1 lds
g_393:
 ds_read_b128 v[44:47], v12 offset:12288
 s_waitcnt lgkmcnt(6)
 v_mfma_f32_32x32x16_bf16 v[96:111], a[48:51], v[20:23], v[96:111]
 s_cbranch_vccz g_394
 buffer_load_dwordx4 v2, s[52:55], s97 offen offset:1024 sc1 lds
g_394:
 v_mfma_f32_32x32x16_bf16 v[112:127], a[52:55], v[20:23], v[112:127]
 s_cbranch_vccz g_395
 buffer_load_dwordx4 v2, s[52:55], s97 offen offset:2048 sc1 lds
g_395:
 ds_read_b128 v[16:19], v12 offset:13312
 s_waitcnt lgkmcnt(6)
 v_mfma_f32_32x32x16_bf16 v[96:111], a[56:59], v[24:27], v[96:111]
 s_cbranch_vccz g_396
 buffer_load_dwordx4 v2, s[52:55], s97 offen offset:3072 sc1 lds
g_396:
 v_mfma_f32_32x32x16_bf16 v[112:127], a[60:63], v[24:27], v[112:127]
 s_cbranch_vccz g_397
 s_add_u32 m0, s96, 8192
 s_add_u32 s97, s97, 4096
 buffer_load_dwordx4 v2, s[52:55], s97 offen offset:0 sc1 lds
g_397:
 ds_read_b128 v[20:23], v12 offset:14336
 s_waitcnt lgkmcnt(6)
 v_mfma_f32_32x32x16_bf16 v[96:111], a[64:67], v[28:31], v[96:111]
 s_cbranch_vccz g_398
 buffer_load_dwordx4 v2, s[52:55], s97 offen offset:1024 sc1 lds
g_398:
 v_mfma_f32_32x32x16_bf16 v[112:127], a[68:71], v[28:31], v[112:127]
 s_cbranch_vccz g_399
 buffer_load_dwordx4 v2, s[52:55], s97 offen offset:2048 sc1 lds
g_399:
 ds_read_b128 v[24:27], v12 offset:15360
 s_waitcnt lgkmcnt(6)
 v_mfma_f32_32x32x16_bf16 v[96:111], a[72:75], v[32:35], v[96:111]
 s_bitcmp1_b32 s90, 1
 s_cbranch_scc0 es_400
 s_cbranch_vccz es_401
 s_waitcnt vmcnt(11)
 s_branch es_402
es_401:
 s_waitcnt vmcnt(0)
es_402:
 s_mov_b64 exec, 1
 buffer_store_dword v0, v10, s[52:55], s69 offen sc1
 s_mov_b64 exec, -1
es_400:
 s_mul_i32 s80, s68, 8388608
 s_add_u32 s80, s80, 159891456
 s_lshl_b32 s70, s67, 17
 s_add_u32 s80, s80, s70
 v_mfma_f32_32x32x16_bf16 v[112:127], a[76:79], v[32:35], v[112:127]
 s_lshl_b32 s70, s98, 11
 s_add_u32 s80, s80, s70
 s_mul_i32 s101, s68, 65
 s_add_u32 s101, s101, s67
 ds_read_b128 v[28:31], v12 offset:16384
 s_waitcnt lgkmcnt(6)
 v_mfma_f32_32x32x16_bf16 v[96:111], a[80:83], v[36:39], v[96:111]
 s_lshl_b32 s101, s101, 8
 s_add_u32 s101, s101, 133120
 s_add_u32 s101, s101, s98
 v_mfma_f32_32x32x16_bf16 v[112:127], a[84:87], v[36:39], v[112:127]
 s_cmp_lg_u32 s3, 0
 s_cbranch_scc1 w0_403
 s_min_u32 s70, s6, 63
 s_min_u32 s71, s7, 63
 s_lshl_b32 s70, s70, 8
 s_lshl_b32 s71, s71, 8
 v_add_u32 v15, s70, v56
 s_mov_b32 exec_lo, 0
 v_add_u32 v15, s71, v56
 s_mov_b32 exec_lo, s87
 s_mov_b32 exec_hi, s87
 buffer_load_dwordx2 v[62:63], v15, s[52:55], 0 offen sc1
 s_mov_b64 exec, -1
w0_403:
 ds_read_b128 v[32:35], v12 offset:17408
 s_waitcnt lgkmcnt(6)
 v_mfma_f32_32x32x16_bf16 v[96:111], a[88:91], v[40:43], v[96:111]
 v_mfma_f32_32x32x16_bf16 v[112:127], a[92:95], v[40:43], v[112:127]
 ds_read_b128 v[36:39], v12 offset:18432
 s_waitcnt lgkmcnt(6)
 v_mfma_f32_32x32x16_bf16 v[96:111], a[96:99], v[44:47], v[96:111]
 v_mfma_f32_32x32x16_bf16 v[112:127], a[100:103], v[44:47], v[112:127]
 ds_read_b128 v[40:43], v12 offset:19456
 s_waitcnt lgkmcnt(6)
 v_mfma_f32_32x32x16_bf16 v[96:111], a[104:107], v[16:19], v[96:111]
 v_mfma_f32_32x32x16_bf16 v[112:127], a[108:111], v[16:19], v[112:127]
 ds_read_b128 v[44:47], v12 offset:20480
 s_waitcnt lgkmcnt(6)
 v_mfma_f32_32x32x16_bf16 v[96:111], a[112:115], v[20:23], v[96:111]
 v_mfma_f32_32x32x16_bf16 v[112:127], a[116:119], v[20:23], v[112:127]
 ds_read_b128 v[16:19], v12 offset:21504
 s_waitcnt lgkmcnt(6)
 v_mfma_f32_32x32x16_bf16 v[96:111], a[120:123], v[24:27], v[96:111]
 v_mfma_f32_32x32x16_bf16 v[112:127], a[124:127], v[24:27], v[112:127]
 ds_read_b128 v[20:23], v12 offset:22528
 s_waitcnt lgkmcnt(6)
 v_mfma_f32_32x32x16_bf16 v[96:111], a[128:131], v[28:31], v[96:111]
 v_mfma_f32_32x32x16_bf16 v[112:127], a[132:135], v[28:31], v[112:127]
 ds_read_b128 v[24:27], v12 offset:23552
 s_waitcnt lgkmcnt(6)
 v_mfma_f32_32x32x16_bf16 v[96:111], a[136:139], v[32:35], v[96:111]
 v_mfma_f32_32x32x16_bf16 v[112:127], a[140:143], v[32:35], v[112:127]
 ds_read_b128 v[28:31], v12 offset:24576
 s_waitcnt lgkmcnt(6)
 v_mfma_f32_32x32x16_bf16 v[96:111], a[144:147], v[36:39], v[96:111]
 v_mfma_f32_32x32x16_bf16 v[112:127], a[148:151], v[36:39], v[112:127]
 ds_read_b128 v[32:35], v12 offset:25600
 s_waitcnt lgkmcnt(6)
 v_mfma_f32_32x32x16_bf16 v[96:111], a[152:155], v[40:43], v[96:111]
 v_mfma_f32_32x32x16_bf16 v[112:127], a[156:159], v[40:43], v[112:127]
 ds_read_b128 v[36:39], v12 offset:26624
 s_waitcnt lgkmcnt(6)
 v_mfma_f32_32x32x16_bf16 v[96:111], a[160:163], v[44:47], v[96:111]
 v_mfma_f32_32x32x16_bf16 v[112:127], a[164:167], v[44:47], v[112:127]
 ds_read_b128 v[40:43], v12 offset:27648
 s_waitcnt lgkmcnt(6)
 v_mfma_f32_32x32x16_bf16 v[96:111], a[168:171], v[16:19], v[96:111]
 v_mfma_f32_32x32x16_bf16 v[112:127], a[172:175], v[16:19], v[112:127]
 ds_read_b128 v[44:47], v12 offset:28672
 s_waitcnt lgkmcnt(6)
 v_mfma_f32_32x32x16_bf16 v[96:111], a[176:179], v[20:23], v[96:111]
 v_mfma_f32_32x32x16_bf16 v[112:127], a[180:183], v[20:23], v[112:127]
 ds_read_b128 v[16:19], v12 offset:29696
 s_waitcnt lgkmcnt(6)
 v_mfma_f32_32x32x16_bf16 v[96:111], a[184:187], v[24:27], v[96:111]
 v_mfma_f32_32x32x16_bf16 v[112:127], a[188:191], v[24:27], v[112:127]
 ds_read_b128 v[20:23], v12 offset:30720
 s_waitcnt lgkmcnt(6)
 v_mfma_f32_32x32x16_bf16 v[96:111], a[192:195], v[28:31], v[96:111]
 v_mfma_f32_32x32x16_bf16 v[112:127], a[196:199], v[28:31], v[112:127]
 ds_read_b128 v[24:27], v12 offset:31744
 s_waitcnt lgkmcnt(6)
 v_mfma_f32_32x32x16_bf16 v[96:111], a[200:203], v[32:35], v[96:111]
 v_mfma_f32_32x32x16_bf16 v[112:127], a[204:207], v[32:35], v[112:127]
 ds_read_b128 v[28:31], v12 offset:32768
 s_waitcnt lgkmcnt(6)
 v_mfma_f32_32x32x16_bf16 v[96:111], a[208:211], v[36:39], v[96:111]
 v_mfma_f32_32x32x16_bf16 v[112:127], a[212:215], v[36:39], v[112:127]
 ds_read_b128 v[32:35], v12 offset:33792
 s_waitcnt lgkmcnt(6)
 v_mfma_f32_32x32x16_bf16 v[96:111], a[216:219], v[40:43], v[96:111]
 v_mfma_f32_32x32x16_bf16 v[112:127], a[220:223], v[40:43], v[112:127]
 ds_read_b128 v[36:39], v12 offset:34816
 s_waitcnt lgkmcnt(6)
 v_mfma_f32_32x32x16_bf16 v[96:111], a[224:227], v[44:47], v[96:111]
 v_mfma_f32_32x32x16_bf16 v[112:127], a[228:231], v[44:47], v[112:127]
 ds_read_b128 v[40:43], v12 offset:35840
 s_waitcnt lgkmcnt(6)
 v_mfma_f32_32x32x16_bf16 v[96:111], a[232:235], v[16:19], v[96:111]
 v_mfma_f32_32x32x16_bf16 v[112:127], a[236:239], v[16:19], v[112:127]
 ds_read_b128 v[44:47], v12 offset:36864
 s_waitcnt lgkmcnt(6)
 v_mfma_f32_32x32x16_bf16 v[96:111], a[240:243], v[20:23], v[96:111]
 v_mfma_f32_32x32x16_bf16 v[112:127], a[244:247], v[20:23], v[112:127]
 ds_read_b128 v[16:19], v12 offset:37888
 s_waitcnt lgkmcnt(6)
 v_mfma_f32_32x32x16_bf16 v[96:111], a[248:251], v[24:27], v[96:111]
 v_mfma_f32_32x32x16_bf16 v[112:127], a[252:255], v[24:27], v[112:127]
 ds_read_b128 v[20:23], v12 offset:38912
 s_waitcnt lgkmcnt(6)
 v_mfma_f32_32x32x16_bf16 v[96:111], v[168:171], v[28:31], v[96:111]
 v_mfma_f32_32x32x16_bf16 v[112:127], v[172:175], v[28:31], v[112:127]
 ds_read_b128 v[24:27], v12 offset:39936
 s_waitcnt lgkmcnt(6)
 v_mfma_f32_32x32x16_bf16 v[96:111], v[176:179], v[32:35], v[96:111]
 s_waitcnt vmcnt(0)
 s_bitcmp1_b32 s90, 0
 s_cbranch_scc0 sg_404
 s_mov_b64 exec, 1
 buffer_store_dword v0, v10, s[52:55], s69 offen sc1
 s_mov_b64 exec, -1
sg_404:
 s_cmp_lg_u32 s3, 0
 s_cbranch_scc1 w0_405
 v_cmp_ge_u32 s[72:73], v62, v57
 v_cmp_ge_u32 s[74:75], v63, v58
 s_and_b64 s[72:73], s[72:73], s[74:75]
 s_mov_b32 s70, 2
 s_cmp_lt_u32 s7, 64
 s_cselect_b32 s71, s73, 0
 s_cmp_eq_u32 s71, -1
 s_cselect_b32 s70, 1, s70
 s_cmp_lt_u32 s6, 64
 s_cselect_b32 s71, s72, 0
 s_cmp_eq_u32 s71, -1
 s_cselect_b32 s70, 0, s70
 v_mov_b32 v5, s70
 v_mov_b32 v6, s95
 ds_write_b32 v6, v5
w0_405:
 v_mfma_f32_32x32x16_bf16 v[112:127], v[180:183], v[32:35], v[112:127]
 ds_read_b128 v[28:31], v12 offset:40960
 s_waitcnt lgkmcnt(6)
 v_mfma_f32_32x32x16_bf16 v[96:111], v[184:187], v[36:39], v[96:111]
 v_mfma_f32_32x32x16_bf16 v[112:127], v[188:191], v[36:39], v[112:127]
 ds_read_b128 v[32:35], v12 offset:41984
 s_waitcnt lgkmcnt(6)
 v_mfma_f32_32x32x16_bf16 v[96:111], v[192:195], v[40:43], v[96:111]
 v_mov_b32 v6, s95
 s_waitcnt lgkmcnt(2)
 s_barrier
 ds_read_b32 v61, v6
 s_xor_b32 s95, s95, 4
 v_mfma_f32_32x32x16_bf16 v[112:127], v[196:199], v[40:43], v[112:127]
 ds_read_b128 v[36:39], v12 offset:43008
 s_waitcnt lgkmcnt(6)
 v_mfma_f32_32x32x16_bf16 v[96:111], v[200:203], v[44:47], v[96:111]
 v_mfma_f32_32x32x16_bf16 v[112:127], v[204:207], v[44:47], v[112:127]
 s_cbranch_vccz down_tail1
 s_waitcnt lgkmcnt(5)
 v_mfma_f32_32x32x16_bf16 v[96:111], v[208:211], v[16:19], v[96:111]
 v_mfma_f32_32x32x16_bf16 v[112:127], v[212:215], v[16:19], v[112:127]
 s_waitcnt lgkmcnt(4)
 v_mfma_f32_32x32x16_bf16 v[96:111], v[216:219], v[20:23], v[96:111]
 v_mfma_f32_32x32x16_bf16 v[112:127], v[220:223], v[20:23], v[112:127]
 s_waitcnt lgkmcnt(3)
 v_mfma_f32_32x32x16_bf16 v[96:111], v[224:227], v[24:27], v[96:111]
 v_mfma_f32_32x32x16_bf16 v[112:127], v[228:231], v[24:27], v[112:127]
 s_waitcnt lgkmcnt(2)
 v_mfma_f32_32x32x16_bf16 v[96:111], v[232:235], v[28:31], v[96:111]
 v_mfma_f32_32x32x16_bf16 v[112:127], v[236:239], v[28:31], v[112:127]
 s_waitcnt lgkmcnt(1)
 v_mfma_f32_32x32x16_bf16 v[96:111], v[240:243], v[32:35], v[96:111]
 v_mfma_f32_32x32x16_bf16 v[112:127], v[244:247], v[32:35], v[112:127]
 s_mov_b32 s90, 1
 s_mov_b32 s91, s80
 s_mov_b32 s69, s101
 s_waitcnt lgkmcnt(0)
 v_mfma_f32_32x32x16_bf16 v[96:111], v[248:251], v[36:39], v[96:111]
 v_mfma_f32_32x32x16_bf16 v[112:127], v[252:255], v[36:39], v[112:127]
 ds_read_b128 v[16:19], v3 offset:0
 ds_read_b128 v[20:23], v3 offset:1024
 ds_read_b128 v[24:27], v3 offset:2048
 ds_read_b128 v[28:31], v3 offset:3072
 ds_read_b128 v[32:35], v3 offset:4096
 ds_read_b128 v[36:39], v3 offset:5120
 v_readfirstlane_b32 s94, v61
 s_cmp_ge_u32 s6, 64
 s_cselect_b32 s70, 0, s68
 s_cmp_lg_u32 s70, 0
 s_cbranch_scc1 down_run0
 s_mov_b32 s90, 2
 s_nop 7
 buffer_store_dwordx4 v[96:99], v4, s[52:55], s80 offen offset:0 sc1
 buffer_store_dwordx4 v[100:103], v4, s[52:55], s80 offen offset:1024 sc1
 buffer_store_dwordx4 v[104:107], v4, s[52:55], s80 offen offset:2048 sc1
 buffer_store_dwordx4 v[108:111], v4, s[52:55], s80 offen offset:3072 sc1
 buffer_store_dwordx4 v[112:115], v11, s[52:55], s80 offen offset:0 sc1
 buffer_store_dwordx4 v[116:119], v11, s[52:55], s80 offen offset:1024 sc1
 buffer_store_dwordx4 v[120:123], v11, s[52:55], s80 offen offset:2048 sc1
 buffer_store_dwordx4 v[124:127], v11, s[52:55], s80 offen offset:3072 sc1
 s_branch down_run0
down_plain1:
 ds_read_b128 v[20:23], v12 offset:6144
 s_waitcnt lgkmcnt(6)
 v_mfma_f32_32x32x16_bf16 v[96:111], a[0:3], v[28:31], 0
 s_mov_b32 s68, s4
 s_mov_b32 s67, s5
 s_mul_i32 s80, s68, 8388608
 s_add_u32 s80, s80, 159891456
 v_mfma_f32_32x32x16_bf16 v[112:127], a[4:7], v[28:31], 0
 s_lshl_b32 s70, s67, 17
 s_add_u32 s80, s80, s70
 s_lshl_b32 s70, s98, 11
 s_add_u32 s80, s80, s70
 ds_read_b128 v[24:27], v12 offset:7168
 s_waitcnt lgkmcnt(6)
 v_mfma_f32_32x32x16_bf16 v[96:111], a[8:11], v[32:35], v[96:111]
 s_mul_i32 s101, s68, 65
 s_add_u32 s101, s101, s67
 s_lshl_b32 s101, s101, 8
 s_add_u32 s101, s101, 133120
 s_barrier
 v_mfma_f32_32x32x16_bf16 v[112:127], a[12:15], v[32:35], v[112:127]
 s_add_u32 s101, s101, s98
 ds_read_b128 v[28:31], v12 offset:8192
 s_waitcnt lgkmcnt(6)
 v_mfma_f32_32x32x16_bf16 v[96:111], a[16:19], v[36:39], v[96:111]
 v_mfma_f32_32x32x16_bf16 v[112:127], a[20:23], v[36:39], v[112:127]
 ds_read_b128 v[32:35], v12 offset:9216
 s_waitcnt lgkmcnt(6)
 v_mfma_f32_32x32x16_bf16 v[96:111], a[24:27], v[40:43], v[96:111]
 v_mfma_f32_32x32x16_bf16 v[112:127], a[28:31], v[40:43], v[112:127]
 ds_read_b128 v[36:39], v12 offset:10240
 s_waitcnt lgkmcnt(6)
 v_mfma_f32_32x32x16_bf16 v[96:111], a[32:35], v[44:47], v[96:111]
 v_mfma_f32_32x32x16_bf16 v[112:127], a[36:39], v[44:47], v[112:127]
 ds_read_b128 v[40:43], v12 offset:11264
 s_waitcnt lgkmcnt(6)
 v_mfma_f32_32x32x16_bf16 v[96:111], a[40:43], v[16:19], v[96:111]
 v_mfma_f32_32x32x16_bf16 v[112:127], a[44:47], v[16:19], v[112:127]
 ds_read_b128 v[44:47], v12 offset:12288
 s_waitcnt lgkmcnt(6)
 v_mfma_f32_32x32x16_bf16 v[96:111], a[48:51], v[20:23], v[96:111]
 v_mfma_f32_32x32x16_bf16 v[112:127], a[52:55], v[20:23], v[112:127]
 ds_read_b128 v[16:19], v12 offset:13312
 s_waitcnt lgkmcnt(6)
 v_mfma_f32_32x32x16_bf16 v[96:111], a[56:59], v[24:27], v[96:111]
 v_mfma_f32_32x32x16_bf16 v[112:127], a[60:63], v[24:27], v[112:127]
 ds_read_b128 v[20:23], v12 offset:14336
 s_waitcnt lgkmcnt(6)
 v_mfma_f32_32x32x16_bf16 v[96:111], a[64:67], v[28:31], v[96:111]
 v_mfma_f32_32x32x16_bf16 v[112:127], a[68:71], v[28:31], v[112:127]
 ds_read_b128 v[24:27], v12 offset:15360
 s_waitcnt lgkmcnt(6)
 v_mfma_f32_32x32x16_bf16 v[96:111], a[72:75], v[32:35], v[96:111]
 v_mfma_f32_32x32x16_bf16 v[112:127], a[76:79], v[32:35], v[112:127]
 ds_read_b128 v[28:31], v12 offset:16384
 s_waitcnt lgkmcnt(6)
 v_mfma_f32_32x32x16_bf16 v[96:111], a[80:83], v[36:39], v[96:111]
 v_mfma_f32_32x32x16_bf16 v[112:127], a[84:87], v[36:39], v[112:127]
 ds_read_b128 v[32:35], v12 offset:17408
 s_waitcnt lgkmcnt(6)
 v_mfma_f32_32x32x16_bf16 v[96:111], a[88:91], v[40:43], v[96:111]
 v_mfma_f32_32x32x16_bf16 v[112:127], a[92:95], v[40:43], v[112:127]
 ds_read_b128 v[36:39], v12 offset:18432
 s_waitcnt lgkmcnt(6)
 v_mfma_f32_32x32x16_bf16 v[96:111], a[96:99], v[44:47], v[96:111]
 v_mfma_f32_32x32x16_bf16 v[112:127], a[100:103], v[44:47], v[112:127]
 ds_read_b128 v[40:43], v12 offset:19456
 s_waitcnt lgkmcnt(6)
 v_mfma_f32_32x32x16_bf16 v[96:111], a[104:107], v[16:19], v[96:111]
 v_mfma_f32_32x32x16_bf16 v[112:127], a[108:111], v[16:19], v[112:127]
 ds_read_b128 v[44:47], v12 offset:20480
 s_waitcnt lgkmcnt(6)
 v_mfma_f32_32x32x16_bf16 v[96:111], a[112:115], v[20:23], v[96:111]
 v_mfma_f32_32x32x16_bf16 v[112:127], a[116:119], v[20:23], v[112:127]
 ds_read_b128 v[16:19], v12 offset:21504
 s_waitcnt lgkmcnt(6)
 v_mfma_f32_32x32x16_bf16 v[96:111], a[120:123], v[24:27], v[96:111]
 v_mfma_f32_32x32x16_bf16 v[112:127], a[124:127], v[24:27], v[112:127]
 ds_read_b128 v[20:23], v12 offset:22528
 s_waitcnt lgkmcnt(6)
 v_mfma_f32_32x32x16_bf16 v[96:111], a[128:131], v[28:31], v[96:111]
 v_mfma_f32_32x32x16_bf16 v[112:127], a[132:135], v[28:31], v[112:127]
 ds_read_b128 v[24:27], v12 offset:23552
 s_waitcnt lgkmcnt(6)
 v_mfma_f32_32x32x16_bf16 v[96:111], a[136:139], v[32:35], v[96:111]
 v_mfma_f32_32x32x16_bf16 v[112:127], a[140:143], v[32:35], v[112:127]
 ds_read_b128 v[28:31], v12 offset:24576
 s_waitcnt lgkmcnt(6)
 v_mfma_f32_32x32x16_bf16 v[96:111], a[144:147], v[36:39], v[96:111]
 v_mfma_f32_32x32x16_bf16 v[112:127], a[148:151], v[36:39], v[112:127]
 ds_read_b128 v[32:35], v12 offset:25600
 s_waitcnt lgkmcnt(6)
 v_mfma_f32_32x32x16_bf16 v[96:111], a[152:155], v[40:43], v[96:111]
 v_mfma_f32_32x32x16_bf16 v[112:127], a[156:159], v[40:43], v[112:127]
 ds_read_b128 v[36:39], v12 offset:26624
 s_waitcnt lgkmcnt(6)
 v_mfma_f32_32x32x16_bf16 v[96:111], a[160:163], v[44:47], v[96:111]
 v_mfma_f32_32x32x16_bf16 v[112:127], a[164:167], v[44:47], v[112:127]
 ds_read_b128 v[40:43], v12 offset:27648
 s_waitcnt lgkmcnt(6)
 v_mfma_f32_32x32x16_bf16 v[96:111], a[168:171], v[16:19], v[96:111]
 v_mfma_f32_32x32x16_bf16 v[112:127], a[172:175], v[16:19], v[112:127]
 ds_read_b128 v[44:47], v12 offset:28672
 s_waitcnt lgkmcnt(6)
 v_mfma_f32_32x32x16_bf16 v[96:111], a[176:179], v[20:23], v[96:111]
 v_mfma_f32_32x32x16_bf16 v[112:127], a[180:183], v[20:23], v[112:127]
 ds_read_b128 v[16:19], v12 offset:29696
 s_waitcnt lgkmcnt(6)
 v_mfma_f32_32x32x16_bf16 v[96:111], a[184:187], v[24:27], v[96:111]
 v_mfma_f32_32x32x16_bf16 v[112:127], a[188:191], v[24:27], v[112:127]
 ds_read_b128 v[20:23], v12 offset:30720
 s_waitcnt lgkmcnt(6)
 v_mfma_f32_32x32x16_bf16 v[96:111], a[192:195], v[28:31], v[96:111]
 v_mfma_f32_32x32x16_bf16 v[112:127], a[196:199], v[28:31], v[112:127]
 ds_read_b128 v[24:27], v12 offset:31744
 s_waitcnt lgkmcnt(6)
 v_mfma_f32_32x32x16_bf16 v[96:111], a[200:203], v[32:35], v[96:111]
 s_cmp_lg_u32 s3, 0
 s_cbranch_scc1 w0_406
 s_min_u32 s70, s6, 63
 s_min_u32 s71, s7, 63
 s_lshl_b32 s70, s70, 8
 s_lshl_b32 s71, s71, 8
 v_add_u32 v15, s70, v56
 s_mov_b32 exec_lo, 0
 v_add_u32 v15, s71, v56
 s_mov_b32 exec_lo, s87
 s_mov_b32 exec_hi, s87
 buffer_load_dwordx2 v[62:63], v15, s[52:55], 0 offen sc1
 s_mov_b64 exec, -1
w0_406:
 v_mfma_f32_32x32x16_bf16 v[112:127], a[204:207], v[32:35], v[112:127]
 ds_read_b128 v[28:31], v12 offset:32768
 s_waitcnt lgkmcnt(6)
 v_mfma_f32_32x32x16_bf16 v[96:111], a[208:211], v[36:39], v[96:111]
 v_mfma_f32_32x32x16_bf16 v[112:127], a[212:215], v[36:39], v[112:127]
 ds_read_b128 v[32:35], v12 offset:33792
 s_waitcnt lgkmcnt(6)
 v_mfma_f32_32x32x16_bf16 v[96:111], a[216:219], v[40:43], v[96:111]
 v_mfma_f32_32x32x16_bf16 v[112:127], a[220:223], v[40:43], v[112:127]
 ds_read_b128 v[36:39], v12 offset:34816
 s_waitcnt lgkmcnt(6)
 v_mfma_f32_32x32x16_bf16 v[96:111], a[224:227], v[44:47], v[96:111]
 v_mfma_f32_32x32x16_bf16 v[112:127], a[228:231], v[44:47], v[112:127]
 ds_read_b128 v[40:43], v12 offset:35840
 s_waitcnt lgkmcnt(6)
 v_mfma_f32_32x32x16_bf16 v[96:111], a[232:235], v[16:19], v[96:111]
 v_mfma_f32_32x32x16_bf16 v[112:127], a[236:239], v[16:19], v[112:127]
 ds_read_b128 v[44:47], v12 offset:36864
 s_waitcnt lgkmcnt(6)
 v_mfma_f32_32x32x16_bf16 v[96:111], a[240:243], v[20:23], v[96:111]
 v_mfma_f32_32x32x16_bf16 v[112:127], a[244:247], v[20:23], v[112:127]
 ds_read_b128 v[16:19], v12 offset:37888
 s_waitcnt lgkmcnt(6)
 v_mfma_f32_32x32x16_bf16 v[96:111], a[248:251], v[24:27], v[96:111]
 v_mfma_f32_32x32x16_bf16 v[112:127], a[252:255], v[24:27], v[112:127]
 ds_read_b128 v[20:23], v12 offset:38912
 s_waitcnt lgkmcnt(6)
 v_mfma_f32_32x32x16_bf16 v[96:111], v[168:171], v[28:31], v[96:111]
 v_mfma_f32_32x32x16_bf16 v[112:127], v[172:175], v[28:31], v[112:127]
 ds_read_b128 v[24:27], v12 offset:39936
 s_waitcnt lgkmcnt(6)
 v_mfma_f32_32x32x16_bf16 v[96:111], v[176:179], v[32:35], v[96:111]
 s_cmp_lg_u32 s3, 0
 s_cbranch_scc1 w0_407
 s_waitcnt vmcnt(0)
 v_cmp_ge_u32 s[72:73], v62, v57
 v_cmp_ge_u32 s[74:75], v63, v58
 s_and_b64 s[72:73], s[72:73], s[74:75]
 s_mov_b32 s70, 2
 s_cmp_lt_u32 s7, 64
 s_cselect_b32 s71, s73, 0
 s_cmp_eq_u32 s71, -1
 s_cselect_b32 s70, 1, s70
 s_cmp_lt_u32 s6, 64
 s_cselect_b32 s71, s72, 0
 s_cmp_eq_u32 s71, -1
 s_cselect_b32 s70, 0, s70
 v_mov_b32 v5, s70
 v_mov_b32 v6, s95
 ds_write_b32 v6, v5
w0_407:
 v_mfma_f32_32x32x16_bf16 v[112:127], v[180:183], v[32:35], v[112:127]
 ds_read_b128 v[28:31], v12 offset:40960
 s_waitcnt lgkmcnt(6)
 v_mfma_f32_32x32x16_bf16 v[96:111], v[184:187], v[36:39], v[96:111]
 v_mfma_f32_32x32x16_bf16 v[112:127], v[188:191], v[36:39], v[112:127]
 ds_read_b128 v[32:35], v12 offset:41984
 s_waitcnt lgkmcnt(6)
 v_mfma_f32_32x32x16_bf16 v[96:111], v[192:195], v[40:43], v[96:111]
 v_mov_b32 v6, s95
 s_waitcnt lgkmcnt(2)
 s_barrier
 ds_read_b32 v61, v6
 s_xor_b32 s95, s95, 4
 v_mfma_f32_32x32x16_bf16 v[112:127], v[196:199], v[40:43], v[112:127]
 ds_read_b128 v[36:39], v12 offset:43008
 s_waitcnt lgkmcnt(6)
 v_mfma_f32_32x32x16_bf16 v[96:111], v[200:203], v[44:47], v[96:111]
 v_mfma_f32_32x32x16_bf16 v[112:127], v[204:207], v[44:47], v[112:127]
down_tail1:
 s_waitcnt lgkmcnt(5)
 v_mfma_f32_32x32x16_bf16 v[96:111], v[208:211], v[16:19], v[96:111]
 v_mfma_f32_32x32x16_bf16 v[112:127], v[212:215], v[16:19], v[112:127]
 s_waitcnt lgkmcnt(4)
 v_mfma_f32_32x32x16_bf16 v[96:111], v[216:219], v[20:23], v[96:111]
 v_mfma_f32_32x32x16_bf16 v[112:127], v[220:223], v[20:23], v[112:127]
 s_waitcnt lgkmcnt(3)
 v_mfma_f32_32x32x16_bf16 v[96:111], v[224:227], v[24:27], v[96:111]
 v_mfma_f32_32x32x16_bf16 v[112:127], v[228:231], v[24:27], v[112:127]
 s_waitcnt lgkmcnt(2)
 v_mfma_f32_32x32x16_bf16 v[96:111], v[232:235], v[28:31], v[96:111]
 v_mfma_f32_32x32x16_bf16 v[112:127], v[236:239], v[28:31], v[112:127]
 s_waitcnt lgkmcnt(1)
 v_mfma_f32_32x32x16_bf16 v[96:111], v[240:243], v[32:35], v[96:111]
 v_mfma_f32_32x32x16_bf16 v[112:127], v[244:247], v[32:35], v[112:127]
 s_waitcnt lgkmcnt(0)
 v_mfma_f32_32x32x16_bf16 v[96:111], v[248:251], v[36:39], v[96:111]
 v_mfma_f32_32x32x16_bf16 v[112:127], v[252:255], v[36:39], v[112:127]
 v_readfirstlane_b32 s94, v61
 s_mov_b32 s88, s6
 s_mov_b32 s89, s7
 s_add_u32 s88, s88, 2
 s_add_u32 s70, s89, 1
 s_cmp_lt_u32 s70, 30
 s_cselect_b32 s70, s70, s66
 s_add_u32 s71, s89, 6
 s_cmp_lt_u32 s89, 30
 s_cselect_b32 s89, s70, s71
 s_and_b32 s4, s94, 1
 s_cmp_eq_u32 s94, 0
 s_cselect_b32 s5, s6, s7
 s_cselect_b32 s6, s88, s6
 s_cmp_eq_u32 s94, 1
 s_cselect_b32 s7, s89, s7
 s_mov_b32 s78, 0
 s_mul_i32 s81, s4, 5636096
 s_add_u32 s81, s81, 148619264
 s_mul_i32 s70, s5, 88064
 s_add_u32 s81, s81, s70
 s_mul_i32 s70, s82, 44032
 s_add_u32 s81, s81, s70
 s_mul_i32 s97, s3, 11264
 s_min_u32 s97, s97, 32768
 s_add_u32 s96, s97, s78
 s_add_u32 s97, s97, s81
 s_sub_u32 s97, s97, 4096
 buffer_store_dwordx4 v[96:99], v4, s[52:55], s80 offen offset:0 sc1
 buffer_store_dwordx4 v[100:103], v4, s[52:55], s80 offen offset:1024 sc1
 buffer_store_dwordx4 v[104:107], v4, s[52:55], s80 offen offset:2048 sc1
 buffer_store_dwordx4 v[108:111], v4, s[52:55], s80 offen offset:3072 sc1
 buffer_store_dwordx4 v[112:115], v11, s[52:55], s80 offen offset:0 sc1
 buffer_store_dwordx4 v[116:119], v11, s[52:55], s80 offen offset:1024 sc1
 buffer_store_dwordx4 v[120:123], v11, s[52:55], s80 offen offset:2048 sc1
 buffer_store_dwordx4 v[124:127], v11, s[52:55], s80 offen offset:3072 sc1
 s_cmp_ge_u32 s94, 2
 s_cbranch_scc1 down_idle1
 s_add_u32 m0, s96, 0
 s_add_u32 s97, s97, 4096
 buffer_load_dwordx4 v2, s[52:55], s97 offen offset:0 sc1 lds
 buffer_load_dwordx4 v2, s[52:55], s97 offen offset:1024 sc1 lds
 buffer_load_dwordx4 v2, s[52:55], s97 offen offset:2048 sc1 lds
 buffer_load_dwordx4 v2, s[52:55], s97 offen offset:3072 sc1 lds
 s_add_u32 m0, s96, 4096
 s_add_u32 s97, s97, 4096
 buffer_load_dwordx4 v2, s[52:55], s97 offen offset:0 sc1 lds
 buffer_load_dwordx4 v2, s[52:55], s97 offen offset:1024 sc1 lds
 buffer_load_dwordx4 v2, s[52:55], s97 offen offset:2048 sc1 lds
 buffer_load_dwordx4 v2, s[52:55], s97 offen offset:3072 sc1 lds
 s_add_u32 m0, s96, 8192
 s_add_u32 s97, s97, 4096
 buffer_load_dwordx4 v2, s[52:55], s97 offen offset:0 sc1 lds
 buffer_load_dwordx4 v2, s[52:55], s97 offen offset:1024 sc1 lds
 buffer_load_dwordx4 v2, s[52:55], s97 offen offset:2048 sc1 lds
 s_waitcnt vmcnt(11)
 s_mov_b64 exec, 1
 buffer_store_dword v0, v10, s[52:55], s101 offen sc1
 s_mov_b64 exec, -1
 s_branch sc_412
down_idle1:
 s_mov_b32 s83, 0x200000
 s_cmp_lg_u32 s3, 0
 s_cbranch_scc1 nw_414
 s_min_u32 s70, s6, 63
 s_min_u32 s71, s7, 63
 s_lshl_b32 s70, s70, 8
 s_lshl_b32 s71, s71, 8
 v_add_u32 v15, s70, v56
 s_mov_b32 exec_lo, 0
 v_add_u32 v15, s71, v56
 s_mov_b32 exec_lo, s87
 s_mov_b32 exec_hi, s87
 buffer_load_dwordx2 v[62:63], v15, s[52:55], 0 offen sc1
 s_mov_b64 exec, -1
 s_waitcnt vmcnt(1)
 s_mov_b64 exec, 1
 buffer_store_dword v0, v10, s[52:55], s101 offen sc1
 s_mov_b64 exec, -1
 s_min_u32 s70, s6, s7
 s_cmp_ge_u32 s70, 64
 s_cbranch_scc1 k_exit
 s_waitcnt vmcnt(1)
 s_branch ev_413
nw_414:
 s_waitcnt vmcnt(0)
 s_mov_b64 exec, 1
 buffer_store_dword v0, v10, s[52:55], s101 offen sc1
 s_mov_b64 exec, -1
down_sched0:
 s_min_u32 s70, s6, s7
 s_cmp_ge_u32 s70, 64
 s_cbranch_scc1 k_exit
 s_cmp_lg_u32 s3, 0
 s_cbranch_scc1 sc_408
 s_mov_b32 s83, 0x200000
sc_409:
 s_min_u32 s70, s6, 63
 s_min_u32 s71, s7, 63
 s_lshl_b32 s70, s70, 8
 s_lshl_b32 s71, s71, 8
 v_add_u32 v15, s70, v56
 s_mov_b32 exec_lo, 0
 v_add_u32 v15, s71, v56
 s_mov_b32 exec_lo, s87
 s_mov_b32 exec_hi, s87
 buffer_load_dwordx2 v[62:63], v15, s[52:55], 0 offen sc1
 s_mov_b64 exec, -1
 s_waitcnt vmcnt(0)
ev_413:
 v_cmp_ge_u32 s[72:73], v62, v57
 v_cmp_ge_u32 s[74:75], v63, v58
 s_and_b64 s[72:73], s[72:73], s[74:75]
 s_mov_b32 s70, 2
 s_cmp_lt_u32 s7, 64
 s_cselect_b32 s71, s73, 0
 s_cmp_eq_u32 s71, -1
 s_cselect_b32 s70, 1, s70
 s_cmp_lt_u32 s6, 64
 s_cselect_b32 s71, s72, 0
 s_cmp_eq_u32 s71, -1
 s_cselect_b32 s70, 0, s70
 s_cmp_lt_u32 s70, 2
 s_cbranch_scc1 sc_410
 s_sub_u32 s83, s83, 1
 s_cmp_lg_u32 s83, 0
 s_cbranch_scc1 sc_409
 s_mov_b32 s70, 3
sc_410:
 v_mov_b32 v5, s70
 v_mov_b32 v6, 163832
 ds_write_b32 v6, v5
 s_waitcnt lgkmcnt(0)
sc_408:
 s_barrier
 v_mov_b32 v6, 163832
 ds_read_b32 v61, v6
 s_waitcnt lgkmcnt(0)
 v_readfirstlane_b32 s94, v61
 s_cmp_ge_u32 s94, 2
 s_cbranch_scc1 k_exit
 s_mov_b32 s88, s6
 s_mov_b32 s89, s7
 s_add_u32 s88, s88, 2
 s_add_u32 s70, s89, 1
 s_cmp_lt_u32 s70, 30
 s_cselect_b32 s70, s70, s66
 s_add_u32 s71, s89, 6
 s_cmp_lt_u32 s89, 30
 s_cselect_b32 s89, s70, s71
 s_and_b32 s4, s94, 1
 s_cmp_eq_u32 s94, 0
 s_cselect_b32 s5, s6, s7
 s_cselect_b32 s6, s88, s6
 s_cmp_eq_u32 s94, 1
 s_cselect_b32 s7, s89, s7
 s_mov_b32 s78, 0
 s_mul_i32 s81, s4, 5636096
 s_add_u32 s81, s81, 148619264
 s_mul_i32 s70, s5, 88064
 s_add_u32 s81, s81, s70
 s_mul_i32 s70, s82, 44032
 s_add_u32 s81, s81, s70
 s_mul_i32 s97, s3, 11264
 s_min_u32 s97, s97, 32768
 s_add_u32 s96, s97, s78
 s_add_u32 s97, s97, s81
 s_sub_u32 s97, s97, 4096
 s_add_u32 m0, s96, 0
 s_add_u32 s97, s97, 4096
 buffer_load_dwordx4 v2, s[52:55], s97 offen offset:0 sc1 lds
 buffer_load_dwordx4 v2, s[52:55], s97 offen offset:1024 sc1 lds
 buffer_load_dwordx4 v2, s[52:55], s97 offen offset:2048 sc1 lds
 buffer_load_dwordx4 v2, s[52:55], s97 offen offset:3072 sc1 lds
 s_add_u32 m0, s96, 4096
 s_add_u32 s97, s97, 4096
 buffer_load_dwordx4 v2, s[52:55], s97 offen offset:0 sc1 lds
 buffer_load_dwordx4 v2, s[52:55], s97 offen offset:1024 sc1 lds
 buffer_load_dwordx4 v2, s[52:55], s97 offen offset:2048 sc1 lds
 buffer_load_dwordx4 v2, s[52:55], s97 offen offset:3072 sc1 lds
 s_add_u32 m0, s96, 8192
 s_add_u32 s97, s97, 4096
 buffer_load_dwordx4 v2, s[52:55], s97 offen offset:0 sc1 lds
 buffer_load_dwordx4 v2, s[52:55], s97 offen offset:1024 sc1 lds
 buffer_load_dwordx4 v2, s[52:55], s97 offen offset:2048 sc1 lds
sc_412:
 s_cmp_lg_u32 s3, 0
 s_cbranch_scc1 sc_411
 s_min_u32 s70, s6, 63
 s_min_u32 s71, s7, 63
 s_lshl_b32 s70, s70, 8
 s_lshl_b32 s71, s71, 8
 v_add_u32 v15, s70, v56
 s_mov_b32 exec_lo, 0
 v_add_u32 v15, s71, v56
 s_mov_b32 exec_lo, s87
 s_mov_b32 exec_hi, s87
 buffer_load_dwordx2 v[62:63], v15, s[52:55], 0 offen sc1
 s_mov_b64 exec, -1
 s_waitcnt vmcnt(0)
 v_cmp_ge_u32 s[72:73], v62, v57
 v_cmp_ge_u32 s[74:75], v63, v58
 s_and_b64 s[72:73], s[72:73], s[74:75]
 s_mov_b32 s70, 2
 s_cmp_lt_u32 s7, 64
 s_cselect_b32 s71, s73, 0
 s_cmp_eq_u32 s71, -1
 s_cselect_b32 s70, 1, s70
 s_cmp_lt_u32 s6, 64
 s_cselect_b32 s71, s72, 0
 s_cmp_eq_u32 s71, -1
 s_cselect_b32 s70, 0, s70
 v_mov_b32 v5, s70
 v_mov_b32 v6, s95
 ds_write_b32 v6, v5
 s_waitcnt lgkmcnt(0)
sc_411:
 s_waitcnt vmcnt(0)
 v_mov_b32 v6, s95
 s_barrier
 ds_read_b32 v61, v6
 s_xor_b32 s95, s95, 4
 s_waitcnt lgkmcnt(0)
 v_readfirstlane_b32 s94, v61
 s_branch down_pro0
role_rln:
 v_lshrrev_b32 v5, 3, v1
 v_bfe_u32 v6, v1, 1, 2
 v_and_b32 v7, 1, v1
 v_lshlrev_b32 v7, 4, v7
 v_lshl_add_u32 v8, v5, 5, v7
 v_lshl_add_u32 v3, v6, 10, v8
 v_lshl_add_u32 v8, v6, 5, v7
 v_lshl_add_u32 v4, v5, 10, v8
 v_lshl_add_u32 v9, v5, 11, v8
 s_mov_b32 s86, 0xffff0000
 v_mov_b32 v13, 0
 v_mov_b32 v14, 1
 v_and_b32 v5, 15, v1
 v_lshlrev_b32 v11, 4, v5
 v_mov_b32 v12, 0
 v_mov_b32 v192, 0
 v_mov_b32 v193, 0
 v_mov_b32 v194, 0
 v_mov_b32 v195, 0
 s_mov_b32 exec_lo, 0xffff
 s_mov_b32 exec_hi, 0x0
 v_add_u32 v11, 133120, v11
 s_mov_b32 exec_lo, 0xfff0
 s_mov_b32 exec_hi, 0x0
 v_mov_b32 v12, 1
 s_mov_b32 exec_lo, 0xffff0000
 s_mov_b32 exec_hi, 0x0
 v_add_u32 v11, 66560, v11
 s_mov_b32 exec_lo, 0x0
 s_mov_b32 exec_hi, 0xffff
 v_add_u32 v11, 83200, v11
 s_mov_b32 exec_lo, 0x0
 s_mov_b32 exec_hi, 0xffff0000
 v_add_u32 v11, 149760, v11
 s_mov_b32 exec_lo, 0x0
 s_mov_b32 exec_hi, 0xfff00000
 v_mov_b32 v12, 1
 s_mov_b64 exec, -1
 s_mul_i32 s70, s3, 14
 s_add_u32 s70, s70, s64
 s_mul_i32 s71, s3, 5
 s_add_u32 s71, s71, s64
 s_add_u32 s71, s71, 42
 s_cmp_lt_u32 s64, 14
 s_cselect_b32 s65, s70, s71
 s_and_b32 s70, s65, 15
 s_cmp_lt_u32 s65, 16
 s_cselect_b32 s88, s70, 512
 s_cselect_b32 s89, 512, s70
 s_cmp_lt_u32 s65, 32
 s_cselect_b32 s89, s89, 512
 s_cselect_b32 s72, 1, 0
 s_sub_u32 s65, s65, 32
 s_add_u32 s90, s65, 48
 s_cmp_lt_u32 s65, 24
 s_cselect_b32 s90, s65, s90
 s_cmp_eq_u32 s72, 1
 s_cselect_b32 s90, 512, s90
 s_add_u32 s91, s65, 48
 s_cmp_lt_u32 s65, 24
 s_cselect_b32 s91, s65, s91
 s_cmp_eq_u32 s72, 1
 s_cselect_b32 s91, 512, s91
 s_mov_b32 s83, 0x400000
 s_mov_b32 s69, 0
rln_loop:
 s_min_u32 s70, s88, 511
 s_lshr_b32 s70, s70, 3
 s_lshl_b32 s70, s70, 8
 s_mov_b32 exec_lo, 0xffff
 s_mov_b32 exec_hi, 0x0
 v_add_u32 v10, s70, v11
 s_min_u32 s70, s89, 511
 s_lshr_b32 s70, s70, 3
 s_lshl_b32 s70, s70, 8
 s_mov_b32 exec_lo, 0xffff0000
 s_mov_b32 exec_hi, 0x0
 v_add_u32 v10, s70, v11
 s_min_u32 s70, s90, 511
 s_lshr_b32 s70, s70, 3
 s_lshl_b32 s70, s70, 8
 s_mov_b32 exec_lo, 0x0
 s_mov_b32 exec_hi, 0xffff
 v_add_u32 v10, s70, v11
 s_min_u32 s70, s91, 511
 s_lshr_b32 s70, s70, 3
 s_lshl_b32 s70, s70, 8
 s_mov_b32 exec_lo, 0x0
 s_mov_b32 exec_hi, 0xffff0000
 v_add_u32 v10, s70, v11
 s_cmp_lt_u32 s88, 512
 s_cselect_b32 s70, 0xf, 0
 s_cmp_lt_u32 s89, 512
 s_cselect_b32 s71, 0xffff0000, 0
 s_or_b32 s92, s70, s71
 s_cmp_lt_u32 s90, 512
 s_cselect_b32 s70, 0xffff, 0
 s_cmp_lt_u32 s91, 512
 s_cselect_b32 s71, 0xf0000, 0
 s_or_b32 s93, s70, s71
 s_or_b32 s92, s92, 1
rln_poll:
 s_mov_b64 exec, s[92:93]
 buffer_load_dwordx4 v[192:195], v10, s[52:55], 0 offen sc1
 s_mov_b64 exec, -1
 s_cmp_eq_u32 s69, 0
 s_cbranch_scc1 rln_np
 s_waitcnt vmcnt(1)
 s_mov_b64 exec, 1
 buffer_store_dword v14, v13, s[52:55], s69 offen sc1
 s_mov_b64 exec, -1
 s_mov_b32 s69, 0
 s_waitcnt vmcnt(1)
 s_branch rln_ev
rln_np:
 s_waitcnt vmcnt(0)
rln_ev:
 s_min_u32 s70, s88, s89
 s_min_u32 s71, s90, s91
 s_min_u32 s70, s70, s71
 s_cmp_ge_u32 s70, 512
 s_cbranch_scc1 k_exit
 v_and_b32 v192, v192, v193
 v_and_b32 v194, v194, v195
 v_and_b32 v192, v192, v194
 v_or_b32 v192, v192, v12
 v_cmp_eq_u32 vcc, 1, v192
 s_cmp_ge_u32 s88, 512
 s_cbranch_scc1 rs_415
 s_lshr_b32 s70, vcc_lo, 0
 s_and_b32 s70, s70, 0xffff
 s_cmp_eq_u32 s70, 0xffff
 s_cbranch_scc1 rln_s0
rs_415:
 s_cmp_ge_u32 s89, 512
 s_cbranch_scc1 rs_416
 s_lshr_b32 s70, vcc_lo, 16
 s_and_b32 s70, s70, 0xffff
 s_cmp_eq_u32 s70, 0xffff
 s_cbranch_scc1 rln_s1
rs_416:
 s_cmp_ge_u32 s90, 512
 s_cbranch_scc1 rs_417
 s_lshr_b32 s70, vcc_hi, 0
 s_and_b32 s70, s70, 0xffff
 s_cmp_eq_u32 s70, 0xffff
 s_cbranch_scc1 rln_s2
rs_417:
 s_cmp_ge_u32 s91, 512
 s_cbranch_scc1 rs_418
 s_lshr_b32 s70, vcc_hi, 16
 s_and_b32 s70, s70, 0xffff
 s_cmp_eq_u32 s70, 0xffff
 s_cbranch_scc1 rln_s3
rs_418:
 s_sub_u32 s83, s83, 1
 s_cmp_lg_u32 s83, 0
 s_cbranch_scc1 rln_poll
 s_endpgm
rln_s0:
 s_mov_b32 s87, s88
 s_add_u32 s88, s88, 16
 s_lshl_b32 s70, s87, 12
 s_lshr_b32 s72, s87, 3
 s_and_b32 s73, s87, 7
 s_lshl_b32 s73, s73, 7
 s_lshl_b32 s72, s72, 17
 s_add_u32 s72, s72, s73
 s_add_u32 s72, s72, 159891456
 buffer_load_dwordx4 v[64:67], v9, s[52:55], s72 offen offset:0 sc1
 buffer_load_dwordx4 v[68:71], v9, s[52:55], s72 offen offset:1024 sc1
 s_add_u32 s72, s72, 16384
 buffer_load_dwordx4 v[72:75], v9, s[52:55], s72 offen offset:0 sc1
 buffer_load_dwordx4 v[76:79], v9, s[52:55], s72 offen offset:1024 sc1
 s_add_u32 s72, s72, 16384
 buffer_load_dwordx4 v[80:83], v9, s[52:55], s72 offen offset:0 sc1
 buffer_load_dwordx4 v[84:87], v9, s[52:55], s72 offen offset:1024 sc1
 s_add_u32 s72, s72, 16384
 buffer_load_dwordx4 v[88:91], v9, s[52:55], s72 offen offset:0 sc1
 buffer_load_dwordx4 v[92:95], v9, s[52:55], s72 offen offset:1024 sc1
 s_add_u32 s72, s72, 16384
 buffer_load_dwordx4 v[96:99], v9, s[52:55], s72 offen offset:0 sc1
 buffer_load_dwordx4 v[100:103], v9, s[52:55], s72 offen offset:1024 sc1
 s_add_u32 s72, s72, 16384
 buffer_load_dwordx4 v[104:107], v9, s[52:55], s72 offen offset:0 sc1
 buffer_load_dwordx4 v[108:111], v9, s[52:55], s72 offen offset:1024 sc1
 s_add_u32 s72, s72, 16384
 buffer_load_dwordx4 v[112:115], v9, s[52:55], s72 offen offset:0 sc1
 buffer_load_dwordx4 v[116:119], v9, s[52:55], s72 offen offset:1024 sc1
 s_add_u32 s72, s72, 16384
 buffer_load_dwordx4 v[120:123], v9, s[52:55], s72 offen offset:0 sc1
 buffer_load_dwordx4 v[124:127], v9, s[52:55], s72 offen offset:1024 sc1
 s_add_u32 s72, s72, 16384
 s_add_u32 s71, s70, 140230656
 buffer_load_dwordx4 v[48:51], v3, s[52:55], s71 offen offset:0 sc1
 buffer_load_dwordx4 v[52:55], v3, s[52:55], s71 offen offset:256 sc1
 buffer_load_dwordx4 v[56:59], v3, s[52:55], s71 offen offset:512 sc1
 buffer_load_dwordx4 v[60:63], v3, s[52:55], s71 offen offset:768 sc1
 s_waitcnt vmcnt(4)
 v_pk_add_f32 v[16:17], v[64:65], v[96:97]
 v_pk_add_f32 v[18:19], v[66:67], v[98:99]
 v_pk_add_f32 v[20:21], v[68:69], v[100:101]
 v_pk_add_f32 v[22:23], v[70:71], v[102:103]
 v_pk_add_f32 v[24:25], v[72:73], v[104:105]
 v_pk_add_f32 v[26:27], v[74:75], v[106:107]
 v_pk_add_f32 v[28:29], v[76:77], v[108:109]
 v_pk_add_f32 v[30:31], v[78:79], v[110:111]
 v_pk_add_f32 v[32:33], v[80:81], v[112:113]
 v_pk_add_f32 v[34:35], v[82:83], v[114:115]
 v_pk_add_f32 v[36:37], v[84:85], v[116:117]
 v_pk_add_f32 v[38:39], v[86:87], v[118:119]
 v_pk_add_f32 v[40:41], v[88:89], v[120:121]
 v_pk_add_f32 v[42:43], v[90:91], v[122:123]
 v_pk_add_f32 v[44:45], v[92:93], v[124:125]
 v_pk_add_f32 v[46:47], v[94:95], v[126:127]
 v_cvt_pk_bf16_f32 v128, v16, v17
 v_cvt_pk_bf16_f32 v129, v18, v19
 v_cvt_pk_bf16_f32 v130, v20, v21
 v_cvt_pk_bf16_f32 v131, v22, v23
 v_cvt_pk_bf16_f32 v132, v24, v25
 v_cvt_pk_bf16_f32 v133, v26, v27
 v_cvt_pk_bf16_f32 v134, v28, v29
 v_cvt_pk_bf16_f32 v135, v30, v31
 v_cvt_pk_bf16_f32 v136, v32, v33
 v_cvt_pk_bf16_f32 v137, v34, v35
 v_cvt_pk_bf16_f32 v138, v36, v37
 v_cvt_pk_bf16_f32 v139, v38, v39
 v_cvt_pk_bf16_f32 v140, v40, v41
 v_cvt_pk_bf16_f32 v141, v42, v43
 v_cvt_pk_bf16_f32 v142, v44, v45
 v_cvt_pk_bf16_f32 v143, v46, v47
 v_lshlrev_b32 v16, 16, v128
 v_and_b32 v17, s86, v128
 v_lshlrev_b32 v18, 16, v129
 v_and_b32 v19, s86, v129
 v_lshlrev_b32 v20, 16, v130
 v_and_b32 v21, s86, v130
 v_lshlrev_b32 v22, 16, v131
 v_and_b32 v23, s86, v131
 v_lshlrev_b32 v24, 16, v132
 v_and_b32 v25, s86, v132
 v_lshlrev_b32 v26, 16, v133
 v_and_b32 v27, s86, v133
 v_lshlrev_b32 v28, 16, v134
 v_and_b32 v29, s86, v134
 v_lshlrev_b32 v30, 16, v135
 v_and_b32 v31, s86, v135
 v_lshlrev_b32 v32, 16, v136
 v_and_b32 v33, s86, v136
 v_lshlrev_b32 v34, 16, v137
 v_and_b32 v35, s86, v137
 v_lshlrev_b32 v36, 16, v138
 v_and_b32 v37, s86, v138
 v_lshlrev_b32 v38, 16, v139
 v_and_b32 v39, s86, v139
 v_lshlrev_b32 v40, 16, v140
 v_and_b32 v41, s86, v140
 v_lshlrev_b32 v42, 16, v141
 v_and_b32 v43, s86, v141
 v_lshlrev_b32 v44, 16, v142
 v_and_b32 v45, s86, v142
 v_lshlrev_b32 v46, 16, v143
 v_and_b32 v47, s86, v143
 s_waitcnt vmcnt(0)
 v_lshlrev_b32 v160, 16, v48
 v_and_b32 v161, s86, v48
 v_lshlrev_b32 v162, 16, v49
 v_and_b32 v163, s86, v49
 v_lshlrev_b32 v164, 16, v50
 v_and_b32 v165, s86, v50
 v_lshlrev_b32 v166, 16, v51
 v_and_b32 v167, s86, v51
 v_lshlrev_b32 v168, 16, v52
 v_and_b32 v169, s86, v52
 v_lshlrev_b32 v170, 16, v53
 v_and_b32 v171, s86, v53
 v_lshlrev_b32 v172, 16, v54
 v_and_b32 v173, s86, v54
 v_lshlrev_b32 v174, 16, v55
 v_and_b32 v175, s86, v55
 v_lshlrev_b32 v176, 16, v56
 v_and_b32 v177, s86, v56
 v_lshlrev_b32 v178, 16, v57
 v_and_b32 v179, s86, v57
 v_lshlrev_b32 v180, 16, v58
 v_and_b32 v181, s86, v58
 v_lshlrev_b32 v182, 16, v59
 v_and_b32 v183, s86, v59
 v_lshlrev_b32 v184, 16, v60
 v_and_b32 v185, s86, v60
 v_lshlrev_b32 v186, 16, v61
 v_and_b32 v187, s86, v61
 v_lshlrev_b32 v188, 16, v62
 v_and_b32 v189, s86, v62
 v_lshlrev_b32 v190, 16, v63
 v_and_b32 v191, s86, v63
 v_pk_add_f32 v[16:17], v[16:17], v[160:161]
 v_pk_add_f32 v[18:19], v[18:19], v[162:163]
 v_pk_add_f32 v[20:21], v[20:21], v[164:165]
 v_pk_add_f32 v[22:23], v[22:23], v[166:167]
 v_pk_add_f32 v[24:25], v[24:25], v[168:169]
 v_pk_add_f32 v[26:27], v[26:27], v[170:171]
 v_pk_add_f32 v[28:29], v[28:29], v[172:173]
 v_pk_add_f32 v[30:31], v[30:31], v[174:175]
 v_pk_add_f32 v[32:33], v[32:33], v[176:177]
 v_pk_add_f32 v[34:35], v[34:35], v[178:179]
 v_pk_add_f32 v[36:37], v[36:37], v[180:181]
 v_pk_add_f32 v[38:39], v[38:39], v[182:183]
 v_pk_add_f32 v[40:41], v[40:41], v[184:185]
 v_pk_add_f32 v[42:43], v[42:43], v[186:187]
 v_pk_add_f32 v[44:45], v[44:45], v[188:189]
 v_pk_add_f32 v[46:47], v[46:47], v[190:191]
 v_cvt_pk_bf16_f32 v128, v16, v17
 v_cvt_pk_bf16_f32 v129, v18, v19
 v_cvt_pk_bf16_f32 v130, v20, v21
 v_cvt_pk_bf16_f32 v131, v22, v23
 v_cvt_pk_bf16_f32 v132, v24, v25
 v_cvt_pk_bf16_f32 v133, v26, v27
 v_cvt_pk_bf16_f32 v134, v28, v29
 v_cvt_pk_bf16_f32 v135, v30, v31
 v_cvt_pk_bf16_f32 v136, v32, v33
 v_cvt_pk_bf16_f32 v137, v34, v35
 v_cvt_pk_bf16_f32 v138, v36, v37
 v_cvt_pk_bf16_f32 v139, v38, v39
 v_cvt_pk_bf16_f32 v140, v40, v41
 v_cvt_pk_bf16_f32 v141, v42, v43
 v_cvt_pk_bf16_f32 v142, v44, v45
 v_cvt_pk_bf16_f32 v143, v46, v47
 s_add_u32 s71, s70, 176668672
 buffer_store_dwordx4 v[128:131], v3, s[52:55], s71 offen offset:0 sc1
 buffer_store_dwordx4 v[132:135], v3, s[52:55], s71 offen offset:256 sc1
 buffer_store_dwordx4 v[136:139], v3, s[52:55], s71 offen offset:512 sc1
 buffer_store_dwordx4 v[140:143], v3, s[52:55], s71 offen offset:768 sc1
 v_lshlrev_b32 v16, 16, v128
 v_and_b32 v17, s86, v128
 v_lshlrev_b32 v18, 16, v129
 v_and_b32 v19, s86, v129
 v_lshlrev_b32 v20, 16, v130
 v_and_b32 v21, s86, v130
 v_lshlrev_b32 v22, 16, v131
 v_and_b32 v23, s86, v131
 v_lshlrev_b32 v24, 16, v132
 v_and_b32 v25, s86, v132
 v_lshlrev_b32 v26, 16, v133
 v_and_b32 v27, s86, v133
 v_lshlrev_b32 v28, 16, v134
 v_and_b32 v29, s86, v134
 v_lshlrev_b32 v30, 16, v135
 v_and_b32 v31, s86, v135
 v_lshlrev_b32 v32, 16, v136
 v_and_b32 v33, s86, v136
 v_lshlrev_b32 v34, 16, v137
 v_and_b32 v35, s86, v137
 v_lshlrev_b32 v36, 16, v138
 v_and_b32 v37, s86, v138
 v_lshlrev_b32 v38, 16, v139
 v_and_b32 v39, s86, v139
 v_lshlrev_b32 v40, 16, v140
 v_and_b32 v41, s86, v140
 v_lshlrev_b32 v42, 16, v141
 v_and_b32 v43, s86, v141
 v_lshlrev_b32 v44, 16, v142
 v_and_b32 v45, s86, v142
 v_lshlrev_b32 v46, 16, v143
 v_and_b32 v47, s86, v143
 v_pk_add_f32 v[160:161], v[16:17], v[32:33]
 v_pk_add_f32 v[162:163], v[18:19], v[34:35]
 v_pk_add_f32 v[164:165], v[20:21], v[36:37]
 v_pk_add_f32 v[166:167], v[22:23], v[38:39]
 v_pk_add_f32 v[168:169], v[24:25], v[40:41]
 v_pk_add_f32 v[170:171], v[26:27], v[42:43]
 v_pk_add_f32 v[172:173], v[28:29], v[44:45]
 v_pk_add_f32 v[174:175], v[30:31], v[46:47]
 v_pk_add_f32 v[160:161], v[160:161], v[168:169]
 v_pk_add_f32 v[162:163], v[162:163], v[170:171]
 v_pk_add_f32 v[164:165], v[164:165], v[172:173]
 v_pk_add_f32 v[166:167], v[166:167], v[174:175]
 v_pk_add_f32 v[160:161], v[160:161], v[164:165]
 v_pk_add_f32 v[162:163], v[162:163], v[166:167]
 v_pk_add_f32 v[160:161], v[160:161], v[162:163]
 v_add_f32 v6, v160, v161
 s_nop 1
 v_add_f32_dpp v6, v6, v6 quad_perm:[1,0,3,2] row_mask:0xf bank_mask:0xf
 s_nop 1
 v_add_f32_dpp v6, v6, v6 row_ror:8 row_mask:0xf bank_mask:0xf
 v_mov_b32 v5, v6
 s_nop 1
 v_permlane16_swap_b32 v6, v5
 s_nop 0
 v_add_f32 v6, v6, v5
 v_mov_b32 v5, v6
 s_nop 1
 v_permlane32_swap_b32 v6, v5
 s_nop 0
 v_add_f32 v6, v6, v5
 v_mul_f32 v6, 0xbb000000, v6
 v_mov_b32 v7, v6
 v_pk_add_f32 v[160:161], v[16:17], v[6:7]
 v_pk_add_f32 v[162:163], v[18:19], v[6:7]
 v_pk_add_f32 v[164:165], v[20:21], v[6:7]
 v_pk_add_f32 v[166:167], v[22:23], v[6:7]
 v_pk_add_f32 v[168:169], v[24:25], v[6:7]
 v_pk_add_f32 v[170:171], v[26:27], v[6:7]
 v_pk_add_f32 v[172:173], v[28:29], v[6:7]
 v_pk_add_f32 v[174:175], v[30:31], v[6:7]
 v_pk_add_f32 v[176:177], v[32:33], v[6:7]
 v_pk_add_f32 v[178:179], v[34:35], v[6:7]
 v_pk_add_f32 v[180:181], v[36:37], v[6:7]
 v_pk_add_f32 v[182:183], v[38:39], v[6:7]
 v_pk_add_f32 v[184:185], v[40:41], v[6:7]
 v_pk_add_f32 v[186:187], v[42:43], v[6:7]
 v_pk_add_f32 v[188:189], v[44:45], v[6:7]
 v_pk_add_f32 v[190:191], v[46:47], v[6:7]
 v_pk_mul_f32 v[64:65], v[160:161], v[160:161]
 v_pk_mul_f32 v[66:67], v[162:163], v[162:163]
 v_pk_fma_f32 v[64:65], v[164:165], v[164:165], v[64:65]
 v_pk_fma_f32 v[66:67], v[166:167], v[166:167], v[66:67]
 v_pk_fma_f32 v[64:65], v[168:169], v[168:169], v[64:65]
 v_pk_fma_f32 v[66:67], v[170:171], v[170:171], v[66:67]
 v_pk_fma_f32 v[64:65], v[172:173], v[172:173], v[64:65]
 v_pk_fma_f32 v[66:67], v[174:175], v[174:175], v[66:67]
 v_pk_fma_f32 v[64:65], v[176:177], v[176:177], v[64:65]
 v_pk_fma_f32 v[66:67], v[178:179], v[178:179], v[66:67]
 v_pk_fma_f32 v[64:65], v[180:181], v[180:181], v[64:65]
 v_pk_fma_f32 v[66:67], v[182:183], v[182:183], v[66:67]
 v_pk_fma_f32 v[64:65], v[184:185], v[184:185], v[64:65]
 v_pk_fma_f32 v[66:67], v[186:187], v[186:187], v[66:67]
 v_pk_fma_f32 v[64:65], v[188:189], v[188:189], v[64:65]
 v_pk_fma_f32 v[66:67], v[190:191], v[190:191], v[66:67]
 v_pk_add_f32 v[64:65], v[64:65], v[66:67]
 v_add_f32 v68, v64, v65
 s_nop 1
 v_add_f32_dpp v68, v68, v68 quad_perm:[1,0,3,2] row_mask:0xf bank_mask:0xf
 s_nop 1
 v_add_f32_dpp v68, v68, v68 row_ror:8 row_mask:0xf bank_mask:0xf
 v_mov_b32 v5, v68
 s_nop 1
 v_permlane16_swap_b32 v68, v5
 s_nop 0
 v_add_f32 v68, v68, v5
 v_mov_b32 v5, v68
 s_nop 1
 v_permlane32_swap_b32 v68, v5
 s_nop 0
 v_add_f32 v68, v68, v5
 v_mul_f32 v68, 0x3b000000, v68
 v_cvt_pk_bf16_f32 v5, v68, v68
 v_lshlrev_b32 v68, 16, v5
 v_add_f32 v68, 0x3727c5ac, v68
 v_cvt_pk_bf16_f32 v5, v68, v68
 v_lshlrev_b32 v68, 16, v5
 v_sqrt_f32 v68, v68
 s_nop 0
 v_cvt_pk_bf16_f32 v5, v68, v68
 v_lshlrev_b32 v68, 16, v5
 v_rcp_f32 v68, v68
 v_cvt_pk_bf16_f32 v5, v6, v6
 v_lshlrev_b32 v6, 16, v5
 v_mov_b32 v7, v6
 v_mov_b32 v69, v68
 v_pk_add_f32 v[16:17], v[16:17], v[6:7]
 v_pk_add_f32 v[18:19], v[18:19], v[6:7]
 v_pk_add_f32 v[20:21], v[20:21], v[6:7]
 v_pk_add_f32 v[22:23], v[22:23], v[6:7]
 v_pk_add_f32 v[24:25], v[24:25], v[6:7]
 v_pk_add_f32 v[26:27], v[26:27], v[6:7]
 v_pk_add_f32 v[28:29], v[28:29], v[6:7]
 v_pk_add_f32 v[30:31], v[30:31], v[6:7]
 v_pk_add_f32 v[32:33], v[32:33], v[6:7]
 v_pk_add_f32 v[34:35], v[34:35], v[6:7]
 v_pk_add_f32 v[36:37], v[36:37], v[6:7]
 v_pk_add_f32 v[38:39], v[38:39], v[6:7]
 v_pk_add_f32 v[40:41], v[40:41], v[6:7]
 v_pk_add_f32 v[42:43], v[42:43], v[6:7]
 v_pk_add_f32 v[44:45], v[44:45], v[6:7]
 v_pk_add_f32 v[46:47], v[46:47], v[6:7]
 v_cvt_pk_bf16_f32 v144, v16, v17
 v_cvt_pk_bf16_f32 v145, v18, v19
 v_cvt_pk_bf16_f32 v146, v20, v21
 v_cvt_pk_bf16_f32 v147, v22, v23
 v_cvt_pk_bf16_f32 v148, v24, v25
 v_cvt_pk_bf16_f32 v149, v26, v27
 v_cvt_pk_bf16_f32 v150, v28, v29
 v_cvt_pk_bf16_f32 v151, v30, v31
 v_cvt_pk_bf16_f32 v152, v32, v33
 v_cvt_pk_bf16_f32 v153, v34, v35
 v_cvt_pk_bf16_f32 v154, v36, v37
 v_cvt_pk_bf16_f32 v155, v38, v39
 v_cvt_pk_bf16_f32 v156, v40, v41
 v_cvt_pk_bf16_f32 v157, v42, v43
 v_cvt_pk_bf16_f32 v158, v44, v45
 v_cvt_pk_bf16_f32 v159, v46, v47
 v_lshlrev_b32 v16, 16, v144
 v_and_b32 v17, s86, v144
 v_lshlrev_b32 v18, 16, v145
 v_and_b32 v19, s86, v145
 v_lshlrev_b32 v20, 16, v146
 v_and_b32 v21, s86, v146
 v_lshlrev_b32 v22, 16, v147
 v_and_b32 v23, s86, v147
 v_lshlrev_b32 v24, 16, v148
 v_and_b32 v25, s86, v148
 v_lshlrev_b32 v26, 16, v149
 v_and_b32 v27, s86, v149
 v_lshlrev_b32 v28, 16, v150
 v_and_b32 v29, s86, v150
 v_lshlrev_b32 v30, 16, v151
 v_and_b32 v31, s86, v151
 v_lshlrev_b32 v32, 16, v152
 v_and_b32 v33, s86, v152
 v_lshlrev_b32 v34, 16, v153
 v_and_b32 v35, s86, v153
 v_lshlrev_b32 v36, 16, v154
 v_and_b32 v37, s86, v154
 v_lshlrev_b32 v38, 16, v155
 v_and_b32 v39, s86, v155
 v_lshlrev_b32 v40, 16, v156
 v_and_b32 v41, s86, v156
 v_lshlrev_b32 v42, 16, v157
 v_and_b32 v43, s86, v157
 v_lshlrev_b32 v44, 16, v158
 v_and_b32 v45, s86, v158
 v_lshlrev_b32 v46, 16, v159
 v_and_b32 v47, s86, v159
 v_pk_mul_f32 v[16:17], v[16:17], v[68:69]
 v_pk_mul_f32 v[18:19], v[18:19], v[68:69]
 v_pk_mul_f32 v[20:21], v[20:21], v[68:69]
 v_pk_mul_f32 v[22:23], v[22:23], v[68:69]
 v_pk_mul_f32 v[24:25], v[24:25], v[68:69]
 v_pk_mul_f32 v[26:27], v[26:27], v[68:69]
 v_pk_mul_f32 v[28:29], v[28:29], v[68:69]
 v_pk_mul_f32 v[30:31], v[30:31], v[68:69]
 v_pk_mul_f32 v[32:33], v[32:33], v[68:69]
 v_pk_mul_f32 v[34:35], v[34:35], v[68:69]
 v_pk_mul_f32 v[36:37], v[36:37], v[68:69]
 v_pk_mul_f32 v[38:39], v[38:39], v[68:69]
 v_pk_mul_f32 v[40:41], v[40:41], v[68:69]
 v_pk_mul_f32 v[42:43], v[42:43], v[68:69]
 v_pk_mul_f32 v[44:45], v[44:45], v[68:69]
 v_pk_mul_f32 v[46:47], v[46:47], v[68:69]
 v_cvt_pk_bf16_f32 v144, v16, v17
 v_cvt_pk_bf16_f32 v145, v18, v19
 v_cvt_pk_bf16_f32 v146, v20, v21
 v_cvt_pk_bf16_f32 v147, v22, v23
 v_cvt_pk_bf16_f32 v148, v24, v25
 v_cvt_pk_bf16_f32 v149, v26, v27
 v_cvt_pk_bf16_f32 v150, v28, v29
 v_cvt_pk_bf16_f32 v151, v30, v31
 v_cvt_pk_bf16_f32 v152, v32, v33
 v_cvt_pk_bf16_f32 v153, v34, v35
 v_cvt_pk_bf16_f32 v154, v36, v37
 v_cvt_pk_bf16_f32 v155, v38, v39
 v_cvt_pk_bf16_f32 v156, v40, v41
 v_cvt_pk_bf16_f32 v157, v42, v43
 v_cvt_pk_bf16_f32 v158, v44, v45
 v_cvt_pk_bf16_f32 v159, v46, v47
 s_add_u32 s71, s70, 3915776
 buffer_store_dwordx4 v[144:147], v3, s[52:55], s71 offen offset:0 sc1
 buffer_store_dwordx4 v[148:151], v3, s[52:55], s71 offen offset:256 sc1
 buffer_store_dwordx4 v[152:155], v3, s[52:55], s71 offen offset:512 sc1
 buffer_store_dwordx4 v[156:159], v3, s[52:55], s71 offen offset:768 sc1
 s_lshr_b32 s69, s87, 3
 s_lshl_b32 s69, s69, 8
 s_and_b32 s70, s87, 7
 s_lshl_b32 s70, s70, 2
 s_add_u32 s69, s69, s70
 s_add_u32 s69, s69, 16640
 s_branch rln_loop
rln_s1:
 s_mov_b32 s87, s89
 s_add_u32 s89, s89, 16
 s_lshl_b32 s70, s87, 12
 s_lshr_b32 s72, s87, 3
 s_and_b32 s73, s87, 7
 s_lshl_b32 s73, s73, 7
 s_lshl_b32 s72, s72, 17
 s_add_u32 s72, s72, s73
 s_add_u32 s72, s72, 123453440
 buffer_load_dwordx4 v[64:67], v4, s[52:55], s72 offen sc1
 s_add_u32 s72, s72, 8192
 buffer_load_dwordx4 v[68:71], v4, s[52:55], s72 offen sc1
 s_add_u32 s72, s72, 8192
 buffer_load_dwordx4 v[72:75], v4, s[52:55], s72 offen sc1
 s_add_u32 s72, s72, 8192
 buffer_load_dwordx4 v[76:79], v4, s[52:55], s72 offen sc1
 s_add_u32 s72, s72, 8192
 buffer_load_dwordx4 v[80:83], v4, s[52:55], s72 offen sc1
 s_add_u32 s72, s72, 8192
 buffer_load_dwordx4 v[84:87], v4, s[52:55], s72 offen sc1
 s_add_u32 s72, s72, 8192
 buffer_load_dwordx4 v[88:91], v4, s[52:55], s72 offen sc1
 s_add_u32 s72, s72, 8192
 buffer_load_dwordx4 v[92:95], v4, s[52:55], s72 offen sc1
 s_add_u32 s72, s72, 8192
 buffer_load_dwordx4 v[96:99], v4, s[52:55], s72 offen sc1
 s_add_u32 s72, s72, 8192
 buffer_load_dwordx4 v[100:103], v4, s[52:55], s72 offen sc1
 s_add_u32 s72, s72, 8192
 buffer_load_dwordx4 v[104:107], v4, s[52:55], s72 offen sc1
 s_add_u32 s72, s72, 8192
 buffer_load_dwordx4 v[108:111], v4, s[52:55], s72 offen sc1
 s_add_u32 s72, s72, 8192
 buffer_load_dwordx4 v[112:115], v4, s[52:55], s72 offen sc1
 s_add_u32 s72, s72, 8192
 buffer_load_dwordx4 v[116:119], v4, s[52:55], s72 offen sc1
 s_add_u32 s72, s72, 8192
 buffer_load_dwordx4 v[120:123], v4, s[52:55], s72 offen sc1
 s_add_u32 s72, s72, 8192
 buffer_load_dwordx4 v[124:127], v4, s[52:55], s72 offen sc1
 s_add_u32 s72, s72, 8192
 s_add_u32 s71, s70, 0
 buffer_load_dwordx4 v[48:51], v3, s[8:11], s71 offen offset:0 sc1
 buffer_load_dwordx4 v[52:55], v3, s[8:11], s71 offen offset:256 sc1
 buffer_load_dwordx4 v[56:59], v3, s[8:11], s71 offen offset:512 sc1
 buffer_load_dwordx4 v[60:63], v3, s[8:11], s71 offen offset:768 sc1
 s_waitcnt vmcnt(16)
 v_lshlrev_b32 v16, 16, v64
 v_and_b32 v17, s86, v64
 v_lshlrev_b32 v18, 16, v65
 v_and_b32 v19, s86, v65
 v_lshlrev_b32 v20, 16, v66
 v_and_b32 v21, s86, v66
 v_lshlrev_b32 v22, 16, v67
 v_and_b32 v23, s86, v67
 v_lshlrev_b32 v24, 16, v68
 v_and_b32 v25, s86, v68
 v_lshlrev_b32 v26, 16, v69
 v_and_b32 v27, s86, v69
 v_lshlrev_b32 v28, 16, v70
 v_and_b32 v29, s86, v70
 v_lshlrev_b32 v30, 16, v71
 v_and_b32 v31, s86, v71
 v_lshlrev_b32 v32, 16, v72
 v_and_b32 v33, s86, v72
 v_lshlrev_b32 v34, 16, v73
 v_and_b32 v35, s86, v73
 v_lshlrev_b32 v36, 16, v74
 v_and_b32 v37, s86, v74
 v_lshlrev_b32 v38, 16, v75
 v_and_b32 v39, s86, v75
 v_lshlrev_b32 v40, 16, v76
 v_and_b32 v41, s86, v76
 v_lshlrev_b32 v42, 16, v77
 v_and_b32 v43, s86, v77
 v_lshlrev_b32 v44, 16, v78
 v_and_b32 v45, s86, v78
 v_lshlrev_b32 v46, 16, v79
 v_and_b32 v47, s86, v79
 s_waitcnt vmcnt(12)
 v_lshlrev_b32 v160, 16, v80
 v_and_b32 v161, s86, v80
 v_lshlrev_b32 v162, 16, v81
 v_and_b32 v163, s86, v81
 v_lshlrev_b32 v164, 16, v82
 v_and_b32 v165, s86, v82
 v_lshlrev_b32 v166, 16, v83
 v_and_b32 v167, s86, v83
 v_lshlrev_b32 v168, 16, v84
 v_and_b32 v169, s86, v84
 v_lshlrev_b32 v170, 16, v85
 v_and_b32 v171, s86, v85
 v_lshlrev_b32 v172, 16, v86
 v_and_b32 v173, s86, v86
 v_lshlrev_b32 v174, 16, v87
 v_and_b32 v175, s86, v87
 v_lshlrev_b32 v176, 16, v88
 v_and_b32 v177, s86, v88
 v_lshlrev_b32 v178, 16, v89
 v_and_b32 v179, s86, v89
 v_lshlrev_b32 v180, 16, v90
 v_and_b32 v181, s86, v90
 v_lshlrev_b32 v182, 16, v91
 v_and_b32 v183, s86, v91
 v_lshlrev_b32 v184, 16, v92
 v_and_b32 v185, s86, v92
 v_lshlrev_b32 v186, 16, v93
 v_and_b32 v187, s86, v93
 v_lshlrev_b32 v188, 16, v94
 v_and_b32 v189, s86, v94
 v_lshlrev_b32 v190, 16, v95
 v_and_b32 v191, s86, v95
 v_pk_add_f32 v[16:17], v[16:17], v[160:161]
 v_pk_add_f32 v[18:19], v[18:19], v[162:163]
 v_pk_add_f32 v[20:21], v[20:21], v[164:165]
 v_pk_add_f32 v[22:23], v[22:23], v[166:167]
 v_pk_add_f32 v[24:25], v[24:25], v[168:169]
 v_pk_add_f32 v[26:27], v[26:27], v[170:171]
 v_pk_add_f32 v[28:29], v[28:29], v[172:173]
 v_pk_add_f32 v[30:31], v[30:31], v[174:175]
 v_pk_add_f32 v[32:33], v[32:33], v[176:177]
 v_pk_add_f32 v[34:35], v[34:35], v[178:179]
 v_pk_add_f32 v[36:37], v[36:37], v[180:181]
 v_pk_add_f32 v[38:39], v[38:39], v[182:183]
 v_pk_add_f32 v[40:41], v[40:41], v[184:185]
 v_pk_add_f32 v[42:43], v[42:43], v[186:187]
 v_pk_add_f32 v[44:45], v[44:45], v[188:189]
 v_pk_add_f32 v[46:47], v[46:47], v[190:191]
 s_waitcnt vmcnt(8)
 v_lshlrev_b32 v160, 16, v96
 v_and_b32 v161, s86, v96
 v_lshlrev_b32 v162, 16, v97
 v_and_b32 v163, s86, v97
 v_lshlrev_b32 v164, 16, v98
 v_and_b32 v165, s86, v98
 v_lshlrev_b32 v166, 16, v99
 v_and_b32 v167, s86, v99
 v_lshlrev_b32 v168, 16, v100
 v_and_b32 v169, s86, v100
 v_lshlrev_b32 v170, 16, v101
 v_and_b32 v171, s86, v101
 v_lshlrev_b32 v172, 16, v102
 v_and_b32 v173, s86, v102
 v_lshlrev_b32 v174, 16, v103
 v_and_b32 v175, s86, v103
 v_lshlrev_b32 v176, 16, v104
 v_and_b32 v177, s86, v104
 v_lshlrev_b32 v178, 16, v105
 v_and_b32 v179, s86, v105
 v_lshlrev_b32 v180, 16, v106
 v_and_b32 v181, s86, v106
 v_lshlrev_b32 v182, 16, v107
 v_and_b32 v183, s86, v107
 v_lshlrev_b32 v184, 16, v108
 v_and_b32 v185, s86, v108
 v_lshlrev_b32 v186, 16, v109
 v_and_b32 v187, s86, v109
 v_lshlrev_b32 v188, 16, v110
 v_and_b32 v189, s86, v110
 v_lshlrev_b32 v190, 16, v111
 v_and_b32 v191, s86, v111
 v_pk_add_f32 v[16:17], v[16:17], v[160:161]
 v_pk_add_f32 v[18:19], v[18:19], v[162:163]
 v_pk_add_f32 v[20:21], v[20:21], v[164:165]
 v_pk_add_f32 v[22:23], v[22:23], v[166:167]
 v_pk_add_f32 v[24:25], v[24:25], v[168:169]
 v_pk_add_f32 v[26:27], v[26:27], v[170:171]
 v_pk_add_f32 v[28:29], v[28:29], v[172:173]
 v_pk_add_f32 v[30:31], v[30:31], v[174:175]
 v_pk_add_f32 v[32:33], v[32:33], v[176:177]
 v_pk_add_f32 v[34:35], v[34:35], v[178:179]
 v_pk_add_f32 v[36:37], v[36:37], v[180:181]
 v_pk_add_f32 v[38:39], v[38:39], v[182:183]
 v_pk_add_f32 v[40:41], v[40:41], v[184:185]
 v_pk_add_f32 v[42:43], v[42:43], v[186:187]
 v_pk_add_f32 v[44:45], v[44:45], v[188:189]
 v_pk_add_f32 v[46:47], v[46:47], v[190:191]
 s_waitcnt vmcnt(4)
 v_lshlrev_b32 v160, 16, v112
 v_and_b32 v161, s86, v112
 v_lshlrev_b32 v162, 16, v113
 v_and_b32 v163, s86, v113
 v_lshlrev_b32 v164, 16, v114
 v_and_b32 v165, s86, v114
 v_lshlrev_b32 v166, 16, v115
 v_and_b32 v167, s86, v115
 v_lshlrev_b32 v168, 16, v116
 v_and_b32 v169, s86, v116
 v_lshlrev_b32 v170, 16, v117
 v_and_b32 v171, s86, v117
 v_lshlrev_b32 v172, 16, v118
 v_and_b32 v173, s86, v118
 v_lshlrev_b32 v174, 16, v119
 v_and_b32 v175, s86, v119
 v_lshlrev_b32 v176, 16, v120
 v_and_b32 v177, s86, v120
 v_lshlrev_b32 v178, 16, v121
 v_and_b32 v179, s86, v121
 v_lshlrev_b32 v180, 16, v122
 v_and_b32 v181, s86, v122
 v_lshlrev_b32 v182, 16, v123
 v_and_b32 v183, s86, v123
 v_lshlrev_b32 v184, 16, v124
 v_and_b32 v185, s86, v124
 v_lshlrev_b32 v186, 16, v125
 v_and_b32 v187, s86, v125
 v_lshlrev_b32 v188, 16, v126
 v_and_b32 v189, s86, v126
 v_lshlrev_b32 v190, 16, v127
 v_and_b32 v191, s86, v127
 v_pk_add_f32 v[16:17], v[16:17], v[160:161]
 v_pk_add_f32 v[18:19], v[18:19], v[162:163]
 v_pk_add_f32 v[20:21], v[20:21], v[164:165]
 v_pk_add_f32 v[22:23], v[22:23], v[166:167]
 v_pk_add_f32 v[24:25], v[24:25], v[168:169]
 v_pk_add_f32 v[26:27], v[26:27], v[170:171]
 v_pk_add_f32 v[28:29], v[28:29], v[172:173]
 v_pk_add_f32 v[30:31], v[30:31], v[174:175]
 v_pk_add_f32 v[32:33], v[32:33], v[176:177]
 v_pk_add_f32 v[34:35], v[34:35], v[178:179]
 v_pk_add_f32 v[36:37], v[36:37], v[180:181]
 v_pk_add_f32 v[38:39], v[38:39], v[182:183]
 v_pk_add_f32 v[40:41], v[40:41], v[184:185]
 v_pk_add_f32 v[42:43], v[42:43], v[186:187]
 v_pk_add_f32 v[44:45], v[44:45], v[188:189]
 v_pk_add_f32 v[46:47], v[46:47], v[190:191]
 v_cvt_pk_bf16_f32 v128, v16, v17
 v_cvt_pk_bf16_f32 v129, v18, v19
 v_cvt_pk_bf16_f32 v130, v20, v21
 v_cvt_pk_bf16_f32 v131, v22, v23
 v_cvt_pk_bf16_f32 v132, v24, v25
 v_cvt_pk_bf16_f32 v133, v26, v27
 v_cvt_pk_bf16_f32 v134, v28, v29
 v_cvt_pk_bf16_f32 v135, v30, v31
 v_cvt_pk_bf16_f32 v136, v32, v33
 v_cvt_pk_bf16_f32 v137, v34, v35
 v_cvt_pk_bf16_f32 v138, v36, v37
 v_cvt_pk_bf16_f32 v139, v38, v39
 v_cvt_pk_bf16_f32 v140, v40, v41
 v_cvt_pk_bf16_f32 v141, v42, v43
 v_cvt_pk_bf16_f32 v142, v44, v45
 v_cvt_pk_bf16_f32 v143, v46, v47
 v_lshlrev_b32 v16, 16, v128
 v_and_b32 v17, s86, v128
 v_lshlrev_b32 v18, 16, v129
 v_and_b32 v19, s86, v129
 v_lshlrev_b32 v20, 16, v130
 v_and_b32 v21, s86, v130
 v_lshlrev_b32 v22, 16, v131
 v_and_b32 v23, s86, v131
 v_lshlrev_b32 v24, 16, v132
 v_and_b32 v25, s86, v132
 v_lshlrev_b32 v26, 16, v133
 v_and_b32 v27, s86, v133
 v_lshlrev_b32 v28, 16, v134
 v_and_b32 v29, s86, v134
 v_lshlrev_b32 v30, 16, v135
 v_and_b32 v31, s86, v135
 v_lshlrev_b32 v32, 16, v136
 v_and_b32 v33, s86, v136
 v_lshlrev_b32 v34, 16, v137
 v_and_b32 v35, s86, v137
 v_lshlrev_b32 v36, 16, v138
 v_and_b32 v37, s86, v138
 v_lshlrev_b32 v38, 16, v139
 v_and_b32 v39, s86, v139
 v_lshlrev_b32 v40, 16, v140
 v_and_b32 v41, s86, v140
 v_lshlrev_b32 v42, 16, v141
 v_and_b32 v43, s86, v141
 v_lshlrev_b32 v44, 16, v142
 v_and_b32 v45, s86, v142
 v_lshlrev_b32 v46, 16, v143
 v_and_b32 v47, s86, v143
 s_waitcnt vmcnt(0)
 v_lshlrev_b32 v160, 16, v48
 v_and_b32 v161, s86, v48
 v_lshlrev_b32 v162, 16, v49
 v_and_b32 v163, s86, v49
 v_lshlrev_b32 v164, 16, v50
 v_and_b32 v165, s86, v50
 v_lshlrev_b32 v166, 16, v51
 v_and_b32 v167, s86, v51
 v_lshlrev_b32 v168, 16, v52
 v_and_b32 v169, s86, v52
 v_lshlrev_b32 v170, 16, v53
 v_and_b32 v171, s86, v53
 v_lshlrev_b32 v172, 16, v54
 v_and_b32 v173, s86, v54
 v_lshlrev_b32 v174, 16, v55
 v_and_b32 v175, s86, v55
 v_lshlrev_b32 v176, 16, v56
 v_and_b32 v177, s86, v56
 v_lshlrev_b32 v178, 16, v57
 v_and_b32 v179, s86, v57
 v_lshlrev_b32 v180, 16, v58
 v_and_b32 v181, s86, v58
 v_lshlrev_b32 v182, 16, v59
 v_and_b32 v183, s86, v59
 v_lshlrev_b32 v184, 16, v60
 v_and_b32 v185, s86, v60
 v_lshlrev_b32 v186, 16, v61
 v_and_b32 v187, s86, v61
 v_lshlrev_b32 v188, 16, v62
 v_and_b32 v189, s86, v62
 v_lshlrev_b32 v190, 16, v63
 v_and_b32 v191, s86, v63
 v_pk_add_f32 v[16:17], v[16:17], v[160:161]
 v_pk_add_f32 v[18:19], v[18:19], v[162:163]
 v_pk_add_f32 v[20:21], v[20:21], v[164:165]
 v_pk_add_f32 v[22:23], v[22:23], v[166:167]
 v_pk_add_f32 v[24:25], v[24:25], v[168:169]
 v_pk_add_f32 v[26:27], v[26:27], v[170:171]
 v_pk_add_f32 v[28:29], v[28:29], v[172:173]
 v_pk_add_f32 v[30:31], v[30:31], v[174:175]
 v_pk_add_f32 v[32:33], v[32:33], v[176:177]
 v_pk_add_f32 v[34:35], v[34:35], v[178:179]
 v_pk_add_f32 v[36:37], v[36:37], v[180:181]
 v_pk_add_f32 v[38:39], v[38:39], v[182:183]
 v_pk_add_f32 v[40:41], v[40:41], v[184:185]
 v_pk_add_f32 v[42:43], v[42:43], v[186:187]
 v_pk_add_f32 v[44:45], v[44:45], v[188:189]
 v_pk_add_f32 v[46:47], v[46:47], v[190:191]
 v_cvt_pk_bf16_f32 v128, v16, v17
 v_cvt_pk_bf16_f32 v129, v18, v19
 v_cvt_pk_bf16_f32 v130, v20, v21
 v_cvt_pk_bf16_f32 v131, v22, v23
 v_cvt_pk_bf16_f32 v132, v24, v25
 v_cvt_pk_bf16_f32 v133, v26, v27
 v_cvt_pk_bf16_f32 v134, v28, v29
 v_cvt_pk_bf16_f32 v135, v30, v31
 v_cvt_pk_bf16_f32 v136, v32, v33
 v_cvt_pk_bf16_f32 v137, v34, v35
 v_cvt_pk_bf16_f32 v138, v36, v37
 v_cvt_pk_bf16_f32 v139, v38, v39
 v_cvt_pk_bf16_f32 v140, v40, v41
 v_cvt_pk_bf16_f32 v141, v42, v43
 v_cvt_pk_bf16_f32 v142, v44, v45
 v_cvt_pk_bf16_f32 v143, v46, v47
 s_add_u32 s71, s70, 140230656
 buffer_store_dwordx4 v[128:131], v3, s[52:55], s71 offen offset:0 sc1
 buffer_store_dwordx4 v[132:135], v3, s[52:55], s71 offen offset:256 sc1
 buffer_store_dwordx4 v[136:139], v3, s[52:55], s71 offen offset:512 sc1
 buffer_store_dwordx4 v[140:143], v3, s[52:55], s71 offen offset:768 sc1
 v_lshlrev_b32 v16, 16, v128
 v_and_b32 v17, s86, v128
 v_lshlrev_b32 v18, 16, v129
 v_and_b32 v19, s86, v129
 v_lshlrev_b32 v20, 16, v130
 v_and_b32 v21, s86, v130
 v_lshlrev_b32 v22, 16, v131
 v_and_b32 v23, s86, v131
 v_lshlrev_b32 v24, 16, v132
 v_and_b32 v25, s86, v132
 v_lshlrev_b32 v26, 16, v133
 v_and_b32 v27, s86, v133
 v_lshlrev_b32 v28, 16, v134
 v_and_b32 v29, s86, v134
 v_lshlrev_b32 v30, 16, v135
 v_and_b32 v31, s86, v135
 v_lshlrev_b32 v32, 16, v136
 v_and_b32 v33, s86, v136
 v_lshlrev_b32 v34, 16, v137
 v_and_b32 v35, s86, v137
 v_lshlrev_b32 v36, 16, v138
 v_and_b32 v37, s86, v138
 v_lshlrev_b32 v38, 16, v139
 v_and_b32 v39, s86, v139
 v_lshlrev_b32 v40, 16, v140
 v_and_b32 v41, s86, v140
 v_lshlrev_b32 v42, 16, v141
 v_and_b32 v43, s86, v141
 v_lshlrev_b32 v44, 16, v142
 v_and_b32 v45, s86, v142
 v_lshlrev_b32 v46, 16, v143
 v_and_b32 v47, s86, v143
 v_pk_add_f32 v[160:161], v[16:17], v[32:33]
 v_pk_add_f32 v[162:163], v[18:19], v[34:35]
 v_pk_add_f32 v[164:165], v[20:21], v[36:37]
 v_pk_add_f32 v[166:167], v[22:23], v[38:39]
 v_pk_add_f32 v[168:169], v[24:25], v[40:41]
 v_pk_add_f32 v[170:171], v[26:27], v[42:43]
 v_pk_add_f32 v[172:173], v[28:29], v[44:45]
 v_pk_add_f32 v[174:175], v[30:31], v[46:47]
 v_pk_add_f32 v[160:161], v[160:161], v[168:169]
 v_pk_add_f32 v[162:163], v[162:163], v[170:171]
 v_pk_add_f32 v[164:165], v[164:165], v[172:173]
 v_pk_add_f32 v[166:167], v[166:167], v[174:175]
 v_pk_add_f32 v[160:161], v[160:161], v[164:165]
 v_pk_add_f32 v[162:163], v[162:163], v[166:167]
 v_pk_add_f32 v[160:161], v[160:161], v[162:163]
 v_add_f32 v6, v160, v161
 s_nop 1
 v_add_f32_dpp v6, v6, v6 quad_perm:[1,0,3,2] row_mask:0xf bank_mask:0xf
 s_nop 1
 v_add_f32_dpp v6, v6, v6 row_ror:8 row_mask:0xf bank_mask:0xf
 v_mov_b32 v5, v6
 s_nop 1
 v_permlane16_swap_b32 v6, v5
 s_nop 0
 v_add_f32 v6, v6, v5
 v_mov_b32 v5, v6
 s_nop 1
 v_permlane32_swap_b32 v6, v5
 s_nop 0
 v_add_f32 v6, v6, v5
 v_mul_f32 v6, 0xbb000000, v6
 v_mov_b32 v7, v6
 v_pk_add_f32 v[160:161], v[16:17], v[6:7]
 v_pk_add_f32 v[162:163], v[18:19], v[6:7]
 v_pk_add_f32 v[164:165], v[20:21], v[6:7]
 v_pk_add_f32 v[166:167], v[22:23], v[6:7]
 v_pk_add_f32 v[168:169], v[24:25], v[6:7]
 v_pk_add_f32 v[170:171], v[26:27], v[6:7]
 v_pk_add_f32 v[172:173], v[28:29], v[6:7]
 v_pk_add_f32 v[174:175], v[30:31], v[6:7]
 v_pk_add_f32 v[176:177], v[32:33], v[6:7]
 v_pk_add_f32 v[178:179], v[34:35], v[6:7]
 v_pk_add_f32 v[180:181], v[36:37], v[6:7]
 v_pk_add_f32 v[182:183], v[38:39], v[6:7]
 v_pk_add_f32 v[184:185], v[40:41], v[6:7]
 v_pk_add_f32 v[186:187], v[42:43], v[6:7]
 v_pk_add_f32 v[188:189], v[44:45], v[6:7]
 v_pk_add_f32 v[190:191], v[46:47], v[6:7]
 v_pk_mul_f32 v[64:65], v[160:161], v[160:161]
 v_pk_mul_f32 v[66:67], v[162:163], v[162:163]
 v_pk_fma_f32 v[64:65], v[164:165], v[164:165], v[64:65]
 v_pk_fma_f32 v[66:67], v[166:167], v[166:167], v[66:67]
 v_pk_fma_f32 v[64:65], v[168:169], v[168:169], v[64:65]
 v_pk_fma_f32 v[66:67], v[170:171], v[170:171], v[66:67]
 v_pk_fma_f32 v[64:65], v[172:173], v[172:173], v[64:65]
 v_pk_fma_f32 v[66:67], v[174:175], v[174:175], v[66:67]
 v_pk_fma_f32 v[64:65], v[176:177], v[176:177], v[64:65]
 v_pk_fma_f32 v[66:67], v[178:179], v[178:179], v[66:67]
 v_pk_fma_f32 v[64:65], v[180:181], v[180:181], v[64:65]
 v_pk_fma_f32 v[66:67], v[182:183], v[182:183], v[66:67]
 v_pk_fma_f32 v[64:65], v[184:185], v[184:185], v[64:65]
 v_pk_fma_f32 v[66:67], v[186:187], v[186:187], v[66:67]
 v_pk_fma_f32 v[64:65], v[188:189], v[188:189], v[64:65]
 v_pk_fma_f32 v[66:67], v[190:191], v[190:191], v[66:67]
 v_pk_add_f32 v[64:65], v[64:65], v[66:67]
 v_add_f32 v68, v64, v65
 s_nop 1
 v_add_f32_dpp v68, v68, v68 quad_perm:[1,0,3,2] row_mask:0xf bank_mask:0xf
 s_nop 1
 v_add_f32_dpp v68, v68, v68 row_ror:8 row_mask:0xf bank_mask:0xf
 v_mov_b32 v5, v68
 s_nop 1
 v_permlane16_swap_b32 v68, v5
 s_nop 0
 v_add_f32 v68, v68, v5
 v_mov_b32 v5, v68
 s_nop 1
 v_permlane32_swap_b32 v68, v5
 s_nop 0
 v_add_f32 v68, v68, v5
 v_mul_f32 v68, 0x3b000000, v68
 v_cvt_pk_bf16_f32 v5, v68, v68
 v_lshlrev_b32 v68, 16, v5
 v_add_f32 v68, 0x3727c5ac, v68
 v_cvt_pk_bf16_f32 v5, v68, v68
 v_lshlrev_b32 v68, 16, v5
 v_sqrt_f32 v68, v68
 s_nop 0
 v_cvt_pk_bf16_f32 v5, v68, v68
 v_lshlrev_b32 v68, 16, v5
 v_rcp_f32 v68, v68
 v_cvt_pk_bf16_f32 v5, v6, v6
 v_lshlrev_b32 v6, 16, v5
 v_mov_b32 v7, v6
 v_mov_b32 v69, v68
 v_pk_add_f32 v[16:17], v[16:17], v[6:7]
 v_pk_add_f32 v[18:19], v[18:19], v[6:7]
 v_pk_add_f32 v[20:21], v[20:21], v[6:7]
 v_pk_add_f32 v[22:23], v[22:23], v[6:7]
 v_pk_add_f32 v[24:25], v[24:25], v[6:7]
 v_pk_add_f32 v[26:27], v[26:27], v[6:7]
 v_pk_add_f32 v[28:29], v[28:29], v[6:7]
 v_pk_add_f32 v[30:31], v[30:31], v[6:7]
 v_pk_add_f32 v[32:33], v[32:33], v[6:7]
 v_pk_add_f32 v[34:35], v[34:35], v[6:7]
 v_pk_add_f32 v[36:37], v[36:37], v[6:7]
 v_pk_add_f32 v[38:39], v[38:39], v[6:7]
 v_pk_add_f32 v[40:41], v[40:41], v[6:7]
 v_pk_add_f32 v[42:43], v[42:43], v[6:7]
 v_pk_add_f32 v[44:45], v[44:45], v[6:7]
 v_pk_add_f32 v[46:47], v[46:47], v[6:7]
 v_cvt_pk_bf16_f32 v144, v16, v17
 v_cvt_pk_bf16_f32 v145, v18, v19
 v_cvt_pk_bf16_f32 v146, v20, v21
 v_cvt_pk_bf16_f32 v147, v22, v23
 v_cvt_pk_bf16_f32 v148, v24, v25
 v_cvt_pk_bf16_f32 v149, v26, v27
 v_cvt_pk_bf16_f32 v150, v28, v29
 v_cvt_pk_bf16_f32 v151, v30, v31
 v_cvt_pk_bf16_f32 v152, v32, v33
 v_cvt_pk_bf16_f32 v153, v34, v35
 v_cvt_pk_bf16_f32 v154, v36, v37
 v_cvt_pk_bf16_f32 v155, v38, v39
 v_cvt_pk_bf16_f32 v156, v40, v41
 v_cvt_pk_bf16_f32 v157, v42, v43
 v_cvt_pk_bf16_f32 v158, v44, v45
 v_cvt_pk_bf16_f32 v159, v46, v47
 v_lshlrev_b32 v16, 16, v144
 v_and_b32 v17, s86, v144
 v_lshlrev_b32 v18, 16, v145
 v_and_b32 v19, s86, v145
 v_lshlrev_b32 v20, 16, v146
 v_and_b32 v21, s86, v146
 v_lshlrev_b32 v22, 16, v147
 v_and_b32 v23, s86, v147
 v_lshlrev_b32 v24, 16, v148
 v_and_b32 v25, s86, v148
 v_lshlrev_b32 v26, 16, v149
 v_and_b32 v27, s86, v149
 v_lshlrev_b32 v28, 16, v150
 v_and_b32 v29, s86, v150
 v_lshlrev_b32 v30, 16, v151
 v_and_b32 v31, s86, v151
 v_lshlrev_b32 v32, 16, v152
 v_and_b32 v33, s86, v152
 v_lshlrev_b32 v34, 16, v153
 v_and_b32 v35, s86, v153
 v_lshlrev_b32 v36, 16, v154
 v_and_b32 v37, s86, v154
 v_lshlrev_b32 v38, 16, v155
 v_and_b32 v39, s86, v155
 v_lshlrev_b32 v40, 16, v156
 v_and_b32 v41, s86, v156
 v_lshlrev_b32 v42, 16, v157
 v_and_b32 v43, s86, v157
 v_lshlrev_b32 v44, 16, v158
 v_and_b32 v45, s86, v158
 v_lshlrev_b32 v46, 16, v159
 v_and_b32 v47, s86, v159
 v_pk_mul_f32 v[16:17], v[16:17], v[68:69]
 v_pk_mul_f32 v[18:19], v[18:19], v[68:69]
 v_pk_mul_f32 v[20:21], v[20:21], v[68:69]
 v_pk_mul_f32 v[22:23], v[22:23], v[68:69]
 v_pk_mul_f32 v[24:25], v[24:25], v[68:69]
 v_pk_mul_f32 v[26:27], v[26:27], v[68:69]
 v_pk_mul_f32 v[28:29], v[28:29], v[68:69]
 v_pk_mul_f32 v[30:31], v[30:31], v[68:69]
 v_pk_mul_f32 v[32:33], v[32:33], v[68:69]
 v_pk_mul_f32 v[34:35], v[34:35], v[68:69]
 v_pk_mul_f32 v[36:37], v[36:37], v[68:69]
 v_pk_mul_f32 v[38:39], v[38:39], v[68:69]
 v_pk_mul_f32 v[40:41], v[40:41], v[68:69]
 v_pk_mul_f32 v[42:43], v[42:43], v[68:69]
 v_pk_mul_f32 v[44:45], v[44:45], v[68:69]
 v_pk_mul_f32 v[46:47], v[46:47], v[68:69]
 v_cvt_pk_bf16_f32 v144, v16, v17
 v_cvt_pk_bf16_f32 v145, v18, v19
 v_cvt_pk_bf16_f32 v146, v20, v21
 v_cvt_pk_bf16_f32 v147, v22, v23
 v_cvt_pk_bf16_f32 v148, v24, v25
 v_cvt_pk_bf16_f32 v149, v26, v27
 v_cvt_pk_bf16_f32 v150, v28, v29
 v_cvt_pk_bf16_f32 v151, v30, v31
 v_cvt_pk_bf16_f32 v152, v32, v33
 v_cvt_pk_bf16_f32 v153, v34, v35
 v_cvt_pk_bf16_f32 v154, v36, v37
 v_cvt_pk_bf16_f32 v155, v38, v39
 v_cvt_pk_bf16_f32 v156, v40, v41
 v_cvt_pk_bf16_f32 v157, v42, v43
 v_cvt_pk_bf16_f32 v158, v44, v45
 v_cvt_pk_bf16_f32 v159, v46, v47
 s_add_u32 s71, s70, 144424960
 buffer_store_dwordx4 v[144:147], v3, s[52:55], s71 offen offset:0 sc1
 buffer_store_dwordx4 v[148:151], v3, s[52:55], s71 offen offset:256 sc1
 buffer_store_dwordx4 v[152:155], v3, s[52:55], s71 offen offset:512 sc1
 buffer_store_dwordx4 v[156:159], v3, s[52:55], s71 offen offset:768 sc1
 s_lshr_b32 s69, s87, 3
 s_lshl_b32 s69, s69, 8
 s_and_b32 s70, s87, 7
 s_lshl_b32 s70, s70, 2
 s_add_u32 s69, s69, s70
 s_add_u32 s69, s69, 33280
 s_branch rln_loop
rln_s2:
 s_mov_b32 s87, s90
 s_add_u32 s70, s90, 24
 s_add_u32 s71, s65, 48
 s_cmp_lt_u32 s70, 48
 s_cselect_b32 s70, s70, s71
 s_add_u32 s71, s90, 44
 s_cmp_lt_u32 s90, 48
 s_cselect_b32 s90, s70, s71
 s_lshl_b32 s70, s87, 12
 s_lshr_b32 s72, s87, 3
 s_and_b32 s73, s87, 7
 s_lshl_b32 s73, s73, 7
 s_lshl_b32 s72, s72, 17
 s_add_u32 s72, s72, s73
 s_add_u32 s72, s72, 131842048
 buffer_load_dwordx4 v[64:67], v4, s[52:55], s72 offen sc1
 s_add_u32 s72, s72, 8192
 buffer_load_dwordx4 v[68:71], v4, s[52:55], s72 offen sc1
 s_add_u32 s72, s72, 8192
 buffer_load_dwordx4 v[72:75], v4, s[52:55], s72 offen sc1
 s_add_u32 s72, s72, 8192
 buffer_load_dwordx4 v[76:79], v4, s[52:55], s72 offen sc1
 s_add_u32 s72, s72, 8192
 buffer_load_dwordx4 v[80:83], v4, s[52:55], s72 offen sc1
 s_add_u32 s72, s72, 8192
 buffer_load_dwordx4 v[84:87], v4, s[52:55], s72 offen sc1
 s_add_u32 s72, s72, 8192
 buffer_load_dwordx4 v[88:91], v4, s[52:55], s72 offen sc1
 s_add_u32 s72, s72, 8192
 buffer_load_dwordx4 v[92:95], v4, s[52:55], s72 offen sc1
 s_add_u32 s72, s72, 8192
 buffer_load_dwordx4 v[96:99], v4, s[52:55], s72 offen sc1
 s_add_u32 s72, s72, 8192
 buffer_load_dwordx4 v[100:103], v4, s[52:55], s72 offen sc1
 s_add_u32 s72, s72, 8192
 buffer_load_dwordx4 v[104:107], v4, s[52:55], s72 offen sc1
 s_add_u32 s72, s72, 8192
 buffer_load_dwordx4 v[108:111], v4, s[52:55], s72 offen sc1
 s_add_u32 s72, s72, 8192
 buffer_load_dwordx4 v[112:115], v4, s[52:55], s72 offen sc1
 s_add_u32 s72, s72, 8192
 buffer_load_dwordx4 v[116:119], v4, s[52:55], s72 offen sc1
 s_add_u32 s72, s72, 8192
 buffer_load_dwordx4 v[120:123], v4, s[52:55], s72 offen sc1
 s_add_u32 s72, s72, 8192
 buffer_load_dwordx4 v[124:127], v4, s[52:55], s72 offen sc1
 s_add_u32 s72, s72, 8192
 s_add_u32 s71, s70, 176668672
 buffer_load_dwordx4 v[48:51], v3, s[52:55], s71 offen offset:0 sc1
 buffer_load_dwordx4 v[52:55], v3, s[52:55], s71 offen offset:256 sc1
 buffer_load_dwordx4 v[56:59], v3, s[52:55], s71 offen offset:512 sc1
 buffer_load_dwordx4 v[60:63], v3, s[52:55], s71 offen offset:768 sc1
 s_waitcnt vmcnt(16)
 v_lshlrev_b32 v16, 16, v64
 v_and_b32 v17, s86, v64
 v_lshlrev_b32 v18, 16, v65
 v_and_b32 v19, s86, v65
 v_lshlrev_b32 v20, 16, v66
 v_and_b32 v21, s86, v66
 v_lshlrev_b32 v22, 16, v67
 v_and_b32 v23, s86, v67
 v_lshlrev_b32 v24, 16, v68
 v_and_b32 v25, s86, v68
 v_lshlrev_b32 v26, 16, v69
 v_and_b32 v27, s86, v69
 v_lshlrev_b32 v28, 16, v70
 v_and_b32 v29, s86, v70
 v_lshlrev_b32 v30, 16, v71
 v_and_b32 v31, s86, v71
 v_lshlrev_b32 v32, 16, v72
 v_and_b32 v33, s86, v72
 v_lshlrev_b32 v34, 16, v73
 v_and_b32 v35, s86, v73
 v_lshlrev_b32 v36, 16, v74
 v_and_b32 v37, s86, v74
 v_lshlrev_b32 v38, 16, v75
 v_and_b32 v39, s86, v75
 v_lshlrev_b32 v40, 16, v76
 v_and_b32 v41, s86, v76
 v_lshlrev_b32 v42, 16, v77
 v_and_b32 v43, s86, v77
 v_lshlrev_b32 v44, 16, v78
 v_and_b32 v45, s86, v78
 v_lshlrev_b32 v46, 16, v79
 v_and_b32 v47, s86, v79
 s_waitcnt vmcnt(12)
 v_lshlrev_b32 v160, 16, v80
 v_and_b32 v161, s86, v80
 v_lshlrev_b32 v162, 16, v81
 v_and_b32 v163, s86, v81
 v_lshlrev_b32 v164, 16, v82
 v_and_b32 v165, s86, v82
 v_lshlrev_b32 v166, 16, v83
 v_and_b32 v167, s86, v83
 v_lshlrev_b32 v168, 16, v84
 v_and_b32 v169, s86, v84
 v_lshlrev_b32 v170, 16, v85
 v_and_b32 v171, s86, v85
 v_lshlrev_b32 v172, 16, v86
 v_and_b32 v173, s86, v86
 v_lshlrev_b32 v174, 16, v87
 v_and_b32 v175, s86, v87
 v_lshlrev_b32 v176, 16, v88
 v_and_b32 v177, s86, v88
 v_lshlrev_b32 v178, 16, v89
 v_and_b32 v179, s86, v89
 v_lshlrev_b32 v180, 16, v90
 v_and_b32 v181, s86, v90
 v_lshlrev_b32 v182, 16, v91
 v_and_b32 v183, s86, v91
 v_lshlrev_b32 v184, 16, v92
 v_and_b32 v185, s86, v92
 v_lshlrev_b32 v186, 16, v93
 v_and_b32 v187, s86, v93
 v_lshlrev_b32 v188, 16, v94
 v_and_b32 v189, s86, v94
 v_lshlrev_b32 v190, 16, v95
 v_and_b32 v191, s86, v95
 v_pk_add_f32 v[16:17], v[16:17], v[160:161]
 v_pk_add_f32 v[18:19], v[18:19], v[162:163]
 v_pk_add_f32 v[20:21], v[20:21], v[164:165]
 v_pk_add_f32 v[22:23], v[22:23], v[166:167]
 v_pk_add_f32 v[24:25], v[24:25], v[168:169]
 v_pk_add_f32 v[26:27], v[26:27], v[170:171]
 v_pk_add_f32 v[28:29], v[28:29], v[172:173]
 v_pk_add_f32 v[30:31], v[30:31], v[174:175]
 v_pk_add_f32 v[32:33], v[32:33], v[176:177]
 v_pk_add_f32 v[34:35], v[34:35], v[178:179]
 v_pk_add_f32 v[36:37], v[36:37], v[180:181]
 v_pk_add_f32 v[38:39], v[38:39], v[182:183]
 v_pk_add_f32 v[40:41], v[40:41], v[184:185]
 v_pk_add_f32 v[42:43], v[42:43], v[186:187]
 v_pk_add_f32 v[44:45], v[44:45], v[188:189]
 v_pk_add_f32 v[46:47], v[46:47], v[190:191]
 s_waitcnt vmcnt(8)
 v_lshlrev_b32 v160, 16, v96
 v_and_b32 v161, s86, v96
 v_lshlrev_b32 v162, 16, v97
 v_and_b32 v163, s86, v97
 v_lshlrev_b32 v164, 16, v98
 v_and_b32 v165, s86, v98
 v_lshlrev_b32 v166, 16, v99
 v_and_b32 v167, s86, v99
 v_lshlrev_b32 v168, 16, v100
 v_and_b32 v169, s86, v100
 v_lshlrev_b32 v170, 16, v101
 v_and_b32 v171, s86, v101
 v_lshlrev_b32 v172, 16, v102
 v_and_b32 v173, s86, v102
 v_lshlrev_b32 v174, 16, v103
 v_and_b32 v175, s86, v103
 v_lshlrev_b32 v176, 16, v104
 v_and_b32 v177, s86, v104
 v_lshlrev_b32 v178, 16, v105
 v_and_b32 v179, s86, v105
 v_lshlrev_b32 v180, 16, v106
 v_and_b32 v181, s86, v106
 v_lshlrev_b32 v182, 16, v107
 v_and_b32 v183, s86, v107
 v_lshlrev_b32 v184, 16, v108
 v_and_b32 v185, s86, v108
 v_lshlrev_b32 v186, 16, v109
 v_and_b32 v187, s86, v109
 v_lshlrev_b32 v188, 16, v110
 v_and_b32 v189, s86, v110
 v_lshlrev_b32 v190, 16, v111
 v_and_b32 v191, s86, v111
 v_pk_add_f32 v[16:17], v[16:17], v[160:161]
 v_pk_add_f32 v[18:19], v[18:19], v[162:163]
 v_pk_add_f32 v[20:21], v[20:21], v[164:165]
 v_pk_add_f32 v[22:23], v[22:23], v[166:167]
 v_pk_add_f32 v[24:25], v[24:25], v[168:169]
 v_pk_add_f32 v[26:27], v[26:27], v[170:171]
 v_pk_add_f32 v[28:29], v[28:29], v[172:173]
 v_pk_add_f32 v[30:31], v[30:31], v[174:175]
 v_pk_add_f32 v[32:33], v[32:33], v[176:177]
 v_pk_add_f32 v[34:35], v[34:35], v[178:179]
 v_pk_add_f32 v[36:37], v[36:37], v[180:181]
 v_pk_add_f32 v[38:39], v[38:39], v[182:183]
 v_pk_add_f32 v[40:41], v[40:41], v[184:185]
 v_pk_add_f32 v[42:43], v[42:43], v[186:187]
 v_pk_add_f32 v[44:45], v[44:45], v[188:189]
 v_pk_add_f32 v[46:47], v[46:47], v[190:191]
 s_waitcnt vmcnt(4)
 v_lshlrev_b32 v160, 16, v112
 v_and_b32 v161, s86, v112
 v_lshlrev_b32 v162, 16, v113
 v_and_b32 v163, s86, v113
 v_lshlrev_b32 v164, 16, v114
 v_and_b32 v165, s86, v114
 v_lshlrev_b32 v166, 16, v115
 v_and_b32 v167, s86, v115
 v_lshlrev_b32 v168, 16, v116
 v_and_b32 v169, s86, v116
 v_lshlrev_b32 v170, 16, v117
 v_and_b32 v171, s86, v117
 v_lshlrev_b32 v172, 16, v118
 v_and_b32 v173, s86, v118
 v_lshlrev_b32 v174, 16, v119
 v_and_b32 v175, s86, v119
 v_lshlrev_b32 v176, 16, v120
 v_and_b32 v177, s86, v120
 v_lshlrev_b32 v178, 16, v121
 v_and_b32 v179, s86, v121
 v_lshlrev_b32 v180, 16, v122
 v_and_b32 v181, s86, v122
 v_lshlrev_b32 v182, 16, v123
 v_and_b32 v183, s86, v123
 v_lshlrev_b32 v184, 16, v124
 v_and_b32 v185, s86, v124
 v_lshlrev_b32 v186, 16, v125
 v_and_b32 v187, s86, v125
 v_lshlrev_b32 v188, 16, v126
 v_and_b32 v189, s86, v126
 v_lshlrev_b32 v190, 16, v127
 v_and_b32 v191, s86, v127
 v_pk_add_f32 v[16:17], v[16:17], v[160:161]
 v_pk_add_f32 v[18:19], v[18:19], v[162:163]
 v_pk_add_f32 v[20:21], v[20:21], v[164:165]
 v_pk_add_f32 v[22:23], v[22:23], v[166:167]
 v_pk_add_f32 v[24:25], v[24:25], v[168:169]
 v_pk_add_f32 v[26:27], v[26:27], v[170:171]
 v_pk_add_f32 v[28:29], v[28:29], v[172:173]
 v_pk_add_f32 v[30:31], v[30:31], v[174:175]
 v_pk_add_f32 v[32:33], v[32:33], v[176:177]
 v_pk_add_f32 v[34:35], v[34:35], v[178:179]
 v_pk_add_f32 v[36:37], v[36:37], v[180:181]
 v_pk_add_f32 v[38:39], v[38:39], v[182:183]
 v_pk_add_f32 v[40:41], v[40:41], v[184:185]
 v_pk_add_f32 v[42:43], v[42:43], v[186:187]
 v_pk_add_f32 v[44:45], v[44:45], v[188:189]
 v_pk_add_f32 v[46:47], v[46:47], v[190:191]
 v_cvt_pk_bf16_f32 v128, v16, v17
 v_cvt_pk_bf16_f32 v129, v18, v19
 v_cvt_pk_bf16_f32 v130, v20, v21
 v_cvt_pk_bf16_f32 v131, v22, v23
 v_cvt_pk_bf16_f32 v132, v24, v25
 v_cvt_pk_bf16_f32 v133, v26, v27
 v_cvt_pk_bf16_f32 v134, v28, v29
 v_cvt_pk_bf16_f32 v135, v30, v31
 v_cvt_pk_bf16_f32 v136, v32, v33
 v_cvt_pk_bf16_f32 v137, v34, v35
 v_cvt_pk_bf16_f32 v138, v36, v37
 v_cvt_pk_bf16_f32 v139, v38, v39
 v_cvt_pk_bf16_f32 v140, v40, v41
 v_cvt_pk_bf16_f32 v141, v42, v43
 v_cvt_pk_bf16_f32 v142, v44, v45
 v_cvt_pk_bf16_f32 v143, v46, v47
 v_lshlrev_b32 v16, 16, v128
 v_and_b32 v17, s86, v128
 v_lshlrev_b32 v18, 16, v129
 v_and_b32 v19, s86, v129
 v_lshlrev_b32 v20, 16, v130
 v_and_b32 v21, s86, v130
 v_lshlrev_b32 v22, 16, v131
 v_and_b32 v23, s86, v131
 v_lshlrev_b32 v24, 16, v132
 v_and_b32 v25, s86, v132
 v_lshlrev_b32 v26, 16, v133
 v_and_b32 v27, s86, v133
 v_lshlrev_b32 v28, 16, v134
 v_and_b32 v29, s86, v134
 v_lshlrev_b32 v30, 16, v135
 v_and_b32 v31, s86, v135
 v_lshlrev_b32 v32, 16, v136
 v_and_b32 v33, s86, v136
 v_lshlrev_b32 v34, 16, v137
 v_and_b32 v35, s86, v137
 v_lshlrev_b32 v36, 16, v138
 v_and_b32 v37, s86, v138
 v_lshlrev_b32 v38, 16, v139
 v_and_b32 v39, s86, v139
 v_lshlrev_b32 v40, 16, v140
 v_and_b32 v41, s86, v140
 v_lshlrev_b32 v42, 16, v141
 v_and_b32 v43, s86, v141
 v_lshlrev_b32 v44, 16, v142
 v_and_b32 v45, s86, v142
 v_lshlrev_b32 v46, 16, v143
 v_and_b32 v47, s86, v143
 s_waitcnt vmcnt(0)
 v_lshlrev_b32 v160, 16, v48
 v_and_b32 v161, s86, v48
 v_lshlrev_b32 v162, 16, v49
 v_and_b32 v163, s86, v49
 v_lshlrev_b32 v164, 16, v50
 v_and_b32 v165, s86, v50
 v_lshlrev_b32 v166, 16, v51
 v_and_b32 v167, s86, v51
 v_lshlrev_b32 v168, 16, v52
 v_and_b32 v169, s86, v52
 v_lshlrev_b32 v170, 16, v53
 v_and_b32 v171, s86, v53
 v_lshlrev_b32 v172, 16, v54
 v_and_b32 v173, s86, v54
 v_lshlrev_b32 v174, 16, v55
 v_and_b32 v175, s86, v55
 v_lshlrev_b32 v176, 16, v56
 v_and_b32 v177, s86, v56
 v_lshlrev_b32 v178, 16, v57
 v_and_b32 v179, s86, v57
 v_lshlrev_b32 v180, 16, v58
 v_and_b32 v181, s86, v58
 v_lshlrev_b32 v182, 16, v59
 v_and_b32 v183, s86, v59
 v_lshlrev_b32 v184, 16, v60
 v_and_b32 v185, s86, v60
 v_lshlrev_b32 v186, 16, v61
 v_and_b32 v187, s86, v61
 v_lshlrev_b32 v188, 16, v62
 v_and_b32 v189, s86, v62
 v_lshlrev_b32 v190, 16, v63
 v_and_b32 v191, s86, v63
 v_pk_add_f32 v[16:17], v[16:17], v[160:161]
 v_pk_add_f32 v[18:19], v[18:19], v[162:163]
 v_pk_add_f32 v[20:21], v[20:21], v[164:165]
 v_pk_add_f32 v[22:23], v[22:23], v[166:167]
 v_pk_add_f32 v[24:25], v[24:25], v[168:169]
 v_pk_add_f32 v[26:27], v[26:27], v[170:171]
 v_pk_add_f32 v[28:29], v[28:29], v[172:173]
 v_pk_add_f32 v[30:31], v[30:31], v[174:175]
 v_pk_add_f32 v[32:33], v[32:33], v[176:177]
 v_pk_add_f32 v[34:35], v[34:35], v[178:179]
 v_pk_add_f32 v[36:37], v[36:37], v[180:181]
 v_pk_add_f32 v[38:39], v[38:39], v[182:183]
 v_pk_add_f32 v[40:41], v[40:41], v[184:185]
 v_pk_add_f32 v[42:43], v[42:43], v[186:187]
 v_pk_add_f32 v[44:45], v[44:45], v[188:189]
 v_pk_add_f32 v[46:47], v[46:47], v[190:191]
 v_cvt_pk_bf16_f32 v128, v16, v17
 v_cvt_pk_bf16_f32 v129, v18, v19
 v_cvt_pk_bf16_f32 v130, v20, v21
 v_cvt_pk_bf16_f32 v131, v22, v23
 v_cvt_pk_bf16_f32 v132, v24, v25
 v_cvt_pk_bf16_f32 v133, v26, v27
 v_cvt_pk_bf16_f32 v134, v28, v29
 v_cvt_pk_bf16_f32 v135, v30, v31
 v_cvt_pk_bf16_f32 v136, v32, v33
 v_cvt_pk_bf16_f32 v137, v34, v35
 v_cvt_pk_bf16_f32 v138, v36, v37
 v_cvt_pk_bf16_f32 v139, v38, v39
 v_cvt_pk_bf16_f32 v140, v40, v41
 v_cvt_pk_bf16_f32 v141, v42, v43
 v_cvt_pk_bf16_f32 v142, v44, v45
 v_cvt_pk_bf16_f32 v143, v46, v47
 s_add_u32 s71, s70, 142327808
 buffer_store_dwordx4 v[128:131], v3, s[52:55], s71 offen offset:0 sc1
 buffer_store_dwordx4 v[132:135], v3, s[52:55], s71 offen offset:256 sc1
 buffer_store_dwordx4 v[136:139], v3, s[52:55], s71 offen offset:512 sc1
 buffer_store_dwordx4 v[140:143], v3, s[52:55], s71 offen offset:768 sc1
 v_lshlrev_b32 v16, 16, v128
 v_and_b32 v17, s86, v128
 v_lshlrev_b32 v18, 16, v129
 v_and_b32 v19, s86, v129
 v_lshlrev_b32 v20, 16, v130
 v_and_b32 v21, s86, v130
 v_lshlrev_b32 v22, 16, v131
 v_and_b32 v23, s86, v131
 v_lshlrev_b32 v24, 16, v132
 v_and_b32 v25, s86, v132
 v_lshlrev_b32 v26, 16, v133
 v_and_b32 v27, s86, v133
 v_lshlrev_b32 v28, 16, v134
 v_and_b32 v29, s86, v134
 v_lshlrev_b32 v30, 16, v135
 v_and_b32 v31, s86, v135
 v_lshlrev_b32 v32, 16, v136
 v_and_b32 v33, s86, v136
 v_lshlrev_b32 v34, 16, v137
 v_and_b32 v35, s86, v137
 v_lshlrev_b32 v36, 16, v138
 v_and_b32 v37, s86, v138
 v_lshlrev_b32 v38, 16, v139
 v_and_b32 v39, s86, v139
 v_lshlrev_b32 v40, 16, v140
 v_and_b32 v41, s86, v140
 v_lshlrev_b32 v42, 16, v141
 v_and_b32 v43, s86, v141
 v_lshlrev_b32 v44, 16, v142
 v_and_b32 v45, s86, v142
 v_lshlrev_b32 v46, 16, v143
 v_and_b32 v47, s86, v143
 v_pk_add_f32 v[160:161], v[16:17], v[32:33]
 v_pk_add_f32 v[162:163], v[18:19], v[34:35]
 v_pk_add_f32 v[164:165], v[20:21], v[36:37]
 v_pk_add_f32 v[166:167], v[22:23], v[38:39]
 v_pk_add_f32 v[168:169], v[24:25], v[40:41]
 v_pk_add_f32 v[170:171], v[26:27], v[42:43]
 v_pk_add_f32 v[172:173], v[28:29], v[44:45]
 v_pk_add_f32 v[174:175], v[30:31], v[46:47]
 v_pk_add_f32 v[160:161], v[160:161], v[168:169]
 v_pk_add_f32 v[162:163], v[162:163], v[170:171]
 v_pk_add_f32 v[164:165], v[164:165], v[172:173]
 v_pk_add_f32 v[166:167], v[166:167], v[174:175]
 v_pk_add_f32 v[160:161], v[160:161], v[164:165]
 v_pk_add_f32 v[162:163], v[162:163], v[166:167]
 v_pk_add_f32 v[160:161], v[160:161], v[162:163]
 v_add_f32 v6, v160, v161
 s_nop 1
 v_add_f32_dpp v6, v6, v6 quad_perm:[1,0,3,2] row_mask:0xf bank_mask:0xf
 s_nop 1
 v_add_f32_dpp v6, v6, v6 row_ror:8 row_mask:0xf bank_mask:0xf
 v_mov_b32 v5, v6
 s_nop 1
 v_permlane16_swap_b32 v6, v5
 s_nop 0
 v_add_f32 v6, v6, v5
 v_mov_b32 v5, v6
 s_nop 1
 v_permlane32_swap_b32 v6, v5
 s_nop 0
 v_add_f32 v6, v6, v5
 v_mul_f32 v6, 0xbb000000, v6
 v_mov_b32 v7, v6
 v_pk_add_f32 v[160:161], v[16:17], v[6:7]
 v_pk_add_f32 v[162:163], v[18:19], v[6:7]
 v_pk_add_f32 v[164:165], v[20:21], v[6:7]
 v_pk_add_f32 v[166:167], v[22:23], v[6:7]
 v_pk_add_f32 v[168:169], v[24:25], v[6:7]
 v_pk_add_f32 v[170:171], v[26:27], v[6:7]
 v_pk_add_f32 v[172:173], v[28:29], v[6:7]
 v_pk_add_f32 v[174:175], v[30:31], v[6:7]
 v_pk_add_f32 v[176:177], v[32:33], v[6:7]
 v_pk_add_f32 v[178:179], v[34:35], v[6:7]
 v_pk_add_f32 v[180:181], v[36:37], v[6:7]
 v_pk_add_f32 v[182:183], v[38:39], v[6:7]
 v_pk_add_f32 v[184:185], v[40:41], v[6:7]
 v_pk_add_f32 v[186:187], v[42:43], v[6:7]
 v_pk_add_f32 v[188:189], v[44:45], v[6:7]
 v_pk_add_f32 v[190:191], v[46:47], v[6:7]
 v_pk_mul_f32 v[64:65], v[160:161], v[160:161]
 v_pk_mul_f32 v[66:67], v[162:163], v[162:163]
 v_pk_fma_f32 v[64:65], v[164:165], v[164:165], v[64:65]
 v_pk_fma_f32 v[66:67], v[166:167], v[166:167], v[66:67]
 v_pk_fma_f32 v[64:65], v[168:169], v[168:169], v[64:65]
 v_pk_fma_f32 v[66:67], v[170:171], v[170:171], v[66:67]
 v_pk_fma_f32 v[64:65], v[172:173], v[172:173], v[64:65]
 v_pk_fma_f32 v[66:67], v[174:175], v[174:175], v[66:67]
 v_pk_fma_f32 v[64:65], v[176:177], v[176:177], v[64:65]
 v_pk_fma_f32 v[66:67], v[178:179], v[178:179], v[66:67]
 v_pk_fma_f32 v[64:65], v[180:181], v[180:181], v[64:65]
 v_pk_fma_f32 v[66:67], v[182:183], v[182:183], v[66:67]
 v_pk_fma_f32 v[64:65], v[184:185], v[184:185], v[64:65]
 v_pk_fma_f32 v[66:67], v[186:187], v[186:187], v[66:67]
 v_pk_fma_f32 v[64:65], v[188:189], v[188:189], v[64:65]
 v_pk_fma_f32 v[66:67], v[190:191], v[190:191], v[66:67]
 v_pk_add_f32 v[64:65], v[64:65], v[66:67]
 v_add_f32 v68, v64, v65
 s_nop 1
 v_add_f32_dpp v68, v68, v68 quad_perm:[1,0,3,2] row_mask:0xf bank_mask:0xf
 s_nop 1
 v_add_f32_dpp v68, v68, v68 row_ror:8 row_mask:0xf bank_mask:0xf
 v_mov_b32 v5, v68
 s_nop 1
 v_permlane16_swap_b32 v68, v5
 s_nop 0
 v_add_f32 v68, v68, v5
 v_mov_b32 v5, v68
 s_nop 1
 v_permlane32_swap_b32 v68, v5
 s_nop 0
 v_add_f32 v68, v68, v5
 v_mul_f32 v68, 0x3b000000, v68
 v_cvt_pk_bf16_f32 v5, v68, v68
 v_lshlrev_b32 v68, 16, v5
 v_add_f32 v68, 0x3727c5ac, v68
 v_cvt_pk_bf16_f32 v5, v68, v68
 v_lshlrev_b32 v68, 16, v5
 v_sqrt_f32 v68, v68
 s_nop 0
 v_cvt_pk_bf16_f32 v5, v68, v68
 v_lshlrev_b32 v68, 16, v5
 v_rcp_f32 v68, v68
 v_cvt_pk_bf16_f32 v5, v6, v6
 v_lshlrev_b32 v6, 16, v5
 v_mov_b32 v7, v6
 v_mov_b32 v69, v68
 v_pk_add_f32 v[16:17], v[16:17], v[6:7]
 v_pk_add_f32 v[18:19], v[18:19], v[6:7]
 v_pk_add_f32 v[20:21], v[20:21], v[6:7]
 v_pk_add_f32 v[22:23], v[22:23], v[6:7]
 v_pk_add_f32 v[24:25], v[24:25], v[6:7]
 v_pk_add_f32 v[26:27], v[26:27], v[6:7]
 v_pk_add_f32 v[28:29], v[28:29], v[6:7]
 v_pk_add_f32 v[30:31], v[30:31], v[6:7]
 v_pk_add_f32 v[32:33], v[32:33], v[6:7]
 v_pk_add_f32 v[34:35], v[34:35], v[6:7]
 v_pk_add_f32 v[36:37], v[36:37], v[6:7]
 v_pk_add_f32 v[38:39], v[38:39], v[6:7]
 v_pk_add_f32 v[40:41], v[40:41], v[6:7]
 v_pk_add_f32 v[42:43], v[42:43], v[6:7]
 v_pk_add_f32 v[44:45], v[44:45], v[6:7]
 v_pk_add_f32 v[46:47], v[46:47], v[6:7]
 v_cvt_pk_bf16_f32 v144, v16, v17
 v_cvt_pk_bf16_f32 v145, v18, v19
 v_cvt_pk_bf16_f32 v146, v20, v21
 v_cvt_pk_bf16_f32 v147, v22, v23
 v_cvt_pk_bf16_f32 v148, v24, v25
 v_cvt_pk_bf16_f32 v149, v26, v27
 v_cvt_pk_bf16_f32 v150, v28, v29
 v_cvt_pk_bf16_f32 v151, v30, v31
 v_cvt_pk_bf16_f32 v152, v32, v33
 v_cvt_pk_bf16_f32 v153, v34, v35
 v_cvt_pk_bf16_f32 v154, v36, v37
 v_cvt_pk_bf16_f32 v155, v38, v39
 v_cvt_pk_bf16_f32 v156, v40, v41
 v_cvt_pk_bf16_f32 v157, v42, v43
 v_cvt_pk_bf16_f32 v158, v44, v45
 v_cvt_pk_bf16_f32 v159, v46, v47
 v_lshlrev_b32 v16, 16, v144
 v_and_b32 v17, s86, v144
 v_lshlrev_b32 v18, 16, v145
 v_and_b32 v19, s86, v145
 v_lshlrev_b32 v20, 16, v146
 v_and_b32 v21, s86, v146
 v_lshlrev_b32 v22, 16, v147
 v_and_b32 v23, s86, v147
 v_lshlrev_b32 v24, 16, v148
 v_and_b32 v25, s86, v148
 v_lshlrev_b32 v26, 16, v149
 v_and_b32 v27, s86, v149
 v_lshlrev_b32 v28, 16, v150
 v_and_b32 v29, s86, v150
 v_lshlrev_b32 v30, 16, v151
 v_and_b32 v31, s86, v151
 v_lshlrev_b32 v32, 16, v152
 v_and_b32 v33, s86, v152
 v_lshlrev_b32 v34, 16, v153
 v_and_b32 v35, s86, v153
 v_lshlrev_b32 v36, 16, v154
 v_and_b32 v37, s86, v154
 v_lshlrev_b32 v38, 16, v155
 v_and_b32 v39, s86, v155
 v_lshlrev_b32 v40, 16, v156
 v_and_b32 v41, s86, v156
 v_lshlrev_b32 v42, 16, v157
 v_and_b32 v43, s86, v157
 v_lshlrev_b32 v44, 16, v158
 v_and_b32 v45, s86, v158
 v_lshlrev_b32 v46, 16, v159
 v_and_b32 v47, s86, v159
 v_pk_mul_f32 v[16:17], v[16:17], v[68:69]
 v_pk_mul_f32 v[18:19], v[18:19], v[68:69]
 v_pk_mul_f32 v[20:21], v[20:21], v[68:69]
 v_pk_mul_f32 v[22:23], v[22:23], v[68:69]
 v_pk_mul_f32 v[24:25], v[24:25], v[68:69]
 v_pk_mul_f32 v[26:27], v[26:27], v[68:69]
 v_pk_mul_f32 v[28:29], v[28:29], v[68:69]
 v_pk_mul_f32 v[30:31], v[30:31], v[68:69]
 v_pk_mul_f32 v[32:33], v[32:33], v[68:69]
 v_pk_mul_f32 v[34:35], v[34:35], v[68:69]
 v_pk_mul_f32 v[36:37], v[36:37], v[68:69]
 v_pk_mul_f32 v[38:39], v[38:39], v[68:69]
 v_pk_mul_f32 v[40:41], v[40:41], v[68:69]
 v_pk_mul_f32 v[42:43], v[42:43], v[68:69]
 v_pk_mul_f32 v[44:45], v[44:45], v[68:69]
 v_pk_mul_f32 v[46:47], v[46:47], v[68:69]
 v_cvt_pk_bf16_f32 v144, v16, v17
 v_cvt_pk_bf16_f32 v145, v18, v19
 v_cvt_pk_bf16_f32 v146, v20, v21
 v_cvt_pk_bf16_f32 v147, v22, v23
 v_cvt_pk_bf16_f32 v148, v24, v25
 v_cvt_pk_bf16_f32 v149, v26, v27
 v_cvt_pk_bf16_f32 v150, v28, v29
 v_cvt_pk_bf16_f32 v151, v30, v31
 v_cvt_pk_bf16_f32 v152, v32, v33
 v_cvt_pk_bf16_f32 v153, v34, v35
 v_cvt_pk_bf16_f32 v154, v36, v37
 v_cvt_pk_bf16_f32 v155, v38, v39
 v_cvt_pk_bf16_f32 v156, v40, v41
 v_cvt_pk_bf16_f32 v157, v42, v43
 v_cvt_pk_bf16_f32 v158, v44, v45
 v_cvt_pk_bf16_f32 v159, v46, v47
 s_add_u32 s71, s70, 146522112
 buffer_store_dwordx4 v[144:147], v3, s[52:55], s71 offen offset:0 sc1
 buffer_store_dwordx4 v[148:151], v3, s[52:55], s71 offen offset:256 sc1
 buffer_store_dwordx4 v[152:155], v3, s[52:55], s71 offen offset:512 sc1
 buffer_store_dwordx4 v[156:159], v3, s[52:55], s71 offen offset:768 sc1
 s_lshr_b32 s69, s87, 3
 s_lshl_b32 s69, s69, 8
 s_and_b32 s70, s87, 7
 s_lshl_b32 s70, s70, 2
 s_add_u32 s69, s69, s70
 s_add_u32 s69, s69, 49920
 s_branch rln_loop
rln_s3:
 s_mov_b32 s87, s91
 s_add_u32 s70, s91, 24
 s_add_u32 s71, s65, 48
 s_cmp_lt_u32 s70, 48
 s_cselect_b32 s70, s70, s71
 s_add_u32 s71, s91, 44
 s_cmp_lt_u32 s91, 48
 s_cselect_b32 s91, s70, s71
 s_lshl_b32 s70, s87, 12
 s_lshr_b32 s72, s87, 3
 s_and_b32 s73, s87, 7
 s_lshl_b32 s73, s73, 7
 s_lshl_b32 s72, s72, 17
 s_add_u32 s72, s72, s73
 s_add_u32 s72, s72, 168280064
 buffer_load_dwordx4 v[64:67], v9, s[52:55], s72 offen offset:0 sc1
 buffer_load_dwordx4 v[68:71], v9, s[52:55], s72 offen offset:1024 sc1
 s_add_u32 s72, s72, 16384
 buffer_load_dwordx4 v[72:75], v9, s[52:55], s72 offen offset:0 sc1
 buffer_load_dwordx4 v[76:79], v9, s[52:55], s72 offen offset:1024 sc1
 s_add_u32 s72, s72, 16384
 buffer_load_dwordx4 v[80:83], v9, s[52:55], s72 offen offset:0 sc1
 buffer_load_dwordx4 v[84:87], v9, s[52:55], s72 offen offset:1024 sc1
 s_add_u32 s72, s72, 16384
 buffer_load_dwordx4 v[88:91], v9, s[52:55], s72 offen offset:0 sc1
 buffer_load_dwordx4 v[92:95], v9, s[52:55], s72 offen offset:1024 sc1
 s_add_u32 s72, s72, 16384
 buffer_load_dwordx4 v[96:99], v9, s[52:55], s72 offen offset:0 sc1
 buffer_load_dwordx4 v[100:103], v9, s[52:55], s72 offen offset:1024 sc1
 s_add_u32 s72, s72, 16384
 buffer_load_dwordx4 v[104:107], v9, s[52:55], s72 offen offset:0 sc1
 buffer_load_dwordx4 v[108:111], v9, s[52:55], s72 offen offset:1024 sc1
 s_add_u32 s72, s72, 16384
 buffer_load_dwordx4 v[112:115], v9, s[52:55], s72 offen offset:0 sc1
 buffer_load_dwordx4 v[116:119], v9, s[52:55], s72 offen offset:1024 sc1
 s_add_u32 s72, s72, 16384
 buffer_load_dwordx4 v[120:123], v9, s[52:55], s72 offen offset:0 sc1
 buffer_load_dwordx4 v[124:127], v9, s[52:55], s72 offen offset:1024 sc1
 s_add_u32 s72, s72, 16384
 s_add_u32 s71, s70, 142327808
 buffer_load_dwordx4 v[48:51], v3, s[52:55], s71 offen offset:0 sc1
 buffer_load_dwordx4 v[52:55], v3, s[52:55], s71 offen offset:256 sc1
 buffer_load_dwordx4 v[56:59], v3, s[52:55], s71 offen offset:512 sc1
 buffer_load_dwordx4 v[60:63], v3, s[52:55], s71 offen offset:768 sc1
 s_waitcnt vmcnt(4)
 v_pk_add_f32 v[16:17], v[64:65], v[96:97]
 v_pk_add_f32 v[18:19], v[66:67], v[98:99]
 v_pk_add_f32 v[20:21], v[68:69], v[100:101]
 v_pk_add_f32 v[22:23], v[70:71], v[102:103]
 v_pk_add_f32 v[24:25], v[72:73], v[104:105]
 v_pk_add_f32 v[26:27], v[74:75], v[106:107]
 v_pk_add_f32 v[28:29], v[76:77], v[108:109]
 v_pk_add_f32 v[30:31], v[78:79], v[110:111]
 v_pk_add_f32 v[32:33], v[80:81], v[112:113]
 v_pk_add_f32 v[34:35], v[82:83], v[114:115]
 v_pk_add_f32 v[36:37], v[84:85], v[116:117]
 v_pk_add_f32 v[38:39], v[86:87], v[118:119]
 v_pk_add_f32 v[40:41], v[88:89], v[120:121]
 v_pk_add_f32 v[42:43], v[90:91], v[122:123]
 v_pk_add_f32 v[44:45], v[92:93], v[124:125]
 v_pk_add_f32 v[46:47], v[94:95], v[126:127]
 v_cvt_pk_bf16_f32 v128, v16, v17
 v_cvt_pk_bf16_f32 v129, v18, v19
 v_cvt_pk_bf16_f32 v130, v20, v21
 v_cvt_pk_bf16_f32 v131, v22, v23
 v_cvt_pk_bf16_f32 v132, v24, v25
 v_cvt_pk_bf16_f32 v133, v26, v27
 v_cvt_pk_bf16_f32 v134, v28, v29
 v_cvt_pk_bf16_f32 v135, v30, v31
 v_cvt_pk_bf16_f32 v136, v32, v33
 v_cvt_pk_bf16_f32 v137, v34, v35
 v_cvt_pk_bf16_f32 v138, v36, v37
 v_cvt_pk_bf16_f32 v139, v38, v39
 v_cvt_pk_bf16_f32 v140, v40, v41
 v_cvt_pk_bf16_f32 v141, v42, v43
 v_cvt_pk_bf16_f32 v142, v44, v45
 v_cvt_pk_bf16_f32 v143, v46, v47
 v_lshlrev_b32 v16, 16, v128
 v_and_b32 v17, s86, v128
 v_lshlrev_b32 v18, 16, v129
 v_and_b32 v19, s86, v129
 v_lshlrev_b32 v20, 16, v130
 v_and_b32 v21, s86, v130
 v_lshlrev_b32 v22, 16, v131
 v_and_b32 v23, s86, v131
 v_lshlrev_b32 v24, 16, v132
 v_and_b32 v25, s86, v132
 v_lshlrev_b32 v26, 16, v133
 v_and_b32 v27, s86, v133
 v_lshlrev_b32 v28, 16, v134
 v_and_b32 v29, s86, v134
 v_lshlrev_b32 v30, 16, v135
 v_and_b32 v31, s86, v135
 v_lshlrev_b32 v32, 16, v136
 v_and_b32 v33, s86, v136
 v_lshlrev_b32 v34, 16, v137
 v_and_b32 v35, s86, v137
 v_lshlrev_b32 v36, 16, v138
 v_and_b32 v37, s86, v138
 v_lshlrev_b32 v38, 16, v139
 v_and_b32 v39, s86, v139
 v_lshlrev_b32 v40, 16, v140
 v_and_b32 v41, s86, v140
 v_lshlrev_b32 v42, 16, v141
 v_and_b32 v43, s86, v141
 v_lshlrev_b32 v44, 16, v142
 v_and_b32 v45, s86, v142
 v_lshlrev_b32 v46, 16, v143
 v_and_b32 v47, s86, v143
 s_waitcnt vmcnt(0)
 v_lshlrev_b32 v160, 16, v48
 v_and_b32 v161, s86, v48
 v_lshlrev_b32 v162, 16, v49
 v_and_b32 v163, s86, v49
 v_lshlrev_b32 v164, 16, v50
 v_and_b32 v165, s86, v50
 v_lshlrev_b32 v166, 16, v51
 v_and_b32 v167, s86, v51
 v_lshlrev_b32 v168, 16, v52
 v_and_b32 v169, s86, v52
 v_lshlrev_b32 v170, 16, v53
 v_and_b32 v171, s86, v53
 v_lshlrev_b32 v172, 16, v54
 v_and_b32 v173, s86, v54
 v_lshlrev_b32 v174, 16, v55
 v_and_b32 v175, s86, v55
 v_lshlrev_b32 v176, 16, v56
 v_and_b32 v177, s86, v56
 v_lshlrev_b32 v178, 16, v57
 v_and_b32 v179, s86, v57
 v_lshlrev_b32 v180, 16, v58
 v_and_b32 v181, s86, v58
 v_lshlrev_b32 v182, 16, v59
 v_and_b32 v183, s86, v59
 v_lshlrev_b32 v184, 16, v60
 v_and_b32 v185, s86, v60
 v_lshlrev_b32 v186, 16, v61
 v_and_b32 v187, s86, v61
 v_lshlrev_b32 v188, 16, v62
 v_and_b32 v189, s86, v62
 v_lshlrev_b32 v190, 16, v63
 v_and_b32 v191, s86, v63
 v_pk_add_f32 v[16:17], v[16:17], v[160:161]
 v_pk_add_f32 v[18:19], v[18:19], v[162:163]
 v_pk_add_f32 v[20:21], v[20:21], v[164:165]
 v_pk_add_f32 v[22:23], v[22:23], v[166:167]
 v_pk_add_f32 v[24:25], v[24:25], v[168:169]
 v_pk_add_f32 v[26:27], v[26:27], v[170:171]
 v_pk_add_f32 v[28:29], v[28:29], v[172:173]
 v_pk_add_f32 v[30:31], v[30:31], v[174:175]
 v_pk_add_f32 v[32:33], v[32:33], v[176:177]
 v_pk_add_f32 v[34:35], v[34:35], v[178:179]
 v_pk_add_f32 v[36:37], v[36:37], v[180:181]
 v_pk_add_f32 v[38:39], v[38:39], v[182:183]
 v_pk_add_f32 v[40:41], v[40:41], v[184:185]
 v_pk_add_f32 v[42:43], v[42:43], v[186:187]
 v_pk_add_f32 v[44:45], v[44:45], v[188:189]
 v_pk_add_f32 v[46:47], v[46:47], v[190:191]
 v_cvt_pk_bf16_f32 v128, v16, v17
 v_cvt_pk_bf16_f32 v129, v18, v19
 v_cvt_pk_bf16_f32 v130, v20, v21
 v_cvt_pk_bf16_f32 v131, v22, v23
 v_cvt_pk_bf16_f32 v132, v24, v25
 v_cvt_pk_bf16_f32 v133, v26, v27
 v_cvt_pk_bf16_f32 v134, v28, v29
 v_cvt_pk_bf16_f32 v135, v30, v31
 v_cvt_pk_bf16_f32 v136, v32, v33
 v_cvt_pk_bf16_f32 v137, v34, v35
 v_cvt_pk_bf16_f32 v138, v36, v37
 v_cvt_pk_bf16_f32 v139, v38, v39
 v_cvt_pk_bf16_f32 v140, v40, v41
 v_cvt_pk_bf16_f32 v141, v42, v43
 v_cvt_pk_bf16_f32 v142, v44, v45
 v_cvt_pk_bf16_f32 v143, v46, v47
 s_add_u32 s71, s70, 0
 buffer_store_dwordx4 v[128:131], v3, s[44:47], s71 offen offset:0 sc1
 buffer_store_dwordx4 v[132:135], v3, s[44:47], s71 offen offset:256 sc1
 buffer_store_dwordx4 v[136:139], v3, s[44:47], s71 offen offset:512 sc1
 buffer_store_dwordx4 v[140:143], v3, s[44:47], s71 offen offset:768 sc1
 s_branch rln_loop
kv_exit:
 s_cmp_lt_u32 s66, 64
 s_cbranch_scc1 k_exit
 s_waitcnt vmcnt(0) lgkmcnt(0)
 s_barrier
 s_mov_b32 s6, 64
 s_mov_b32 s65, 64
 s_mov_b32 s7, 0
 s_mov_b32 s66, 39
 s_cmp_lt_u32 s64, 16
 s_cbranch_scc1 role_wo
 s_mov_b32 s6, 64
 s_mov_b32 s65, 64
 s_mov_b32 s7, 0
 s_mov_b32 s66, 36
 s_sub_u32 s64, s64, 16
 s_cmp_lt_u32 s64, 11
 s_cbranch_scc1 role_up
 s_add_u32 s64, s64, 3
 s_branch role_rln
role_rec:
 v_bfe_u32 v20, v1, 1, 1
 v_mov_b32 v21, 0x4444
 v_mov_b32 v22, 0xeeee
 v_cmp_eq_u32 vcc, 1, v20
 s_nop 1
 v_cndmask_b32 v3, v21, v22, vcc
 s_xor_b32 s70, s3, 0
 s_lshl_b32 s70, s70, 11
 v_add_u32 v4, s70, v2
 s_xor_b32 s70, s3, 1
 s_lshl_b32 s70, s70, 11
 v_add_u32 v5, s70, v2
 s_xor_b32 s70, s3, 2
 s_lshl_b32 s70, s70, 11
 v_add_u32 v6, s70, v2
 s_xor_b32 s70, s3, 3
 s_lshl_b32 s70, s70, 11
 v_add_u32 v7, s70, v2
 v_lshrrev_b32 v20, 4, v1
 v_and_b32 v21, 15, v1
 s_lshl_b32 s70, s3, 6
 s_add_u32 s70, s70, 18432
 v_mul_u32_u24 v22, 544, v20
 v_lshl_add_u32 v22, v21, 1, v22
 v_add_u32 v8, s70, v22
 v_and_b32 v22, 7, v21
 v_mul_u32_u24 v22, 272, v22
 v_lshl_add_u32 v22, v20, 4, v22
 v_add_u32 v9, 18432, v22
 v_lshrrev_b32 v22, 2, v21
 v_and_b32 v23, 1, v21
 v_lshl_add_u32 v22, v22, 1, v23
 v_mul_u32_u24 v23, 272, v22
 v_lshl_add_u32 v23, v20, 4, v23
 v_add_u32 v10, 20736, v23
 v_and_b32 v22, 7, v1
 v_bfe_u32 v23, v1, 3, 2
 v_mul_u32_u24 v32, 272, v22
 v_lshl_add_u32 v32, v23, 4, v32
 s_lshl_b32 s70, s3, 6
 s_add_u32 s70, s70, 20736
 v_add_u32 v32, s70, v32
 v_and_b32 v33, 31, v1
 v_lshlrev_b32 v33, 4, v33
 s_lshl_b32 s70, s3, 11
 v_add_u32 v34, s70, v33
 v_cmp_gt_u32 vcc, 32, v1
 s_lshl_b32 s70, s3, 9
 v_add_u32 v33, s70, v33
 v_add_u32 v35, 8388608, v33
 v_cndmask_b32 v32, v34, v32, vcc
 v_cndmask_b32 v17, v35, v33, vcc
 v_lshlrev_b32 v23, 2, v20
 v_lshl_add_u32 v23, v21, 4, v23
 s_lshl_b32 s71, s3, 11
 v_add_u32 v18, s71, v23
 v_lshrrev_b32 v22, 1, v20
 v_lshlrev_b32 v22, 8, v22
 v_bfe_u32 v23, v21, 1, 2
 v_lshl_add_u32 v22, v23, 6, v22
 v_and_b32 v23, 1, v20
 v_lshl_add_u32 v22, v23, 5, v22
 v_and_b32 v23, 1, v21
 v_lshl_add_u32 v22, v23, 4, v22
 s_add_u32 s70, s70, 16384
 v_add_u32 v11, s70, v22
 s_lshl_b32 s70, s3, 15
 s_add_u32 s70, s70, 32768
 v_add_u32 v12, s70, v2
 v_lshlrev_b32 v22, 9, v20
 v_lshrrev_b32 v23, 3, v21
 v_lshl_add_u32 v22, v23, 8, v22
 v_and_b32 v23, 7, v21
 v_lshl_add_u32 v22, v23, 4, v22
 v_add_u32 v13, 8192, v22
 s_lshl_b32 s70, s3, 11
 v_lshlrev_b32 v22, 9, v20
 v_lshl_add_u32 v22, v21, 4, v22
 v_add_u32 v22, s70, v22
 v_add_u32 v14, 33554432, v22
 s_add_u32 s65, s70, 8192
 v_lshrrev_b32 v22, 2, v1
 v_lshlrev_b32 v22, 13, v22
 v_and_b32 v23, 3, v1
 v_lshl_add_u32 v15, v23, 4, v22
 v_lshlrev_b32 v22, 4, v20
 v_bfe_u32 v33, v1, 1, 1
 v_lshl_add_u32 v22, v33, 5, v22
 v_and_b32 v33, 1, v1
 v_lshl_add_u32 v16, v33, 3, v22
 v_mov_b32 v22, 0x3f80
 v_mov_b32 v33, 0x3f800000
 v_cmp_gt_u32 vcc, 4, v21
 s_nop 1
 v_cndmask_b32 v22, v33, v22, vcc
 v_cmp_gt_u32 vcc, 8, v21
 s_nop 1
 v_cndmask_b32 v22, 0, v22, vcc
 v_cmp_eq_u32 vcc, 0, v23
 s_nop 1
 v_cndmask_b32 v24, 0, v22, vcc
 v_cmp_eq_u32 vcc, 1, v23
 s_nop 1
 v_cndmask_b32 v25, 0, v22, vcc
 v_cmp_eq_u32 vcc, 2, v23
 s_nop 1
 v_cndmask_b32 v26, 0, v22, vcc
 v_cmp_eq_u32 vcc, 3, v23
 s_nop 1
 v_cndmask_b32 v27, 0, v22, vcc
 v_mov_b32 v0, v32
 s_mov_b32 s82, 0x3e0293ee
 s_mov_b32 s83, 0x3e0293ee
 s_mov_b32 s94, 0xfffffffe
 v_mov_b32 v29, 0
 v_mov_b32 v31, 0
 s_lshl_b32 s71, s3, 15
 s_add_u32 s71, s71, 32768
 v_lshrrev_b32 v20, 4, v1
 v_bfe_u32 v21, v1, 2, 2
 v_and_b32 v22, 3, v1
 v_lshrrev_b32 v23, 1, v20
 v_lshlrev_b32 v23, 2, v23
 v_and_b32 v104, 1, v20
 v_add_u32 v23, v23, v104
 v_and_b32 v104, 1, v21
 v_lshl_add_u32 v23, v104, 4, v23
 v_lshrrev_b32 v104, 1, v21
 v_lshl_add_u32 v23, v104, 1, v23
 v_lshlrev_b32 v23, 13, v23
 v_lshl_add_u32 v96, v22, 4, v23
 v_and_b32 v23, 1, v20
 v_lshlrev_b32 v23, 4, v23
 v_lshrrev_b32 v104, 1, v20
 v_lshl_add_u32 v23, v104, 3, v23
 v_lshrrev_b32 v104, 1, v21
 v_lshl_add_u32 v23, v104, 2, v23
 v_and_b32 v104, 1, v21
 v_add_u32 v23, v23, v104
 v_lshlrev_b32 v23, 10, v23
 v_lshl_add_u32 v97, v22, 4, v23
 v_lshrrev_b32 v23, 2, v1
 v_lshlrev_b32 v23, 6, v23
 v_add_u32 v23, s71, v23
 v_lshl_add_u32 v99, v22, 3, v23
 v_and_b32 v104, 1, v1
 v_lshl_add_u32 v23, v104, 4, v23
 v_bfe_u32 v104, v1, 1, 1
 v_lshl_add_u32 v98, v104, 3, v23
 s_lshl_b32 s72, s64, 8
 s_lshl_b32 s70, s3, 6
 s_add_u32 s72, s72, s70
 s_lshl_b32 s73, s64, 17
 s_lshl_b32 s70, s3, 8
 s_add_u32 s73, s73, s70
 s_bitcmp1_b32 s3, 0
 s_cbranch_scc1 rec_ld_odd
 s_xor_b32 s74, s3, 0
 s_lshl_b32 s74, s74, 20
 s_add_u32 s74, s74, s72
 s_add_u32 s74, s74, 524288
 s_add_u32 s75, s74, 0
 s_add_u32 m0, s71, 0
 s_nop 0
 buffer_load_dwordx4 v96, s[16:19], s75 offen lds
 s_add_u32 s75, s74, 262144
 s_add_u32 m0, s71, 1024
 s_nop 0
 buffer_load_dwordx4 v96, s[16:19], s75 offen lds
 s_add_u32 s75, s74, 65536
 s_add_u32 m0, s71, 2048
 s_nop 0
 buffer_load_dwordx4 v96, s[16:19], s75 offen lds
 s_add_u32 s75, s74, 327680
 s_add_u32 m0, s71, 3072
 s_nop 0
 buffer_load_dwordx4 v96, s[16:19], s75 offen lds
 s_xor_b32 s74, s3, 1
 s_lshl_b32 s74, s74, 20
 s_add_u32 s74, s74, s72
 s_add_u32 s74, s74, 524288
 s_add_u32 s75, s74, 0
 s_add_u32 m0, s71, 4096
 s_nop 0
 buffer_load_dwordx4 v96, s[16:19], s75 offen lds
 s_add_u32 s75, s74, 262144
 s_add_u32 m0, s71, 5120
 s_nop 0
 buffer_load_dwordx4 v96, s[16:19], s75 offen lds
 s_add_u32 s75, s74, 65536
 s_add_u32 m0, s71, 6144
 s_nop 0
 buffer_load_dwordx4 v96, s[16:19], s75 offen lds
 s_add_u32 s75, s74, 327680
 s_add_u32 m0, s71, 7168
 s_nop 0
 buffer_load_dwordx4 v96, s[16:19], s75 offen lds
 s_xor_b32 s74, s3, 2
 s_lshl_b32 s74, s74, 20
 s_add_u32 s74, s74, s72
 s_add_u32 s74, s74, 524288
 s_add_u32 s75, s74, 0
 s_add_u32 m0, s71, 8192
 s_nop 0
 buffer_load_dwordx4 v96, s[16:19], s75 offen lds
 s_add_u32 s75, s74, 262144
 s_add_u32 m0, s71, 9216
 s_nop 0
 buffer_load_dwordx4 v96, s[16:19], s75 offen lds
 s_add_u32 s75, s74, 65536
 s_add_u32 m0, s71, 10240
 s_nop 0
 buffer_load_dwordx4 v96, s[16:19], s75 offen lds
 s_add_u32 s75, s74, 327680
 s_add_u32 m0, s71, 11264
 s_nop 0
 buffer_load_dwordx4 v96, s[16:19], s75 offen lds
 s_xor_b32 s74, s3, 3
 s_lshl_b32 s74, s74, 20
 s_add_u32 s74, s74, s72
 s_add_u32 s74, s74, 524288
 s_add_u32 s75, s74, 0
 s_add_u32 m0, s71, 12288
 s_nop 0
 buffer_load_dwordx4 v96, s[16:19], s75 offen lds
 s_add_u32 s75, s74, 262144
 s_add_u32 m0, s71, 13312
 s_nop 0
 buffer_load_dwordx4 v96, s[16:19], s75 offen lds
 s_add_u32 s75, s74, 65536
 s_add_u32 m0, s71, 14336
 s_nop 0
 buffer_load_dwordx4 v96, s[16:19], s75 offen lds
 s_add_u32 s75, s74, 327680
 s_add_u32 m0, s71, 15360
 s_nop 0
 buffer_load_dwordx4 v96, s[16:19], s75 offen lds
 s_xor_b32 s74, s3, 0
 s_lshl_b32 s74, s74, 20
 s_add_u32 s74, s74, s72
 s_add_u32 s74, s74, 524288
 s_add_u32 s75, s74, 0
 s_add_u32 m0, s71, 16384
 s_nop 0
 buffer_load_dwordx4 v96, s[20:23], s75 offen lds
 s_add_u32 s75, s74, 262144
 s_add_u32 m0, s71, 17408
 s_nop 0
 buffer_load_dwordx4 v96, s[20:23], s75 offen lds
 s_add_u32 s75, s74, 65536
 s_add_u32 m0, s71, 18432
 s_nop 0
 buffer_load_dwordx4 v96, s[20:23], s75 offen lds
 s_add_u32 s75, s74, 327680
 s_add_u32 m0, s71, 19456
 s_nop 0
 buffer_load_dwordx4 v96, s[20:23], s75 offen lds
 s_xor_b32 s74, s3, 1
 s_lshl_b32 s74, s74, 20
 s_add_u32 s74, s74, s72
 s_add_u32 s74, s74, 524288
 s_add_u32 s75, s74, 0
 s_add_u32 m0, s71, 20480
 s_nop 0
 buffer_load_dwordx4 v96, s[20:23], s75 offen lds
 s_add_u32 s75, s74, 262144
 s_add_u32 m0, s71, 21504
 s_nop 0
 buffer_load_dwordx4 v96, s[20:23], s75 offen lds
 s_add_u32 s75, s74, 65536
 s_add_u32 m0, s71, 22528
 s_nop 0
 buffer_load_dwordx4 v96, s[20:23], s75 offen lds
 s_add_u32 s75, s74, 327680
 s_add_u32 m0, s71, 23552
 s_nop 0
 buffer_load_dwordx4 v96, s[20:23], s75 offen lds
 s_xor_b32 s74, s3, 2
 s_lshl_b32 s74, s74, 20
 s_add_u32 s74, s74, s72
 s_add_u32 s74, s74, 524288
 s_add_u32 s75, s74, 0
 s_add_u32 m0, s71, 24576
 s_nop 0
 buffer_load_dwordx4 v96, s[20:23], s75 offen lds
 s_add_u32 s75, s74, 262144
 s_add_u32 m0, s71, 25600
 s_nop 0
 buffer_load_dwordx4 v96, s[20:23], s75 offen lds
 s_add_u32 s75, s74, 65536
 s_add_u32 m0, s71, 26624
 s_nop 0
 buffer_load_dwordx4 v96, s[20:23], s75 offen lds
 s_add_u32 s75, s74, 327680
 s_add_u32 m0, s71, 27648
 s_nop 0
 buffer_load_dwordx4 v96, s[20:23], s75 offen lds
 s_xor_b32 s74, s3, 3
 s_lshl_b32 s74, s74, 20
 s_add_u32 s74, s74, s72
 s_add_u32 s74, s74, 524288
 s_add_u32 s75, s74, 0
 s_add_u32 m0, s71, 28672
 s_nop 0
 buffer_load_dwordx4 v96, s[20:23], s75 offen lds
 s_add_u32 s75, s74, 262144
 s_add_u32 m0, s71, 29696
 s_nop 0
 buffer_load_dwordx4 v96, s[20:23], s75 offen lds
 s_add_u32 s75, s74, 65536
 s_add_u32 m0, s71, 30720
 s_nop 0
 buffer_load_dwordx4 v96, s[20:23], s75 offen lds
 s_add_u32 s75, s74, 327680
 s_add_u32 m0, s71, 31744
 s_nop 0
 buffer_load_dwordx4 v96, s[20:23], s75 offen lds
 s_waitcnt vmcnt(16)
 ds_read_b64_tr_b16 a[0:1], v98 offset:0
 ds_read_b64_tr_b16 a[8:9], v98 offset:32
 ds_read_b64_tr_b16 a[2:3], v98 offset:1024
 ds_read_b64_tr_b16 a[10:11], v98 offset:1056
 ds_read_b64_tr_b16 a[4:5], v98 offset:2048
 ds_read_b64_tr_b16 a[12:13], v98 offset:2080
 ds_read_b64_tr_b16 a[6:7], v98 offset:3072
 ds_read_b64_tr_b16 a[14:15], v98 offset:3104
 ds_read_b64_tr_b16 a[32:33], v98 offset:4096
 ds_read_b64_tr_b16 a[40:41], v98 offset:4128
 ds_read_b64_tr_b16 a[34:35], v98 offset:5120
 ds_read_b64_tr_b16 a[42:43], v98 offset:5152
 ds_read_b64_tr_b16 a[36:37], v98 offset:6144
 ds_read_b64_tr_b16 a[44:45], v98 offset:6176
 ds_read_b64_tr_b16 a[38:39], v98 offset:7168
 ds_read_b64_tr_b16 a[46:47], v98 offset:7200
 ds_read_b64_tr_b16 a[48:49], v98 offset:8192
 ds_read_b64_tr_b16 a[56:57], v98 offset:8224
 ds_read_b64_tr_b16 a[50:51], v98 offset:9216
 ds_read_b64_tr_b16 a[58:59], v98 offset:9248
 ds_read_b64_tr_b16 a[52:53], v98 offset:10240
 ds_read_b64_tr_b16 a[60:61], v98 offset:10272
 ds_read_b64_tr_b16 a[54:55], v98 offset:11264
 ds_read_b64_tr_b16 a[62:63], v98 offset:11296
 ds_read_b64_tr_b16 a[80:81], v98 offset:12288
 ds_read_b64_tr_b16 a[88:89], v98 offset:12320
 ds_read_b64_tr_b16 a[82:83], v98 offset:13312
 ds_read_b64_tr_b16 a[90:91], v98 offset:13344
 ds_read_b64_tr_b16 a[84:85], v98 offset:14336
 ds_read_b64_tr_b16 a[92:93], v98 offset:14368
 ds_read_b64_tr_b16 a[86:87], v98 offset:15360
 ds_read_b64_tr_b16 a[94:95], v98 offset:15392
 s_waitcnt lgkmcnt(0)
 s_xor_b32 s74, s3, 0
 s_lshl_b32 s74, s74, 20
 s_add_u32 s74, s74, s72
 s_add_u32 s74, s74, 0
 s_add_u32 s75, s74, 0
 s_add_u32 m0, s71, 0
 s_nop 0
 buffer_load_dwordx4 v96, s[24:27], s75 offen lds
 s_add_u32 s75, s74, 262144
 s_add_u32 m0, s71, 1024
 s_nop 0
 buffer_load_dwordx4 v96, s[24:27], s75 offen lds
 s_add_u32 s75, s74, 65536
 s_add_u32 m0, s71, 2048
 s_nop 0
 buffer_load_dwordx4 v96, s[24:27], s75 offen lds
 s_add_u32 s75, s74, 327680
 s_add_u32 m0, s71, 3072
 s_nop 0
 buffer_load_dwordx4 v96, s[24:27], s75 offen lds
 s_xor_b32 s74, s3, 0
 s_lshl_b32 s74, s74, 20
 s_add_u32 s74, s74, s72
 s_add_u32 s74, s74, 524288
 s_add_u32 s75, s74, 0
 s_add_u32 m0, s71, 4096
 s_nop 0
 buffer_load_dwordx4 v96, s[24:27], s75 offen lds
 s_add_u32 s75, s74, 262144
 s_add_u32 m0, s71, 5120
 s_nop 0
 buffer_load_dwordx4 v96, s[24:27], s75 offen lds
 s_add_u32 s75, s74, 65536
 s_add_u32 m0, s71, 6144
 s_nop 0
 buffer_load_dwordx4 v96, s[24:27], s75 offen lds
 s_add_u32 s75, s74, 327680
 s_add_u32 m0, s71, 7168
 s_nop 0
 buffer_load_dwordx4 v96, s[24:27], s75 offen lds
 s_xor_b32 s74, s3, 1
 s_lshl_b32 s74, s74, 20
 s_add_u32 s74, s74, s72
 s_add_u32 s74, s74, 0
 s_add_u32 s75, s74, 0
 s_add_u32 m0, s71, 8192
 s_nop 0
 buffer_load_dwordx4 v96, s[24:27], s75 offen lds
 s_add_u32 s75, s74, 262144
 s_add_u32 m0, s71, 9216
 s_nop 0
 buffer_load_dwordx4 v96, s[24:27], s75 offen lds
 s_add_u32 s75, s74, 65536
 s_add_u32 m0, s71, 10240
 s_nop 0
 buffer_load_dwordx4 v96, s[24:27], s75 offen lds
 s_add_u32 s75, s74, 327680
 s_add_u32 m0, s71, 11264
 s_nop 0
 buffer_load_dwordx4 v96, s[24:27], s75 offen lds
 s_xor_b32 s74, s3, 1
 s_lshl_b32 s74, s74, 20
 s_add_u32 s74, s74, s72
 s_add_u32 s74, s74, 524288
 s_add_u32 s75, s74, 0
 s_add_u32 m0, s71, 12288
 s_nop 0
 buffer_load_dwordx4 v96, s[24:27], s75 offen lds
 s_add_u32 s75, s74, 262144
 s_add_u32 m0, s71, 13312
 s_nop 0
 buffer_load_dwordx4 v96, s[24:27], s75 offen lds
 s_add_u32 s75, s74, 65536
 s_add_u32 m0, s71, 14336
 s_nop 0
 buffer_load_dwordx4 v96, s[24:27], s75 offen lds
 s_add_u32 s75, s74, 327680
 s_add_u32 m0, s71, 15360
 s_nop 0
 buffer_load_dwordx4 v96, s[24:27], s75 offen lds
 s_waitcnt vmcnt(16)
 ds_read_b64_tr_b16 a[96:97], v98 offset:16384
 ds_read_b64_tr_b16 a[104:105], v98 offset:16416
 ds_read_b64_tr_b16 a[98:99], v98 offset:17408
 ds_read_b64_tr_b16 a[106:107], v98 offset:17440
 ds_read_b64_tr_b16 a[100:101], v98 offset:18432
 ds_read_b64_tr_b16 a[108:109], v98 offset:18464
 ds_read_b64_tr_b16 a[102:103], v98 offset:19456
 ds_read_b64_tr_b16 a[110:111], v98 offset:19488
 ds_read_b64_tr_b16 a[128:129], v98 offset:20480
 ds_read_b64_tr_b16 a[136:137], v98 offset:20512
 ds_read_b64_tr_b16 a[130:131], v98 offset:21504
 ds_read_b64_tr_b16 a[138:139], v98 offset:21536
 ds_read_b64_tr_b16 a[132:133], v98 offset:22528
 ds_read_b64_tr_b16 a[140:141], v98 offset:22560
 ds_read_b64_tr_b16 a[134:135], v98 offset:23552
 ds_read_b64_tr_b16 a[142:143], v98 offset:23584
 ds_read_b64_tr_b16 a[144:145], v98 offset:24576
 ds_read_b64_tr_b16 a[152:153], v98 offset:24608
 ds_read_b64_tr_b16 a[146:147], v98 offset:25600
 ds_read_b64_tr_b16 a[154:155], v98 offset:25632
 ds_read_b64_tr_b16 a[148:149], v98 offset:26624
 ds_read_b64_tr_b16 a[156:157], v98 offset:26656
 ds_read_b64_tr_b16 a[150:151], v98 offset:27648
 ds_read_b64_tr_b16 a[158:159], v98 offset:27680
 ds_read_b64_tr_b16 a[176:177], v98 offset:28672
 ds_read_b64_tr_b16 a[184:185], v98 offset:28704
 ds_read_b64_tr_b16 a[178:179], v98 offset:29696
 ds_read_b64_tr_b16 a[186:187], v98 offset:29728
 ds_read_b64_tr_b16 a[180:181], v98 offset:30720
 ds_read_b64_tr_b16 a[188:189], v98 offset:30752
 ds_read_b64_tr_b16 a[182:183], v98 offset:31744
 ds_read_b64_tr_b16 a[190:191], v98 offset:31776
 s_waitcnt lgkmcnt(0)
 s_xor_b32 s74, s3, 2
 s_lshl_b32 s74, s74, 20
 s_add_u32 s74, s74, s72
 s_add_u32 s74, s74, 0
 s_add_u32 s75, s74, 0
 s_add_u32 m0, s71, 16384
 s_nop 0
 buffer_load_dwordx4 v96, s[24:27], s75 offen lds
 s_add_u32 s75, s74, 262144
 s_add_u32 m0, s71, 17408
 s_nop 0
 buffer_load_dwordx4 v96, s[24:27], s75 offen lds
 s_add_u32 s75, s74, 65536
 s_add_u32 m0, s71, 18432
 s_nop 0
 buffer_load_dwordx4 v96, s[24:27], s75 offen lds
 s_add_u32 s75, s74, 327680
 s_add_u32 m0, s71, 19456
 s_nop 0
 buffer_load_dwordx4 v96, s[24:27], s75 offen lds
 s_xor_b32 s74, s3, 2
 s_lshl_b32 s74, s74, 20
 s_add_u32 s74, s74, s72
 s_add_u32 s74, s74, 524288
 s_add_u32 s75, s74, 0
 s_add_u32 m0, s71, 20480
 s_nop 0
 buffer_load_dwordx4 v96, s[24:27], s75 offen lds
 s_add_u32 s75, s74, 262144
 s_add_u32 m0, s71, 21504
 s_nop 0
 buffer_load_dwordx4 v96, s[24:27], s75 offen lds
 s_add_u32 s75, s74, 65536
 s_add_u32 m0, s71, 22528
 s_nop 0
 buffer_load_dwordx4 v96, s[24:27], s75 offen lds
 s_add_u32 s75, s74, 327680
 s_add_u32 m0, s71, 23552
 s_nop 0
 buffer_load_dwordx4 v96, s[24:27], s75 offen lds
 s_xor_b32 s74, s3, 3
 s_lshl_b32 s74, s74, 20
 s_add_u32 s74, s74, s72
 s_add_u32 s74, s74, 0
 s_add_u32 s75, s74, 0
 s_add_u32 m0, s71, 24576
 s_nop 0
 buffer_load_dwordx4 v96, s[24:27], s75 offen lds
 s_add_u32 s75, s74, 262144
 s_add_u32 m0, s71, 25600
 s_nop 0
 buffer_load_dwordx4 v96, s[24:27], s75 offen lds
 s_add_u32 s75, s74, 65536
 s_add_u32 m0, s71, 26624
 s_nop 0
 buffer_load_dwordx4 v96, s[24:27], s75 offen lds
 s_add_u32 s75, s74, 327680
 s_add_u32 m0, s71, 27648
 s_nop 0
 buffer_load_dwordx4 v96, s[24:27], s75 offen lds
 s_xor_b32 s74, s3, 3
 s_lshl_b32 s74, s74, 20
 s_add_u32 s74, s74, s72
 s_add_u32 s74, s74, 524288
 s_add_u32 s75, s74, 0
 s_add_u32 m0, s71, 28672
 s_nop 0
 buffer_load_dwordx4 v96, s[24:27], s75 offen lds
 s_add_u32 s75, s74, 262144
 s_add_u32 m0, s71, 29696
 s_nop 0
 buffer_load_dwordx4 v96, s[24:27], s75 offen lds
 s_add_u32 s75, s74, 65536
 s_add_u32 m0, s71, 30720
 s_nop 0
 buffer_load_dwordx4 v96, s[24:27], s75 offen lds
 s_add_u32 s75, s74, 327680
 s_add_u32 m0, s71, 31744
 s_nop 0
 buffer_load_dwordx4 v96, s[24:27], s75 offen lds
 s_waitcnt vmcnt(16)
 ds_read_b64_tr_b16 a[192:193], v99 offset:0
 ds_read_b64_tr_b16 a[200:201], v99 offset:32
 ds_read_b64_tr_b16 a[194:195], v99 offset:1024
 ds_read_b64_tr_b16 a[202:203], v99 offset:1056
 ds_read_b64_tr_b16 a[196:197], v99 offset:2048
 ds_read_b64_tr_b16 a[204:205], v99 offset:2080
 ds_read_b64_tr_b16 a[198:199], v99 offset:3072
 ds_read_b64_tr_b16 a[206:207], v99 offset:3104
 ds_read_b64_tr_b16 a[208:209], v99 offset:4096
 ds_read_b64_tr_b16 a[216:217], v99 offset:4128
 ds_read_b64_tr_b16 a[210:211], v99 offset:5120
 ds_read_b64_tr_b16 a[218:219], v99 offset:5152
 ds_read_b64_tr_b16 a[212:213], v99 offset:6144
 ds_read_b64_tr_b16 a[220:221], v99 offset:6176
 ds_read_b64_tr_b16 a[214:215], v99 offset:7168
 ds_read_b64_tr_b16 a[222:223], v99 offset:7200
 ds_read_b64_tr_b16 a[224:225], v99 offset:8192
 ds_read_b64_tr_b16 a[232:233], v99 offset:8224
 ds_read_b64_tr_b16 a[226:227], v99 offset:9216
 ds_read_b64_tr_b16 a[234:235], v99 offset:9248
 ds_read_b64_tr_b16 a[228:229], v99 offset:10240
 ds_read_b64_tr_b16 a[236:237], v99 offset:10272
 ds_read_b64_tr_b16 a[230:231], v99 offset:11264
 ds_read_b64_tr_b16 a[238:239], v99 offset:11296
 ds_read_b64_tr_b16 a[240:241], v99 offset:12288
 ds_read_b64_tr_b16 a[248:249], v99 offset:12320
 ds_read_b64_tr_b16 a[242:243], v99 offset:13312
 ds_read_b64_tr_b16 a[250:251], v99 offset:13344
 ds_read_b64_tr_b16 a[244:245], v99 offset:14336
 ds_read_b64_tr_b16 a[252:253], v99 offset:14368
 ds_read_b64_tr_b16 a[246:247], v99 offset:15360
 ds_read_b64_tr_b16 a[254:255], v99 offset:15392
 s_waitcnt lgkmcnt(0)
 s_add_u32 s75, s73, 128
 s_add_u32 m0, s71, 0
 s_nop 0
 buffer_load_dwordx4 v97, s[28:31], s75 offen lds
 s_add_u32 s75, s73, 192
 s_add_u32 m0, s71, 1024
 s_nop 0
 buffer_load_dwordx4 v97, s[28:31], s75 offen lds
 s_add_u32 s75, s73, 2176
 s_add_u32 m0, s71, 2048
 s_nop 0
 buffer_load_dwordx4 v97, s[28:31], s75 offen lds
 s_add_u32 s75, s73, 2240
 s_add_u32 m0, s71, 3072
 s_nop 0
 buffer_load_dwordx4 v97, s[28:31], s75 offen lds
 s_add_u32 s75, s73, 32896
 s_add_u32 m0, s71, 4096
 s_nop 0
 buffer_load_dwordx4 v97, s[28:31], s75 offen lds
 s_add_u32 s75, s73, 32960
 s_add_u32 m0, s71, 5120
 s_nop 0
 buffer_load_dwordx4 v97, s[28:31], s75 offen lds
 s_add_u32 s75, s73, 34944
 s_add_u32 m0, s71, 6144
 s_nop 0
 buffer_load_dwordx4 v97, s[28:31], s75 offen lds
 s_add_u32 s75, s73, 35008
 s_add_u32 m0, s71, 7168
 s_nop 0
 buffer_load_dwordx4 v97, s[28:31], s75 offen lds
 s_add_u32 s75, s73, 65664
 s_add_u32 m0, s71, 8192
 s_nop 0
 buffer_load_dwordx4 v97, s[28:31], s75 offen lds
 s_add_u32 s75, s73, 65728
 s_add_u32 m0, s71, 9216
 s_nop 0
 buffer_load_dwordx4 v97, s[28:31], s75 offen lds
 s_add_u32 s75, s73, 67712
 s_add_u32 m0, s71, 10240
 s_nop 0
 buffer_load_dwordx4 v97, s[28:31], s75 offen lds
 s_add_u32 s75, s73, 67776
 s_add_u32 m0, s71, 11264
 s_nop 0
 buffer_load_dwordx4 v97, s[28:31], s75 offen lds
 s_add_u32 s75, s73, 98432
 s_add_u32 m0, s71, 12288
 s_nop 0
 buffer_load_dwordx4 v97, s[28:31], s75 offen lds
 s_add_u32 s75, s73, 98496
 s_add_u32 m0, s71, 13312
 s_nop 0
 buffer_load_dwordx4 v97, s[28:31], s75 offen lds
 s_add_u32 s75, s73, 100480
 s_add_u32 m0, s71, 14336
 s_nop 0
 buffer_load_dwordx4 v97, s[28:31], s75 offen lds
 s_add_u32 s75, s73, 100544
 s_add_u32 m0, s71, 15360
 s_nop 0
 buffer_load_dwordx4 v97, s[28:31], s75 offen lds
 s_waitcnt vmcnt(16)
 ds_read_b64_tr_b16 v[128:129], v99 offset:16384
 ds_read_b64_tr_b16 v[136:137], v99 offset:16416
 ds_read_b64_tr_b16 v[130:131], v99 offset:17408
 ds_read_b64_tr_b16 v[138:139], v99 offset:17440
 ds_read_b64_tr_b16 v[132:133], v99 offset:18432
 ds_read_b64_tr_b16 v[140:141], v99 offset:18464
 ds_read_b64_tr_b16 v[134:135], v99 offset:19456
 ds_read_b64_tr_b16 v[142:143], v99 offset:19488
 ds_read_b64_tr_b16 v[144:145], v99 offset:20480
 ds_read_b64_tr_b16 v[152:153], v99 offset:20512
 ds_read_b64_tr_b16 v[146:147], v99 offset:21504
 ds_read_b64_tr_b16 v[154:155], v99 offset:21536
 ds_read_b64_tr_b16 v[148:149], v99 offset:22528
 ds_read_b64_tr_b16 v[156:157], v99 offset:22560
 ds_read_b64_tr_b16 v[150:151], v99 offset:23552
 ds_read_b64_tr_b16 v[158:159], v99 offset:23584
 ds_read_b64_tr_b16 v[160:161], v99 offset:24576
 ds_read_b64_tr_b16 v[168:169], v99 offset:24608
 ds_read_b64_tr_b16 v[162:163], v99 offset:25600
 ds_read_b64_tr_b16 v[170:171], v99 offset:25632
 ds_read_b64_tr_b16 v[164:165], v99 offset:26624
 ds_read_b64_tr_b16 v[172:173], v99 offset:26656
 ds_read_b64_tr_b16 v[166:167], v99 offset:27648
 ds_read_b64_tr_b16 v[174:175], v99 offset:27680
 ds_read_b64_tr_b16 v[176:177], v99 offset:28672
 ds_read_b64_tr_b16 v[184:185], v99 offset:28704
 ds_read_b64_tr_b16 v[178:179], v99 offset:29696
 ds_read_b64_tr_b16 v[186:187], v99 offset:29728
 ds_read_b64_tr_b16 v[180:181], v99 offset:30720
 ds_read_b64_tr_b16 v[188:189], v99 offset:30752
 ds_read_b64_tr_b16 v[182:183], v99 offset:31744
 ds_read_b64_tr_b16 v[190:191], v99 offset:31776
 s_waitcnt lgkmcnt(0)
 s_xor_b32 s74, s3, 1
 s_lshl_b32 s74, s74, 20
 s_add_u32 s74, s74, s72
 s_add_u32 s74, s74, 0
 s_add_u32 s75, s74, 0
 s_add_u32 m0, s71, 16384
 s_nop 0
 buffer_load_dwordx4 v96, s[16:19], s75 offen lds
 s_add_u32 s75, s74, 262144
 s_add_u32 m0, s71, 17408
 s_nop 0
 buffer_load_dwordx4 v96, s[16:19], s75 offen lds
 s_add_u32 s75, s74, 65536
 s_add_u32 m0, s71, 18432
 s_nop 0
 buffer_load_dwordx4 v96, s[16:19], s75 offen lds
 s_add_u32 s75, s74, 327680
 s_add_u32 m0, s71, 19456
 s_nop 0
 buffer_load_dwordx4 v96, s[16:19], s75 offen lds
 s_xor_b32 s74, s3, 3
 s_lshl_b32 s74, s74, 20
 s_add_u32 s74, s74, s72
 s_add_u32 s74, s74, 0
 s_add_u32 s75, s74, 0
 s_add_u32 m0, s71, 20480
 s_nop 0
 buffer_load_dwordx4 v96, s[16:19], s75 offen lds
 s_add_u32 s75, s74, 262144
 s_add_u32 m0, s71, 21504
 s_nop 0
 buffer_load_dwordx4 v96, s[16:19], s75 offen lds
 s_add_u32 s75, s74, 65536
 s_add_u32 m0, s71, 22528
 s_nop 0
 buffer_load_dwordx4 v96, s[16:19], s75 offen lds
 s_add_u32 s75, s74, 327680
 s_add_u32 m0, s71, 23552
 s_nop 0
 buffer_load_dwordx4 v96, s[16:19], s75 offen lds
 s_xor_b32 s74, s3, 1
 s_lshl_b32 s74, s74, 20
 s_add_u32 s74, s74, s72
 s_add_u32 s74, s74, 0
 s_add_u32 s75, s74, 0
 s_add_u32 m0, s71, 24576
 s_nop 0
 buffer_load_dwordx4 v96, s[20:23], s75 offen lds
 s_add_u32 s75, s74, 262144
 s_add_u32 m0, s71, 25600
 s_nop 0
 buffer_load_dwordx4 v96, s[20:23], s75 offen lds
 s_add_u32 s75, s74, 65536
 s_add_u32 m0, s71, 26624
 s_nop 0
 buffer_load_dwordx4 v96, s[20:23], s75 offen lds
 s_add_u32 s75, s74, 327680
 s_add_u32 m0, s71, 27648
 s_nop 0
 buffer_load_dwordx4 v96, s[20:23], s75 offen lds
 s_xor_b32 s74, s3, 3
 s_lshl_b32 s74, s74, 20
 s_add_u32 s74, s74, s72
 s_add_u32 s74, s74, 0
 s_add_u32 s75, s74, 0
 s_add_u32 m0, s71, 28672
 s_nop 0
 buffer_load_dwordx4 v96, s[20:23], s75 offen lds
 s_add_u32 s75, s74, 262144
 s_add_u32 m0, s71, 29696
 s_nop 0
 buffer_load_dwordx4 v96, s[20:23], s75 offen lds
 s_add_u32 s75, s74, 65536
 s_add_u32 m0, s71, 30720
 s_nop 0
 buffer_load_dwordx4 v96, s[20:23], s75 offen lds
 s_add_u32 s75, s74, 327680
 s_add_u32 m0, s71, 31744
 s_nop 0
 buffer_load_dwordx4 v96, s[20:23], s75 offen lds
 s_waitcnt vmcnt(16)
 ds_read_b64_tr_b16 v[192:193], v99 offset:0
 ds_read_b64_tr_b16 v[208:209], v99 offset:32
 ds_read_b64_tr_b16 v[224:225], v99 offset:1024
 ds_read_b64_tr_b16 v[240:241], v99 offset:1056
 ds_read_b64_tr_b16 v[194:195], v99 offset:2048
 ds_read_b64_tr_b16 v[210:211], v99 offset:2080
 ds_read_b64_tr_b16 v[226:227], v99 offset:3072
 ds_read_b64_tr_b16 v[242:243], v99 offset:3104
 ds_read_b64_tr_b16 v[196:197], v99 offset:4096
 ds_read_b64_tr_b16 v[212:213], v99 offset:4128
 ds_read_b64_tr_b16 v[228:229], v99 offset:5120
 ds_read_b64_tr_b16 v[244:245], v99 offset:5152
 ds_read_b64_tr_b16 v[198:199], v99 offset:6144
 ds_read_b64_tr_b16 v[214:215], v99 offset:6176
 ds_read_b64_tr_b16 v[230:231], v99 offset:7168
 ds_read_b64_tr_b16 v[246:247], v99 offset:7200
 ds_read_b64_tr_b16 v[200:201], v99 offset:8192
 ds_read_b64_tr_b16 v[216:217], v99 offset:8224
 ds_read_b64_tr_b16 v[232:233], v99 offset:9216
 ds_read_b64_tr_b16 v[248:249], v99 offset:9248
 ds_read_b64_tr_b16 v[202:203], v99 offset:10240
 ds_read_b64_tr_b16 v[218:219], v99 offset:10272
 ds_read_b64_tr_b16 v[234:235], v99 offset:11264
 ds_read_b64_tr_b16 v[250:251], v99 offset:11296
 ds_read_b64_tr_b16 v[204:205], v99 offset:12288
 ds_read_b64_tr_b16 v[220:221], v99 offset:12320
 ds_read_b64_tr_b16 v[236:237], v99 offset:13312
 ds_read_b64_tr_b16 v[252:253], v99 offset:13344
 ds_read_b64_tr_b16 v[206:207], v99 offset:14336
 ds_read_b64_tr_b16 v[222:223], v99 offset:14368
 ds_read_b64_tr_b16 v[238:239], v99 offset:15360
 ds_read_b64_tr_b16 v[254:255], v99 offset:15392
 s_waitcnt lgkmcnt(0)
 s_xor_b32 s74, s3, 0
 s_lshl_b32 s74, s74, 20
 s_add_u32 s74, s74, s72
 s_add_u32 s74, s74, 0
 s_add_u32 s75, s74, 0
 s_add_u32 m0, s71, 0
 s_nop 0
 buffer_load_dwordx4 v96, s[16:19], s75 offen lds
 s_add_u32 s75, s74, 262144
 s_add_u32 m0, s71, 1024
 s_nop 0
 buffer_load_dwordx4 v96, s[16:19], s75 offen lds
 s_add_u32 s75, s74, 65536
 s_add_u32 m0, s71, 2048
 s_nop 0
 buffer_load_dwordx4 v96, s[16:19], s75 offen lds
 s_add_u32 s75, s74, 327680
 s_add_u32 m0, s71, 3072
 s_nop 0
 buffer_load_dwordx4 v96, s[16:19], s75 offen lds
 s_xor_b32 s74, s3, 2
 s_lshl_b32 s74, s74, 20
 s_add_u32 s74, s74, s72
 s_add_u32 s74, s74, 0
 s_add_u32 s75, s74, 0
 s_add_u32 m0, s71, 4096
 s_nop 0
 buffer_load_dwordx4 v96, s[16:19], s75 offen lds
 s_add_u32 s75, s74, 262144
 s_add_u32 m0, s71, 5120
 s_nop 0
 buffer_load_dwordx4 v96, s[16:19], s75 offen lds
 s_add_u32 s75, s74, 65536
 s_add_u32 m0, s71, 6144
 s_nop 0
 buffer_load_dwordx4 v96, s[16:19], s75 offen lds
 s_add_u32 s75, s74, 327680
 s_add_u32 m0, s71, 7168
 s_nop 0
 buffer_load_dwordx4 v96, s[16:19], s75 offen lds
 s_xor_b32 s74, s3, 0
 s_lshl_b32 s74, s74, 20
 s_add_u32 s74, s74, s72
 s_add_u32 s74, s74, 0
 s_add_u32 s75, s74, 0
 s_add_u32 m0, s71, 8192
 s_nop 0
 buffer_load_dwordx4 v96, s[20:23], s75 offen lds
 s_add_u32 s75, s74, 262144
 s_add_u32 m0, s71, 9216
 s_nop 0
 buffer_load_dwordx4 v96, s[20:23], s75 offen lds
 s_add_u32 s75, s74, 65536
 s_add_u32 m0, s71, 10240
 s_nop 0
 buffer_load_dwordx4 v96, s[20:23], s75 offen lds
 s_add_u32 s75, s74, 327680
 s_add_u32 m0, s71, 11264
 s_nop 0
 buffer_load_dwordx4 v96, s[20:23], s75 offen lds
 s_xor_b32 s74, s3, 2
 s_lshl_b32 s74, s74, 20
 s_add_u32 s74, s74, s72
 s_add_u32 s74, s74, 0
 s_add_u32 s75, s74, 0
 s_add_u32 m0, s71, 12288
 s_nop 0
 buffer_load_dwordx4 v96, s[20:23], s75 offen lds
 s_add_u32 s75, s74, 262144
 s_add_u32 m0, s71, 13312
 s_nop 0
 buffer_load_dwordx4 v96, s[20:23], s75 offen lds
 s_add_u32 s75, s74, 65536
 s_add_u32 m0, s71, 14336
 s_nop 0
 buffer_load_dwordx4 v96, s[20:23], s75 offen lds
 s_add_u32 s75, s74, 327680
 s_add_u32 m0, s71, 15360
 s_nop 0
 buffer_load_dwordx4 v96, s[20:23], s75 offen lds
 s_waitcnt vmcnt(16)
 ds_read_b64_tr_b16 a[16:17], v98 offset:16384
 ds_read_b64_tr_b16 a[24:25], v98 offset:16416
 ds_read_b64_tr_b16 a[18:19], v98 offset:17408
 ds_read_b64_tr_b16 a[26:27], v98 offset:17440
 ds_read_b64_tr_b16 a[20:21], v98 offset:18432
 ds_read_b64_tr_b16 a[28:29], v98 offset:18464
 ds_read_b64_tr_b16 a[22:23], v98 offset:19456
 ds_read_b64_tr_b16 a[30:31], v98 offset:19488
 ds_read_b64_tr_b16 a[64:65], v98 offset:20480
 ds_read_b64_tr_b16 a[72:73], v98 offset:20512
 ds_read_b64_tr_b16 a[66:67], v98 offset:21504
 ds_read_b64_tr_b16 a[74:75], v98 offset:21536
 ds_read_b64_tr_b16 a[68:69], v98 offset:22528
 ds_read_b64_tr_b16 a[76:77], v98 offset:22560
 ds_read_b64_tr_b16 a[70:71], v98 offset:23552
 ds_read_b64_tr_b16 a[78:79], v98 offset:23584
 ds_read_b64_tr_b16 a[112:113], v98 offset:24576
 ds_read_b64_tr_b16 a[120:121], v98 offset:24608
 ds_read_b64_tr_b16 a[114:115], v98 offset:25600
 ds_read_b64_tr_b16 a[122:123], v98 offset:25632
 ds_read_b64_tr_b16 a[116:117], v98 offset:26624
 ds_read_b64_tr_b16 a[124:125], v98 offset:26656
 ds_read_b64_tr_b16 a[118:119], v98 offset:27648
 ds_read_b64_tr_b16 a[126:127], v98 offset:27680
 ds_read_b64_tr_b16 a[160:161], v98 offset:28672
 ds_read_b64_tr_b16 a[168:169], v98 offset:28704
 ds_read_b64_tr_b16 a[162:163], v98 offset:29696
 ds_read_b64_tr_b16 a[170:171], v98 offset:29728
 ds_read_b64_tr_b16 a[164:165], v98 offset:30720
 ds_read_b64_tr_b16 a[172:173], v98 offset:30752
 ds_read_b64_tr_b16 a[166:167], v98 offset:31744
 ds_read_b64_tr_b16 a[174:175], v98 offset:31776
 s_waitcnt lgkmcnt(0)
 s_add_u32 s75, s73, 0
 s_add_u32 m0, s71, 16384
 s_nop 0
 buffer_load_dwordx4 v97, s[28:31], s75 offen lds
 s_add_u32 s75, s73, 64
 s_add_u32 m0, s71, 17408
 s_nop 0
 buffer_load_dwordx4 v97, s[28:31], s75 offen lds
 s_add_u32 s75, s73, 2048
 s_add_u32 m0, s71, 18432
 s_nop 0
 buffer_load_dwordx4 v97, s[28:31], s75 offen lds
 s_add_u32 s75, s73, 2112
 s_add_u32 m0, s71, 19456
 s_nop 0
 buffer_load_dwordx4 v97, s[28:31], s75 offen lds
 s_add_u32 s75, s73, 32768
 s_add_u32 m0, s71, 20480
 s_nop 0
 buffer_load_dwordx4 v97, s[28:31], s75 offen lds
 s_add_u32 s75, s73, 32832
 s_add_u32 m0, s71, 21504
 s_nop 0
 buffer_load_dwordx4 v97, s[28:31], s75 offen lds
 s_add_u32 s75, s73, 34816
 s_add_u32 m0, s71, 22528
 s_nop 0
 buffer_load_dwordx4 v97, s[28:31], s75 offen lds
 s_add_u32 s75, s73, 34880
 s_add_u32 m0, s71, 23552
 s_nop 0
 buffer_load_dwordx4 v97, s[28:31], s75 offen lds
 s_add_u32 s75, s73, 65536
 s_add_u32 m0, s71, 24576
 s_nop 0
 buffer_load_dwordx4 v97, s[28:31], s75 offen lds
 s_add_u32 s75, s73, 65600
 s_add_u32 m0, s71, 25600
 s_nop 0
 buffer_load_dwordx4 v97, s[28:31], s75 offen lds
 s_add_u32 s75, s73, 67584
 s_add_u32 m0, s71, 26624
 s_nop 0
 buffer_load_dwordx4 v97, s[28:31], s75 offen lds
 s_add_u32 s75, s73, 67648
 s_add_u32 m0, s71, 27648
 s_nop 0
 buffer_load_dwordx4 v97, s[28:31], s75 offen lds
 s_add_u32 s75, s73, 98304
 s_add_u32 m0, s71, 28672
 s_nop 0
 buffer_load_dwordx4 v97, s[28:31], s75 offen lds
 s_add_u32 s75, s73, 98368
 s_add_u32 m0, s71, 29696
 s_nop 0
 buffer_load_dwordx4 v97, s[28:31], s75 offen lds
 s_add_u32 s75, s73, 100352
 s_add_u32 m0, s71, 30720
 s_nop 0
 buffer_load_dwordx4 v97, s[28:31], s75 offen lds
 s_add_u32 s75, s73, 100416
 s_add_u32 m0, s71, 31744
 s_nop 0
 buffer_load_dwordx4 v97, s[28:31], s75 offen lds
 s_waitcnt vmcnt(16)
 ds_read_b64_tr_b16 v[32:33], v98 offset:0
 ds_read_b64_tr_b16 v[40:41], v98 offset:32
 ds_read_b64_tr_b16 v[34:35], v98 offset:1024
 ds_read_b64_tr_b16 v[42:43], v98 offset:1056
 ds_read_b64_tr_b16 v[36:37], v98 offset:2048
 ds_read_b64_tr_b16 v[44:45], v98 offset:2080
 ds_read_b64_tr_b16 v[38:39], v98 offset:3072
 ds_read_b64_tr_b16 v[46:47], v98 offset:3104
 ds_read_b64_tr_b16 v[64:65], v98 offset:4096
 ds_read_b64_tr_b16 v[72:73], v98 offset:4128
 ds_read_b64_tr_b16 v[66:67], v98 offset:5120
 ds_read_b64_tr_b16 v[74:75], v98 offset:5152
 ds_read_b64_tr_b16 v[68:69], v98 offset:6144
 ds_read_b64_tr_b16 v[76:77], v98 offset:6176
 ds_read_b64_tr_b16 v[70:71], v98 offset:7168
 ds_read_b64_tr_b16 v[78:79], v98 offset:7200
 ds_read_b64_tr_b16 v[48:49], v98 offset:8192
 ds_read_b64_tr_b16 v[56:57], v98 offset:8224
 ds_read_b64_tr_b16 v[50:51], v98 offset:9216
 ds_read_b64_tr_b16 v[58:59], v98 offset:9248
 ds_read_b64_tr_b16 v[52:53], v98 offset:10240
 ds_read_b64_tr_b16 v[60:61], v98 offset:10272
 ds_read_b64_tr_b16 v[54:55], v98 offset:11264
 ds_read_b64_tr_b16 v[62:63], v98 offset:11296
 ds_read_b64_tr_b16 v[80:81], v98 offset:12288
 ds_read_b64_tr_b16 v[88:89], v98 offset:12320
 ds_read_b64_tr_b16 v[82:83], v98 offset:13312
 ds_read_b64_tr_b16 v[90:91], v98 offset:13344
 ds_read_b64_tr_b16 v[84:85], v98 offset:14336
 ds_read_b64_tr_b16 v[92:93], v98 offset:14368
 ds_read_b64_tr_b16 v[86:87], v98 offset:15360
 ds_read_b64_tr_b16 v[94:95], v98 offset:15392
 s_waitcnt lgkmcnt(0)
 ds_write_b128 v12, v[32:35] offset:0
 ds_write_b128 v12, v[36:39] offset:1024
 ds_write_b128 v12, v[40:43] offset:2048
 ds_write_b128 v12, v[44:47] offset:3072
 ds_write_b128 v12, v[48:51] offset:4096
 ds_write_b128 v12, v[52:55] offset:5120
 ds_write_b128 v12, v[56:59] offset:6144
 ds_write_b128 v12, v[60:63] offset:7168
 ds_write_b128 v12, v[64:67] offset:8192
 ds_write_b128 v12, v[68:71] offset:9216
 ds_write_b128 v12, v[72:75] offset:10240
 ds_write_b128 v12, v[76:79] offset:11264
 ds_write_b128 v12, v[80:83] offset:12288
 ds_write_b128 v12, v[84:87] offset:13312
 ds_write_b128 v12, v[88:91] offset:14336
 ds_write_b128 v12, v[92:95] offset:15360
 s_waitcnt lgkmcnt(0)
 s_waitcnt vmcnt(0)
 ds_read_b64_tr_b16 v[32:33], v99 offset:16384
 ds_read_b64_tr_b16 v[48:49], v99 offset:16416
 ds_read_b64_tr_b16 v[64:65], v99 offset:17408
 ds_read_b64_tr_b16 v[80:81], v99 offset:17440
 ds_read_b64_tr_b16 v[34:35], v99 offset:18432
 ds_read_b64_tr_b16 v[50:51], v99 offset:18464
 ds_read_b64_tr_b16 v[66:67], v99 offset:19456
 ds_read_b64_tr_b16 v[82:83], v99 offset:19488
 ds_read_b64_tr_b16 v[36:37], v99 offset:20480
 ds_read_b64_tr_b16 v[52:53], v99 offset:20512
 ds_read_b64_tr_b16 v[68:69], v99 offset:21504
 ds_read_b64_tr_b16 v[84:85], v99 offset:21536
 ds_read_b64_tr_b16 v[38:39], v99 offset:22528
 ds_read_b64_tr_b16 v[54:55], v99 offset:22560
 ds_read_b64_tr_b16 v[70:71], v99 offset:23552
 ds_read_b64_tr_b16 v[86:87], v99 offset:23584
 ds_read_b64_tr_b16 v[40:41], v99 offset:24576
 ds_read_b64_tr_b16 v[56:57], v99 offset:24608
 ds_read_b64_tr_b16 v[72:73], v99 offset:25600
 ds_read_b64_tr_b16 v[88:89], v99 offset:25632
 ds_read_b64_tr_b16 v[42:43], v99 offset:26624
 ds_read_b64_tr_b16 v[58:59], v99 offset:26656
 ds_read_b64_tr_b16 v[74:75], v99 offset:27648
 ds_read_b64_tr_b16 v[90:91], v99 offset:27680
 ds_read_b64_tr_b16 v[44:45], v99 offset:28672
 ds_read_b64_tr_b16 v[60:61], v99 offset:28704
 ds_read_b64_tr_b16 v[76:77], v99 offset:29696
 ds_read_b64_tr_b16 v[92:93], v99 offset:29728
 ds_read_b64_tr_b16 v[46:47], v99 offset:30720
 ds_read_b64_tr_b16 v[62:63], v99 offset:30752
 ds_read_b64_tr_b16 v[78:79], v99 offset:31744
 ds_read_b64_tr_b16 v[94:95], v99 offset:31776
 s_waitcnt lgkmcnt(0)
 ds_write_b128 v12, v[32:35] offset:16384
 ds_write_b128 v12, v[36:39] offset:17408
 ds_write_b128 v12, v[40:43] offset:18432
 ds_write_b128 v12, v[44:47] offset:19456
 ds_write_b128 v12, v[48:51] offset:20480
 ds_write_b128 v12, v[52:55] offset:21504
 ds_write_b128 v12, v[56:59] offset:22528
 ds_write_b128 v12, v[60:63] offset:23552
 ds_write_b128 v12, v[64:67] offset:24576
 ds_write_b128 v12, v[68:71] offset:25600
 ds_write_b128 v12, v[72:75] offset:26624
 ds_write_b128 v12, v[76:79] offset:27648
 ds_write_b128 v12, v[80:83] offset:28672
 ds_write_b128 v12, v[84:87] offset:29696
 ds_write_b128 v12, v[88:91] offset:30720
 ds_write_b128 v12, v[92:95] offset:31744
 s_waitcnt lgkmcnt(0)
 s_branch rec_ld_done
rec_ld_odd:
 s_xor_b32 s74, s3, 1
 s_lshl_b32 s74, s74, 20
 s_add_u32 s74, s74, s72
 s_add_u32 s74, s74, 524288
 s_add_u32 s75, s74, 0
 s_add_u32 m0, s71, 16384
 s_nop 0
 buffer_load_dwordx4 v96, s[16:19], s75 offen lds
 s_add_u32 s75, s74, 262144
 s_add_u32 m0, s71, 17408
 s_nop 0
 buffer_load_dwordx4 v96, s[16:19], s75 offen lds
 s_add_u32 s75, s74, 65536
 s_add_u32 m0, s71, 18432
 s_nop 0
 buffer_load_dwordx4 v96, s[16:19], s75 offen lds
 s_add_u32 s75, s74, 327680
 s_add_u32 m0, s71, 19456
 s_nop 0
 buffer_load_dwordx4 v96, s[16:19], s75 offen lds
 s_xor_b32 s74, s3, 0
 s_lshl_b32 s74, s74, 20
 s_add_u32 s74, s74, s72
 s_add_u32 s74, s74, 524288
 s_add_u32 s75, s74, 0
 s_add_u32 m0, s71, 20480
 s_nop 0
 buffer_load_dwordx4 v96, s[16:19], s75 offen lds
 s_add_u32 s75, s74, 262144
 s_add_u32 m0, s71, 21504
 s_nop 0
 buffer_load_dwordx4 v96, s[16:19], s75 offen lds
 s_add_u32 s75, s74, 65536
 s_add_u32 m0, s71, 22528
 s_nop 0
 buffer_load_dwordx4 v96, s[16:19], s75 offen lds
 s_add_u32 s75, s74, 327680
 s_add_u32 m0, s71, 23552
 s_nop 0
 buffer_load_dwordx4 v96, s[16:19], s75 offen lds
 s_xor_b32 s74, s3, 3
 s_lshl_b32 s74, s74, 20
 s_add_u32 s74, s74, s72
 s_add_u32 s74, s74, 524288
 s_add_u32 s75, s74, 0
 s_add_u32 m0, s71, 24576
 s_nop 0
 buffer_load_dwordx4 v96, s[16:19], s75 offen lds
 s_add_u32 s75, s74, 262144
 s_add_u32 m0, s71, 25600
 s_nop 0
 buffer_load_dwordx4 v96, s[16:19], s75 offen lds
 s_add_u32 s75, s74, 65536
 s_add_u32 m0, s71, 26624
 s_nop 0
 buffer_load_dwordx4 v96, s[16:19], s75 offen lds
 s_add_u32 s75, s74, 327680
 s_add_u32 m0, s71, 27648
 s_nop 0
 buffer_load_dwordx4 v96, s[16:19], s75 offen lds
 s_xor_b32 s74, s3, 2
 s_lshl_b32 s74, s74, 20
 s_add_u32 s74, s74, s72
 s_add_u32 s74, s74, 524288
 s_add_u32 s75, s74, 0
 s_add_u32 m0, s71, 28672
 s_nop 0
 buffer_load_dwordx4 v96, s[16:19], s75 offen lds
 s_add_u32 s75, s74, 262144
 s_add_u32 m0, s71, 29696
 s_nop 0
 buffer_load_dwordx4 v96, s[16:19], s75 offen lds
 s_add_u32 s75, s74, 65536
 s_add_u32 m0, s71, 30720
 s_nop 0
 buffer_load_dwordx4 v96, s[16:19], s75 offen lds
 s_add_u32 s75, s74, 327680
 s_add_u32 m0, s71, 31744
 s_nop 0
 buffer_load_dwordx4 v96, s[16:19], s75 offen lds
 s_xor_b32 s74, s3, 1
 s_lshl_b32 s74, s74, 20
 s_add_u32 s74, s74, s72
 s_add_u32 s74, s74, 524288
 s_add_u32 s75, s74, 0
 s_add_u32 m0, s71, 0
 s_nop 0
 buffer_load_dwordx4 v96, s[20:23], s75 offen lds
 s_add_u32 s75, s74, 262144
 s_add_u32 m0, s71, 1024
 s_nop 0
 buffer_load_dwordx4 v96, s[20:23], s75 offen lds
 s_add_u32 s75, s74, 65536
 s_add_u32 m0, s71, 2048
 s_nop 0
 buffer_load_dwordx4 v96, s[20:23], s75 offen lds
 s_add_u32 s75, s74, 327680
 s_add_u32 m0, s71, 3072
 s_nop 0
 buffer_load_dwordx4 v96, s[20:23], s75 offen lds
 s_xor_b32 s74, s3, 0
 s_lshl_b32 s74, s74, 20
 s_add_u32 s74, s74, s72
 s_add_u32 s74, s74, 524288
 s_add_u32 s75, s74, 0
 s_add_u32 m0, s71, 4096
 s_nop 0
 buffer_load_dwordx4 v96, s[20:23], s75 offen lds
 s_add_u32 s75, s74, 262144
 s_add_u32 m0, s71, 5120
 s_nop 0
 buffer_load_dwordx4 v96, s[20:23], s75 offen lds
 s_add_u32 s75, s74, 65536
 s_add_u32 m0, s71, 6144
 s_nop 0
 buffer_load_dwordx4 v96, s[20:23], s75 offen lds
 s_add_u32 s75, s74, 327680
 s_add_u32 m0, s71, 7168
 s_nop 0
 buffer_load_dwordx4 v96, s[20:23], s75 offen lds
 s_xor_b32 s74, s3, 3
 s_lshl_b32 s74, s74, 20
 s_add_u32 s74, s74, s72
 s_add_u32 s74, s74, 524288
 s_add_u32 s75, s74, 0
 s_add_u32 m0, s71, 8192
 s_nop 0
 buffer_load_dwordx4 v96, s[20:23], s75 offen lds
 s_add_u32 s75, s74, 262144
 s_add_u32 m0, s71, 9216
 s_nop 0
 buffer_load_dwordx4 v96, s[20:23], s75 offen lds
 s_add_u32 s75, s74, 65536
 s_add_u32 m0, s71, 10240
 s_nop 0
 buffer_load_dwordx4 v96, s[20:23], s75 offen lds
 s_add_u32 s75, s74, 327680
 s_add_u32 m0, s71, 11264
 s_nop 0
 buffer_load_dwordx4 v96, s[20:23], s75 offen lds
 s_xor_b32 s74, s3, 2
 s_lshl_b32 s74, s74, 20
 s_add_u32 s74, s74, s72
 s_add_u32 s74, s74, 524288
 s_add_u32 s75, s74, 0
 s_add_u32 m0, s71, 12288
 s_nop 0
 buffer_load_dwordx4 v96, s[20:23], s75 offen lds
 s_add_u32 s75, s74, 262144
 s_add_u32 m0, s71, 13312
 s_nop 0
 buffer_load_dwordx4 v96, s[20:23], s75 offen lds
 s_add_u32 s75, s74, 65536
 s_add_u32 m0, s71, 14336
 s_nop 0
 buffer_load_dwordx4 v96, s[20:23], s75 offen lds
 s_add_u32 s75, s74, 327680
 s_add_u32 m0, s71, 15360
 s_nop 0
 buffer_load_dwordx4 v96, s[20:23], s75 offen lds
 s_waitcnt vmcnt(16)
 ds_read_b64_tr_b16 a[32:33], v98 offset:16384
 ds_read_b64_tr_b16 a[40:41], v98 offset:16416
 ds_read_b64_tr_b16 a[34:35], v98 offset:17408
 ds_read_b64_tr_b16 a[42:43], v98 offset:17440
 ds_read_b64_tr_b16 a[36:37], v98 offset:18432
 ds_read_b64_tr_b16 a[44:45], v98 offset:18464
 ds_read_b64_tr_b16 a[38:39], v98 offset:19456
 ds_read_b64_tr_b16 a[46:47], v98 offset:19488
 ds_read_b64_tr_b16 a[0:1], v98 offset:20480
 ds_read_b64_tr_b16 a[8:9], v98 offset:20512
 ds_read_b64_tr_b16 a[2:3], v98 offset:21504
 ds_read_b64_tr_b16 a[10:11], v98 offset:21536
 ds_read_b64_tr_b16 a[4:5], v98 offset:22528
 ds_read_b64_tr_b16 a[12:13], v98 offset:22560
 ds_read_b64_tr_b16 a[6:7], v98 offset:23552
 ds_read_b64_tr_b16 a[14:15], v98 offset:23584
 ds_read_b64_tr_b16 a[80:81], v98 offset:24576
 ds_read_b64_tr_b16 a[88:89], v98 offset:24608
 ds_read_b64_tr_b16 a[82:83], v98 offset:25600
 ds_read_b64_tr_b16 a[90:91], v98 offset:25632
 ds_read_b64_tr_b16 a[84:85], v98 offset:26624
 ds_read_b64_tr_b16 a[92:93], v98 offset:26656
 ds_read_b64_tr_b16 a[86:87], v98 offset:27648
 ds_read_b64_tr_b16 a[94:95], v98 offset:27680
 ds_read_b64_tr_b16 a[48:49], v98 offset:28672
 ds_read_b64_tr_b16 a[56:57], v98 offset:28704
 ds_read_b64_tr_b16 a[50:51], v98 offset:29696
 ds_read_b64_tr_b16 a[58:59], v98 offset:29728
 ds_read_b64_tr_b16 a[52:53], v98 offset:30720
 ds_read_b64_tr_b16 a[60:61], v98 offset:30752
 ds_read_b64_tr_b16 a[54:55], v98 offset:31744
 ds_read_b64_tr_b16 a[62:63], v98 offset:31776
 s_waitcnt lgkmcnt(0)
 s_xor_b32 s74, s3, 1
 s_lshl_b32 s74, s74, 20
 s_add_u32 s74, s74, s72
 s_add_u32 s74, s74, 0
 s_add_u32 s75, s74, 0
 s_add_u32 m0, s71, 16384
 s_nop 0
 buffer_load_dwordx4 v96, s[24:27], s75 offen lds
 s_add_u32 s75, s74, 262144
 s_add_u32 m0, s71, 17408
 s_nop 0
 buffer_load_dwordx4 v96, s[24:27], s75 offen lds
 s_add_u32 s75, s74, 65536
 s_add_u32 m0, s71, 18432
 s_nop 0
 buffer_load_dwordx4 v96, s[24:27], s75 offen lds
 s_add_u32 s75, s74, 327680
 s_add_u32 m0, s71, 19456
 s_nop 0
 buffer_load_dwordx4 v96, s[24:27], s75 offen lds
 s_xor_b32 s74, s3, 1
 s_lshl_b32 s74, s74, 20
 s_add_u32 s74, s74, s72
 s_add_u32 s74, s74, 524288
 s_add_u32 s75, s74, 0
 s_add_u32 m0, s71, 20480
 s_nop 0
 buffer_load_dwordx4 v96, s[24:27], s75 offen lds
 s_add_u32 s75, s74, 262144
 s_add_u32 m0, s71, 21504
 s_nop 0
 buffer_load_dwordx4 v96, s[24:27], s75 offen lds
 s_add_u32 s75, s74, 65536
 s_add_u32 m0, s71, 22528
 s_nop 0
 buffer_load_dwordx4 v96, s[24:27], s75 offen lds
 s_add_u32 s75, s74, 327680
 s_add_u32 m0, s71, 23552
 s_nop 0
 buffer_load_dwordx4 v96, s[24:27], s75 offen lds
 s_xor_b32 s74, s3, 0
 s_lshl_b32 s74, s74, 20
 s_add_u32 s74, s74, s72
 s_add_u32 s74, s74, 0
 s_add_u32 s75, s74, 0
 s_add_u32 m0, s71, 24576
 s_nop 0
 buffer_load_dwordx4 v96, s[24:27], s75 offen lds
 s_add_u32 s75, s74, 262144
 s_add_u32 m0, s71, 25600
 s_nop 0
 buffer_load_dwordx4 v96, s[24:27], s75 offen lds
 s_add_u32 s75, s74, 65536
 s_add_u32 m0, s71, 26624
 s_nop 0
 buffer_load_dwordx4 v96, s[24:27], s75 offen lds
 s_add_u32 s75, s74, 327680
 s_add_u32 m0, s71, 27648
 s_nop 0
 buffer_load_dwordx4 v96, s[24:27], s75 offen lds
 s_xor_b32 s74, s3, 0
 s_lshl_b32 s74, s74, 20
 s_add_u32 s74, s74, s72
 s_add_u32 s74, s74, 524288
 s_add_u32 s75, s74, 0
 s_add_u32 m0, s71, 28672
 s_nop 0
 buffer_load_dwordx4 v96, s[24:27], s75 offen lds
 s_add_u32 s75, s74, 262144
 s_add_u32 m0, s71, 29696
 s_nop 0
 buffer_load_dwordx4 v96, s[24:27], s75 offen lds
 s_add_u32 s75, s74, 65536
 s_add_u32 m0, s71, 30720
 s_nop 0
 buffer_load_dwordx4 v96, s[24:27], s75 offen lds
 s_add_u32 s75, s74, 327680
 s_add_u32 m0, s71, 31744
 s_nop 0
 buffer_load_dwordx4 v96, s[24:27], s75 offen lds
 s_waitcnt vmcnt(16)
 ds_read_b64_tr_b16 a[128:129], v98 offset:0
 ds_read_b64_tr_b16 a[136:137], v98 offset:32
 ds_read_b64_tr_b16 a[130:131], v98 offset:1024
 ds_read_b64_tr_b16 a[138:139], v98 offset:1056
 ds_read_b64_tr_b16 a[132:133], v98 offset:2048
 ds_read_b64_tr_b16 a[140:141], v98 offset:2080
 ds_read_b64_tr_b16 a[134:135], v98 offset:3072
 ds_read_b64_tr_b16 a[142:143], v98 offset:3104
 ds_read_b64_tr_b16 a[96:97], v98 offset:4096
 ds_read_b64_tr_b16 a[104:105], v98 offset:4128
 ds_read_b64_tr_b16 a[98:99], v98 offset:5120
 ds_read_b64_tr_b16 a[106:107], v98 offset:5152
 ds_read_b64_tr_b16 a[100:101], v98 offset:6144
 ds_read_b64_tr_b16 a[108:109], v98 offset:6176
 ds_read_b64_tr_b16 a[102:103], v98 offset:7168
 ds_read_b64_tr_b16 a[110:111], v98 offset:7200
 ds_read_b64_tr_b16 a[176:177], v98 offset:8192
 ds_read_b64_tr_b16 a[184:185], v98 offset:8224
 ds_read_b64_tr_b16 a[178:179], v98 offset:9216
 ds_read_b64_tr_b16 a[186:187], v98 offset:9248
 ds_read_b64_tr_b16 a[180:181], v98 offset:10240
 ds_read_b64_tr_b16 a[188:189], v98 offset:10272
 ds_read_b64_tr_b16 a[182:183], v98 offset:11264
 ds_read_b64_tr_b16 a[190:191], v98 offset:11296
 ds_read_b64_tr_b16 a[144:145], v98 offset:12288
 ds_read_b64_tr_b16 a[152:153], v98 offset:12320
 ds_read_b64_tr_b16 a[146:147], v98 offset:13312
 ds_read_b64_tr_b16 a[154:155], v98 offset:13344
 ds_read_b64_tr_b16 a[148:149], v98 offset:14336
 ds_read_b64_tr_b16 a[156:157], v98 offset:14368
 ds_read_b64_tr_b16 a[150:151], v98 offset:15360
 ds_read_b64_tr_b16 a[158:159], v98 offset:15392
 s_waitcnt lgkmcnt(0)
 s_xor_b32 s74, s3, 3
 s_lshl_b32 s74, s74, 20
 s_add_u32 s74, s74, s72
 s_add_u32 s74, s74, 0
 s_add_u32 s75, s74, 0
 s_add_u32 m0, s71, 0
 s_nop 0
 buffer_load_dwordx4 v96, s[24:27], s75 offen lds
 s_add_u32 s75, s74, 262144
 s_add_u32 m0, s71, 1024
 s_nop 0
 buffer_load_dwordx4 v96, s[24:27], s75 offen lds
 s_add_u32 s75, s74, 65536
 s_add_u32 m0, s71, 2048
 s_nop 0
 buffer_load_dwordx4 v96, s[24:27], s75 offen lds
 s_add_u32 s75, s74, 327680
 s_add_u32 m0, s71, 3072
 s_nop 0
 buffer_load_dwordx4 v96, s[24:27], s75 offen lds
 s_xor_b32 s74, s3, 3
 s_lshl_b32 s74, s74, 20
 s_add_u32 s74, s74, s72
 s_add_u32 s74, s74, 524288
 s_add_u32 s75, s74, 0
 s_add_u32 m0, s71, 4096
 s_nop 0
 buffer_load_dwordx4 v96, s[24:27], s75 offen lds
 s_add_u32 s75, s74, 262144
 s_add_u32 m0, s71, 5120
 s_nop 0
 buffer_load_dwordx4 v96, s[24:27], s75 offen lds
 s_add_u32 s75, s74, 65536
 s_add_u32 m0, s71, 6144
 s_nop 0
 buffer_load_dwordx4 v96, s[24:27], s75 offen lds
 s_add_u32 s75, s74, 327680
 s_add_u32 m0, s71, 7168
 s_nop 0
 buffer_load_dwordx4 v96, s[24:27], s75 offen lds
 s_xor_b32 s74, s3, 2
 s_lshl_b32 s74, s74, 20
 s_add_u32 s74, s74, s72
 s_add_u32 s74, s74, 0
 s_add_u32 s75, s74, 0
 s_add_u32 m0, s71, 8192
 s_nop 0
 buffer_load_dwordx4 v96, s[24:27], s75 offen lds
 s_add_u32 s75, s74, 262144
 s_add_u32 m0, s71, 9216
 s_nop 0
 buffer_load_dwordx4 v96, s[24:27], s75 offen lds
 s_add_u32 s75, s74, 65536
 s_add_u32 m0, s71, 10240
 s_nop 0
 buffer_load_dwordx4 v96, s[24:27], s75 offen lds
 s_add_u32 s75, s74, 327680
 s_add_u32 m0, s71, 11264
 s_nop 0
 buffer_load_dwordx4 v96, s[24:27], s75 offen lds
 s_xor_b32 s74, s3, 2
 s_lshl_b32 s74, s74, 20
 s_add_u32 s74, s74, s72
 s_add_u32 s74, s74, 524288
 s_add_u32 s75, s74, 0
 s_add_u32 m0, s71, 12288
 s_nop 0
 buffer_load_dwordx4 v96, s[24:27], s75 offen lds
 s_add_u32 s75, s74, 262144
 s_add_u32 m0, s71, 13312
 s_nop 0
 buffer_load_dwordx4 v96, s[24:27], s75 offen lds
 s_add_u32 s75, s74, 65536
 s_add_u32 m0, s71, 14336
 s_nop 0
 buffer_load_dwordx4 v96, s[24:27], s75 offen lds
 s_add_u32 s75, s74, 327680
 s_add_u32 m0, s71, 15360
 s_nop 0
 buffer_load_dwordx4 v96, s[24:27], s75 offen lds
 s_waitcnt vmcnt(16)
 ds_read_b64_tr_b16 a[224:225], v99 offset:16384
 ds_read_b64_tr_b16 a[232:233], v99 offset:16416
 ds_read_b64_tr_b16 a[226:227], v99 offset:17408
 ds_read_b64_tr_b16 a[234:235], v99 offset:17440
 ds_read_b64_tr_b16 a[228:229], v99 offset:18432
 ds_read_b64_tr_b16 a[236:237], v99 offset:18464
 ds_read_b64_tr_b16 a[230:231], v99 offset:19456
 ds_read_b64_tr_b16 a[238:239], v99 offset:19488
 ds_read_b64_tr_b16 a[240:241], v99 offset:20480
 ds_read_b64_tr_b16 a[248:249], v99 offset:20512
 ds_read_b64_tr_b16 a[242:243], v99 offset:21504
 ds_read_b64_tr_b16 a[250:251], v99 offset:21536
 ds_read_b64_tr_b16 a[244:245], v99 offset:22528
 ds_read_b64_tr_b16 a[252:253], v99 offset:22560
 ds_read_b64_tr_b16 a[246:247], v99 offset:23552
 ds_read_b64_tr_b16 a[254:255], v99 offset:23584
 ds_read_b64_tr_b16 a[192:193], v99 offset:24576
 ds_read_b64_tr_b16 a[200:201], v99 offset:24608
 ds_read_b64_tr_b16 a[194:195], v99 offset:25600
 ds_read_b64_tr_b16 a[202:203], v99 offset:25632
 ds_read_b64_tr_b16 a[196:197], v99 offset:26624
 ds_read_b64_tr_b16 a[204:205], v99 offset:26656
 ds_read_b64_tr_b16 a[198:199], v99 offset:27648
 ds_read_b64_tr_b16 a[206:207], v99 offset:27680
 ds_read_b64_tr_b16 a[208:209], v99 offset:28672
 ds_read_b64_tr_b16 a[216:217], v99 offset:28704
 ds_read_b64_tr_b16 a[210:211], v99 offset:29696
 ds_read_b64_tr_b16 a[218:219], v99 offset:29728
 ds_read_b64_tr_b16 a[212:213], v99 offset:30720
 ds_read_b64_tr_b16 a[220:221], v99 offset:30752
 ds_read_b64_tr_b16 a[214:215], v99 offset:31744
 ds_read_b64_tr_b16 a[222:223], v99 offset:31776
 s_waitcnt lgkmcnt(0)
 s_add_u32 s75, s73, 128
 s_add_u32 m0, s71, 16384
 s_nop 0
 buffer_load_dwordx4 v97, s[28:31], s75 offen lds
 s_add_u32 s75, s73, 192
 s_add_u32 m0, s71, 17408
 s_nop 0
 buffer_load_dwordx4 v97, s[28:31], s75 offen lds
 s_add_u32 s75, s73, 2176
 s_add_u32 m0, s71, 18432
 s_nop 0
 buffer_load_dwordx4 v97, s[28:31], s75 offen lds
 s_add_u32 s75, s73, 2240
 s_add_u32 m0, s71, 19456
 s_nop 0
 buffer_load_dwordx4 v97, s[28:31], s75 offen lds
 s_add_u32 s75, s73, 32896
 s_add_u32 m0, s71, 20480
 s_nop 0
 buffer_load_dwordx4 v97, s[28:31], s75 offen lds
 s_add_u32 s75, s73, 32960
 s_add_u32 m0, s71, 21504
 s_nop 0
 buffer_load_dwordx4 v97, s[28:31], s75 offen lds
 s_add_u32 s75, s73, 34944
 s_add_u32 m0, s71, 22528
 s_nop 0
 buffer_load_dwordx4 v97, s[28:31], s75 offen lds
 s_add_u32 s75, s73, 35008
 s_add_u32 m0, s71, 23552
 s_nop 0
 buffer_load_dwordx4 v97, s[28:31], s75 offen lds
 s_add_u32 s75, s73, 65664
 s_add_u32 m0, s71, 24576
 s_nop 0
 buffer_load_dwordx4 v97, s[28:31], s75 offen lds
 s_add_u32 s75, s73, 65728
 s_add_u32 m0, s71, 25600
 s_nop 0
 buffer_load_dwordx4 v97, s[28:31], s75 offen lds
 s_add_u32 s75, s73, 67712
 s_add_u32 m0, s71, 26624
 s_nop 0
 buffer_load_dwordx4 v97, s[28:31], s75 offen lds
 s_add_u32 s75, s73, 67776
 s_add_u32 m0, s71, 27648
 s_nop 0
 buffer_load_dwordx4 v97, s[28:31], s75 offen lds
 s_add_u32 s75, s73, 98432
 s_add_u32 m0, s71, 28672
 s_nop 0
 buffer_load_dwordx4 v97, s[28:31], s75 offen lds
 s_add_u32 s75, s73, 98496
 s_add_u32 m0, s71, 29696
 s_nop 0
 buffer_load_dwordx4 v97, s[28:31], s75 offen lds
 s_add_u32 s75, s73, 100480
 s_add_u32 m0, s71, 30720
 s_nop 0
 buffer_load_dwordx4 v97, s[28:31], s75 offen lds
 s_add_u32 s75, s73, 100544
 s_add_u32 m0, s71, 31744
 s_nop 0
 buffer_load_dwordx4 v97, s[28:31], s75 offen lds
 s_waitcnt vmcnt(16)
 ds_read_b64_tr_b16 v[160:161], v99 offset:0
 ds_read_b64_tr_b16 v[168:169], v99 offset:32
 ds_read_b64_tr_b16 v[162:163], v99 offset:1024
 ds_read_b64_tr_b16 v[170:171], v99 offset:1056
 ds_read_b64_tr_b16 v[164:165], v99 offset:2048
 ds_read_b64_tr_b16 v[172:173], v99 offset:2080
 ds_read_b64_tr_b16 v[166:167], v99 offset:3072
 ds_read_b64_tr_b16 v[174:175], v99 offset:3104
 ds_read_b64_tr_b16 v[176:177], v99 offset:4096
 ds_read_b64_tr_b16 v[184:185], v99 offset:4128
 ds_read_b64_tr_b16 v[178:179], v99 offset:5120
 ds_read_b64_tr_b16 v[186:187], v99 offset:5152
 ds_read_b64_tr_b16 v[180:181], v99 offset:6144
 ds_read_b64_tr_b16 v[188:189], v99 offset:6176
 ds_read_b64_tr_b16 v[182:183], v99 offset:7168
 ds_read_b64_tr_b16 v[190:191], v99 offset:7200
 ds_read_b64_tr_b16 v[128:129], v99 offset:8192
 ds_read_b64_tr_b16 v[136:137], v99 offset:8224
 ds_read_b64_tr_b16 v[130:131], v99 offset:9216
 ds_read_b64_tr_b16 v[138:139], v99 offset:9248
 ds_read_b64_tr_b16 v[132:133], v99 offset:10240
 ds_read_b64_tr_b16 v[140:141], v99 offset:10272
 ds_read_b64_tr_b16 v[134:135], v99 offset:11264
 ds_read_b64_tr_b16 v[142:143], v99 offset:11296
 ds_read_b64_tr_b16 v[144:145], v99 offset:12288
 ds_read_b64_tr_b16 v[152:153], v99 offset:12320
 ds_read_b64_tr_b16 v[146:147], v99 offset:13312
 ds_read_b64_tr_b16 v[154:155], v99 offset:13344
 ds_read_b64_tr_b16 v[148:149], v99 offset:14336
 ds_read_b64_tr_b16 v[156:157], v99 offset:14368
 ds_read_b64_tr_b16 v[150:151], v99 offset:15360
 ds_read_b64_tr_b16 v[158:159], v99 offset:15392
 s_waitcnt lgkmcnt(0)
 s_xor_b32 s74, s3, 0
 s_lshl_b32 s74, s74, 20
 s_add_u32 s74, s74, s72
 s_add_u32 s74, s74, 0
 s_add_u32 s75, s74, 0
 s_add_u32 m0, s71, 0
 s_nop 0
 buffer_load_dwordx4 v96, s[16:19], s75 offen lds
 s_add_u32 s75, s74, 262144
 s_add_u32 m0, s71, 1024
 s_nop 0
 buffer_load_dwordx4 v96, s[16:19], s75 offen lds
 s_add_u32 s75, s74, 65536
 s_add_u32 m0, s71, 2048
 s_nop 0
 buffer_load_dwordx4 v96, s[16:19], s75 offen lds
 s_add_u32 s75, s74, 327680
 s_add_u32 m0, s71, 3072
 s_nop 0
 buffer_load_dwordx4 v96, s[16:19], s75 offen lds
 s_xor_b32 s74, s3, 2
 s_lshl_b32 s74, s74, 20
 s_add_u32 s74, s74, s72
 s_add_u32 s74, s74, 0
 s_add_u32 s75, s74, 0
 s_add_u32 m0, s71, 4096
 s_nop 0
 buffer_load_dwordx4 v96, s[16:19], s75 offen lds
 s_add_u32 s75, s74, 262144
 s_add_u32 m0, s71, 5120
 s_nop 0
 buffer_load_dwordx4 v96, s[16:19], s75 offen lds
 s_add_u32 s75, s74, 65536
 s_add_u32 m0, s71, 6144
 s_nop 0
 buffer_load_dwordx4 v96, s[16:19], s75 offen lds
 s_add_u32 s75, s74, 327680
 s_add_u32 m0, s71, 7168
 s_nop 0
 buffer_load_dwordx4 v96, s[16:19], s75 offen lds
 s_xor_b32 s74, s3, 0
 s_lshl_b32 s74, s74, 20
 s_add_u32 s74, s74, s72
 s_add_u32 s74, s74, 0
 s_add_u32 s75, s74, 0
 s_add_u32 m0, s71, 8192
 s_nop 0
 buffer_load_dwordx4 v96, s[20:23], s75 offen lds
 s_add_u32 s75, s74, 262144
 s_add_u32 m0, s71, 9216
 s_nop 0
 buffer_load_dwordx4 v96, s[20:23], s75 offen lds
 s_add_u32 s75, s74, 65536
 s_add_u32 m0, s71, 10240
 s_nop 0
 buffer_load_dwordx4 v96, s[20:23], s75 offen lds
 s_add_u32 s75, s74, 327680
 s_add_u32 m0, s71, 11264
 s_nop 0
 buffer_load_dwordx4 v96, s[20:23], s75 offen lds
 s_xor_b32 s74, s3, 2
 s_lshl_b32 s74, s74, 20
 s_add_u32 s74, s74, s72
 s_add_u32 s74, s74, 0
 s_add_u32 s75, s74, 0
 s_add_u32 m0, s71, 12288
 s_nop 0
 buffer_load_dwordx4 v96, s[20:23], s75 offen lds
 s_add_u32 s75, s74, 262144
 s_add_u32 m0, s71, 13312
 s_nop 0
 buffer_load_dwordx4 v96, s[20:23], s75 offen lds
 s_add_u32 s75, s74, 65536
 s_add_u32 m0, s71, 14336
 s_nop 0
 buffer_load_dwordx4 v96, s[20:23], s75 offen lds
 s_add_u32 s75, s74, 327680
 s_add_u32 m0, s71, 15360
 s_nop 0
 buffer_load_dwordx4 v96, s[20:23], s75 offen lds
 s_waitcnt vmcnt(16)
 ds_read_b64_tr_b16 v[192:193], v99 offset:16384
 ds_read_b64_tr_b16 v[208:209], v99 offset:16416
 ds_read_b64_tr_b16 v[224:225], v99 offset:17408
 ds_read_b64_tr_b16 v[240:241], v99 offset:17440
 ds_read_b64_tr_b16 v[194:195], v99 offset:18432
 ds_read_b64_tr_b16 v[210:211], v99 offset:18464
 ds_read_b64_tr_b16 v[226:227], v99 offset:19456
 ds_read_b64_tr_b16 v[242:243], v99 offset:19488
 ds_read_b64_tr_b16 v[196:197], v99 offset:20480
 ds_read_b64_tr_b16 v[212:213], v99 offset:20512
 ds_read_b64_tr_b16 v[228:229], v99 offset:21504
 ds_read_b64_tr_b16 v[244:245], v99 offset:21536
 ds_read_b64_tr_b16 v[198:199], v99 offset:22528
 ds_read_b64_tr_b16 v[214:215], v99 offset:22560
 ds_read_b64_tr_b16 v[230:231], v99 offset:23552
 ds_read_b64_tr_b16 v[246:247], v99 offset:23584
 ds_read_b64_tr_b16 v[200:201], v99 offset:24576
 ds_read_b64_tr_b16 v[216:217], v99 offset:24608
 ds_read_b64_tr_b16 v[232:233], v99 offset:25600
 ds_read_b64_tr_b16 v[248:249], v99 offset:25632
 ds_read_b64_tr_b16 v[202:203], v99 offset:26624
 ds_read_b64_tr_b16 v[218:219], v99 offset:26656
 ds_read_b64_tr_b16 v[234:235], v99 offset:27648
 ds_read_b64_tr_b16 v[250:251], v99 offset:27680
 ds_read_b64_tr_b16 v[204:205], v99 offset:28672
 ds_read_b64_tr_b16 v[220:221], v99 offset:28704
 ds_read_b64_tr_b16 v[236:237], v99 offset:29696
 ds_read_b64_tr_b16 v[252:253], v99 offset:29728
 ds_read_b64_tr_b16 v[206:207], v99 offset:30720
 ds_read_b64_tr_b16 v[222:223], v99 offset:30752
 ds_read_b64_tr_b16 v[238:239], v99 offset:31744
 ds_read_b64_tr_b16 v[254:255], v99 offset:31776
 s_waitcnt lgkmcnt(0)
 s_xor_b32 s74, s3, 1
 s_lshl_b32 s74, s74, 20
 s_add_u32 s74, s74, s72
 s_add_u32 s74, s74, 0
 s_add_u32 s75, s74, 0
 s_add_u32 m0, s71, 16384
 s_nop 0
 buffer_load_dwordx4 v96, s[16:19], s75 offen lds
 s_add_u32 s75, s74, 262144
 s_add_u32 m0, s71, 17408
 s_nop 0
 buffer_load_dwordx4 v96, s[16:19], s75 offen lds
 s_add_u32 s75, s74, 65536
 s_add_u32 m0, s71, 18432
 s_nop 0
 buffer_load_dwordx4 v96, s[16:19], s75 offen lds
 s_add_u32 s75, s74, 327680
 s_add_u32 m0, s71, 19456
 s_nop 0
 buffer_load_dwordx4 v96, s[16:19], s75 offen lds
 s_xor_b32 s74, s3, 3
 s_lshl_b32 s74, s74, 20
 s_add_u32 s74, s74, s72
 s_add_u32 s74, s74, 0
 s_add_u32 s75, s74, 0
 s_add_u32 m0, s71, 20480
 s_nop 0
 buffer_load_dwordx4 v96, s[16:19], s75 offen lds
 s_add_u32 s75, s74, 262144
 s_add_u32 m0, s71, 21504
 s_nop 0
 buffer_load_dwordx4 v96, s[16:19], s75 offen lds
 s_add_u32 s75, s74, 65536
 s_add_u32 m0, s71, 22528
 s_nop 0
 buffer_load_dwordx4 v96, s[16:19], s75 offen lds
 s_add_u32 s75, s74, 327680
 s_add_u32 m0, s71, 23552
 s_nop 0
 buffer_load_dwordx4 v96, s[16:19], s75 offen lds
 s_xor_b32 s74, s3, 1
 s_lshl_b32 s74, s74, 20
 s_add_u32 s74, s74, s72
 s_add_u32 s74, s74, 0
 s_add_u32 s75, s74, 0
 s_add_u32 m0, s71, 24576
 s_nop 0
 buffer_load_dwordx4 v96, s[20:23], s75 offen lds
 s_add_u32 s75, s74, 262144
 s_add_u32 m0, s71, 25600
 s_nop 0
 buffer_load_dwordx4 v96, s[20:23], s75 offen lds
 s_add_u32 s75, s74, 65536
 s_add_u32 m0, s71, 26624
 s_nop 0
 buffer_load_dwordx4 v96, s[20:23], s75 offen lds
 s_add_u32 s75, s74, 327680
 s_add_u32 m0, s71, 27648
 s_nop 0
 buffer_load_dwordx4 v96, s[20:23], s75 offen lds
 s_xor_b32 s74, s3, 3
 s_lshl_b32 s74, s74, 20
 s_add_u32 s74, s74, s72
 s_add_u32 s74, s74, 0
 s_add_u32 s75, s74, 0
 s_add_u32 m0, s71, 28672
 s_nop 0
 buffer_load_dwordx4 v96, s[20:23], s75 offen lds
 s_add_u32 s75, s74, 262144
 s_add_u32 m0, s71, 29696
 s_nop 0
 buffer_load_dwordx4 v96, s[20:23], s75 offen lds
 s_add_u32 s75, s74, 65536
 s_add_u32 m0, s71, 30720
 s_nop 0
 buffer_load_dwordx4 v96, s[20:23], s75 offen lds
 s_add_u32 s75, s74, 327680
 s_add_u32 m0, s71, 31744
 s_nop 0
 buffer_load_dwordx4 v96, s[20:23], s75 offen lds
 s_waitcnt vmcnt(16)
 ds_read_b64_tr_b16 v[32:33], v98 offset:0
 ds_read_b64_tr_b16 v[40:41], v98 offset:32
 ds_read_b64_tr_b16 v[34:35], v98 offset:1024
 ds_read_b64_tr_b16 v[42:43], v98 offset:1056
 ds_read_b64_tr_b16 v[36:37], v98 offset:2048
 ds_read_b64_tr_b16 v[44:45], v98 offset:2080
 ds_read_b64_tr_b16 v[38:39], v98 offset:3072
 ds_read_b64_tr_b16 v[46:47], v98 offset:3104
 ds_read_b64_tr_b16 v[64:65], v98 offset:4096
 ds_read_b64_tr_b16 v[72:73], v98 offset:4128
 ds_read_b64_tr_b16 v[66:67], v98 offset:5120
 ds_read_b64_tr_b16 v[74:75], v98 offset:5152
 ds_read_b64_tr_b16 v[68:69], v98 offset:6144
 ds_read_b64_tr_b16 v[76:77], v98 offset:6176
 ds_read_b64_tr_b16 v[70:71], v98 offset:7168
 ds_read_b64_tr_b16 v[78:79], v98 offset:7200
 ds_read_b64_tr_b16 v[48:49], v98 offset:8192
 ds_read_b64_tr_b16 v[56:57], v98 offset:8224
 ds_read_b64_tr_b16 v[50:51], v98 offset:9216
 ds_read_b64_tr_b16 v[58:59], v98 offset:9248
 ds_read_b64_tr_b16 v[52:53], v98 offset:10240
 ds_read_b64_tr_b16 v[60:61], v98 offset:10272
 ds_read_b64_tr_b16 v[54:55], v98 offset:11264
 ds_read_b64_tr_b16 v[62:63], v98 offset:11296
 ds_read_b64_tr_b16 v[80:81], v98 offset:12288
 ds_read_b64_tr_b16 v[88:89], v98 offset:12320
 ds_read_b64_tr_b16 v[82:83], v98 offset:13312
 ds_read_b64_tr_b16 v[90:91], v98 offset:13344
 ds_read_b64_tr_b16 v[84:85], v98 offset:14336
 ds_read_b64_tr_b16 v[92:93], v98 offset:14368
 ds_read_b64_tr_b16 v[86:87], v98 offset:15360
 ds_read_b64_tr_b16 v[94:95], v98 offset:15392
 s_waitcnt lgkmcnt(0)
 ds_write_b128 v12, v[32:35] offset:0
 ds_write_b128 v12, v[36:39] offset:1024
 ds_write_b128 v12, v[40:43] offset:2048
 ds_write_b128 v12, v[44:47] offset:3072
 ds_write_b128 v12, v[48:51] offset:4096
 ds_write_b128 v12, v[52:55] offset:5120
 ds_write_b128 v12, v[56:59] offset:6144
 ds_write_b128 v12, v[60:63] offset:7168
 ds_write_b128 v12, v[64:67] offset:8192
 ds_write_b128 v12, v[68:71] offset:9216
 ds_write_b128 v12, v[72:75] offset:10240
 ds_write_b128 v12, v[76:79] offset:11264
 ds_write_b128 v12, v[80:83] offset:12288
 ds_write_b128 v12, v[84:87] offset:13312
 ds_write_b128 v12, v[88:91] offset:14336
 ds_write_b128 v12, v[92:95] offset:15360
 s_waitcnt lgkmcnt(0)
 s_waitcnt vmcnt(0)
 ds_read_b64_tr_b16 a[16:17], v98 offset:16384
 ds_read_b64_tr_b16 a[24:25], v98 offset:16416
 ds_read_b64_tr_b16 a[18:19], v98 offset:17408
 ds_read_b64_tr_b16 a[26:27], v98 offset:17440
 ds_read_b64_tr_b16 a[20:21], v98 offset:18432
 ds_read_b64_tr_b16 a[28:29], v98 offset:18464
 ds_read_b64_tr_b16 a[22:23], v98 offset:19456
 ds_read_b64_tr_b16 a[30:31], v98 offset:19488
 ds_read_b64_tr_b16 a[64:65], v98 offset:20480
 ds_read_b64_tr_b16 a[72:73], v98 offset:20512
 ds_read_b64_tr_b16 a[66:67], v98 offset:21504
 ds_read_b64_tr_b16 a[74:75], v98 offset:21536
 ds_read_b64_tr_b16 a[68:69], v98 offset:22528
 ds_read_b64_tr_b16 a[76:77], v98 offset:22560
 ds_read_b64_tr_b16 a[70:71], v98 offset:23552
 ds_read_b64_tr_b16 a[78:79], v98 offset:23584
 ds_read_b64_tr_b16 a[112:113], v98 offset:24576
 ds_read_b64_tr_b16 a[120:121], v98 offset:24608
 ds_read_b64_tr_b16 a[114:115], v98 offset:25600
 ds_read_b64_tr_b16 a[122:123], v98 offset:25632
 ds_read_b64_tr_b16 a[116:117], v98 offset:26624
 ds_read_b64_tr_b16 a[124:125], v98 offset:26656
 ds_read_b64_tr_b16 a[118:119], v98 offset:27648
 ds_read_b64_tr_b16 a[126:127], v98 offset:27680
 ds_read_b64_tr_b16 a[160:161], v98 offset:28672
 ds_read_b64_tr_b16 a[168:169], v98 offset:28704
 ds_read_b64_tr_b16 a[162:163], v98 offset:29696
 ds_read_b64_tr_b16 a[170:171], v98 offset:29728
 ds_read_b64_tr_b16 a[164:165], v98 offset:30720
 ds_read_b64_tr_b16 a[172:173], v98 offset:30752
 ds_read_b64_tr_b16 a[166:167], v98 offset:31744
 ds_read_b64_tr_b16 a[174:175], v98 offset:31776
 s_waitcnt lgkmcnt(0)
 s_add_u32 s75, s73, 0
 s_add_u32 m0, s71, 16384
 s_nop 0
 buffer_load_dwordx4 v97, s[28:31], s75 offen lds
 s_add_u32 s75, s73, 64
 s_add_u32 m0, s71, 17408
 s_nop 0
 buffer_load_dwordx4 v97, s[28:31], s75 offen lds
 s_add_u32 s75, s73, 2048
 s_add_u32 m0, s71, 18432
 s_nop 0
 buffer_load_dwordx4 v97, s[28:31], s75 offen lds
 s_add_u32 s75, s73, 2112
 s_add_u32 m0, s71, 19456
 s_nop 0
 buffer_load_dwordx4 v97, s[28:31], s75 offen lds
 s_add_u32 s75, s73, 32768
 s_add_u32 m0, s71, 20480
 s_nop 0
 buffer_load_dwordx4 v97, s[28:31], s75 offen lds
 s_add_u32 s75, s73, 32832
 s_add_u32 m0, s71, 21504
 s_nop 0
 buffer_load_dwordx4 v97, s[28:31], s75 offen lds
 s_add_u32 s75, s73, 34816
 s_add_u32 m0, s71, 22528
 s_nop 0
 buffer_load_dwordx4 v97, s[28:31], s75 offen lds
 s_add_u32 s75, s73, 34880
 s_add_u32 m0, s71, 23552
 s_nop 0
 buffer_load_dwordx4 v97, s[28:31], s75 offen lds
 s_add_u32 s75, s73, 65536
 s_add_u32 m0, s71, 24576
 s_nop 0
 buffer_load_dwordx4 v97, s[28:31], s75 offen lds
 s_add_u32 s75, s73, 65600
 s_add_u32 m0, s71, 25600
 s_nop 0
 buffer_load_dwordx4 v97, s[28:31], s75 offen lds
 s_add_u32 s75, s73, 67584
 s_add_u32 m0, s71, 26624
 s_nop 0
 buffer_load_dwordx4 v97, s[28:31], s75 offen lds
 s_add_u32 s75, s73, 67648
 s_add_u32 m0, s71, 27648
 s_nop 0
 buffer_load_dwordx4 v97, s[28:31], s75 offen lds
 s_add_u32 s75, s73, 98304
 s_add_u32 m0, s71, 28672
 s_nop 0
 buffer_load_dwordx4 v97, s[28:31], s75 offen lds
 s_add_u32 s75, s73, 98368
 s_add_u32 m0, s71, 29696
 s_nop 0
 buffer_load_dwordx4 v97, s[28:31], s75 offen lds
 s_add_u32 s75, s73, 100352
 s_add_u32 m0, s71, 30720
 s_nop 0
 buffer_load_dwordx4 v97, s[28:31], s75 offen lds
 s_add_u32 s75, s73, 100416
 s_add_u32 m0, s71, 31744
 s_nop 0
 buffer_load_dwordx4 v97, s[28:31], s75 offen lds
 s_waitcnt vmcnt(0)
 ds_read_b64_tr_b16 v[32:33], v99 offset:16384
 ds_read_b64_tr_b16 v[48:49], v99 offset:16416
 ds_read_b64_tr_b16 v[64:65], v99 offset:17408
 ds_read_b64_tr_b16 v[80:81], v99 offset:17440
 ds_read_b64_tr_b16 v[34:35], v99 offset:18432
 ds_read_b64_tr_b16 v[50:51], v99 offset:18464
 ds_read_b64_tr_b16 v[66:67], v99 offset:19456
 ds_read_b64_tr_b16 v[82:83], v99 offset:19488
 ds_read_b64_tr_b16 v[36:37], v99 offset:20480
 ds_read_b64_tr_b16 v[52:53], v99 offset:20512
 ds_read_b64_tr_b16 v[68:69], v99 offset:21504
 ds_read_b64_tr_b16 v[84:85], v99 offset:21536
 ds_read_b64_tr_b16 v[38:39], v99 offset:22528
 ds_read_b64_tr_b16 v[54:55], v99 offset:22560
 ds_read_b64_tr_b16 v[70:71], v99 offset:23552
 ds_read_b64_tr_b16 v[86:87], v99 offset:23584
 ds_read_b64_tr_b16 v[40:41], v99 offset:24576
 ds_read_b64_tr_b16 v[56:57], v99 offset:24608
 ds_read_b64_tr_b16 v[72:73], v99 offset:25600
 ds_read_b64_tr_b16 v[88:89], v99 offset:25632
 ds_read_b64_tr_b16 v[42:43], v99 offset:26624
 ds_read_b64_tr_b16 v[58:59], v99 offset:26656
 ds_read_b64_tr_b16 v[74:75], v99 offset:27648
 ds_read_b64_tr_b16 v[90:91], v99 offset:27680
 ds_read_b64_tr_b16 v[44:45], v99 offset:28672
 ds_read_b64_tr_b16 v[60:61], v99 offset:28704
 ds_read_b64_tr_b16 v[76:77], v99 offset:29696
 ds_read_b64_tr_b16 v[92:93], v99 offset:29728
 ds_read_b64_tr_b16 v[46:47], v99 offset:30720
 ds_read_b64_tr_b16 v[62:63], v99 offset:30752
 ds_read_b64_tr_b16 v[78:79], v99 offset:31744
 ds_read_b64_tr_b16 v[94:95], v99 offset:31776
 s_waitcnt lgkmcnt(0)
 ds_write_b128 v12, v[32:35] offset:16384
 ds_write_b128 v12, v[36:39] offset:17408
 ds_write_b128 v12, v[40:43] offset:18432
 ds_write_b128 v12, v[44:47] offset:19456
 ds_write_b128 v12, v[48:51] offset:20480
 ds_write_b128 v12, v[52:55] offset:21504
 ds_write_b128 v12, v[56:59] offset:22528
 ds_write_b128 v12, v[60:63] offset:23552
 ds_write_b128 v12, v[64:67] offset:24576
 ds_write_b128 v12, v[68:71] offset:25600
 ds_write_b128 v12, v[72:75] offset:26624
 ds_write_b128 v12, v[76:79] offset:27648
 ds_write_b128 v12, v[80:83] offset:28672
 ds_write_b128 v12, v[84:87] offset:29696
 ds_write_b128 v12, v[88:91] offset:30720
 ds_write_b128 v12, v[92:95] offset:31744
 s_waitcnt lgkmcnt(0)
rec_ld_done:
 v_lshlrev_b32 v20, 1, v2
 s_mov_b32 s73, 0x200000
wz_421:
 s_mov_b64 exec, 0xff
 buffer_load_dword v21, v20, s[48:51], 0 offen offset:8 sc1
 s_waitcnt vmcnt(0)
 v_cmp_eq_u32 vcc, 16, v21
 s_mov_b64 exec, -1
 s_cmp_eq_u32 vcc_lo, 0xff
 s_cbranch_scc1 wzd_422
 s_sleep 4
 s_sub_u32 s73, s73, 1
 s_cmp_lg_u32 s73, 0
 s_cbranch_scc1 wz_421
 s_endpgm
wzd_422:
 v_and_b32 v21, 7, v1
 v_lshlrev_b32 v21, 5, v21
 v_bfe_u32 v22, v1, 3, 1
 v_lshl_add_u32 v21, v22, 2, v21
 s_mov_b32 s93, 0x400000
fm_419:
 s_mov_b64 exec, 0xffff
 buffer_load_dword v20, v21, s[48:51], 0 offen sc1
 s_waitcnt vmcnt(0)
 s_mov_b64 exec, -1
 s_mov_b32 s75, 0
 s_nop 3
 v_readlane_b32 s70, v20, s68
 s_cmp_ge_u32 s70, 32
 s_cbranch_scc1 fmd_420
 s_mov_b32 s75, 1
 s_mov_b32 s72, 0
 v_readlane_b32 s70, v20, 0
 s_add_u32 s72, s72, s70
 v_readlane_b32 s70, v20, 1
 s_add_u32 s72, s72, s70
 v_readlane_b32 s70, v20, 2
 s_add_u32 s72, s72, s70
 v_readlane_b32 s70, v20, 3
 s_add_u32 s72, s72, s70
 v_readlane_b32 s70, v20, 4
 s_add_u32 s72, s72, s70
 v_readlane_b32 s70, v20, 5
 s_add_u32 s72, s72, s70
 v_readlane_b32 s70, v20, 6
 s_add_u32 s72, s72, s70
 v_readlane_b32 s70, v20, 7
 s_add_u32 s72, s72, s70
 v_readlane_b32 s70, v20, 8
 s_add_u32 s72, s72, s70
 v_readlane_b32 s70, v20, 9
 s_add_u32 s72, s72, s70
 v_readlane_b32 s70, v20, 10
 s_add_u32 s72, s72, s70
 v_readlane_b32 s70, v20, 11
 s_add_u32 s72, s72, s70
 v_readlane_b32 s70, v20, 12
 s_add_u32 s72, s72, s70
 v_readlane_b32 s70, v20, 13
 s_add_u32 s72, s72, s70
 v_readlane_b32 s70, v20, 14
 s_add_u32 s72, s72, s70
 v_readlane_b32 s70, v20, 15
 s_add_u32 s72, s72, s70
 s_cmp_ge_u32 s72, 256
 s_cbranch_scc1 fmd_420
 s_sleep 2
 s_sub_u32 s93, s93, 1
 s_cmp_lg_u32 s93, 0
 s_cbranch_scc1 fm_419
 s_endpgm
fmd_420:
 s_mul_i32 s88, s68, 16777216
 s_add_u32 s88, s88, 6012928
 s_lshl_b32 s70, s64, 13
 s_add_u32 s88, s88, s70
 s_mul_i32 s89, s68, 4194304
 s_add_u32 s89, s89, 73121792
 s_lshl_b32 s70, s64, 11
 s_add_u32 s89, s89, s70
 s_mul_i32 s71, s68, 524288
 s_add_u32 s71, s71, 737280
 s_lshl_b32 s84, s64, 13
 s_add_u32 s84, s84, s71
 s_lshl_b32 s70, s3, 11
 s_add_u32 s84, s84, s70
 s_lshl_b32 s85, s64, 8
 s_add_u32 s85, s85, s71
 s_lshl_b32 s70, s3, 6
 s_add_u32 s85, s85, s70
 s_add_u32 s92, s85, 131072
 s_mul_i32 s71, s68, 16384
 s_add_u32 s71, s71, 1785856
 s_lshr_b32 s86, s64, 2
 s_lshl_b32 s86, s86, 10
 s_add_u32 s86, s86, s71
 s_lshl_b32 s70, s3, 8
 s_add_u32 s86, s86, s70
 s_and_b32 s70, s64, 3
 s_lshl_b32 s70, s70, 6
 s_add_u32 s86, s86, s70
 s_lshl_b32 s87, s3, 11
 s_add_u32 s87, s87, s71
 s_mov_b32 s95, 262144
 s_mov_b32 s96, 8192
 s_mov_b32 s66, 0
 v_mov_b32 v19, 1
 v_lshrrev_b32 v20, 4, v1
 v_bfe_u32 v21, v1, 2, 2
 v_and_b32 v22, 1, v1
 v_lshl_add_u32 v21, v21, 1, v22
 v_bfe_u32 v22, v1, 1, 1
 v_lshlrev_b32 v21, 10, v21
 v_lshl_add_u32 v21, v20, 3, v21
 v_lshl_add_u32 v21, v22, 2, v21
 s_lshl_b32 s70, s3, 8
 buffer_load_dword v40, v21, s[12:15], s70 offen offset:0
 buffer_load_dword v41, v21, s[12:15], s70 offen offset:32
 buffer_load_dword v42, v21, s[12:15], s70 offen offset:64
 buffer_load_dword v43, v21, s[12:15], s70 offen offset:96
 buffer_load_dword v44, v21, s[12:15], s70 offen offset:128
 buffer_load_dword v45, v21, s[12:15], s70 offen offset:160
 buffer_load_dword v46, v21, s[12:15], s70 offen offset:192
 buffer_load_dword v47, v21, s[12:15], s70 offen offset:224
 s_mov_b32 s72, 0
 s_mov_b32 s74, 178765824
 s_lshl_b32 s73, s64, 6
 s_mul_i32 s97, s68, 65
 s_add_u32 s97, s97, s72
 s_lshl_b32 s97, s97, 11
 s_add_u32 s97, s97, 204800
 s_add_u32 s97, s97, s73
 s_mul_i32 s98, s68, 65
 s_add_u32 s98, s98, s72
 s_lshl_b32 s98, s98, 11
 s_add_u32 s98, s98, 471040
 s_add_u32 s98, s98, s73
 s_lshl_b32 s73, s3, 4
 s_add_u32 s98, s98, s73
 s_mov_b32 s93, 0x200000
wh_423:
 s_mov_b64 exec, 0xf
 buffer_load_dword v1, v2, s[52:55], s97 offen sc1
 s_waitcnt vmcnt(0)
 v_cmp_eq_u32 vcc, 1, v1
 s_mov_b64 exec, -1
 s_cmp_eq_u32 vcc_lo, 15
 s_cbranch_scc1 whd_424
 s_sleep 1
 s_sub_u32 s93, s93, 1
 s_cmp_lg_u32 s93, 0
 s_cbranch_scc1 wh_423
 s_endpgm
whd_424:
 s_add_u32 s97, s97, 2048
 s_mov_b64 exec, 0xf
 buffer_load_dword v1, v2, s[52:55], s97 offen offset:0 sc1
 s_mov_b64 exec, -1
 s_mov_b32 m0, s65
 s_add_u32 s70, s88, 0
 buffer_load_dwordx4 v4, s[52:55], s70 offen sc1 lds
 buffer_load_dwordx4 v4, s[52:55], s70 offen offset:1024 sc1 lds
 s_mov_b32 s69, 16384
 s_add_u32 s65, s65, s69
 s_mov_b32 s70, 0x05040100
 s_mov_b32 s71, 0x07060302
 s_waitcnt vmcnt(0)
 v_perm_b32 v32, v41, v40, s70
 v_perm_b32 v33, v43, v42, s70
 v_perm_b32 v34, v41, v40, s71
 v_perm_b32 v35, v43, v42, s71
 v_perm_b32 v36, v45, v44, s70
 v_perm_b32 v37, v47, v46, s70
 v_perm_b32 v38, v45, v44, s71
 v_perm_b32 v39, v47, v46, s71
 v_mov_b64 v[64:65], 0
 v_mov_b64 v[66:67], 0
 v_mov_b64 v[68:69], 0
 v_mov_b64 v[70:71], 0
 v_mov_b64 v[72:73], 0
 v_mov_b64 v[74:75], 0
 v_mov_b64 v[76:77], 0
 v_mov_b64 v[78:79], 0
 v_mov_b64 v[80:81], 0
 v_mov_b64 v[82:83], 0
 v_mov_b64 v[84:85], 0
 v_mov_b64 v[86:87], 0
 ds_read_b128 v[96:99], v12 offset:0
 ds_read_b128 v[100:103], v12 offset:1024
 ds_read_b128 v[104:107], v12 offset:2048
 ds_read_b128 v[108:111], v12 offset:3072
 ds_read_b128 v[112:115], v12 offset:4096
 ds_read_b128 v[116:119], v12 offset:5120
 ds_read_b128 v[120:123], v12 offset:6144
 ds_read_b128 v[124:127], v12 offset:7168
 s_cmp_eq_u32 s75, 0
 s_cbranch_scc0 rec_step_s
rec_step_f:
 ds_write_b128 v4, v[32:35] offset:0
 ds_write_b128 v4, v[36:39] offset:1024
 v_smfmac_f32_16x16x64_bf16 v[64:67], v[36:39], a[0:7], v3
 v_smfmac_f32_16x16x64_bf16 v[68:71], v[36:39], a[8:15], v3
 buffer_load_dwordx4 v[88:91], v14, s[52:55], s88 offen offset:0 sc1
 buffer_load_dwordx4 v[92:95], v14, s[52:55], s88 offen offset:256 sc1
 s_mov_b32 m0, s65
 v_cmp_eq_u32 vcc, 1, v1
 s_and_b32 s70, vcc_lo, 15
 s_cmp_eq_u32 s70, 15
 s_cselect_b32 s67, 0, 1
 s_cbranch_scc0 k_late_f
 s_add_u32 s70, s88, 262144
 buffer_load_dwordx4 v4, s[52:55], s70 offen sc1 lds
 buffer_load_dwordx4 v4, s[52:55], s70 offen offset:1024 sc1 lds
 s_mov_b64 exec, 0xf
 buffer_load_dword v1, v2, s[52:55], s97 offen offset:2048 sc1
 s_mov_b64 exec, -1
k_back_f:
 s_mov_b64 exec, 1
 buffer_store_dword v21, v29, s[52:55], s74 offen sc1
 s_mov_b64 exec, -1
 s_waitcnt lgkmcnt(0)
 s_barrier
 ds_read_b128 v[40:43], v5 offset:0
 ds_read_b128 v[44:47], v5 offset:1024
 v_smfmac_f32_16x16x64_bf16 v[64:67], v[32:35], v[96:103], v3
 ds_read_b128 v[52:55], v6 offset:1024
 v_smfmac_f32_16x16x64_bf16 v[68:71], v[32:35], v[104:111], v3
 ds_read_b128 v[48:51], v6 offset:0
 v_smfmac_f32_16x16x64_bf16 v[72:75], v[32:35], v[112:119], v3
 ds_read_b128 v[56:59], v7 offset:0
 v_smfmac_f32_16x16x64_bf16 v[76:79], v[32:35], v[120:127], v3
 ds_read_b128 v[60:63], v7 offset:1024
 v_smfmac_f32_16x16x64_bf16 v[72:75], v[36:39], a[96:103], v3
 ds_read_b128 v[96:99], v12 offset:8192
 v_smfmac_f32_16x16x64_bf16 v[76:79], v[36:39], a[104:111], v3
 ds_read_b128 v[100:103], v12 offset:9216
 s_waitcnt lgkmcnt(7)
 v_smfmac_f32_16x16x64_bf16 v[64:67], v[40:43], a[16:23], v3
 ds_read_b128 v[104:107], v12 offset:10240
 v_smfmac_f32_16x16x64_bf16 v[68:71], v[40:43], a[24:31], v3
 ds_read_b128 v[108:111], v12 offset:11264
 v_smfmac_f32_16x16x64_bf16 v[72:75], v[40:43], a[112:119], v3
 ds_read_b128 v[112:115], v12 offset:12288
 v_smfmac_f32_16x16x64_bf16 v[76:79], v[40:43], a[120:127], v3
 ds_read_b128 v[116:119], v12 offset:13312
 s_waitcnt lgkmcnt(10)
 v_smfmac_f32_16x16x64_bf16 v[64:67], v[44:47], a[32:39], v3
 ds_read_b128 v[120:123], v12 offset:14336
 v_smfmac_f32_16x16x64_bf16 v[68:71], v[44:47], a[40:47], v3
 ds_read_b128 v[124:127], v12 offset:15360
 v_smfmac_f32_16x16x64_bf16 v[72:75], v[44:47], a[128:135], v3
 v_smfmac_f32_16x16x64_bf16 v[76:79], v[44:47], a[136:143], v3
 s_waitcnt lgkmcnt(11)
 v_smfmac_f32_16x16x64_bf16 v[64:67], v[52:55], a[48:55], v3
 v_smfmac_f32_16x16x64_bf16 v[68:71], v[52:55], a[56:63], v3
 v_smfmac_f32_16x16x64_bf16 v[72:75], v[52:55], a[144:151], v3
 v_smfmac_f32_16x16x64_bf16 v[76:79], v[52:55], a[152:159], v3
 s_waitcnt lgkmcnt(10)
 s_waitcnt lgkmcnt(6)
 v_smfmac_f32_16x16x64_bf16 v[64:67], v[48:51], v[96:103], v3
 s_waitcnt lgkmcnt(4)
 v_smfmac_f32_16x16x64_bf16 v[68:71], v[48:51], v[104:111], v3
 ds_read_b128 v[96:99], v13 offset:0
 s_waitcnt lgkmcnt(3)
 v_smfmac_f32_16x16x64_bf16 v[72:75], v[48:51], v[112:119], v3
 ds_read_b128 v[100:103], v13 offset:128
 s_waitcnt lgkmcnt(2)
 v_smfmac_f32_16x16x64_bf16 v[76:79], v[48:51], v[120:127], v3
 ds_read_b128 v[104:107], v13 offset:2048
 s_waitcnt lgkmcnt(12)
 v_smfmac_f32_16x16x64_bf16 v[64:67], v[56:59], a[64:71], v3
 ds_read_b128 v[108:111], v13 offset:2176
 v_smfmac_f32_16x16x64_bf16 v[68:71], v[56:59], a[72:79], v3
 ds_read_b128 v[112:115], v13 offset:4096
 v_smfmac_f32_16x16x64_bf16 v[72:75], v[56:59], a[160:167], v3
 ds_read_b128 v[116:119], v13 offset:4224
 v_smfmac_f32_16x16x64_bf16 v[76:79], v[56:59], a[168:175], v3
 ds_read_b128 v[120:123], v13 offset:6144
 s_waitcnt lgkmcnt(15)
 v_smfmac_f32_16x16x64_bf16 v[64:67], v[60:63], a[80:87], v3
 ds_read_b128 v[124:127], v13 offset:6272
 v_smfmac_f32_16x16x64_bf16 v[68:71], v[60:63], a[88:95], v3
 v_smfmac_f32_16x16x64_bf16 v[72:75], v[60:63], a[176:183], v3
 v_smfmac_f32_16x16x64_bf16 v[76:79], v[60:63], a[184:191], v3
 v_smfmac_f32_16x16x64_bf16 v[80:83], v[32:35], a[192:199], v3
 s_nop 3
 v_add_f32 v64, v64, v66
 v_add_f32 v65, v65, v67
 v_cvt_pk_bf16_f32 v64, v64, v65
 ds_write_b16 v8, v64 offset:0
 ds_write_b16_d16_hi v8, v64 offset:272
 v_add_f32 v68, v68, v70
 v_add_f32 v69, v69, v71
 v_cvt_pk_bf16_f32 v68, v68, v69
 ds_write_b16 v8, v68 offset:32
 ds_write_b16_d16_hi v8, v68 offset:304
 v_add_f32 v72, v72, v74
 v_add_f32 v73, v73, v75
 v_cvt_pk_bf16_f32 v72, v72, v73
 ds_write_b16 v8, v72 offset:2304
 ds_write_b16_d16_hi v8, v72 offset:2576
 v_add_f32 v76, v76, v78
 v_add_f32 v77, v77, v79
 v_cvt_pk_bf16_f32 v76, v76, v77
 ds_write_b16 v8, v76 offset:2336
 ds_write_b16_d16_hi v8, v76 offset:2608
 v_smfmac_f32_16x16x64_bf16 v[84:87], v[32:35], a[200:207], v3
 v_smfmac_f32_16x16x64_bf16 v[80:83], v[36:39], a[208:215], v3
 v_smfmac_f32_16x16x64_bf16 v[84:87], v[36:39], a[216:223], v3
 s_waitcnt lgkmcnt(0)
 s_barrier
 ds_read_b128 v[64:67], v9 offset:0
 ds_read_b128 v[68:71], v9 offset:64
 ds_read_b128 v[72:75], v9 offset:128
 ds_read_b128 v[76:79], v9 offset:192
 v_smfmac_f32_16x16x64_bf16 v[80:83], v[40:43], a[224:231], v3
 v_smfmac_f32_16x16x64_bf16 v[84:87], v[40:43], a[232:239], v3
 v_smfmac_f32_16x16x64_bf16 v[80:83], v[44:47], a[240:247], v3
 v_smfmac_f32_16x16x64_bf16 v[84:87], v[44:47], a[248:255], v3
 v_smfmac_f32_16x16x64_bf16 v[80:83], v[48:51], v[128:135], v3
 ds_read_b128 v[32:35], v10 offset:0
 v_smfmac_f32_16x16x64_bf16 v[84:87], v[48:51], v[136:143], v3
 ds_read_b128 v[36:39], v10 offset:64
 v_smfmac_f32_16x16x64_bf16 v[80:83], v[52:55], v[144:151], v3
 ds_read_b128 v[40:43], v10 offset:128
 v_smfmac_f32_16x16x64_bf16 v[84:87], v[52:55], v[152:159], v3
 ds_read_b128 v[44:47], v10 offset:192
 v_smfmac_f32_16x16x64_bf16 v[80:83], v[56:59], v[160:167], v3
 s_cmp_lg_u32 s67, 0
 s_cbranch_scc1 k_late1_f
k_back1_f:
 v_smfmac_f32_16x16x64_bf16 v[84:87], v[56:59], v[168:175], v3
 v_smfmac_f32_16x16x64_bf16 v[80:83], v[60:63], v[176:183], v3
 v_smfmac_f32_16x16x64_bf16 v[84:87], v[60:63], v[184:191], v3
 s_waitcnt lgkmcnt(4)
 v_mfma_f32_16x16x32_bf16 v[48:51], v[96:99], v[64:67], 0
 v_mfma_f32_16x16x32_bf16 v[52:55], v[100:103], v[64:67], 0
 v_mfma_f32_16x16x32_bf16 v[48:51], v[104:107], v[68:71], v[48:51]
 ds_read_b128 v[96:99], v12 offset:16384
 v_mfma_f32_16x16x32_bf16 v[52:55], v[108:111], v[68:71], v[52:55]
 ds_read_b128 v[100:103], v12 offset:17408
 v_mfma_f32_16x16x32_bf16 v[48:51], v[112:115], v[72:75], v[48:51]
 ds_read_b128 v[104:107], v12 offset:18432
 v_mfma_f32_16x16x32_bf16 v[52:55], v[116:119], v[72:75], v[52:55]
 ds_read_b128 v[108:111], v12 offset:19456
 v_add_f32 v80, v80, v82
 v_mfma_f32_16x16x32_bf16 v[48:51], v[120:123], v[76:79], v[48:51]
 ds_read_b128 v[112:115], v12 offset:20480
 v_add_f32 v81, v81, v83
 v_mfma_f32_16x16x32_bf16 v[52:55], v[124:127], v[76:79], v[52:55]
 ds_read_b128 v[116:119], v12 offset:21504
 v_cvt_pk_bf16_f32 v28, v80, v81
 s_waitcnt lgkmcnt(6)
 v_mfma_f32_16x16x32_bf16 v[56:59], v[32:35], v[64:67], 0
 ds_read_b128 v[120:123], v12 offset:22528
 v_add_f32 v84, v84, v86
 v_mfma_f32_16x16x32_bf16 v[56:59], v[36:39], v[68:71], v[56:59]
 ds_read_b128 v[124:127], v12 offset:23552
 v_add_f32 v85, v85, v87
 v_mfma_f32_16x16x32_bf16 v[56:59], v[40:43], v[72:75], v[56:59]
 v_cvt_pk_bf16_f32 v30, v84, v85
 v_mfma_f32_16x16x32_bf16 v[56:59], v[44:47], v[76:79], v[56:59]
 ds_write_b32 v18, v28
 v_max3_f32 v22, v48, v49, v50
 v_max3_f32 v23, v51, v52, v53
 v_max3_f32 v22, v22, v54, v55
 ds_write_b32 v18, v30 offset:256
 v_mov_b32 v80, 0x3f803f80
 v_mov_b32 v81, 0x3f803f80
 v_mov_b32 v82, 0x3f803f80
 v_mov_b32 v83, 0x3f803f80
 s_cmp_eq_u32 s66, 63
 s_cbranch_scc1 rec_done
 ds_read_b128 v[60:63], v0
 v_max3_f32 v23, v23, v56, v57
 v_max_f32 v22, v22, v23
 v_mov_b32 v23, v22
 ds_read_b128 v[32:35], v12 offset:24576
 ds_read_b128 v[36:39], v12 offset:25600
 v_permlane16_swap_b32 v22, v23
 s_nop 0
 v_max_f32 v22, v22, v23
 v_mov_b32 v23, v22
 ds_read_b128 v[40:43], v12 offset:26624
 ds_read_b128 v[44:47], v12 offset:27648
 v_permlane32_swap_b32 v22, v23
 s_nop 0
 v_max_f32 v22, v22, v23
 v_mul_f32 v22, s82, v22
 v_pk_fma_f32 v[48:49], v[48:49], s[82:83], v[22:23] op_sel_hi:[1,1,0] neg_lo:[0,0,1] neg_hi:[0,0,1]
 v_pk_fma_f32 v[50:51], v[50:51], s[82:83], v[22:23] op_sel_hi:[1,1,0] neg_lo:[0,0,1] neg_hi:[0,0,1]
 v_pk_fma_f32 v[52:53], v[52:53], s[82:83], v[22:23] op_sel_hi:[1,1,0] neg_lo:[0,0,1] neg_hi:[0,0,1]
 v_pk_fma_f32 v[54:55], v[54:55], s[82:83], v[22:23] op_sel_hi:[1,1,0] neg_lo:[0,0,1] neg_hi:[0,0,1]
 v_pk_fma_f32 v[56:57], v[56:57], s[82:83], v[22:23] op_sel_hi:[1,1,0] neg_lo:[0,0,1] neg_hi:[0,0,1]
 v_exp_f32 v48, v48
 v_exp_f32 v49, v49
 v_exp_f32 v50, v50
 v_exp_f32 v51, v51
 s_waitcnt lgkmcnt(4)
 buffer_store_dwordx4 v[60:63], v17, s[52:55], s89 offen sc1
axs_425:
 v_exp_f32 v52, v52
 v_exp_f32 v53, v53
 v_exp_f32 v54, v54
 v_exp_f32 v55, v55
 v_exp_f32 v56, v56
 v_exp_f32 v57, v57
 v_mov_b32 v23, 0
 v_cvt_pk_bf16_f32 v60, v48, v49
 v_cvt_pk_bf16_f32 v61, v50, v51
 v_cvt_pk_bf16_f32 v62, v52, v53
 v_cvt_pk_bf16_f32 v63, v54, v55
 v_cvt_pk_bf16_f32 v22, v56, v57
 s_waitcnt vmcnt(5)
 v_mfma_f32_16x16x32_bf16 v[56:59], v[80:83], v[60:63], 0
 ds_read_b128 v[64:67], v12 offset:28672
 ds_read_b128 v[68:71], v12 offset:29696
 v_mfma_f32_16x16x32_bf16 v[48:51], v[88:91], v[60:63], 0
 ds_read_b128 v[72:75], v12 offset:30720
 s_nop 0
 v_mfma_f32_16x16x32_bf16 v[52:55], v[92:95], v[60:63], 0
 ds_read_b128 v[76:79], v12 offset:31744
 s_nop 0
 v_mfma_f32_16x16x16_bf16 v[56:59], v[80:81], v[22:23], v[56:59]
 s_nop 1
 v_mfma_f32_16x16x16_bf16 v[48:51], v[28:29], v[22:23], v[48:51]
 s_nop 1
 v_mfma_f32_16x16x16_bf16 v[52:55], v[30:31], v[22:23], v[52:55]
 v_mov_b64 v[84:85], 0
 v_mov_b64 v[86:87], 0
 s_nop 0
 v_rcp_f32 v56, v56
 v_mov_b64 v[88:89], 0
 v_mov_b64 v[90:91], 0
 v_mov_b64 v[92:93], 0
 v_pk_mul_f32 v[48:49], v[48:49], v[56:57] op_sel_hi:[1,0]
 v_pk_mul_f32 v[50:51], v[50:51], v[56:57] op_sel_hi:[1,0]
 v_pk_mul_f32 v[52:53], v[52:53], v[56:57] op_sel_hi:[1,0]
 v_pk_mul_f32 v[54:55], v[54:55], v[56:57] op_sel_hi:[1,0]
 v_cvt_pk_bf16_f32 v20, v48, v49
 v_cvt_pk_bf16_f32 v21, v50, v51
 v_cvt_pk_bf16_f32 v22, v52, v53
 v_cvt_pk_bf16_f32 v23, v54, v55
 ds_write_b128 v11, v[20:23]
 v_mov_b64 v[94:95], 0
 v_mov_b64 v[80:81], 0
 v_mov_b64 v[82:83], 0
 v_mov_b64 v[56:57], 0
 v_mov_b64 v[58:59], 0
 v_mov_b64 v[60:61], 0
 v_mov_b64 v[62:63], 0
 s_waitcnt lgkmcnt(0)
 s_barrier
 ds_read_b128 v[48:51], v2 offset:16384
 ds_read_b128 v[52:55], v2 offset:17408
 s_waitcnt lgkmcnt(1)
 v_smfmac_f32_16x16x64_bf16 v[80:83], v[48:51], v[96:103], v3
 v_smfmac_f32_16x16x64_bf16 v[84:87], v[48:51], v[112:119], v3
 v_mov_b64 v[96:97], 0
 v_smfmac_f32_16x16x64_bf16 v[56:59], v[48:51], v[32:39], v3
 v_mov_b64 v[98:99], 0
 v_smfmac_f32_16x16x64_bf16 v[60:63], v[48:51], v[64:71], v3
 v_mov_b64 v[100:101], 0
 s_waitcnt lgkmcnt(0)
 v_smfmac_f32_16x16x64_bf16 v[80:83], v[52:55], v[104:111], v3
 v_mov_b64 v[102:103], 0
 v_smfmac_f32_16x16x64_bf16 v[84:87], v[52:55], v[120:127], v3
 v_smfmac_f32_16x16x64_bf16 v[56:59], v[52:55], v[40:47], v3
 v_smfmac_f32_16x16x64_bf16 v[60:63], v[52:55], v[72:79], v3
 v_smfmac_f32_16x16x64_bf16 v[88:91], v[48:51], v[192:199], v3
 v_smfmac_f32_16x16x64_bf16 v[88:91], v[52:55], v[200:207], v3
 s_nop 2
 v_add_f32 v80, v80, v82
 v_add_f32 v81, v81, v83
 v_cvt_pk_bf16_f32 v64, v80, v81
 v_and_or_b32 v64, v64, s94, v19
 v_smfmac_f32_16x16x64_bf16 v[92:95], v[48:51], v[208:215], v3
 v_add_f32 v84, v84, v86
 v_add_f32 v85, v85, v87
 v_cvt_pk_bf16_f32 v65, v84, v85
 v_smfmac_f32_16x16x64_bf16 v[92:95], v[52:55], v[216:223], v3
 v_add_f32 v56, v56, v58
 v_add_f32 v57, v57, v59
 v_cvt_pk_bf16_f32 v66, v56, v57
 v_smfmac_f32_16x16x64_bf16 v[96:99], v[48:51], v[224:231], v3
 v_add_f32 v60, v60, v62
 v_add_f32 v61, v61, v63
 v_cvt_pk_bf16_f32 v67, v60, v61
 buffer_store_dwordx4 v[64:67], v2, s[52:55], s84 offen
 v_smfmac_f32_16x16x64_bf16 v[96:99], v[52:55], v[232:239], v3
 v_smfmac_f32_16x16x64_bf16 v[100:103], v[48:51], v[240:247], v3
 v_smfmac_f32_16x16x64_bf16 v[100:103], v[52:55], v[248:255], v3
 v_pk_add_f32 v[88:89], v[88:89], v[90:91]
 v_cvt_pk_bf16_f32 v68, v88, v89
 v_and_or_b32 v68, v68, s94, v19
 v_pk_add_f32 v[92:93], v[92:93], v[94:95]
 v_cvt_pk_bf16_f32 v69, v92, v93
 s_nop 1
 v_pk_add_f32 v[96:97], v[96:97], v[98:99]
 v_cvt_pk_bf16_f32 v70, v96, v97
 v_pk_add_f32 v[100:101], v[100:101], v[102:103]
 v_cvt_pk_bf16_f32 v71, v100, v101
 buffer_store_dwordx4 v[68:71], v2, s[52:55], s84 offen offset:1024
 ds_read_b128 v[96:99], v12 offset:0
 ds_read_b128 v[100:103], v12 offset:1024
 ds_read_b128 v[104:107], v12 offset:2048
 ds_read_b128 v[108:111], v12 offset:3072
 ds_read_b128 v[112:115], v12 offset:4096
 ds_read_b128 v[116:119], v12 offset:5120
 ds_read_b128 v[120:123], v12 offset:6144
 ds_read_b128 v[124:127], v12 offset:7168
 s_mov_b32 s93, 0x100000
 v_mov_b64 v[72:73], 0
 v_mov_b64 v[74:75], 0
 v_mov_b64 v[76:77], 0
 v_mov_b64 v[78:79], 0
 v_mov_b64 v[84:85], 0
 v_mov_b64 v[86:87], 0
 v_mov_b32 v21, 1
 s_cmp_lg_u32 s67, 0
 s_cbranch_scc1 k_late3_f
k_back3_f:
 s_sleep 4
h1_loop_f:
 buffer_load_dwordx4 v[40:43], v15, s[52:55], s85 offen sc1
 buffer_load_dwordx4 v[44:47], v15, s[52:55], s92 offen sc1
 s_waitcnt vmcnt(0)
h1_chk_f:
 v_mfma_f32_16x16x32_bf16 v[80:83], v[24:27], v[40:43], 0
 v_mfma_f32_16x16x32_bf16 v[80:83], v[24:27], v[44:47], v[80:83]
 v_xor_b32 v20, v40, v19
 v_bitop3_b32 v20, v20, v44, v19 bitop3:0xf6
 v_and_b32 v20, 1, v20
 v_cmp_ne_u32 vcc, 0, v20
 s_nop 2
 s_cbranch_vccz h1_done_f
 s_sub_u32 s93, s93, 1
 s_cmp_lg_u32 s93, 0
 s_cbranch_scc1 h1_loop_f
 s_endpgm
h1_done_f:
 v_add_f32_dpp v80, v80, v80 row_ror:4 row_mask:0xf bank_mask:0xf
 v_add_f32_dpp v81, v81, v81 row_ror:4 row_mask:0xf bank_mask:0xf
 v_add_f32_dpp v82, v82, v82 row_ror:4 row_mask:0xf bank_mask:0xf
 v_add_f32_dpp v83, v83, v83 row_ror:4 row_mask:0xf bank_mask:0xf
 v_add_f32_dpp v80, v80, v80 row_ror:8 row_mask:0xf bank_mask:0xf
 v_add_f32_dpp v81, v81, v81 row_ror:8 row_mask:0xf bank_mask:0xf
 v_add_f32_dpp v82, v82, v82 row_ror:8 row_mask:0xf bank_mask:0xf
 v_add_f32_dpp v83, v83, v83 row_ror:8 row_mask:0xf bank_mask:0xf
 v_cvt_pk_bf16_f32 v22, v80, v81
 v_cvt_pk_bf16_f32 v23, v82, v83
 s_mov_b64 exec, 0x000f000f
 v_and_or_b32 v22, v22, s94, v19
 buffer_store_dwordx2 v[22:23], v16, s[52:55], s86 offen
 s_mov_b64 exec, -1
 v_mov_b64 v[64:65], 0
 v_mov_b64 v[66:67], 0
 v_mov_b64 v[68:69], 0
 v_mov_b64 v[70:71], 0
 v_mov_b64 v[80:81], 0
 v_mov_b64 v[82:83], 0
 s_add_u32 s84, s84, s95
 s_add_u32 s85, s85, s95
 s_add_u32 s92, s92, s95
 s_add_u32 s86, s86, s96
 s_sub_u32 s95, 0, s95
 s_add_u32 s89, s89, 65536
 s_mov_b32 s93, 0x100000
 s_mov_b32 s74, s98
 v_mov_b32 v21, 1
 s_cmp_lg_u32 s67, 0
 s_cbranch_scc1 k_late2_f
k_back2_f:
 s_add_u32 s98, s98, 2048
 s_add_u32 s97, s97, 2048
 s_add_u32 s88, s88, 262144
 v_add_u32 v13, s69, v13
 s_sub_u32 s65, s65, s69
 s_sub_u32 s69, 0, s69
 s_sleep 3
 buffer_load_dwordx4 v[32:35], v2, s[52:55], s87 offen sc1
 buffer_load_dwordx4 v[36:39], v2, s[52:55], s87 offen offset:1024 sc1
h2_loop_f:
 s_waitcnt vmcnt(0)
h2_chk_f:
 v_xor_b32 v20, v32, v19
 v_bitop3_b32 v20, v20, v34, v19 bitop3:0xf6
 v_bitop3_b32 v20, v20, v36, v19 bitop3:0xf6
 v_bitop3_b32 v20, v20, v38, v19 bitop3:0xf6
 v_and_b32 v20, 1, v20
 v_cmp_ne_u32 vcc, 0, v20
 s_cbranch_vccz h2_done_f
 buffer_load_dwordx4 v[32:35], v2, s[52:55], s87 offen sc1
 buffer_load_dwordx4 v[36:39], v2, s[52:55], s87 offen offset:1024 sc1
 s_sub_u32 s93, s93, 1
 s_cmp_lg_u32 s93, 0
 s_cbranch_scc1 h2_loop_f
 s_endpgm
h2_done_f:
 s_add_u32 s87, s87, s96
 s_sub_u32 s96, 0, s96
 s_and_b32 s70, s66, 1
 v_xor_b32 v19, s70, v19
 s_add_u32 s66, s66, 1
 s_branch rec_step_f
k_late_f:
 s_mov_b64 exec, 0xf
 buffer_load_dword v1, v2, s[52:55], s97 offen offset:0 sc1
 s_mov_b64 exec, -1
 s_branch k_back_f
k_late1_f:
 s_waitcnt vmcnt(0)
 v_cmp_eq_u32 vcc, 1, v1
 s_and_b32 s70, vcc_lo, 15
 s_cmp_eq_u32 s70, 15
 s_cbranch_scc0 k_back1_f
 s_mov_b32 s67, 0
 s_mov_b32 m0, s65
 s_add_u32 s70, s88, 262144
 buffer_load_dwordx4 v4, s[52:55], s70 offen sc1 lds
 buffer_load_dwordx4 v4, s[52:55], s70 offen offset:1024 sc1 lds
 s_mov_b64 exec, 0xf
 buffer_load_dword v1, v2, s[52:55], s97 offen offset:2048 sc1
 s_mov_b64 exec, -1
 s_branch k_back1_f
k_late3_f:
 s_mov_b64 exec, 0xf
 buffer_load_dword v1, v2, s[52:55], s97 offen offset:0 sc1
 s_mov_b64 exec, -1
 s_branch k_back3_f
k_late2_f:
 v_cmp_eq_u32 vcc, 1, v1
 s_and_b32 s70, vcc_lo, 15
 s_cmp_eq_u32 s70, 15
 s_cbranch_scc1 k_go_f
 s_mov_b64 exec, 1
 buffer_store_dword v21, v29, s[52:55], s98 offen sc1
 s_mov_b64 exec, -1
 s_mov_b32 s74, 178765824
 s_mov_b32 s71, 0x200000
wh_426:
 s_mov_b64 exec, 0xf
 buffer_load_dword v1, v2, s[52:55], s97 offen sc1
 s_waitcnt vmcnt(0)
 v_cmp_eq_u32 vcc, 1, v1
 s_mov_b64 exec, -1
 s_cmp_eq_u32 vcc_lo, 15
 s_cbranch_scc1 whd_427
 s_sleep 1
 s_sub_u32 s71, s71, 1
 s_cmp_lg_u32 s71, 0
 s_cbranch_scc1 wh_426
 s_endpgm
whd_427:
k_go_f:
 s_mov_b32 m0, s65
 s_add_u32 s70, s88, 262144
 buffer_load_dwordx4 v4, s[52:55], s70 offen sc1 lds
 buffer_load_dwordx4 v4, s[52:55], s70 offen offset:1024 sc1 lds
 s_mov_b64 exec, 0xf
 buffer_load_dword v1, v2, s[52:55], s97 offen offset:2048 sc1
 s_mov_b64 exec, -1
 s_branch k_back2_f
rec_step_s:
 ds_write_b128 v4, v[32:35] offset:0
 ds_write_b128 v4, v[36:39] offset:1024
 v_smfmac_f32_16x16x64_bf16 v[64:67], v[36:39], a[0:7], v3
 v_smfmac_f32_16x16x64_bf16 v[68:71], v[36:39], a[8:15], v3
 buffer_load_dwordx4 v[88:91], v14, s[52:55], s88 offen offset:0 sc1
 buffer_load_dwordx4 v[92:95], v14, s[52:55], s88 offen offset:256 sc1
 s_mov_b32 m0, s65
 v_cmp_eq_u32 vcc, 1, v1
 s_and_b32 s70, vcc_lo, 15
 s_cmp_eq_u32 s70, 15
 s_cselect_b32 s67, 0, 1
 s_cbranch_scc0 k_late_s
 s_add_u32 s70, s88, 262144
 buffer_load_dwordx4 v4, s[52:55], s70 offen sc1 lds
 buffer_load_dwordx4 v4, s[52:55], s70 offen offset:1024 sc1 lds
 s_mov_b64 exec, 0xf
 buffer_load_dword v1, v2, s[52:55], s97 offen offset:2048 sc1
 s_mov_b64 exec, -1
k_back_s:
 s_mov_b64 exec, 1
 buffer_store_dword v21, v29, s[52:55], s74 offen sc1
 s_mov_b64 exec, -1
 s_waitcnt lgkmcnt(0)
 s_barrier
 ds_read_b128 v[40:43], v5 offset:0
 ds_read_b128 v[44:47], v5 offset:1024
 v_smfmac_f32_16x16x64_bf16 v[64:67], v[32:35], v[96:103], v3
 ds_read_b128 v[52:55], v6 offset:1024
 v_smfmac_f32_16x16x64_bf16 v[68:71], v[32:35], v[104:111], v3
 ds_read_b128 v[48:51], v6 offset:0
 v_smfmac_f32_16x16x64_bf16 v[72:75], v[32:35], v[112:119], v3
 ds_read_b128 v[56:59], v7 offset:0
 v_smfmac_f32_16x16x64_bf16 v[76:79], v[32:35], v[120:127], v3
 ds_read_b128 v[60:63], v7 offset:1024
 v_smfmac_f32_16x16x64_bf16 v[72:75], v[36:39], a[96:103], v3
 ds_read_b128 v[96:99], v12 offset:8192
 v_smfmac_f32_16x16x64_bf16 v[76:79], v[36:39], a[104:111], v3
 ds_read_b128 v[100:103], v12 offset:9216
 s_waitcnt lgkmcnt(7)
 v_smfmac_f32_16x16x64_bf16 v[64:67], v[40:43], a[16:23], v3
 ds_read_b128 v[104:107], v12 offset:10240
 v_smfmac_f32_16x16x64_bf16 v[68:71], v[40:43], a[24:31], v3
 ds_read_b128 v[108:111], v12 offset:11264
 v_smfmac_f32_16x16x64_bf16 v[72:75], v[40:43], a[112:119], v3
 ds_read_b128 v[112:115], v12 offset:12288
 v_smfmac_f32_16x16x64_bf16 v[76:79], v[40:43], a[120:127], v3
 ds_read_b128 v[116:119], v12 offset:13312
 s_waitcnt lgkmcnt(10)
 v_smfmac_f32_16x16x64_bf16 v[64:67], v[44:47], a[32:39], v3
 ds_read_b128 v[120:123], v12 offset:14336
 v_smfmac_f32_16x16x64_bf16 v[68:71], v[44:47], a[40:47], v3
 ds_read_b128 v[124:127], v12 offset:15360
 v_smfmac_f32_16x16x64_bf16 v[72:75], v[44:47], a[128:135], v3
 v_smfmac_f32_16x16x64_bf16 v[76:79], v[44:47], a[136:143], v3
 s_waitcnt lgkmcnt(11)
 v_smfmac_f32_16x16x64_bf16 v[64:67], v[52:55], a[48:55], v3
 v_smfmac_f32_16x16x64_bf16 v[68:71], v[52:55], a[56:63], v3
 v_smfmac_f32_16x16x64_bf16 v[72:75], v[52:55], a[144:151], v3
 v_smfmac_f32_16x16x64_bf16 v[76:79], v[52:55], a[152:159], v3
 s_waitcnt lgkmcnt(10)
 s_waitcnt lgkmcnt(6)
 v_smfmac_f32_16x16x64_bf16 v[64:67], v[48:51], v[96:103], v3
 s_waitcnt lgkmcnt(4)
 v_smfmac_f32_16x16x64_bf16 v[68:71], v[48:51], v[104:111], v3
 ds_read_b128 v[96:99], v13 offset:0
 s_waitcnt lgkmcnt(3)
 v_smfmac_f32_16x16x64_bf16 v[72:75], v[48:51], v[112:119], v3
 ds_read_b128 v[100:103], v13 offset:128
 s_waitcnt lgkmcnt(2)
 v_smfmac_f32_16x16x64_bf16 v[76:79], v[48:51], v[120:127], v3
 ds_read_b128 v[104:107], v13 offset:2048
 s_waitcnt lgkmcnt(12)
 v_smfmac_f32_16x16x64_bf16 v[64:67], v[56:59], a[64:71], v3
 ds_read_b128 v[108:111], v13 offset:2176
 v_smfmac_f32_16x16x64_bf16 v[68:71], v[56:59], a[72:79], v3
 ds_read_b128 v[112:115], v13 offset:4096
 v_smfmac_f32_16x16x64_bf16 v[72:75], v[56:59], a[160:167], v3
 ds_read_b128 v[116:119], v13 offset:4224
 v_smfmac_f32_16x16x64_bf16 v[76:79], v[56:59], a[168:175], v3
 ds_read_b128 v[120:123], v13 offset:6144
 s_waitcnt lgkmcnt(15)
 v_smfmac_f32_16x16x64_bf16 v[64:67], v[60:63], a[80:87], v3
 ds_read_b128 v[124:127], v13 offset:6272
 v_smfmac_f32_16x16x64_bf16 v[68:71], v[60:63], a[88:95], v3
 v_smfmac_f32_16x16x64_bf16 v[72:75], v[60:63], a[176:183], v3
 v_smfmac_f32_16x16x64_bf16 v[76:79], v[60:63], a[184:191], v3
 v_smfmac_f32_16x16x64_bf16 v[80:83], v[32:35], a[192:199], v3
 s_nop 3
 v_add_f32 v64, v64, v66
 v_add_f32 v65, v65, v67
 v_cvt_pk_bf16_f32 v64, v64, v65
 ds_write_b16 v8, v64 offset:0
 ds_write_b16_d16_hi v8, v64 offset:272
 v_add_f32 v68, v68, v70
 v_add_f32 v69, v69, v71
 v_cvt_pk_bf16_f32 v68, v68, v69
 ds_write_b16 v8, v68 offset:32
 ds_write_b16_d16_hi v8, v68 offset:304
 v_add_f32 v72, v72, v74
 v_add_f32 v73, v73, v75
 v_cvt_pk_bf16_f32 v72, v72, v73
 ds_write_b16 v8, v72 offset:2304
 ds_write_b16_d16_hi v8, v72 offset:2576
 v_add_f32 v76, v76, v78
 v_add_f32 v77, v77, v79
 v_cvt_pk_bf16_f32 v76, v76, v77
 ds_write_b16 v8, v76 offset:2336
 ds_write_b16_d16_hi v8, v76 offset:2608
 v_smfmac_f32_16x16x64_bf16 v[84:87], v[32:35], a[200:207], v3
 v_smfmac_f32_16x16x64_bf16 v[80:83], v[36:39], a[208:215], v3
 v_smfmac_f32_16x16x64_bf16 v[84:87], v[36:39], a[216:223], v3
 s_waitcnt lgkmcnt(0)
 s_barrier
 ds_read_b128 v[64:67], v9 offset:0
 ds_read_b128 v[68:71], v9 offset:64
 ds_read_b128 v[72:75], v9 offset:128
 ds_read_b128 v[76:79], v9 offset:192
 v_smfmac_f32_16x16x64_bf16 v[80:83], v[40:43], a[224:231], v3
 v_smfmac_f32_16x16x64_bf16 v[84:87], v[40:43], a[232:239], v3
 v_smfmac_f32_16x16x64_bf16 v[80:83], v[44:47], a[240:247], v3
 v_smfmac_f32_16x16x64_bf16 v[84:87], v[44:47], a[248:255], v3
 v_smfmac_f32_16x16x64_bf16 v[80:83], v[48:51], v[128:135], v3
 ds_read_b128 v[32:35], v10 offset:0
 v_smfmac_f32_16x16x64_bf16 v[84:87], v[48:51], v[136:143], v3
 ds_read_b128 v[36:39], v10 offset:64
 v_smfmac_f32_16x16x64_bf16 v[80:83], v[52:55], v[144:151], v3
 ds_read_b128 v[40:43], v10 offset:128
 v_smfmac_f32_16x16x64_bf16 v[84:87], v[52:55], v[152:159], v3
 ds_read_b128 v[44:47], v10 offset:192
 v_smfmac_f32_16x16x64_bf16 v[80:83], v[56:59], v[160:167], v3
 s_cmp_lg_u32 s67, 0
 s_cbranch_scc1 k_late1_s
k_back1_s:
 v_smfmac_f32_16x16x64_bf16 v[84:87], v[56:59], v[168:175], v3
 v_smfmac_f32_16x16x64_bf16 v[80:83], v[60:63], v[176:183], v3
 v_smfmac_f32_16x16x64_bf16 v[84:87], v[60:63], v[184:191], v3
 s_waitcnt lgkmcnt(4)
 v_mfma_f32_16x16x32_bf16 v[48:51], v[96:99], v[64:67], 0
 v_mfma_f32_16x16x32_bf16 v[52:55], v[100:103], v[64:67], 0
 v_mfma_f32_16x16x32_bf16 v[48:51], v[104:107], v[68:71], v[48:51]
 ds_read_b128 v[96:99], v12 offset:16384
 v_mfma_f32_16x16x32_bf16 v[52:55], v[108:111], v[68:71], v[52:55]
 ds_read_b128 v[100:103], v12 offset:17408
 v_mfma_f32_16x16x32_bf16 v[48:51], v[112:115], v[72:75], v[48:51]
 ds_read_b128 v[104:107], v12 offset:18432
 v_mfma_f32_16x16x32_bf16 v[52:55], v[116:119], v[72:75], v[52:55]
 ds_read_b128 v[108:111], v12 offset:19456
 v_add_f32 v80, v80, v82
 v_mfma_f32_16x16x32_bf16 v[48:51], v[120:123], v[76:79], v[48:51]
 ds_read_b128 v[112:115], v12 offset:20480
 v_add_f32 v81, v81, v83
 v_mfma_f32_16x16x32_bf16 v[52:55], v[124:127], v[76:79], v[52:55]
 ds_read_b128 v[116:119], v12 offset:21504
 v_cvt_pk_bf16_f32 v28, v80, v81
 s_waitcnt lgkmcnt(6)
 v_mfma_f32_16x16x32_bf16 v[56:59], v[32:35], v[64:67], 0
 ds_read_b128 v[120:123], v12 offset:22528
 v_add_f32 v84, v84, v86
 v_mfma_f32_16x16x32_bf16 v[56:59], v[36:39], v[68:71], v[56:59]
 ds_read_b128 v[124:127], v12 offset:23552
 v_add_f32 v85, v85, v87
 v_mfma_f32_16x16x32_bf16 v[56:59], v[40:43], v[72:75], v[56:59]
 v_cvt_pk_bf16_f32 v30, v84, v85
 v_mfma_f32_16x16x32_bf16 v[56:59], v[44:47], v[76:79], v[56:59]
 ds_write_b32 v18, v28
 v_max3_f32 v22, v48, v49, v50
 v_max3_f32 v23, v51, v52, v53
 v_max3_f32 v22, v22, v54, v55
 ds_write_b32 v18, v30 offset:256
 v_mov_b32 v80, 0x3f803f80
 v_mov_b32 v81, 0x3f803f80
 v_mov_b32 v82, 0x3f803f80
 v_mov_b32 v83, 0x3f803f80
 s_cmp_eq_u32 s66, 63
 s_cbranch_scc1 rec_done
 ds_read_b128 v[60:63], v0
 v_max3_f32 v23, v23, v56, v57
 v_max_f32 v22, v22, v23
 v_mov_b32 v23, v22
 ds_read_b128 v[32:35], v12 offset:24576
 ds_read_b128 v[36:39], v12 offset:25600
 v_permlane16_swap_b32 v22, v23
 s_nop 0
 v_max_f32 v22, v22, v23
 v_mov_b32 v23, v22
 ds_read_b128 v[40:43], v12 offset:26624
 ds_read_b128 v[44:47], v12 offset:27648
 v_permlane32_swap_b32 v22, v23
 s_nop 0
 v_max_f32 v22, v22, v23
 v_mul_f32 v22, s82, v22
 v_pk_fma_f32 v[48:49], v[48:49], s[82:83], v[22:23] op_sel_hi:[1,1,0] neg_lo:[0,0,1] neg_hi:[0,0,1]
 v_pk_fma_f32 v[50:51], v[50:51], s[82:83], v[22:23] op_sel_hi:[1,1,0] neg_lo:[0,0,1] neg_hi:[0,0,1]
 v_pk_fma_f32 v[52:53], v[52:53], s[82:83], v[22:23] op_sel_hi:[1,1,0] neg_lo:[0,0,1] neg_hi:[0,0,1]
 v_pk_fma_f32 v[54:55], v[54:55], s[82:83], v[22:23] op_sel_hi:[1,1,0] neg_lo:[0,0,1] neg_hi:[0,0,1]
 v_pk_fma_f32 v[56:57], v[56:57], s[82:83], v[22:23] op_sel_hi:[1,1,0] neg_lo:[0,0,1] neg_hi:[0,0,1]
 v_exp_f32 v48, v48
 v_exp_f32 v49, v49
 v_exp_f32 v50, v50
 v_exp_f32 v51, v51
 s_waitcnt lgkmcnt(4)
 buffer_store_dwordx4 v[60:63], v17, s[52:55], s89 offen sc1
axs_428:
 v_exp_f32 v52, v52
 v_exp_f32 v53, v53
 v_exp_f32 v54, v54
 v_exp_f32 v55, v55
 v_exp_f32 v56, v56
 v_exp_f32 v57, v57
 v_mov_b32 v23, 0
 v_cvt_pk_bf16_f32 v60, v48, v49
 v_cvt_pk_bf16_f32 v61, v50, v51
 v_cvt_pk_bf16_f32 v62, v52, v53
 v_cvt_pk_bf16_f32 v63, v54, v55
 v_cvt_pk_bf16_f32 v22, v56, v57
 s_waitcnt vmcnt(5)
 v_mfma_f32_16x16x32_bf16 v[56:59], v[80:83], v[60:63], 0
 ds_read_b128 v[64:67], v12 offset:28672
 ds_read_b128 v[68:71], v12 offset:29696
 v_mfma_f32_16x16x32_bf16 v[48:51], v[88:91], v[60:63], 0
 ds_read_b128 v[72:75], v12 offset:30720
 s_nop 0
 v_mfma_f32_16x16x32_bf16 v[52:55], v[92:95], v[60:63], 0
 ds_read_b128 v[76:79], v12 offset:31744
 s_nop 0
 v_mfma_f32_16x16x16_bf16 v[56:59], v[80:81], v[22:23], v[56:59]
 s_nop 1
 v_mfma_f32_16x16x16_bf16 v[48:51], v[28:29], v[22:23], v[48:51]
 s_nop 1
 v_mfma_f32_16x16x16_bf16 v[52:55], v[30:31], v[22:23], v[52:55]
 v_mov_b64 v[84:85], 0
 v_mov_b64 v[86:87], 0
 s_nop 0
 v_rcp_f32 v56, v56
 v_mov_b64 v[88:89], 0
 v_mov_b64 v[90:91], 0
 v_mov_b64 v[92:93], 0
 v_pk_mul_f32 v[48:49], v[48:49], v[56:57] op_sel_hi:[1,0]
 v_pk_mul_f32 v[50:51], v[50:51], v[56:57] op_sel_hi:[1,0]
 v_pk_mul_f32 v[52:53], v[52:53], v[56:57] op_sel_hi:[1,0]
 v_pk_mul_f32 v[54:55], v[54:55], v[56:57] op_sel_hi:[1,0]
 v_cvt_pk_bf16_f32 v20, v48, v49
 v_cvt_pk_bf16_f32 v21, v50, v51
 v_cvt_pk_bf16_f32 v22, v52, v53
 v_cvt_pk_bf16_f32 v23, v54, v55
 ds_write_b128 v11, v[20:23]
 v_mov_b64 v[94:95], 0
 v_mov_b64 v[80:81], 0
 v_mov_b64 v[82:83], 0
 v_mov_b64 v[56:57], 0
 v_mov_b64 v[58:59], 0
 v_mov_b64 v[60:61], 0
 v_mov_b64 v[62:63], 0
 s_waitcnt lgkmcnt(0)
 s_barrier
 ds_read_b128 v[48:51], v2 offset:16384
 ds_read_b128 v[52:55], v2 offset:17408
 s_waitcnt lgkmcnt(1)
 v_smfmac_f32_16x16x64_bf16 v[80:83], v[48:51], v[96:103], v3
 v_smfmac_f32_16x16x64_bf16 v[84:87], v[48:51], v[112:119], v3
 v_mov_b64 v[96:97], 0
 v_smfmac_f32_16x16x64_bf16 v[56:59], v[48:51], v[32:39], v3
 v_mov_b64 v[98:99], 0
 v_smfmac_f32_16x16x64_bf16 v[60:63], v[48:51], v[64:71], v3
 v_mov_b64 v[100:101], 0
 s_waitcnt lgkmcnt(0)
 v_smfmac_f32_16x16x64_bf16 v[80:83], v[52:55], v[104:111], v3
 v_mov_b64 v[102:103], 0
 v_smfmac_f32_16x16x64_bf16 v[84:87], v[52:55], v[120:127], v3
 v_smfmac_f32_16x16x64_bf16 v[56:59], v[52:55], v[40:47], v3
 v_smfmac_f32_16x16x64_bf16 v[60:63], v[52:55], v[72:79], v3
 v_smfmac_f32_16x16x64_bf16 v[88:91], v[48:51], v[192:199], v3
 v_smfmac_f32_16x16x64_bf16 v[88:91], v[52:55], v[200:207], v3
 s_nop 2
 v_add_f32 v80, v80, v82
 v_add_f32 v81, v81, v83
 v_cvt_pk_bf16_f32 v64, v80, v81
 v_and_or_b32 v64, v64, s94, v19
 v_smfmac_f32_16x16x64_bf16 v[92:95], v[48:51], v[208:215], v3
 v_add_f32 v84, v84, v86
 v_add_f32 v85, v85, v87
 v_cvt_pk_bf16_f32 v65, v84, v85
 v_smfmac_f32_16x16x64_bf16 v[92:95], v[52:55], v[216:223], v3
 v_add_f32 v56, v56, v58
 v_add_f32 v57, v57, v59
 v_cvt_pk_bf16_f32 v66, v56, v57
 v_smfmac_f32_16x16x64_bf16 v[96:99], v[48:51], v[224:231], v3
 v_add_f32 v60, v60, v62
 v_add_f32 v61, v61, v63
 v_cvt_pk_bf16_f32 v67, v60, v61
 buffer_store_dwordx4 v[64:67], v2, s[52:55], s84 offen sc1
 v_smfmac_f32_16x16x64_bf16 v[96:99], v[52:55], v[232:239], v3
 v_smfmac_f32_16x16x64_bf16 v[100:103], v[48:51], v[240:247], v3
 v_smfmac_f32_16x16x64_bf16 v[100:103], v[52:55], v[248:255], v3
 v_pk_add_f32 v[88:89], v[88:89], v[90:91]
 v_cvt_pk_bf16_f32 v68, v88, v89
 v_and_or_b32 v68, v68, s94, v19
 v_pk_add_f32 v[92:93], v[92:93], v[94:95]
 v_cvt_pk_bf16_f32 v69, v92, v93
 s_nop 1
 v_pk_add_f32 v[96:97], v[96:97], v[98:99]
 v_cvt_pk_bf16_f32 v70, v96, v97
 v_pk_add_f32 v[100:101], v[100:101], v[102:103]
 v_cvt_pk_bf16_f32 v71, v100, v101
 buffer_store_dwordx4 v[68:71], v2, s[52:55], s84 offen offset:1024 sc1
 ds_read_b128 v[96:99], v12 offset:0
 ds_read_b128 v[100:103], v12 offset:1024
 ds_read_b128 v[104:107], v12 offset:2048
 ds_read_b128 v[108:111], v12 offset:3072
 ds_read_b128 v[112:115], v12 offset:4096
 ds_read_b128 v[116:119], v12 offset:5120
 ds_read_b128 v[120:123], v12 offset:6144
 ds_read_b128 v[124:127], v12 offset:7168
 s_mov_b32 s93, 0x100000
 v_mov_b64 v[72:73], 0
 v_mov_b64 v[74:75], 0
 v_mov_b64 v[76:77], 0
 v_mov_b64 v[78:79], 0
 v_mov_b64 v[84:85], 0
 v_mov_b64 v[86:87], 0
 v_mov_b32 v21, 1
 s_cmp_lg_u32 s67, 0
 s_cbranch_scc1 k_late3_s
k_back3_s:
 s_sleep 4
h1_loop_s:
 buffer_load_dwordx4 v[40:43], v15, s[52:55], s85 offen sc1
 buffer_load_dwordx4 v[44:47], v15, s[52:55], s92 offen sc1
 s_waitcnt vmcnt(0)
h1_chk_s:
 v_mfma_f32_16x16x32_bf16 v[80:83], v[24:27], v[40:43], 0
 v_mfma_f32_16x16x32_bf16 v[80:83], v[24:27], v[44:47], v[80:83]
 v_xor_b32 v20, v40, v19
 v_bitop3_b32 v20, v20, v44, v19 bitop3:0xf6
 v_and_b32 v20, 1, v20
 v_cmp_ne_u32 vcc, 0, v20
 s_nop 2
 s_cbranch_vccz h1_done_s
 s_sub_u32 s93, s93, 1
 s_cmp_lg_u32 s93, 0
 s_cbranch_scc1 h1_loop_s
 s_endpgm
h1_done_s:
 v_add_f32_dpp v80, v80, v80 row_ror:4 row_mask:0xf bank_mask:0xf
 v_add_f32_dpp v81, v81, v81 row_ror:4 row_mask:0xf bank_mask:0xf
 v_add_f32_dpp v82, v82, v82 row_ror:4 row_mask:0xf bank_mask:0xf
 v_add_f32_dpp v83, v83, v83 row_ror:4 row_mask:0xf bank_mask:0xf
 v_add_f32_dpp v80, v80, v80 row_ror:8 row_mask:0xf bank_mask:0xf
 v_add_f32_dpp v81, v81, v81 row_ror:8 row_mask:0xf bank_mask:0xf
 v_add_f32_dpp v82, v82, v82 row_ror:8 row_mask:0xf bank_mask:0xf
 v_add_f32_dpp v83, v83, v83 row_ror:8 row_mask:0xf bank_mask:0xf
 v_cvt_pk_bf16_f32 v22, v80, v81
 v_cvt_pk_bf16_f32 v23, v82, v83
 s_mov_b64 exec, 0x000f000f
 v_and_or_b32 v22, v22, s94, v19
 buffer_store_dwordx2 v[22:23], v16, s[52:55], s86 offen sc1
 s_mov_b64 exec, -1
 v_mov_b64 v[64:65], 0
 v_mov_b64 v[66:67], 0
 v_mov_b64 v[68:69], 0
 v_mov_b64 v[70:71], 0
 v_mov_b64 v[80:81], 0
 v_mov_b64 v[82:83], 0
 s_add_u32 s84, s84, s95
 s_add_u32 s85, s85, s95
 s_add_u32 s92, s92, s95
 s_add_u32 s86, s86, s96
 s_sub_u32 s95, 0, s95
 s_add_u32 s89, s89, 65536
 s_mov_b32 s93, 0x100000
 s_mov_b32 s74, s98
 v_mov_b32 v21, 1
 s_cmp_lg_u32 s67, 0
 s_cbranch_scc1 k_late2_s
k_back2_s:
 s_add_u32 s98, s98, 2048
 s_add_u32 s97, s97, 2048
 s_add_u32 s88, s88, 262144
 v_add_u32 v13, s69, v13
 s_sub_u32 s65, s65, s69
 s_sub_u32 s69, 0, s69
 s_sleep 3
 buffer_load_dwordx4 v[32:35], v2, s[52:55], s87 offen sc1
 buffer_load_dwordx4 v[36:39], v2, s[52:55], s87 offen offset:1024 sc1
h2_loop_s:
 s_waitcnt vmcnt(0)
h2_chk_s:
 v_xor_b32 v20, v32, v19
 v_bitop3_b32 v20, v20, v34, v19 bitop3:0xf6
 v_bitop3_b32 v20, v20, v36, v19 bitop3:0xf6
 v_bitop3_b32 v20, v20, v38, v19 bitop3:0xf6
 v_and_b32 v20, 1, v20
 v_cmp_ne_u32 vcc, 0, v20
 s_cbranch_vccz h2_done_s
 buffer_load_dwordx4 v[32:35], v2, s[52:55], s87 offen sc1
 buffer_load_dwordx4 v[36:39], v2, s[52:55], s87 offen offset:1024 sc1
 s_sub_u32 s93, s93, 1
 s_cmp_lg_u32 s93, 0
 s_cbranch_scc1 h2_loop_s
 s_endpgm
h2_done_s:
 s_add_u32 s87, s87, s96
 s_sub_u32 s96, 0, s96
 s_and_b32 s70, s66, 1
 v_xor_b32 v19, s70, v19
 s_add_u32 s66, s66, 1
 s_branch rec_step_s
k_late_s:
 s_mov_b64 exec, 0xf
 buffer_load_dword v1, v2, s[52:55], s97 offen offset:0 sc1
 s_mov_b64 exec, -1
 s_branch k_back_s
k_late1_s:
 s_waitcnt vmcnt(0)
 v_cmp_eq_u32 vcc, 1, v1
 s_and_b32 s70, vcc_lo, 15
 s_cmp_eq_u32 s70, 15
 s_cbranch_scc0 k_back1_s
 s_mov_b32 s67, 0
 s_mov_b32 m0, s65
 s_add_u32 s70, s88, 262144
 buffer_load_dwordx4 v4, s[52:55], s70 offen sc1 lds
 buffer_load_dwordx4 v4, s[52:55], s70 offen offset:1024 sc1 lds
 s_mov_b64 exec, 0xf
 buffer_load_dword v1, v2, s[52:55], s97 offen offset:2048 sc1
 s_mov_b64 exec, -1
 s_branch k_back1_s
k_late3_s:
 s_mov_b64 exec, 0xf
 buffer_load_dword v1, v2, s[52:55], s97 offen offset:0 sc1
 s_mov_b64 exec, -1
 s_branch k_back3_s
k_late2_s:
 v_cmp_eq_u32 vcc, 1, v1
 s_and_b32 s70, vcc_lo, 15
 s_cmp_eq_u32 s70, 15
 s_cbranch_scc1 k_go_s
 s_mov_b64 exec, 1
 buffer_store_dword v21, v29, s[52:55], s98 offen sc1
 s_mov_b64 exec, -1
 s_mov_b32 s74, 178765824
 s_mov_b32 s71, 0x200000
wh_429:
 s_mov_b64 exec, 0xf
 buffer_load_dword v1, v2, s[52:55], s97 offen sc1
 s_waitcnt vmcnt(0)
 v_cmp_eq_u32 vcc, 1, v1
 s_mov_b64 exec, -1
 s_cmp_eq_u32 vcc_lo, 15
 s_cbranch_scc1 whd_430
 s_sleep 1
 s_sub_u32 s71, s71, 1
 s_cmp_lg_u32 s71, 0
 s_cbranch_scc1 wh_429
 s_endpgm
whd_430:
k_go_s:
 s_mov_b32 m0, s65
 s_add_u32 s70, s88, 262144
 buffer_load_dwordx4 v4, s[52:55], s70 offen sc1 lds
 buffer_load_dwordx4 v4, s[52:55], s70 offen offset:1024 sc1 lds
 s_mov_b64 exec, 0xf
 buffer_load_dword v1, v2, s[52:55], s97 offen offset:2048 sc1
 s_mov_b64 exec, -1
 s_branch k_back2_s
rec_done:
 s_waitcnt lgkmcnt(0)
 ds_read_b128 v[60:63], v0
 s_waitcnt lgkmcnt(0)
 buffer_store_dwordx4 v[60:63], v17, s[52:55], s89 offen sc1
axs_431:
 s_waitcnt vmcnt(0)
 v_mov_b32 v21, 1
 s_mov_b64 exec, 1
 buffer_store_dword v21, v29, s[52:55], s98 offen sc1
 s_mov_b64 exec, -1
 s_branch rec_exit
rec_exit:
 s_cmp_lg_u32 s68, 0
 s_cbranch_scc1 k_exit
 s_waitcnt vmcnt(0) lgkmcnt(0)
 s_barrier
 v_lshrrev_b32 v1, 4, v2
 s_mov_b32 s75, s64
 s_and_b32 s64, s75, 3
 s_mov_b32 s6, 64
 s_mov_b32 s65, 64
 s_mov_b32 s7, 33
 s_mov_b32 s66, 33
 s_cmp_lt_u32 s75, 4
 s_cbranch_scc1 role_down
 s_mov_b32 s6, 64
 s_mov_b32 s65, 64
 s_mov_b32 s7, 34
 s_mov_b32 s66, 34
 s_cmp_lt_u32 s75, 8
 s_cbranch_scc1 role_down
 s_mov_b32 s6, 64
 s_mov_b32 s65, 64
 s_mov_b32 s7, 35
 s_mov_b32 s66, 35
 s_cmp_lt_u32 s75, 12
 s_cbranch_scc1 role_down
 s_mov_b32 s6, 64
 s_mov_b32 s65, 64
 s_mov_b32 s7, 39
 s_mov_b32 s66, 39
 s_sub_u32 s64, s75, 12
 s_cmp_lt_u32 s64, 11
 s_cbranch_scc1 role_up
 s_endpgm
code_end:
.section .rodata,"a"
.p2align 6
.amdhsa_kernel interleave_layers__memory_aug_recurrent_mem_tr__swiglu_ffn__prompt_kernel
  .amdhsa_next_free_vgpr 512
  .amdhsa_next_free_sgpr 102
  .amdhsa_accum_offset 256
  .amdhsa_group_segment_fixed_size 0
  .amdhsa_kernarg_size 112
  .amdhsa_user_sgpr_count 2
  .amdhsa_user_sgpr_kernarg_segment_ptr 1
  .amdhsa_system_sgpr_workgroup_id_x 1
.end_amdhsa_kernel
```
